```python
import torch

def _softmax(x, axis=-1):
    return torch.softmax(x, dim=axis)
def _gelu(x):
    return torch.nn.functional.gelu(x, approximate="tanh")
def _silu(x):
    return torch.nn.functional.silu(x)
def _sigmoid(x):
    return torch.sigmoid(x)
def _layernorm(x, axis=-1, eps=1e-5):
    m = x.mean(dim=axis, keepdim=True)
    v = x.var(dim=axis, keepdim=True, unbiased=False)
    return (x - m) / torch.sqrt(v + eps)
def _scatter_add(tgt, idx, src, axis=0):
    return tgt.clone().index_add_(axis, idx, src)
def _segment_sum(src, seg, n):
    out = torch.zeros((n,) + src.shape[1:], dtype=src.dtype)
    return out.index_add_(0, seg, src)
def _pad(x, pw):
    flat = tuple(v for pair in reversed(pw) for v in pair)
    return torch.nn.functional.pad(x, flat)

kernel_name = 'interleave_layers__mha_block_cached__glu_gated_glu__decode'

def setup_inputs():

    _w = (lambda a: (lambda t: t.to(torch.bfloat16) if t.is_floating_point() else t)(torch.as_tensor(a)))
    def _A_setup():
        B, Sq, D = 2, 1, 448
        H, Sk, Dh = 16, 16384, 256
        return {
            "x": _w((lambda *s: torch.randn(*s, dtype=torch.bfloat16) * 0.05)(B, Sq, D)),
            "k_cache": _w((lambda *s: torch.randn(*s, dtype=torch.bfloat16) * 1.6)(B, H, Sk, Dh)),
            "v_cache": _w((lambda *s: torch.randn(*s, dtype=torch.bfloat16) * 1.6)(B, H, Sk, Dh)),
            "wq": _w((lambda *s: torch.randn(*s, dtype=torch.bfloat16) * 1.6)(D, H * Dh) * (D ** -0.5)),
            "wo": _w((lambda *s: torch.randn(*s, dtype=torch.bfloat16) * 1.6)(H * Dh, D) * ((H * Dh) ** -0.5)),
        }
    _A_in = _A_setup()

    def _B_setup():
        B, S, D, F = 2, 1, 448, 1792
        return {
            "x": _w((lambda *s: torch.randn(*s, dtype=torch.bfloat16) * 0.05)(B, S, D)),
            "w_gate": _w((lambda *s: torch.randn(*s, dtype=torch.bfloat16) * 0.05)(D, F)),
            "w_up": _w((lambda *s: torch.randn(*s, dtype=torch.bfloat16) * 0.05)(D, F)),
            "w_down": _w((lambda *s: torch.randn(*s, dtype=torch.bfloat16) * 0.05)(F, D)),
        }
    _B_in = _B_setup()

    return {
        "A_x": _A_in["x"],
        "A_k_cache": _A_in["k_cache"],
        "A_v_cache": _A_in["v_cache"],
        "A_wq": _A_in["wq"],
        "A_wo": _A_in["wo"],
        "B_x": _B_in["x"],
        "B_w_gate": _B_in["w_gate"],
        "B_w_up": _B_in["w_up"],
        "B_w_down": _B_in["w_down"],
    }

def reference(A_x, A_k_cache, A_v_cache, A_wq, A_wo, B_x, B_w_gate, B_w_up, B_w_down):
    def _A_ref(x, k_cache, v_cache, wq, wo):
        B, Sq, D = x.shape
        H, Dh = 16, 256
        q = (lambda x, *d: x.permute(*d))((x @ wq).reshape(B, Sq, H, Dh), 0, 2, 1, 3)
        scores = torch.einsum("bhqd,bhkd->bhqk", q, k_cache) * (Dh ** -0.5)
        p = _softmax(scores, axis=-1)
        o = torch.einsum("bhqk,bhkd->bhqd", p, v_cache)
        return (lambda x, *d: x.permute(*d))(o, 0, 2, 1, 3).reshape(B, Sq, H * Dh) @ wo

    def _B_ref(x, w_gate, w_up, w_down):
        g = torch.einsum("bsd,df->bsf", x, w_gate)
        u = torch.einsum("bsd,df->bsf", x, w_up)
        h = _sigmoid(g) * u
        return torch.einsum("bsf,fd->bsd", h, w_down)

    x = A_x
    x = x + _A_ref(_layernorm(x, axis=-1), A_k_cache, A_v_cache, A_wq, A_wo)
    x = x + _B_ref(_layernorm(x, axis=-1), B_w_gate, B_w_up, B_w_down)
    x = x + _A_ref(_layernorm(x, axis=-1), A_k_cache, A_v_cache, A_wq, A_wo)
    x = x + _B_ref(_layernorm(x, axis=-1), B_w_gate, B_w_up, B_w_down)
    return x
```

```asm
; @launch grid=(256,1,1) block=(256,1,1) lds=163840
.amdgcn_target "amdgcn-amd-amdhsa--gfx950"
.text
.globl interleave_layers__mha_block_cached__glu_gated_glu__decode_kernel
.p2align 8
.type interleave_layers__mha_block_cached__glu_gated_glu__decode_kernel,@function
interleave_layers__mha_block_cached__glu_gated_glu__decode_kernel:
  s_cmp_ge_u32 s2, 256
  s_cbranch_scc1 L_exit
  s_cmp_lt_u32 s2, 32
  s_cbranch_scc1 L_chain_tramp
  s_load_dwordx4 s[56:59], s[0:1], 8
  s_load_dwordx2 s[20:21], s[0:1], 88
  s_sub_u32 s47, s2, 32
  s_mul_hi_u32 s43, s47, 0x12492493
  s_mul_i32 s50, s43, 14
  s_sub_u32 s44, s47, s50
  v_lshrrev_b32 v1, 6, v0
  s_nop 0
  v_readfirstlane_b32 s42, v1
  v_and_b32 v0, 63, v0
  v_and_b32 v1, 7, v0
  v_lshlrev_b32 v1, 9, v1
  v_and_b32 v20, 8, v0
  v_lshl_or_b32 v1, v20, 3, v1
  v_and_b32 v20, 48, v0
  v_or_b32 v1, v1, v20
  v_xor_b32 v2, 0x1040, v1
  v_lshlrev_b32 v3, 7, v20
  v_and_b32 v20, 15, v0
  v_lshl_or_b32 v3, v20, 4, v3
  s_lshl_b32 s47, s44, 2
  s_add_u32 s47, s47, s42
  s_lshl_b32 s47, s47, 13
  s_lshl_b32 s12, s43, 23
  s_add_u32 s13, s12, 0x8000000
  s_add_u32 s28, s47, s12
  s_add_u32 s29, s47, s13
  s_mul_i32 s32, s42, 38912
  s_add_u32 s32, s32, 8192
  s_mov_b32 s7, 0x00020000
  s_mov_b32 s11, 0x00020000
  s_mov_b32 s23, 0x00020000
  s_mov_b32 s6, 0x10000000
  s_mov_b32 s10, 0x10000000
  s_mov_b32 s22, 0x500000
  s_getpc_b64 s[24:25]
PCS_1:
  s_sub_u32 s24, s24, (PCS_1 - interleave_layers__mha_block_cached__glu_gated_glu__decode_kernel)
  s_subb_u32 s25, s25, 0
  s_mov_b32 s26, (L_code_end - interleave_layers__mha_block_cached__glu_gated_glu__decode_kernel)
  s_mov_b32 s27, 0x00020000
  s_lshr_b32 s50, s2, 3
  s_lshl_b32 s50, s50, 2
  s_add_u32 s50, s50, s42
  s_sub_u32 s50, s50, 14
  s_lshl_b32 s50, s50, 10
  v_lshlrev_b32 v56, 4, v0
  buffer_load_dwordx4 v[56:59], v56, s[24:27], s50 offen
  s_waitcnt lgkmcnt(0)
  s_mov_b32 s4, s56
  s_mov_b32 s5, s57
  s_mov_b32 s8, s58
  s_mov_b32 s9, s59
  s_load_dword s33, s[20:21], 0
  s_add_u32 s30, s28, 3670016
  buffer_load_dwordx4 v[84:87], v1, s[4:7], s30 offen nt
  buffer_load_dwordx4 v[88:91], v1, s[4:7], s30 offen offset:128 nt
  buffer_load_dwordx4 v[92:95], v1, s[4:7], s30 offen offset:256 nt
  buffer_load_dwordx4 v[96:99], v1, s[4:7], s30 offen offset:384 nt
  buffer_load_dwordx4 v[100:103], v2, s[4:7], s30 offen nt
  buffer_load_dwordx4 v[104:107], v2, s[4:7], s30 offen offset:128 nt
  buffer_load_dwordx4 v[108:111], v2, s[4:7], s30 offen offset:256 nt
  buffer_load_dwordx4 v[112:115], v2, s[4:7], s30 offen offset:384 nt
  s_add_u32 s31, s28, 3670016
  buffer_load_dwordx4 v[116:119], v3, s[8:11], s31 offen nt
  buffer_load_dwordx4 v[120:123], v3, s[8:11], s31 offen offset:256 nt
  buffer_load_dwordx4 v[124:127], v3, s[8:11], s31 offen offset:512 nt
  buffer_load_dwordx4 v[128:131], v3, s[8:11], s31 offen offset:768 nt
  buffer_load_dwordx4 v[132:135], v3, s[8:11], s31 offen offset:1024 nt
  buffer_load_dwordx4 v[136:139], v3, s[8:11], s31 offen offset:1280 nt
  buffer_load_dwordx4 v[140:143], v3, s[8:11], s31 offen offset:1536 nt
  buffer_load_dwordx4 v[144:147], v3, s[8:11], s31 offen offset:1792 nt
  v_lshlrev_b32 v75, 4, v0
  v_add_u32 v75, s32, v75
  s_lshl_b32 s45, s43, 10
  s_add_u32 s45, s45, 0x10000
  s_lshl_b32 s14, s43, 8
  s_add_u32 s14, s14, 0x2000
  s_lshl_b32 s46, s43, 4
  s_add_u32 s46, s46, s44
  s_lshl_b32 s46, s46, 11
  s_add_u32 s46, s46, 0x100000
  s_mov_b32 s34, 0x3db8aa3b
  s_mov_b32 s35, 0xff7f0000
  v_mov_b32 v74, 0xbdb8aa3b
  v_and_b32 v20, 8, v0
  v_cmp_ne_u32 s[40:41], 0, v20
  v_lshrrev_b32 v21, 2, v0
  v_xor_b32 v21, v21, v0
  v_and_b32 v21, 8, v21
  v_cmp_eq_u32 s[48:49], 0, v21
  v_cmp_eq_u32 s[18:19], 0, v21
  v_mov_b32 v20, 0x03020100
  v_mov_b32 v72, 0x05040c0c
  v_mov_b32 v73, 0x07060c0c
  v_cndmask_b32 v72, v20, v72, s[48:49]
  v_cndmask_b32 v73, v20, v73, s[48:49]
  v_and_b32 v20, 1, v0
  v_cmp_ne_u32 s[48:49], 0, v20
  v_mov_b32 v20, 0xffff
  v_mov_b32 v21, 0xffff0000
  v_cndmask_b32 v20, v20, v21, s[48:49]
  v_bfe_u32 v21, v0, 1, 2
  v_cmp_eq_u32 s[48:49], 0, v21
  s_nop 1
  v_cndmask_b32 v68, 0, v20, s[48:49]
  v_cmp_eq_u32 s[48:49], 1, v21
  s_nop 1
  v_cndmask_b32 v69, 0, v20, s[48:49]
  v_cmp_eq_u32 s[48:49], 2, v21
  s_nop 1
  v_cndmask_b32 v70, 0, v20, s[48:49]
  v_cmp_eq_u32 s[48:49], 3, v21
  s_nop 1
  v_cndmask_b32 v71, 0, v20, s[48:49]
  v_mov_b32 v52, 0
  v_mov_b32 v53, 0
  v_mov_b32 v54, 0
  v_mov_b32 v55, 0
  v_lshlrev_b32 v20, 4, v0
  s_lshl_b32 s47, s42, 19
  s_add_u32 s47, s47, s46
  buffer_store_dwordx4 v[52:55], v20, s[20:23], s47 offen sc1
  buffer_store_dwordx4 v[52:55], v20, s[20:23], s47 offen offset:1024 sc1
  v_mov_b32 v21, 1088
  ds_write_b128 v21, v[52:55]
  s_waitcnt lgkmcnt(0)
  s_add_u32 s33, s33, 1
  s_max_u32 s33, s33, 1
  s_barrier
  s_add_u32 s30, s28, 0
  s_add_u32 m0, s32, 0x0
  s_nop 0
  buffer_load_dwordx4 v1, s[4:7], s30 offen nt lds
  s_add_u32 m0, s32, 0x380
  s_nop 0
  buffer_load_dwordx4 v1, s[4:7], s30 offen offset:128 nt lds
  s_add_u32 m0, s32, 0x700
  s_nop 0
  buffer_load_dwordx4 v1, s[4:7], s30 offen offset:256 nt lds
  s_add_u32 m0, s32, 0xa80
  s_nop 0
  buffer_load_dwordx4 v1, s[4:7], s30 offen offset:384 nt lds
  s_add_u32 m0, s32, 0x1000
  s_nop 0
  buffer_load_dwordx4 v2, s[4:7], s30 offen nt lds
  s_waitcnt vmcnt(16)
  s_add_u32 m0, s32, 0x1380
  s_nop 0
  buffer_load_dwordx4 v2, s[4:7], s30 offen offset:128 nt lds
  s_add_u32 m0, s32, 0x1700
  s_nop 0
  buffer_load_dwordx4 v2, s[4:7], s30 offen offset:256 nt lds
  s_add_u32 m0, s32, 0x1a80
  s_nop 0
  buffer_load_dwordx4 v2, s[4:7], s30 offen offset:384 nt lds
  s_add_u32 s31, s28, 0
  s_add_u32 m0, s32, 0x2000
  s_nop 0
  buffer_load_dwordx4 v3, s[8:11], s31 offen nt lds
  s_add_u32 m0, s32, 0x2300
  s_nop 0
  buffer_load_dwordx4 v3, s[8:11], s31 offen offset:256 nt lds
  s_add_u32 m0, s32, 0x2600
  s_nop 0
  buffer_load_dwordx4 v3, s[8:11], s31 offen offset:512 nt lds
  s_add_u32 m0, s32, 0x2900
  s_nop 0
  buffer_load_dwordx4 v3, s[8:11], s31 offen offset:768 nt lds
  s_add_u32 m0, s32, 0x2c00
  s_nop 0
  buffer_load_dwordx4 v3, s[8:11], s31 offen offset:1024 nt lds
  s_waitcnt vmcnt(16)
  s_add_u32 m0, s32, 0x2f00
  s_nop 0
  buffer_load_dwordx4 v3, s[8:11], s31 offen offset:1280 nt lds
  s_add_u32 m0, s32, 0x3200
  s_nop 0
  buffer_load_dwordx4 v3, s[8:11], s31 offen offset:1536 nt lds
  s_add_u32 m0, s32, 0x3500
  s_nop 0
  buffer_load_dwordx4 v3, s[8:11], s31 offen offset:1792 nt lds
  s_add_u32 s30, s28, 458752
  s_add_u32 m0, s32, 0x4000
  s_nop 0
  buffer_load_dwordx4 v1, s[4:7], s30 offen nt lds
  s_add_u32 m0, s32, 0x4380
  s_nop 0
  buffer_load_dwordx4 v1, s[4:7], s30 offen offset:128 nt lds
  s_add_u32 m0, s32, 0x4700
  s_nop 0
  buffer_load_dwordx4 v1, s[4:7], s30 offen offset:256 nt lds
  s_add_u32 m0, s32, 0x4a80
  s_nop 0
  buffer_load_dwordx4 v1, s[4:7], s30 offen offset:384 nt lds
  s_add_u32 m0, s32, 0x5000
  s_nop 0
  buffer_load_dwordx4 v2, s[4:7], s30 offen nt lds
  s_waitcnt vmcnt(16)
  s_add_u32 m0, s32, 0x5380
  s_nop 0
  buffer_load_dwordx4 v2, s[4:7], s30 offen offset:128 nt lds
  s_add_u32 m0, s32, 0x5700
  s_nop 0
  buffer_load_dwordx4 v2, s[4:7], s30 offen offset:256 nt lds
  s_add_u32 m0, s32, 0x5a80
  s_nop 0
  buffer_load_dwordx4 v2, s[4:7], s30 offen offset:384 nt lds
  s_add_u32 s31, s28, 458752
  s_add_u32 m0, s32, 0x6000
  s_nop 0
  buffer_load_dwordx4 v3, s[8:11], s31 offen nt lds
  s_add_u32 m0, s32, 0x6300
  s_nop 0
  buffer_load_dwordx4 v3, s[8:11], s31 offen offset:256 nt lds
  s_add_u32 m0, s32, 0x6600
  s_nop 0
  buffer_load_dwordx4 v3, s[8:11], s31 offen offset:512 nt lds
  s_add_u32 m0, s32, 0x6900
  s_nop 0
  buffer_load_dwordx4 v3, s[8:11], s31 offen offset:768 nt lds
  s_add_u32 m0, s32, 0x6c00
  s_nop 0
  buffer_load_dwordx4 v3, s[8:11], s31 offen offset:1024 nt lds
  s_waitcnt vmcnt(16)
  s_add_u32 m0, s32, 0x6f00
  s_nop 0
  buffer_load_dwordx4 v3, s[8:11], s31 offen offset:1280 nt lds
  s_add_u32 m0, s32, 0x7200
  s_nop 0
  buffer_load_dwordx4 v3, s[8:11], s31 offen offset:1536 nt lds
  s_add_u32 m0, s32, 0x7500
  s_nop 0
  buffer_load_dwordx4 v3, s[8:11], s31 offen offset:1792 nt lds
  s_add_u32 s30, s28, 917504
  s_add_u32 m0, s32, 0x8000
  s_nop 0
  buffer_load_dwordx4 v1, s[4:7], s30 offen nt lds
  s_add_u32 m0, s32, 0x8380
  s_nop 0
  buffer_load_dwordx4 v1, s[4:7], s30 offen offset:128 nt lds
  s_add_u32 m0, s32, 0x8700
  s_nop 0
  buffer_load_dwordx4 v1, s[4:7], s30 offen offset:256 nt lds
  s_add_u32 m0, s32, 0x8a80
  s_nop 0
  buffer_load_dwordx4 v1, s[4:7], s30 offen offset:384 nt lds
  s_add_u32 m0, s32, 0x9000
  s_nop 0
  buffer_load_dwordx4 v2, s[4:7], s30 offen nt lds
  s_waitcnt vmcnt(16)
  s_add_u32 m0, s32, 0x9380
  s_nop 0
  buffer_load_dwordx4 v2, s[4:7], s30 offen offset:128 nt lds
  buffer_load_dwordx4 a[0:3], v2, s[4:7], s30 offen offset:256 nt
  buffer_load_dwordx4 a[4:7], v2, s[4:7], s30 offen offset:384 nt
  s_add_u32 s31, s28, 917504
  buffer_load_dwordx4 a[8:11], v3, s[8:11], s31 offen nt
  buffer_load_dwordx4 a[12:15], v3, s[8:11], s31 offen offset:256 nt
  buffer_load_dwordx4 a[16:19], v3, s[8:11], s31 offen offset:512 nt
  buffer_load_dwordx4 a[20:23], v3, s[8:11], s31 offen offset:768 nt
  buffer_load_dwordx4 a[24:27], v3, s[8:11], s31 offen offset:1024 nt
  s_waitcnt vmcnt(16)
  buffer_load_dwordx4 a[28:31], v3, s[8:11], s31 offen offset:1280 nt
  buffer_load_dwordx4 a[32:35], v3, s[8:11], s31 offen offset:1536 nt
  buffer_load_dwordx4 a[36:39], v3, s[8:11], s31 offen offset:1792 nt
  s_add_u32 s30, s28, 1376256
  buffer_load_dwordx4 a[40:43], v1, s[4:7], s30 offen nt
  buffer_load_dwordx4 a[44:47], v1, s[4:7], s30 offen offset:128 nt
  buffer_load_dwordx4 a[48:51], v1, s[4:7], s30 offen offset:256 nt
  buffer_load_dwordx4 a[52:55], v1, s[4:7], s30 offen offset:384 nt
  buffer_load_dwordx4 a[56:59], v2, s[4:7], s30 offen nt
  s_waitcnt vmcnt(16)
  buffer_load_dwordx4 a[60:63], v2, s[4:7], s30 offen offset:128 nt
  buffer_load_dwordx4 a[64:67], v2, s[4:7], s30 offen offset:256 nt
  buffer_load_dwordx4 a[68:71], v2, s[4:7], s30 offen offset:384 nt
  s_add_u32 s31, s28, 1376256
  buffer_load_dwordx4 a[72:75], v3, s[8:11], s31 offen nt
  buffer_load_dwordx4 a[76:79], v3, s[8:11], s31 offen offset:256 nt
  buffer_load_dwordx4 a[80:83], v3, s[8:11], s31 offen offset:512 nt
  buffer_load_dwordx4 a[84:87], v3, s[8:11], s31 offen offset:768 nt
  buffer_load_dwordx4 a[88:91], v3, s[8:11], s31 offen offset:1024 nt
  s_waitcnt vmcnt(16)
  buffer_load_dwordx4 a[92:95], v3, s[8:11], s31 offen offset:1280 nt
  buffer_load_dwordx4 a[96:99], v3, s[8:11], s31 offen offset:1536 nt
  buffer_load_dwordx4 a[100:103], v3, s[8:11], s31 offen offset:1792 nt
  s_add_u32 s30, s28, 1835008
  buffer_load_dwordx4 a[104:107], v1, s[4:7], s30 offen nt
  buffer_load_dwordx4 a[108:111], v1, s[4:7], s30 offen offset:128 nt
  s_add_u32 s47, s45, 0
  v_subrev_u32 v28, s32, v75
  buffer_load_dwordx4 v[148:151], v28, s[20:23], s47 offen sc1
  buffer_load_dwordx4 a[112:115], v1, s[4:7], s30 offen offset:256 nt
  buffer_load_dwordx4 a[116:119], v1, s[4:7], s30 offen offset:384 nt
  s_waitcnt vmcnt(16)
  buffer_load_dwordx4 a[120:123], v2, s[4:7], s30 offen nt
  buffer_load_dwordx4 a[124:127], v2, s[4:7], s30 offen offset:128 nt
  s_waitcnt vmcnt(4)
  v_mov_b32 v20, v148
  v_mov_b32 v21, v149
  v_mov_b32 v22, v150
  v_mov_b32 v23, v151
  s_mov_b32 s51, 0
  s_branch QC_3
QR_2:
  s_add_u32 s47, s45, 0
  v_subrev_u32 v20, s32, v75
  buffer_load_dwordx4 v[20:23], v20, s[20:23], s47 offen sc1
  s_waitcnt vmcnt(0)
QC_3:
  v_cmp_eq_u32 s[48:49], s33, v21
  v_cmp_eq_u32 s[54:55], s33, v23
  s_nop 1
  s_and_b64 s[48:49], s[48:49], s[54:55]
  s_cmp_eq_u64 s[48:49], -1
  s_cbranch_scc1 QO_4
  s_add_u32 s51, s51, 1
  s_cmp_gt_u32 s51, 40000
  s_cbranch_scc1 QO_4
  s_sleep 8
  s_branch QR_2
QO_4:
  v_subrev_u32 v28, s32, v75
  v_lshrrev_b32 v28, 1, v28
  ds_write2_b32 v28, v20, v22 offset0:0 offset1:1
  s_waitcnt lgkmcnt(0)
  v_and_b32 v28, 0x70, v1
  ds_read_b128 v[4:7], v28 offset:0
  ds_read_b128 v[8:11], v28 offset:128
  ds_read_b128 v[12:15], v28 offset:256
  ds_read_b128 v[16:19], v28 offset:384
  s_waitcnt lgkmcnt(0)
  buffer_load_dwordx4 a[128:131], v2, s[4:7], s30 offen offset:256 nt
  buffer_load_dwordx4 a[132:135], v2, s[4:7], s30 offen offset:384 nt
  s_add_u32 s31, s28, 1835008
  buffer_load_dwordx4 a[136:139], v3, s[8:11], s31 offen nt
  buffer_load_dwordx4 a[140:143], v3, s[8:11], s31 offen offset:256 nt
  buffer_load_dwordx4 a[144:147], v3, s[8:11], s31 offen offset:512 nt
  buffer_load_dwordx4 a[148:151], v3, s[8:11], s31 offen offset:768 nt
  buffer_load_dwordx4 a[152:155], v3, s[8:11], s31 offen offset:1024 nt
  buffer_load_dwordx4 a[156:159], v3, s[8:11], s31 offen offset:1280 nt
  buffer_load_dwordx4 a[160:163], v3, s[8:11], s31 offen offset:1536 nt
  buffer_load_dwordx4 a[164:167], v3, s[8:11], s31 offen offset:1792 nt
  s_add_u32 s30, s28, 2293760
  buffer_load_dwordx4 a[168:171], v1, s[4:7], s30 offen nt
  buffer_load_dwordx4 a[172:175], v1, s[4:7], s30 offen offset:128 nt
  buffer_load_dwordx4 a[176:179], v1, s[4:7], s30 offen offset:256 nt
  buffer_load_dwordx4 a[180:183], v1, s[4:7], s30 offen offset:384 nt
  buffer_load_dwordx4 a[184:187], v2, s[4:7], s30 offen nt
  buffer_load_dwordx4 a[188:191], v2, s[4:7], s30 offen offset:128 nt
  buffer_load_dwordx4 a[192:195], v2, s[4:7], s30 offen offset:256 nt
  buffer_load_dwordx4 a[196:199], v2, s[4:7], s30 offen offset:384 nt
  s_add_u32 s31, s28, 2293760
  buffer_load_dwordx4 a[200:203], v3, s[8:11], s31 offen nt
  buffer_load_dwordx4 a[204:207], v3, s[8:11], s31 offen offset:256 nt
  s_waitcnt vmcnt(16)
  buffer_load_dwordx4 a[208:211], v3, s[8:11], s31 offen offset:512 nt
  buffer_load_dwordx4 a[212:215], v3, s[8:11], s31 offen offset:768 nt
  buffer_load_dwordx4 a[216:219], v3, s[8:11], s31 offen offset:1024 nt
  buffer_load_dwordx4 a[220:223], v3, s[8:11], s31 offen offset:1280 nt
  buffer_load_dwordx4 a[224:227], v3, s[8:11], s31 offen offset:1536 nt
  buffer_load_dwordx4 a[228:231], v3, s[8:11], s31 offen offset:1792 nt
  s_add_u32 s30, s28, 2752512
  buffer_load_dwordx4 a[232:235], v1, s[4:7], s30 offen nt
  buffer_load_dwordx4 a[236:239], v1, s[4:7], s30 offen offset:128 nt
  s_waitcnt vmcnt(16)
  buffer_load_dwordx4 a[240:243], v1, s[4:7], s30 offen offset:256 nt
  buffer_load_dwordx4 a[244:247], v1, s[4:7], s30 offen offset:384 nt
  buffer_load_dwordx4 a[248:251], v2, s[4:7], s30 offen nt
  buffer_load_dwordx4 a[252:255], v2, s[4:7], s30 offen offset:128 nt
  buffer_load_dwordx4 v[152:155], v2, s[4:7], s30 offen offset:256 nt
  buffer_load_dwordx4 v[156:159], v2, s[4:7], s30 offen offset:384 nt
  s_add_u32 s31, s28, 2752512
  buffer_load_dwordx4 v[160:163], v3, s[8:11], s31 offen nt
  buffer_load_dwordx4 v[164:167], v3, s[8:11], s31 offen offset:256 nt
  s_waitcnt vmcnt(16)
  buffer_load_dwordx4 v[168:171], v3, s[8:11], s31 offen offset:512 nt
  buffer_load_dwordx4 v[172:175], v3, s[8:11], s31 offen offset:768 nt
  buffer_load_dwordx4 v[176:179], v3, s[8:11], s31 offen offset:1024 nt
  buffer_load_dwordx4 v[180:183], v3, s[8:11], s31 offen offset:1280 nt
  buffer_load_dwordx4 v[184:187], v3, s[8:11], s31 offen offset:1536 nt
  buffer_load_dwordx4 v[188:191], v3, s[8:11], s31 offen offset:1792 nt
  s_add_u32 s30, s28, 3211264
  buffer_load_dwordx4 v[192:195], v1, s[4:7], s30 offen nt
  buffer_load_dwordx4 v[196:199], v1, s[4:7], s30 offen offset:128 nt
  s_waitcnt vmcnt(16)
  buffer_load_dwordx4 v[200:203], v1, s[4:7], s30 offen offset:256 nt
  buffer_load_dwordx4 v[204:207], v1, s[4:7], s30 offen offset:384 nt
  buffer_load_dwordx4 v[208:211], v2, s[4:7], s30 offen nt
  buffer_load_dwordx4 v[212:215], v2, s[4:7], s30 offen offset:128 nt
  buffer_load_dwordx4 v[216:219], v2, s[4:7], s30 offen offset:256 nt
  buffer_load_dwordx4 v[220:223], v2, s[4:7], s30 offen offset:384 nt
  s_add_u32 s31, s28, 3211264
  buffer_load_dwordx4 v[224:227], v3, s[8:11], s31 offen nt
  buffer_load_dwordx4 v[228:231], v3, s[8:11], s31 offen offset:256 nt
  s_waitcnt vmcnt(17)
  buffer_load_dwordx4 v[232:235], v3, s[8:11], s31 offen offset:512 nt
  buffer_load_dwordx4 v[236:239], v3, s[8:11], s31 offen offset:768 nt
  buffer_load_dwordx4 v[240:243], v3, s[8:11], s31 offen offset:1024 nt
  buffer_load_dwordx4 v[244:247], v3, s[8:11], s31 offen offset:1280 nt
  buffer_load_dwordx4 v[248:251], v3, s[8:11], s31 offen offset:1536 nt
  buffer_load_dwordx4 v[252:255], v3, s[8:11], s31 offen offset:1792 nt
  s_add_u32 s47, s14, 0
  v_mov_b32 v80, 1
  s_mov_b64 exec, 1
  buffer_atomic_add v80, off, s[20:23], s47 sc0
  s_mov_b64 exec, -1
  ds_read_b128 v[52:55], v75 offset:0
  ds_read_b128 v[56:59], v75 offset:4096
  ds_read_b128 v[60:63], v75 offset:1024
  ds_read_b128 v[64:67], v75 offset:5120
  s_waitcnt lgkmcnt(3)
  v_mfma_f32_16x16x32_bf16 v[20:23], v[52:55], v[4:7], 0
  ds_read_b128 v[52:55], v75 offset:2048
  s_waitcnt lgkmcnt(3)
  v_mfma_f32_16x16x32_bf16 v[24:27], v[56:59], v[4:7], 0
  ds_read_b128 v[56:59], v75 offset:6144
  s_waitcnt lgkmcnt(3)
  v_mfma_f32_16x16x32_bf16 v[20:23], v[60:63], v[8:11], v[20:23]
  ds_read_b128 v[60:63], v75 offset:3072
  s_waitcnt lgkmcnt(3)
  v_mfma_f32_16x16x32_bf16 v[24:27], v[64:67], v[8:11], v[24:27]
  ds_read_b128 v[64:67], v75 offset:7168
  s_waitcnt lgkmcnt(3)
  v_mfma_f32_16x16x32_bf16 v[20:23], v[52:55], v[12:15], v[20:23]
  s_waitcnt lgkmcnt(2)
  v_mfma_f32_16x16x32_bf16 v[24:27], v[56:59], v[12:15], v[24:27]
  s_waitcnt lgkmcnt(1)
  v_mfma_f32_16x16x32_bf16 v[20:23], v[60:63], v[16:19], v[20:23]
  s_waitcnt lgkmcnt(0)
  v_mfma_f32_16x16x32_bf16 v[24:27], v[64:67], v[16:19], v[24:27]
  s_nop 7
  v_permlane32_swap_b32 v20, v24
  v_permlane32_swap_b32 v21, v25
  v_permlane32_swap_b32 v22, v26
  v_permlane32_swap_b32 v23, v27
  v_add_f32_dpp v20, v24, v20 row_ror:8 row_mask:0xf bank_mask:0xf
  v_add_f32_dpp v21, v25, v21 row_ror:8 row_mask:0xf bank_mask:0xf
  v_add_f32_dpp v22, v26, v22 row_ror:8 row_mask:0xf bank_mask:0xf
  v_add_f32_dpp v23, v27, v23 row_ror:8 row_mask:0xf bank_mask:0xf
  v_cvt_pk_bf16_f32 v24, v20, v21
  v_cvt_pk_bf16_f32 v25, v22, v23
  v_perm_b32 v20, v24, s35, v72
  v_perm_b32 v21, v24, s35, v73
  v_perm_b32 v22, v25, s35, v72
  v_perm_b32 v23, v25, s35, v73
  v_max3_f32 v26, v20, v21, v22
  v_max_f32 v26, v26, v23
  s_nop 1
  v_max_f32_dpp v26, v26, v26 row_ror:8 row_mask:0xf bank_mask:0xf
  s_nop 1
  v_max_f32_dpp v26, v26, v26 row_bcast:15 row_mask:0xa bank_mask:0xf
  s_nop 1
  v_max_f32_dpp v26, v26, v26 row_bcast:31 row_mask:0xc bank_mask:0xf
  s_nop 0
  v_readlane_b32 s36, v26, 63
  s_nop 1
  v_mul_f32 v0, s36, v74
  v_fma_f32 v20, v20, s34, v0
  v_fma_f32 v21, v21, s34, v0
  v_fma_f32 v22, v22, s34, v0
  v_fma_f32 v23, v23, s34, v0
  v_exp_f32 v20, v20
  v_exp_f32 v21, v21
  v_exp_f32 v22, v22
  v_exp_f32 v23, v23
  v_add_f32 v26, v20, v21
  v_add_f32 v24, v22, v23
  v_cvt_pk_bf16_f32 v20, v20, v20
  v_cvt_pk_bf16_f32 v21, v21, v21
  v_cvt_pk_bf16_f32 v22, v22, v22
  v_cvt_pk_bf16_f32 v23, v23, v23
  v_add_f32 v76, v26, v24
  v_and_b32 v28, v20, v68
  v_and_b32 v29, v20, v69
  v_and_b32 v30, v20, v70
  v_and_b32 v31, v20, v71
  v_and_b32 v32, v21, v68
  v_and_b32 v33, v21, v69
  v_and_b32 v34, v21, v70
  v_and_b32 v35, v21, v71
  ds_read_b128 v[52:55], v75 offset:8192
  ds_read_b128 v[56:59], v75 offset:9216
  ds_read_b128 v[60:63], v75 offset:10240
  ds_read_b128 v[64:67], v75 offset:11264
  s_waitcnt lgkmcnt(3)
  v_mfma_f32_16x16x32_bf16 v[36:39], v[52:55], v[28:31], 0
  ds_read_b128 v[52:55], v75 offset:12288
  s_waitcnt lgkmcnt(3)
  v_mfma_f32_16x16x32_bf16 v[40:43], v[56:59], v[28:31], 0
  ds_read_b128 v[56:59], v75 offset:13312
  v_and_b32 v28, v22, v68
  v_and_b32 v29, v22, v69
  v_and_b32 v30, v22, v70
  v_and_b32 v31, v22, v71
  s_waitcnt lgkmcnt(3)
  v_mfma_f32_16x16x32_bf16 v[36:39], v[60:63], v[32:35], v[36:39]
  ds_read_b128 v[60:63], v75 offset:14336
  s_waitcnt lgkmcnt(3)
  v_mfma_f32_16x16x32_bf16 v[40:43], v[64:67], v[32:35], v[40:43]
  ds_read_b128 v[64:67], v75 offset:15360
  v_and_b32 v32, v23, v68
  v_and_b32 v33, v23, v69
  v_and_b32 v34, v23, v70
  v_and_b32 v35, v23, v71
  s_waitcnt lgkmcnt(3)
  v_mfma_f32_16x16x32_bf16 v[36:39], v[52:55], v[28:31], v[36:39]
  s_waitcnt lgkmcnt(2)
  v_mfma_f32_16x16x32_bf16 v[40:43], v[56:59], v[28:31], v[40:43]
  s_waitcnt lgkmcnt(1)
  v_mfma_f32_16x16x32_bf16 v[36:39], v[60:63], v[32:35], v[36:39]
  s_waitcnt lgkmcnt(0)
  v_mfma_f32_16x16x32_bf16 v[40:43], v[64:67], v[32:35], v[40:43]
  ds_read_b128 v[52:55], v75 offset:16384
  ds_read_b128 v[56:59], v75 offset:20480
  ds_read_b128 v[60:63], v75 offset:17408
  ds_read_b128 v[64:67], v75 offset:21504
  s_waitcnt lgkmcnt(3)
  v_mfma_f32_16x16x32_bf16 v[20:23], v[52:55], v[4:7], 0
  ds_read_b128 v[52:55], v75 offset:18432
  s_waitcnt lgkmcnt(3)
  v_mfma_f32_16x16x32_bf16 v[24:27], v[56:59], v[4:7], 0
  ds_read_b128 v[56:59], v75 offset:22528
  s_waitcnt lgkmcnt(3)
  v_mfma_f32_16x16x32_bf16 v[20:23], v[60:63], v[8:11], v[20:23]
  ds_read_b128 v[60:63], v75 offset:19456
  s_waitcnt lgkmcnt(3)
  v_mfma_f32_16x16x32_bf16 v[24:27], v[64:67], v[8:11], v[24:27]
  ds_read_b128 v[64:67], v75 offset:23552
  s_waitcnt lgkmcnt(3)
  v_mfma_f32_16x16x32_bf16 v[20:23], v[52:55], v[12:15], v[20:23]
  s_waitcnt lgkmcnt(2)
  v_mfma_f32_16x16x32_bf16 v[24:27], v[56:59], v[12:15], v[24:27]
  s_waitcnt lgkmcnt(1)
  v_mfma_f32_16x16x32_bf16 v[20:23], v[60:63], v[16:19], v[20:23]
  s_waitcnt lgkmcnt(0)
  v_mfma_f32_16x16x32_bf16 v[24:27], v[64:67], v[16:19], v[24:27]
  s_nop 7
  v_permlane32_swap_b32 v20, v24
  v_permlane32_swap_b32 v21, v25
  v_permlane32_swap_b32 v22, v26
  v_permlane32_swap_b32 v23, v27
  v_add_f32_dpp v20, v24, v20 row_ror:8 row_mask:0xf bank_mask:0xf
  v_add_f32_dpp v21, v25, v21 row_ror:8 row_mask:0xf bank_mask:0xf
  v_add_f32_dpp v22, v26, v22 row_ror:8 row_mask:0xf bank_mask:0xf
  v_add_f32_dpp v23, v27, v23 row_ror:8 row_mask:0xf bank_mask:0xf
  v_cvt_pk_bf16_f32 v24, v20, v21
  v_cvt_pk_bf16_f32 v25, v22, v23
  v_perm_b32 v20, v24, s35, v72
  v_perm_b32 v21, v24, s35, v73
  v_perm_b32 v22, v25, s35, v72
  v_perm_b32 v23, v25, s35, v73
  v_max3_f32 v26, v20, v21, v22
  v_max3_f32 v26, v26, v23, s36
  s_nop 1
  v_max_f32_dpp v26, v26, v26 row_ror:8 row_mask:0xf bank_mask:0xf
  s_nop 1
  v_max_f32_dpp v26, v26, v26 row_bcast:15 row_mask:0xa bank_mask:0xf
  s_nop 1
  v_max_f32_dpp v26, v26, v26 row_bcast:31 row_mask:0xc bank_mask:0xf
  s_nop 0
  v_readlane_b32 s36, v26, 63
  s_nop 1
  v_mul_f32 v78, s36, v74
  v_fma_f32 v20, v20, s34, v78
  v_fma_f32 v21, v21, s34, v78
  v_fma_f32 v22, v22, s34, v78
  v_fma_f32 v23, v23, s34, v78
  v_sub_f32 v27, v78, v0
  v_exp_f32 v20, v20
  v_exp_f32 v21, v21
  v_exp_f32 v22, v22
  v_exp_f32 v23, v23
  v_exp_f32 v27, v27
  v_add_f32 v26, v20, v21
  v_add_f32 v24, v22, v23
  v_cvt_pk_bf16_f32 v20, v20, v20
  v_cvt_pk_bf16_f32 v21, v21, v21
  v_cvt_pk_bf16_f32 v22, v22, v22
  v_cvt_pk_bf16_f32 v23, v23, v23
  v_add_f32 v26, v26, v24
  v_fma_f32 v76, v76, v27, v26
  v_mul_f32 v36, v27, v36
  v_mul_f32 v37, v27, v37
  v_mul_f32 v38, v27, v38
  v_mul_f32 v39, v27, v39
  v_mul_f32 v40, v27, v40
  v_mul_f32 v41, v27, v41
  v_mul_f32 v42, v27, v42
  v_mul_f32 v43, v27, v43
  v_and_b32 v28, v20, v68
  v_and_b32 v29, v20, v69
  v_and_b32 v30, v20, v70
  v_and_b32 v31, v20, v71
  v_and_b32 v32, v21, v68
  v_and_b32 v33, v21, v69
  v_and_b32 v34, v21, v70
  v_and_b32 v35, v21, v71
  ds_read_b128 v[52:55], v75 offset:24576
  ds_read_b128 v[56:59], v75 offset:25600
  ds_read_b128 v[60:63], v75 offset:26624
  ds_read_b128 v[64:67], v75 offset:27648
  s_waitcnt lgkmcnt(3)
  v_mfma_f32_16x16x32_bf16 v[36:39], v[52:55], v[28:31], v[36:39]
  ds_read_b128 v[52:55], v75 offset:28672
  s_waitcnt lgkmcnt(3)
  v_mfma_f32_16x16x32_bf16 v[40:43], v[56:59], v[28:31], v[40:43]
  ds_read_b128 v[56:59], v75 offset:29696
  v_and_b32 v28, v22, v68
  v_and_b32 v29, v22, v69
  v_and_b32 v30, v22, v70
  v_and_b32 v31, v22, v71
  s_waitcnt lgkmcnt(3)
  v_mfma_f32_16x16x32_bf16 v[36:39], v[60:63], v[32:35], v[36:39]
  ds_read_b128 v[60:63], v75 offset:30720
  s_waitcnt lgkmcnt(3)
  v_mfma_f32_16x16x32_bf16 v[40:43], v[64:67], v[32:35], v[40:43]
  ds_read_b128 v[64:67], v75 offset:31744
  v_and_b32 v32, v23, v68
  v_and_b32 v33, v23, v69
  v_and_b32 v34, v23, v70
  v_and_b32 v35, v23, v71
  s_waitcnt lgkmcnt(3)
  v_mfma_f32_16x16x32_bf16 v[36:39], v[52:55], v[28:31], v[36:39]
  s_waitcnt lgkmcnt(2)
  v_mfma_f32_16x16x32_bf16 v[40:43], v[56:59], v[28:31], v[40:43]
  s_waitcnt lgkmcnt(1)
  v_mfma_f32_16x16x32_bf16 v[36:39], v[60:63], v[32:35], v[36:39]
  s_waitcnt lgkmcnt(0)
  v_mfma_f32_16x16x32_bf16 v[40:43], v[64:67], v[32:35], v[40:43]
  ds_read_b128 v[52:55], v75 offset:32768
  ds_read_b128 v[56:59], v75 offset:36864
  ds_read_b128 v[60:63], v75 offset:33792
  ds_read_b128 v[64:67], v75 offset:37888
  s_waitcnt lgkmcnt(3)
  v_mfma_f32_16x16x32_bf16 v[20:23], v[52:55], v[4:7], 0
  ds_read_b128 v[52:55], v75 offset:34816
  s_waitcnt lgkmcnt(3)
  v_mfma_f32_16x16x32_bf16 v[24:27], v[56:59], v[4:7], 0
  ds_read_b128 v[56:59], v75 offset:35840
  s_waitcnt lgkmcnt(3)
  v_mfma_f32_16x16x32_bf16 v[20:23], v[60:63], v[8:11], v[20:23]
  s_waitcnt lgkmcnt(2)
  v_mfma_f32_16x16x32_bf16 v[24:27], v[64:67], v[8:11], v[24:27]
  s_waitcnt lgkmcnt(1)
  v_mfma_f32_16x16x32_bf16 v[20:23], v[52:55], v[12:15], v[20:23]
  v_mfma_f32_16x16x32_bf16 v[24:27], a[0:3], v[12:15], v[24:27]
  s_waitcnt lgkmcnt(0)
  v_mfma_f32_16x16x32_bf16 v[20:23], v[56:59], v[16:19], v[20:23]
  v_mfma_f32_16x16x32_bf16 v[24:27], a[4:7], v[16:19], v[24:27]
  s_nop 7
  v_permlane32_swap_b32 v20, v24
  v_permlane32_swap_b32 v21, v25
  v_permlane32_swap_b32 v22, v26
  v_permlane32_swap_b32 v23, v27
  v_add_f32_dpp v20, v24, v20 row_ror:8 row_mask:0xf bank_mask:0xf
  v_add_f32_dpp v21, v25, v21 row_ror:8 row_mask:0xf bank_mask:0xf
  v_add_f32_dpp v22, v26, v22 row_ror:8 row_mask:0xf bank_mask:0xf
  v_add_f32_dpp v23, v27, v23 row_ror:8 row_mask:0xf bank_mask:0xf
  v_cvt_pk_bf16_f32 v24, v20, v21
  v_cvt_pk_bf16_f32 v25, v22, v23
  v_perm_b32 v20, v24, s35, v72
  v_perm_b32 v21, v24, s35, v73
  v_perm_b32 v22, v25, s35, v72
  v_perm_b32 v23, v25, s35, v73
  v_max3_f32 v26, v20, v21, v22
  v_max3_f32 v26, v26, v23, s36
  s_nop 1
  v_max_f32_dpp v26, v26, v26 row_ror:8 row_mask:0xf bank_mask:0xf
  s_nop 1
  v_max_f32_dpp v26, v26, v26 row_bcast:15 row_mask:0xa bank_mask:0xf
  s_nop 1
  v_max_f32_dpp v26, v26, v26 row_bcast:31 row_mask:0xc bank_mask:0xf
  s_nop 0
  v_readlane_b32 s36, v26, 63
  s_nop 1
  v_mul_f32 v0, s36, v74
  v_fma_f32 v20, v20, s34, v0
  v_fma_f32 v21, v21, s34, v0
  v_fma_f32 v22, v22, s34, v0
  v_fma_f32 v23, v23, s34, v0
  v_sub_f32 v27, v0, v78
  v_exp_f32 v20, v20
  v_exp_f32 v21, v21
  v_exp_f32 v22, v22
  v_exp_f32 v23, v23
  v_exp_f32 v27, v27
  v_add_f32 v26, v20, v21
  v_add_f32 v24, v22, v23
  v_cvt_pk_bf16_f32 v20, v20, v20
  v_cvt_pk_bf16_f32 v21, v21, v21
  v_cvt_pk_bf16_f32 v22, v22, v22
  v_cvt_pk_bf16_f32 v23, v23, v23
  v_add_f32 v26, v26, v24
  v_fma_f32 v76, v76, v27, v26
  v_mul_f32 v36, v27, v36
  v_mul_f32 v37, v27, v37
  v_mul_f32 v38, v27, v38
  v_mul_f32 v39, v27, v39
  v_mul_f32 v40, v27, v40
  v_mul_f32 v41, v27, v41
  v_mul_f32 v42, v27, v42
  v_mul_f32 v43, v27, v43
  v_and_b32 v28, v20, v68
  v_and_b32 v29, v20, v69
  v_and_b32 v30, v20, v70
  v_and_b32 v31, v20, v71
  v_and_b32 v32, v21, v68
  v_and_b32 v33, v21, v69
  v_and_b32 v34, v21, v70
  v_and_b32 v35, v21, v71
  v_mfma_f32_16x16x32_bf16 v[36:39], a[8:11], v[28:31], v[36:39]
  v_mfma_f32_16x16x32_bf16 v[40:43], a[12:15], v[28:31], v[40:43]
  v_and_b32 v28, v22, v68
  v_and_b32 v29, v22, v69
  v_and_b32 v30, v22, v70
  v_and_b32 v31, v22, v71
  v_mfma_f32_16x16x32_bf16 v[36:39], a[16:19], v[32:35], v[36:39]
  v_mfma_f32_16x16x32_bf16 v[40:43], a[20:23], v[32:35], v[40:43]
  v_and_b32 v32, v23, v68
  v_and_b32 v33, v23, v69
  v_and_b32 v34, v23, v70
  v_and_b32 v35, v23, v71
  v_mfma_f32_16x16x32_bf16 v[36:39], a[24:27], v[28:31], v[36:39]
  v_mfma_f32_16x16x32_bf16 v[40:43], a[28:31], v[28:31], v[40:43]
  v_mfma_f32_16x16x32_bf16 v[36:39], a[32:35], v[32:35], v[36:39]
  v_mfma_f32_16x16x32_bf16 v[40:43], a[36:39], v[32:35], v[40:43]
  v_mfma_f32_16x16x32_bf16 v[20:23], a[40:43], v[4:7], 0
  v_mfma_f32_16x16x32_bf16 v[24:27], a[56:59], v[4:7], 0
  v_mfma_f32_16x16x32_bf16 v[20:23], a[44:47], v[8:11], v[20:23]
  v_mfma_f32_16x16x32_bf16 v[24:27], a[60:63], v[8:11], v[24:27]
  v_mfma_f32_16x16x32_bf16 v[20:23], a[48:51], v[12:15], v[20:23]
  v_mfma_f32_16x16x32_bf16 v[24:27], a[64:67], v[12:15], v[24:27]
  v_mfma_f32_16x16x32_bf16 v[20:23], a[52:55], v[16:19], v[20:23]
  v_mfma_f32_16x16x32_bf16 v[24:27], a[68:71], v[16:19], v[24:27]
  s_nop 7
  v_permlane32_swap_b32 v20, v24
  v_permlane32_swap_b32 v21, v25
  v_permlane32_swap_b32 v22, v26
  v_permlane32_swap_b32 v23, v27
  v_add_f32_dpp v20, v24, v20 row_ror:8 row_mask:0xf bank_mask:0xf
  v_add_f32_dpp v21, v25, v21 row_ror:8 row_mask:0xf bank_mask:0xf
  v_add_f32_dpp v22, v26, v22 row_ror:8 row_mask:0xf bank_mask:0xf
  v_add_f32_dpp v23, v27, v23 row_ror:8 row_mask:0xf bank_mask:0xf
  v_cvt_pk_bf16_f32 v24, v20, v21
  v_cvt_pk_bf16_f32 v25, v22, v23
  v_perm_b32 v20, v24, s35, v72
  v_perm_b32 v21, v24, s35, v73
  v_perm_b32 v22, v25, s35, v72
  v_perm_b32 v23, v25, s35, v73
  v_max3_f32 v26, v20, v21, v22
  v_max3_f32 v26, v26, v23, s36
  s_nop 1
  v_max_f32_dpp v26, v26, v26 row_ror:8 row_mask:0xf bank_mask:0xf
  s_nop 1
  v_max_f32_dpp v26, v26, v26 row_bcast:15 row_mask:0xa bank_mask:0xf
  s_nop 1
  v_max_f32_dpp v26, v26, v26 row_bcast:31 row_mask:0xc bank_mask:0xf
  s_nop 0
  v_readlane_b32 s36, v26, 63
  s_nop 1
  v_mul_f32 v78, s36, v74
  v_fma_f32 v20, v20, s34, v78
  v_fma_f32 v21, v21, s34, v78
  v_fma_f32 v22, v22, s34, v78
  v_fma_f32 v23, v23, s34, v78
  v_sub_f32 v27, v78, v0
  v_exp_f32 v20, v20
  v_exp_f32 v21, v21
  v_exp_f32 v22, v22
  v_exp_f32 v23, v23
  v_exp_f32 v27, v27
  v_add_f32 v26, v20, v21
  v_add_f32 v24, v22, v23
  v_cvt_pk_bf16_f32 v20, v20, v20
  v_cvt_pk_bf16_f32 v21, v21, v21
  v_cvt_pk_bf16_f32 v22, v22, v22
  v_cvt_pk_bf16_f32 v23, v23, v23
  v_add_f32 v26, v26, v24
  v_fma_f32 v76, v76, v27, v26
  v_mul_f32 v36, v27, v36
  v_mul_f32 v37, v27, v37
  v_mul_f32 v38, v27, v38
  v_mul_f32 v39, v27, v39
  v_mul_f32 v40, v27, v40
  v_mul_f32 v41, v27, v41
  v_mul_f32 v42, v27, v42
  v_mul_f32 v43, v27, v43
  v_and_b32 v28, v20, v68
  v_and_b32 v29, v20, v69
  v_and_b32 v30, v20, v70
  v_and_b32 v31, v20, v71
  v_and_b32 v32, v21, v68
  v_and_b32 v33, v21, v69
  v_and_b32 v34, v21, v70
  v_and_b32 v35, v21, v71
  v_mfma_f32_16x16x32_bf16 v[36:39], a[72:75], v[28:31], v[36:39]
  v_mfma_f32_16x16x32_bf16 v[40:43], a[76:79], v[28:31], v[40:43]
  v_and_b32 v28, v22, v68
  v_and_b32 v29, v22, v69
  v_and_b32 v30, v22, v70
  v_and_b32 v31, v22, v71
  v_mfma_f32_16x16x32_bf16 v[36:39], a[80:83], v[32:35], v[36:39]
  v_mfma_f32_16x16x32_bf16 v[40:43], a[84:87], v[32:35], v[40:43]
  v_and_b32 v32, v23, v68
  v_and_b32 v33, v23, v69
  v_and_b32 v34, v23, v70
  v_and_b32 v35, v23, v71
  v_mfma_f32_16x16x32_bf16 v[36:39], a[88:91], v[28:31], v[36:39]
  v_mfma_f32_16x16x32_bf16 v[40:43], a[92:95], v[28:31], v[40:43]
  v_mfma_f32_16x16x32_bf16 v[36:39], a[96:99], v[32:35], v[36:39]
  v_mfma_f32_16x16x32_bf16 v[40:43], a[100:103], v[32:35], v[40:43]
  v_mfma_f32_16x16x32_bf16 v[20:23], a[104:107], v[4:7], 0
  v_mfma_f32_16x16x32_bf16 v[24:27], a[120:123], v[4:7], 0
  v_mfma_f32_16x16x32_bf16 v[20:23], a[108:111], v[8:11], v[20:23]
  v_mfma_f32_16x16x32_bf16 v[24:27], a[124:127], v[8:11], v[24:27]
  v_mfma_f32_16x16x32_bf16 v[20:23], a[112:115], v[12:15], v[20:23]
  v_mfma_f32_16x16x32_bf16 v[24:27], a[128:131], v[12:15], v[24:27]
  v_mfma_f32_16x16x32_bf16 v[20:23], a[116:119], v[16:19], v[20:23]
  v_mfma_f32_16x16x32_bf16 v[24:27], a[132:135], v[16:19], v[24:27]
  s_nop 7
  v_permlane32_swap_b32 v20, v24
  v_permlane32_swap_b32 v21, v25
  v_permlane32_swap_b32 v22, v26
  v_permlane32_swap_b32 v23, v27
  v_add_f32_dpp v20, v24, v20 row_ror:8 row_mask:0xf bank_mask:0xf
  v_add_f32_dpp v21, v25, v21 row_ror:8 row_mask:0xf bank_mask:0xf
  v_add_f32_dpp v22, v26, v22 row_ror:8 row_mask:0xf bank_mask:0xf
  v_add_f32_dpp v23, v27, v23 row_ror:8 row_mask:0xf bank_mask:0xf
  v_cvt_pk_bf16_f32 v24, v20, v21
  v_cvt_pk_bf16_f32 v25, v22, v23
  v_perm_b32 v20, v24, s35, v72
  v_perm_b32 v21, v24, s35, v73
  v_perm_b32 v22, v25, s35, v72
  v_perm_b32 v23, v25, s35, v73
  v_max3_f32 v26, v20, v21, v22
  v_max3_f32 v26, v26, v23, s36
  s_nop 1
  v_max_f32_dpp v26, v26, v26 row_ror:8 row_mask:0xf bank_mask:0xf
  s_nop 1
  v_max_f32_dpp v26, v26, v26 row_bcast:15 row_mask:0xa bank_mask:0xf
  s_nop 1
  v_max_f32_dpp v26, v26, v26 row_bcast:31 row_mask:0xc bank_mask:0xf
  s_nop 0
  v_readlane_b32 s36, v26, 63
  s_nop 1
  v_mul_f32 v0, s36, v74
  v_fma_f32 v20, v20, s34, v0
  v_fma_f32 v21, v21, s34, v0
  v_fma_f32 v22, v22, s34, v0
  v_fma_f32 v23, v23, s34, v0
  v_sub_f32 v27, v0, v78
  v_exp_f32 v20, v20
  v_exp_f32 v21, v21
  v_exp_f32 v22, v22
  v_exp_f32 v23, v23
  v_exp_f32 v27, v27
  v_add_f32 v26, v20, v21
  v_add_f32 v24, v22, v23
  v_cvt_pk_bf16_f32 v20, v20, v20
  v_cvt_pk_bf16_f32 v21, v21, v21
  v_cvt_pk_bf16_f32 v22, v22, v22
  v_cvt_pk_bf16_f32 v23, v23, v23
  v_add_f32 v26, v26, v24
  v_fma_f32 v76, v76, v27, v26
  v_mul_f32 v36, v27, v36
  v_mul_f32 v37, v27, v37
  v_mul_f32 v38, v27, v38
  v_mul_f32 v39, v27, v39
  v_mul_f32 v40, v27, v40
  v_mul_f32 v41, v27, v41
  v_mul_f32 v42, v27, v42
  v_mul_f32 v43, v27, v43
  v_and_b32 v28, v20, v68
  v_and_b32 v29, v20, v69
  v_and_b32 v30, v20, v70
  v_and_b32 v31, v20, v71
  v_and_b32 v32, v21, v68
  v_and_b32 v33, v21, v69
  v_and_b32 v34, v21, v70
  v_and_b32 v35, v21, v71
  v_mfma_f32_16x16x32_bf16 v[36:39], a[136:139], v[28:31], v[36:39]
  v_mfma_f32_16x16x32_bf16 v[40:43], a[140:143], v[28:31], v[40:43]
  v_and_b32 v28, v22, v68
  v_and_b32 v29, v22, v69
  v_and_b32 v30, v22, v70
  v_and_b32 v31, v22, v71
  v_mfma_f32_16x16x32_bf16 v[36:39], a[144:147], v[32:35], v[36:39]
  v_mfma_f32_16x16x32_bf16 v[40:43], a[148:151], v[32:35], v[40:43]
  v_and_b32 v32, v23, v68
  v_and_b32 v33, v23, v69
  v_and_b32 v34, v23, v70
  v_and_b32 v35, v23, v71
  v_mfma_f32_16x16x32_bf16 v[36:39], a[152:155], v[28:31], v[36:39]
  v_mfma_f32_16x16x32_bf16 v[40:43], a[156:159], v[28:31], v[40:43]
  v_mfma_f32_16x16x32_bf16 v[36:39], a[160:163], v[32:35], v[36:39]
  v_mfma_f32_16x16x32_bf16 v[40:43], a[164:167], v[32:35], v[40:43]
  v_mfma_f32_16x16x32_bf16 v[20:23], a[168:171], v[4:7], 0
  v_mfma_f32_16x16x32_bf16 v[24:27], a[184:187], v[4:7], 0
  v_mfma_f32_16x16x32_bf16 v[20:23], a[172:175], v[8:11], v[20:23]
  v_mfma_f32_16x16x32_bf16 v[24:27], a[188:191], v[8:11], v[24:27]
  v_mfma_f32_16x16x32_bf16 v[20:23], a[176:179], v[12:15], v[20:23]
  v_mfma_f32_16x16x32_bf16 v[24:27], a[192:195], v[12:15], v[24:27]
  v_mfma_f32_16x16x32_bf16 v[20:23], a[180:183], v[16:19], v[20:23]
  v_mfma_f32_16x16x32_bf16 v[24:27], a[196:199], v[16:19], v[24:27]
  s_nop 7
  v_permlane32_swap_b32 v20, v24
  v_permlane32_swap_b32 v21, v25
  v_permlane32_swap_b32 v22, v26
  v_permlane32_swap_b32 v23, v27
  v_add_f32_dpp v20, v24, v20 row_ror:8 row_mask:0xf bank_mask:0xf
  v_add_f32_dpp v21, v25, v21 row_ror:8 row_mask:0xf bank_mask:0xf
  v_add_f32_dpp v22, v26, v22 row_ror:8 row_mask:0xf bank_mask:0xf
  v_add_f32_dpp v23, v27, v23 row_ror:8 row_mask:0xf bank_mask:0xf
  v_cvt_pk_bf16_f32 v24, v20, v21
  v_cvt_pk_bf16_f32 v25, v22, v23
  v_perm_b32 v20, v24, s35, v72
  v_perm_b32 v21, v24, s35, v73
  v_perm_b32 v22, v25, s35, v72
  v_perm_b32 v23, v25, s35, v73
  v_max3_f32 v26, v20, v21, v22
  v_max3_f32 v26, v26, v23, s36
  s_nop 1
  v_max_f32_dpp v26, v26, v26 row_ror:8 row_mask:0xf bank_mask:0xf
  s_nop 1
  v_max_f32_dpp v26, v26, v26 row_bcast:15 row_mask:0xa bank_mask:0xf
  s_nop 1
  v_max_f32_dpp v26, v26, v26 row_bcast:31 row_mask:0xc bank_mask:0xf
  s_nop 0
  v_readlane_b32 s36, v26, 63
  s_nop 1
  v_mul_f32 v78, s36, v74
  v_fma_f32 v20, v20, s34, v78
  v_fma_f32 v21, v21, s34, v78
  v_fma_f32 v22, v22, s34, v78
  v_fma_f32 v23, v23, s34, v78
  v_sub_f32 v27, v78, v0
  v_exp_f32 v20, v20
  v_exp_f32 v21, v21
  v_exp_f32 v22, v22
  v_exp_f32 v23, v23
  v_exp_f32 v27, v27
  v_add_f32 v26, v20, v21
  v_add_f32 v24, v22, v23
  v_cvt_pk_bf16_f32 v20, v20, v20
  v_cvt_pk_bf16_f32 v21, v21, v21
  v_cvt_pk_bf16_f32 v22, v22, v22
  v_cvt_pk_bf16_f32 v23, v23, v23
  v_add_f32 v26, v26, v24
  v_fma_f32 v76, v76, v27, v26
  v_mul_f32 v36, v27, v36
  v_mul_f32 v37, v27, v37
  v_mul_f32 v38, v27, v38
  v_mul_f32 v39, v27, v39
  v_mul_f32 v40, v27, v40
  v_mul_f32 v41, v27, v41
  v_mul_f32 v42, v27, v42
  v_mul_f32 v43, v27, v43
  v_and_b32 v28, v20, v68
  v_and_b32 v29, v20, v69
  v_and_b32 v30, v20, v70
  v_and_b32 v31, v20, v71
  v_and_b32 v32, v21, v68
  v_and_b32 v33, v21, v69
  v_and_b32 v34, v21, v70
  v_and_b32 v35, v21, v71
  v_mfma_f32_16x16x32_bf16 v[36:39], a[200:203], v[28:31], v[36:39]
  v_mfma_f32_16x16x32_bf16 v[40:43], a[204:207], v[28:31], v[40:43]
  v_and_b32 v28, v22, v68
  v_and_b32 v29, v22, v69
  v_and_b32 v30, v22, v70
  v_and_b32 v31, v22, v71
  v_mfma_f32_16x16x32_bf16 v[36:39], a[208:211], v[32:35], v[36:39]
  v_mfma_f32_16x16x32_bf16 v[40:43], a[212:215], v[32:35], v[40:43]
  v_and_b32 v32, v23, v68
  v_and_b32 v33, v23, v69
  v_and_b32 v34, v23, v70
  v_and_b32 v35, v23, v71
  v_mfma_f32_16x16x32_bf16 v[36:39], a[216:219], v[28:31], v[36:39]
  v_mfma_f32_16x16x32_bf16 v[40:43], a[220:223], v[28:31], v[40:43]
  v_mfma_f32_16x16x32_bf16 v[36:39], a[224:227], v[32:35], v[36:39]
  v_mfma_f32_16x16x32_bf16 v[40:43], a[228:231], v[32:35], v[40:43]
  v_mfma_f32_16x16x32_bf16 v[20:23], a[232:235], v[4:7], 0
  v_mfma_f32_16x16x32_bf16 v[24:27], a[248:251], v[4:7], 0
  v_mfma_f32_16x16x32_bf16 v[20:23], a[236:239], v[8:11], v[20:23]
  v_mfma_f32_16x16x32_bf16 v[24:27], a[252:255], v[8:11], v[24:27]
  v_mfma_f32_16x16x32_bf16 v[20:23], a[240:243], v[12:15], v[20:23]
  v_mfma_f32_16x16x32_bf16 v[24:27], v[152:155], v[12:15], v[24:27]
  v_mfma_f32_16x16x32_bf16 v[20:23], a[244:247], v[16:19], v[20:23]
  v_mfma_f32_16x16x32_bf16 v[24:27], v[156:159], v[16:19], v[24:27]
  s_nop 7
  v_permlane32_swap_b32 v20, v24
  v_permlane32_swap_b32 v21, v25
  v_permlane32_swap_b32 v22, v26
  v_permlane32_swap_b32 v23, v27
  v_add_f32_dpp v20, v24, v20 row_ror:8 row_mask:0xf bank_mask:0xf
  v_add_f32_dpp v21, v25, v21 row_ror:8 row_mask:0xf bank_mask:0xf
  v_add_f32_dpp v22, v26, v22 row_ror:8 row_mask:0xf bank_mask:0xf
  v_add_f32_dpp v23, v27, v23 row_ror:8 row_mask:0xf bank_mask:0xf
  v_cvt_pk_bf16_f32 v24, v20, v21
  v_cvt_pk_bf16_f32 v25, v22, v23
  v_perm_b32 v20, v24, s35, v72
  v_perm_b32 v21, v24, s35, v73
  v_perm_b32 v22, v25, s35, v72
  v_perm_b32 v23, v25, s35, v73
  v_max3_f32 v26, v20, v21, v22
  v_max3_f32 v26, v26, v23, s36
  s_nop 1
  v_max_f32_dpp v26, v26, v26 row_ror:8 row_mask:0xf bank_mask:0xf
  s_nop 1
  v_max_f32_dpp v26, v26, v26 row_bcast:15 row_mask:0xa bank_mask:0xf
  s_nop 1
  v_max_f32_dpp v26, v26, v26 row_bcast:31 row_mask:0xc bank_mask:0xf
  s_nop 0
  v_readlane_b32 s36, v26, 63
  s_nop 1
  v_mul_f32 v0, s36, v74
  v_fma_f32 v20, v20, s34, v0
  v_fma_f32 v21, v21, s34, v0
  v_fma_f32 v22, v22, s34, v0
  v_fma_f32 v23, v23, s34, v0
  v_sub_f32 v27, v0, v78
  v_exp_f32 v20, v20
  v_exp_f32 v21, v21
  v_exp_f32 v22, v22
  v_exp_f32 v23, v23
  v_exp_f32 v27, v27
  v_add_f32 v26, v20, v21
  v_add_f32 v24, v22, v23
  v_cvt_pk_bf16_f32 v20, v20, v20
  v_cvt_pk_bf16_f32 v21, v21, v21
  v_cvt_pk_bf16_f32 v22, v22, v22
  v_cvt_pk_bf16_f32 v23, v23, v23
  v_add_f32 v26, v26, v24
  v_fma_f32 v76, v76, v27, v26
  v_mul_f32 v36, v27, v36
  v_mul_f32 v37, v27, v37
  v_mul_f32 v38, v27, v38
  v_mul_f32 v39, v27, v39
  v_mul_f32 v40, v27, v40
  v_mul_f32 v41, v27, v41
  v_mul_f32 v42, v27, v42
  v_mul_f32 v43, v27, v43
  v_and_b32 v28, v20, v68
  v_and_b32 v29, v20, v69
  v_and_b32 v30, v20, v70
  v_and_b32 v31, v20, v71
  v_and_b32 v32, v21, v68
  v_and_b32 v33, v21, v69
  v_and_b32 v34, v21, v70
  v_and_b32 v35, v21, v71
  s_waitcnt vmcnt(17)
  v_mfma_f32_16x16x32_bf16 v[36:39], v[160:163], v[28:31], v[36:39]
  v_mfma_f32_16x16x32_bf16 v[40:43], v[164:167], v[28:31], v[40:43]
  v_and_b32 v28, v22, v68
  v_and_b32 v29, v22, v69
  v_and_b32 v30, v22, v70
  v_and_b32 v31, v22, v71
  v_mfma_f32_16x16x32_bf16 v[36:39], v[168:171], v[32:35], v[36:39]
  v_mfma_f32_16x16x32_bf16 v[40:43], v[172:175], v[32:35], v[40:43]
  v_and_b32 v32, v23, v68
  v_and_b32 v33, v23, v69
  v_and_b32 v34, v23, v70
  v_and_b32 v35, v23, v71
  v_mfma_f32_16x16x32_bf16 v[36:39], v[176:179], v[28:31], v[36:39]
  v_mfma_f32_16x16x32_bf16 v[40:43], v[180:183], v[28:31], v[40:43]
  v_mfma_f32_16x16x32_bf16 v[36:39], v[184:187], v[32:35], v[36:39]
  v_mfma_f32_16x16x32_bf16 v[40:43], v[188:191], v[32:35], v[40:43]
  s_waitcnt vmcnt(9)
  v_mfma_f32_16x16x32_bf16 v[20:23], v[192:195], v[4:7], 0
  v_mfma_f32_16x16x32_bf16 v[24:27], v[208:211], v[4:7], 0
  v_mfma_f32_16x16x32_bf16 v[20:23], v[196:199], v[8:11], v[20:23]
  v_mfma_f32_16x16x32_bf16 v[24:27], v[212:215], v[8:11], v[24:27]
  v_mfma_f32_16x16x32_bf16 v[20:23], v[200:203], v[12:15], v[20:23]
  v_mfma_f32_16x16x32_bf16 v[24:27], v[216:219], v[12:15], v[24:27]
  v_mfma_f32_16x16x32_bf16 v[20:23], v[204:207], v[16:19], v[20:23]
  v_mfma_f32_16x16x32_bf16 v[24:27], v[220:223], v[16:19], v[24:27]
  s_nop 7
  v_permlane32_swap_b32 v20, v24
  v_permlane32_swap_b32 v21, v25
  v_permlane32_swap_b32 v22, v26
  v_permlane32_swap_b32 v23, v27
  v_add_f32_dpp v20, v24, v20 row_ror:8 row_mask:0xf bank_mask:0xf
  v_add_f32_dpp v21, v25, v21 row_ror:8 row_mask:0xf bank_mask:0xf
  v_add_f32_dpp v22, v26, v22 row_ror:8 row_mask:0xf bank_mask:0xf
  v_add_f32_dpp v23, v27, v23 row_ror:8 row_mask:0xf bank_mask:0xf
  v_cvt_pk_bf16_f32 v24, v20, v21
  v_cvt_pk_bf16_f32 v25, v22, v23
  v_perm_b32 v20, v24, s35, v72
  v_perm_b32 v21, v24, s35, v73
  v_perm_b32 v22, v25, s35, v72
  v_perm_b32 v23, v25, s35, v73
  v_max3_f32 v26, v20, v21, v22
  v_max3_f32 v26, v26, v23, s36
  s_nop 1
  v_max_f32_dpp v26, v26, v26 row_ror:8 row_mask:0xf bank_mask:0xf
  s_nop 1
  v_max_f32_dpp v26, v26, v26 row_bcast:15 row_mask:0xa bank_mask:0xf
  s_nop 1
  v_max_f32_dpp v26, v26, v26 row_bcast:31 row_mask:0xc bank_mask:0xf
  s_nop 0
  v_readlane_b32 s36, v26, 63
  s_nop 1
  v_mul_f32 v78, s36, v74
  v_fma_f32 v20, v20, s34, v78
  v_fma_f32 v21, v21, s34, v78
  v_fma_f32 v22, v22, s34, v78
  v_fma_f32 v23, v23, s34, v78
  v_sub_f32 v27, v78, v0
  v_exp_f32 v20, v20
  v_exp_f32 v21, v21
  v_exp_f32 v22, v22
  v_exp_f32 v23, v23
  v_exp_f32 v27, v27
  v_add_f32 v26, v20, v21
  v_add_f32 v24, v22, v23
  v_cvt_pk_bf16_f32 v20, v20, v20
  v_cvt_pk_bf16_f32 v21, v21, v21
  v_cvt_pk_bf16_f32 v22, v22, v22
  v_cvt_pk_bf16_f32 v23, v23, v23
  v_add_f32 v26, v26, v24
  v_fma_f32 v76, v76, v27, v26
  v_mul_f32 v36, v27, v36
  v_mul_f32 v37, v27, v37
  v_mul_f32 v38, v27, v38
  v_mul_f32 v39, v27, v39
  v_mul_f32 v40, v27, v40
  v_mul_f32 v41, v27, v41
  v_mul_f32 v42, v27, v42
  v_mul_f32 v43, v27, v43
  v_and_b32 v28, v20, v68
  v_and_b32 v29, v20, v69
  v_and_b32 v30, v20, v70
  v_and_b32 v31, v20, v71
  v_and_b32 v32, v21, v68
  v_and_b32 v33, v21, v69
  v_and_b32 v34, v21, v70
  v_and_b32 v35, v21, v71
  s_waitcnt vmcnt(1)
  v_mfma_f32_16x16x32_bf16 v[36:39], v[224:227], v[28:31], v[36:39]
  v_mfma_f32_16x16x32_bf16 v[40:43], v[228:231], v[28:31], v[40:43]
  v_and_b32 v28, v22, v68
  v_and_b32 v29, v22, v69
  v_and_b32 v30, v22, v70
  v_and_b32 v31, v22, v71
  v_mfma_f32_16x16x32_bf16 v[36:39], v[232:235], v[32:35], v[36:39]
  v_mfma_f32_16x16x32_bf16 v[40:43], v[236:239], v[32:35], v[40:43]
  v_and_b32 v32, v23, v68
  v_and_b32 v33, v23, v69
  v_and_b32 v34, v23, v70
  v_and_b32 v35, v23, v71
  v_mfma_f32_16x16x32_bf16 v[36:39], v[240:243], v[28:31], v[36:39]
  v_mfma_f32_16x16x32_bf16 v[40:43], v[244:247], v[28:31], v[40:43]
  v_mfma_f32_16x16x32_bf16 v[36:39], v[248:251], v[32:35], v[36:39]
  v_mfma_f32_16x16x32_bf16 v[40:43], v[252:255], v[32:35], v[40:43]
  s_waitcnt vmcnt(0)
DL_5:
  s_waitcnt vmcnt(9)
  v_mfma_f32_16x16x32_bf16 v[20:23], v[84:87], v[4:7], 0
  v_mfma_f32_16x16x32_bf16 v[24:27], v[100:103], v[4:7], 0
  v_mfma_f32_16x16x32_bf16 v[20:23], v[88:91], v[8:11], v[20:23]
  v_mfma_f32_16x16x32_bf16 v[24:27], v[104:107], v[8:11], v[24:27]
  v_mfma_f32_16x16x32_bf16 v[20:23], v[92:95], v[12:15], v[20:23]
  v_mfma_f32_16x16x32_bf16 v[24:27], v[108:111], v[12:15], v[24:27]
  v_mfma_f32_16x16x32_bf16 v[20:23], v[96:99], v[16:19], v[20:23]
  v_mfma_f32_16x16x32_bf16 v[24:27], v[112:115], v[16:19], v[24:27]
  s_waitcnt vmcnt(8)
  v_readfirstlane_b32 s15, v80
  s_nop 1
  s_add_u32 s15, s15, 504
  s_cmp_ge_u32 s15, 1008
  s_cbranch_scc1 DF_6
  s_lshl_b32 s15, s15, 13
  s_add_u32 s15, s15, s12
  buffer_load_dwordx4 v[84:87], v1, s[4:7], s15 offen nt
  buffer_load_dwordx4 v[88:91], v1, s[4:7], s15 offen offset:128 nt
  buffer_load_dwordx4 v[92:95], v1, s[4:7], s15 offen offset:256 nt
  buffer_load_dwordx4 v[96:99], v1, s[4:7], s15 offen offset:384 nt
  buffer_load_dwordx4 v[100:103], v2, s[4:7], s15 offen nt
  buffer_load_dwordx4 v[104:107], v2, s[4:7], s15 offen offset:128 nt
  buffer_load_dwordx4 v[108:111], v2, s[4:7], s15 offen offset:256 nt
  buffer_load_dwordx4 v[112:115], v2, s[4:7], s15 offen offset:384 nt
  s_add_u32 s47, s14, 0
  v_mov_b32 v80, 1
  s_mov_b64 exec, 1
  buffer_atomic_add v80, off, s[20:23], s47 sc0
  s_mov_b64 exec, -1
  v_permlane32_swap_b32 v20, v24
  v_permlane32_swap_b32 v21, v25
  v_permlane32_swap_b32 v22, v26
  v_permlane32_swap_b32 v23, v27
  v_add_f32_dpp v20, v24, v20 row_ror:8 row_mask:0xf bank_mask:0xf
  v_add_f32_dpp v21, v25, v21 row_ror:8 row_mask:0xf bank_mask:0xf
  v_add_f32_dpp v22, v26, v22 row_ror:8 row_mask:0xf bank_mask:0xf
  v_add_f32_dpp v23, v27, v23 row_ror:8 row_mask:0xf bank_mask:0xf
  v_cvt_pk_bf16_f32 v24, v20, v21
  v_cvt_pk_bf16_f32 v25, v22, v23
  v_perm_b32 v20, v24, s35, v72
  v_perm_b32 v21, v24, s35, v73
  v_perm_b32 v22, v25, s35, v72
  v_perm_b32 v23, v25, s35, v73
  v_max3_f32 v26, v20, v21, v22
  v_max3_f32 v26, v26, v23, s36
  s_nop 1
  v_max_f32_dpp v26, v26, v26 row_ror:8 row_mask:0xf bank_mask:0xf
  s_nop 1
  v_max_f32_dpp v26, v26, v26 row_bcast:15 row_mask:0xa bank_mask:0xf
  s_nop 1
  v_max_f32_dpp v26, v26, v26 row_bcast:31 row_mask:0xc bank_mask:0xf
  s_nop 0
  v_readlane_b32 s36, v26, 63
  s_nop 1
  v_mul_f32 v0, s36, v74
  v_fma_f32 v20, v20, s34, v0
  v_fma_f32 v21, v21, s34, v0
  v_fma_f32 v22, v22, s34, v0
  v_fma_f32 v23, v23, s34, v0
  v_sub_f32 v27, v0, v78
  v_exp_f32 v20, v20
  v_exp_f32 v21, v21
  v_exp_f32 v22, v22
  v_exp_f32 v23, v23
  v_exp_f32 v27, v27
  v_mov_b32 v78, v0
  v_add_f32 v26, v20, v21
  v_add_f32 v24, v22, v23
  v_cvt_pk_bf16_f32 v20, v20, v20
  v_cvt_pk_bf16_f32 v21, v21, v21
  v_cvt_pk_bf16_f32 v22, v22, v22
  v_cvt_pk_bf16_f32 v23, v23, v23
  v_add_f32 v26, v26, v24
  v_fma_f32 v76, v76, v27, v26
  v_mul_f32 v36, v27, v36
  v_mul_f32 v37, v27, v37
  v_mul_f32 v38, v27, v38
  v_mul_f32 v39, v27, v39
  v_mul_f32 v40, v27, v40
  v_mul_f32 v41, v27, v41
  v_mul_f32 v42, v27, v42
  v_mul_f32 v43, v27, v43
  v_and_b32 v28, v20, v68
  v_and_b32 v29, v20, v69
  v_and_b32 v30, v20, v70
  v_and_b32 v31, v20, v71
  v_and_b32 v32, v21, v68
  v_and_b32 v33, v21, v69
  v_and_b32 v34, v21, v70
  v_and_b32 v35, v21, v71
  s_waitcnt vmcnt(9)
  v_mfma_f32_16x16x32_bf16 v[36:39], v[116:119], v[28:31], v[36:39]
  v_mfma_f32_16x16x32_bf16 v[40:43], v[120:123], v[28:31], v[40:43]
  v_and_b32 v28, v22, v68
  v_and_b32 v29, v22, v69
  v_and_b32 v30, v22, v70
  v_and_b32 v31, v22, v71
  v_mfma_f32_16x16x32_bf16 v[36:39], v[124:127], v[32:35], v[36:39]
  v_mfma_f32_16x16x32_bf16 v[40:43], v[128:131], v[32:35], v[40:43]
  v_and_b32 v32, v23, v68
  v_and_b32 v33, v23, v69
  v_and_b32 v34, v23, v70
  v_and_b32 v35, v23, v71
  v_mfma_f32_16x16x32_bf16 v[36:39], v[132:135], v[28:31], v[36:39]
  v_mfma_f32_16x16x32_bf16 v[40:43], v[136:139], v[28:31], v[40:43]
  v_mfma_f32_16x16x32_bf16 v[36:39], v[140:143], v[32:35], v[36:39]
  v_mfma_f32_16x16x32_bf16 v[40:43], v[144:147], v[32:35], v[40:43]
  buffer_load_dwordx4 v[116:119], v3, s[8:11], s15 offen nt
  buffer_load_dwordx4 v[120:123], v3, s[8:11], s15 offen offset:256 nt
  buffer_load_dwordx4 v[124:127], v3, s[8:11], s15 offen offset:512 nt
  buffer_load_dwordx4 v[128:131], v3, s[8:11], s15 offen offset:768 nt
  buffer_load_dwordx4 v[132:135], v3, s[8:11], s15 offen offset:1024 nt
  buffer_load_dwordx4 v[136:139], v3, s[8:11], s15 offen offset:1280 nt
  buffer_load_dwordx4 v[140:143], v3, s[8:11], s15 offen offset:1536 nt
  buffer_load_dwordx4 v[144:147], v3, s[8:11], s15 offen offset:1792 nt
  s_branch DL_5
DF_6:
  s_add_u32 s47, s45, 16384
  v_subrev_u32 v28, s32, v75
  buffer_load_dwordx4 v[148:151], v28, s[20:23], s47 offen sc1
  s_add_u32 s30, s29, 3670016
  buffer_load_dwordx4 v[84:87], v1, s[4:7], s30 offen nt
  buffer_load_dwordx4 v[88:91], v1, s[4:7], s30 offen offset:128 nt
  buffer_load_dwordx4 v[92:95], v1, s[4:7], s30 offen offset:256 nt
  buffer_load_dwordx4 v[96:99], v1, s[4:7], s30 offen offset:384 nt
  buffer_load_dwordx4 v[100:103], v2, s[4:7], s30 offen nt
  buffer_load_dwordx4 v[104:107], v2, s[4:7], s30 offen offset:128 nt
  buffer_load_dwordx4 v[108:111], v2, s[4:7], s30 offen offset:256 nt
  buffer_load_dwordx4 v[112:115], v2, s[4:7], s30 offen offset:384 nt
  s_add_u32 s47, s14, 4096
  v_mov_b32 v80, 1
  s_mov_b64 exec, 1
  buffer_atomic_add v80, off, s[20:23], s47 sc0
  s_mov_b64 exec, -1
  v_permlane32_swap_b32 v20, v24
  v_permlane32_swap_b32 v21, v25
  v_permlane32_swap_b32 v22, v26
  v_permlane32_swap_b32 v23, v27
  v_add_f32_dpp v20, v24, v20 row_ror:8 row_mask:0xf bank_mask:0xf
  v_add_f32_dpp v21, v25, v21 row_ror:8 row_mask:0xf bank_mask:0xf
  v_add_f32_dpp v22, v26, v22 row_ror:8 row_mask:0xf bank_mask:0xf
  v_add_f32_dpp v23, v27, v23 row_ror:8 row_mask:0xf bank_mask:0xf
  v_cvt_pk_bf16_f32 v24, v20, v21
  v_cvt_pk_bf16_f32 v25, v22, v23
  v_perm_b32 v20, v24, s35, v72
  v_perm_b32 v21, v24, s35, v73
  v_perm_b32 v22, v25, s35, v72
  v_perm_b32 v23, v25, s35, v73
  v_max3_f32 v26, v20, v21, v22
  v_max3_f32 v26, v26, v23, s36
  s_nop 1
  v_max_f32_dpp v26, v26, v26 row_ror:8 row_mask:0xf bank_mask:0xf
  s_nop 1
  v_max_f32_dpp v26, v26, v26 row_bcast:15 row_mask:0xa bank_mask:0xf
  s_nop 1
  v_max_f32_dpp v26, v26, v26 row_bcast:31 row_mask:0xc bank_mask:0xf
  s_nop 0
  v_readlane_b32 s36, v26, 63
  s_nop 1
  v_mul_f32 v0, s36, v74
  v_fma_f32 v20, v20, s34, v0
  v_fma_f32 v21, v21, s34, v0
  v_fma_f32 v22, v22, s34, v0
  v_fma_f32 v23, v23, s34, v0
  v_sub_f32 v27, v0, v78
  v_exp_f32 v20, v20
  v_exp_f32 v21, v21
  v_exp_f32 v22, v22
  v_exp_f32 v23, v23
  v_exp_f32 v27, v27
  v_add_f32 v26, v20, v21
  v_add_f32 v24, v22, v23
  v_cvt_pk_bf16_f32 v20, v20, v20
  v_cvt_pk_bf16_f32 v21, v21, v21
  v_cvt_pk_bf16_f32 v22, v22, v22
  v_cvt_pk_bf16_f32 v23, v23, v23
  v_add_f32 v26, v26, v24
  v_fma_f32 v76, v76, v27, v26
  v_mul_f32 v36, v27, v36
  v_mul_f32 v37, v27, v37
  v_mul_f32 v38, v27, v38
  v_mul_f32 v39, v27, v39
  v_mul_f32 v40, v27, v40
  v_mul_f32 v41, v27, v41
  v_mul_f32 v42, v27, v42
  v_mul_f32 v43, v27, v43
  v_and_b32 v28, v20, v68
  v_and_b32 v29, v20, v69
  v_and_b32 v30, v20, v70
  v_and_b32 v31, v20, v71
  v_and_b32 v32, v21, v68
  v_and_b32 v33, v21, v69
  v_and_b32 v34, v21, v70
  v_and_b32 v35, v21, v71
  s_waitcnt vmcnt(10)
  v_mfma_f32_16x16x32_bf16 v[36:39], v[116:119], v[28:31], v[36:39]
  v_mfma_f32_16x16x32_bf16 v[40:43], v[120:123], v[28:31], v[40:43]
  v_and_b32 v28, v22, v68
  v_and_b32 v29, v22, v69
  v_and_b32 v30, v22, v70
  v_and_b32 v31, v22, v71
  v_mfma_f32_16x16x32_bf16 v[36:39], v[124:127], v[32:35], v[36:39]
  v_mfma_f32_16x16x32_bf16 v[40:43], v[128:131], v[32:35], v[40:43]
  v_and_b32 v32, v23, v68
  v_and_b32 v33, v23, v69
  v_and_b32 v34, v23, v70
  v_and_b32 v35, v23, v71
  v_mfma_f32_16x16x32_bf16 v[36:39], v[132:135], v[28:31], v[36:39]
  v_mfma_f32_16x16x32_bf16 v[40:43], v[136:139], v[28:31], v[40:43]
  v_mfma_f32_16x16x32_bf16 v[36:39], v[140:143], v[32:35], v[36:39]
  v_mfma_f32_16x16x32_bf16 v[40:43], v[144:147], v[32:35], v[40:43]
  s_add_u32 s31, s29, 3670016
  buffer_load_dwordx4 v[116:119], v3, s[8:11], s31 offen nt
  buffer_load_dwordx4 v[120:123], v3, s[8:11], s31 offen offset:256 nt
  buffer_load_dwordx4 v[124:127], v3, s[8:11], s31 offen offset:512 nt
  buffer_load_dwordx4 v[128:131], v3, s[8:11], s31 offen offset:768 nt
  buffer_load_dwordx4 v[132:135], v3, s[8:11], s31 offen offset:1024 nt
  buffer_load_dwordx4 v[136:139], v3, s[8:11], s31 offen offset:1280 nt
  buffer_load_dwordx4 v[140:143], v3, s[8:11], s31 offen offset:1536 nt
  buffer_load_dwordx4 v[144:147], v3, s[8:11], s31 offen offset:1792 nt
  v_subrev_u32 v27, s32, v75
  v_cndmask_b32 v28, v36, v40, s[40:41]
  v_cndmask_b32 v32, v40, v36, s[40:41]
  v_cndmask_b32 v29, v37, v41, s[40:41]
  v_cndmask_b32 v33, v41, v37, s[40:41]
  v_cndmask_b32 v30, v38, v42, s[40:41]
  v_cndmask_b32 v34, v42, v38, s[40:41]
  v_cndmask_b32 v31, v39, v43, s[40:41]
  v_cndmask_b32 v35, v43, v39, s[40:41]
  v_add_f32_dpp v76, v76, v76 row_ror:8 row_mask:0xf bank_mask:0xf
  v_add_f32_dpp v28, v32, v28 row_ror:8 row_mask:0xf bank_mask:0xf
  v_add_f32_dpp v29, v33, v29 row_ror:8 row_mask:0xf bank_mask:0xf
  v_add_f32_dpp v30, v34, v30 row_ror:8 row_mask:0xf bank_mask:0xf
  v_add_f32_dpp v31, v35, v31 row_ror:8 row_mask:0xf bank_mask:0xf
  v_mov_b32 v24, v76
  s_nop 1
  v_permlane16_swap_b32 v76, v24
  v_add_f32 v76, v76, v24
  v_mov_b32 v24, v76
  s_nop 1
  v_permlane32_swap_b32 v76, v24
  v_add_f32 v25, v76, v24
  v_sub_f32 v24, 0, v0
  s_lshl_b32 s47, s42, 10
  v_add_u32 v32, s47, v27
  ds_write_b128 v32, v[28:31] offset:2048
  s_lshl_b32 s47, s42, 3
  v_mov_b32 v33, s47
  ds_write_b64 v33, v[24:25] offset:1024
  v_mov_b32 v34, 1088
  v_mov_b32 v35, 1
  s_waitcnt lgkmcnt(0)
  s_mov_b64 exec, 1
  ds_add_rtn_u32 v33, v34, v35
  s_waitcnt lgkmcnt(0)
  v_readfirstlane_b32 s47, v33
  s_mov_b64 exec, -1
  s_nop 0
  s_cmp_eq_u32 s47, 3
  s_cbranch_scc0 PS_7
  ds_read_b128 v[52:55], v27 offset:2048
  ds_read_b128 v[56:59], v27 offset:3072
  ds_read_b128 v[60:63], v27 offset:4096
  ds_read_b128 v[64:67], v27 offset:5120
  v_mov_b32 v32, 0
  ds_read_b128 v[20:23], v32 offset:1024
  ds_read_b128 v[28:31], v32 offset:1040
  v_and_b32 v32, 0x70, v27
  v_lshlrev_b32 v32, 1, v32
  v_and_b32 v33, 0x80, v27
  v_lshl_or_b32 v32, v33, 3, v32
  v_and_b32 v33, 0x300, v27
  v_or_b32 v32, v32, v33
  s_add_u32 s47, s46, 0
  s_waitcnt lgkmcnt(0)
  s_mov_b64 exec, 1
  ds_add_u32 v34, v35
  s_mov_b64 exec, -1
  v_max3_f32 v25, v20, v22, v28
  v_max_f32 v25, v25, v30
  v_sub_f32 v20, v20, v25
  v_sub_f32 v22, v22, v25
  v_sub_f32 v28, v28, v25
  v_sub_f32 v30, v30, v25
  v_exp_f32 v20, v20
  v_exp_f32 v22, v22
  v_exp_f32 v28, v28
  v_exp_f32 v30, v30
  v_mov_b32 v27, s33
  v_mul_f32 v26, v20, v21
  v_fmac_f32 v26, v22, v23
  v_fmac_f32 v26, v28, v29
  v_fmac_f32 v26, v30, v31
  v_mul_f32 v52, v20, v52
  v_mul_f32 v53, v20, v53
  v_mul_f32 v54, v20, v54
  v_mul_f32 v55, v20, v55
  v_fmac_f32 v52, v22, v56
  v_fmac_f32 v53, v22, v57
  v_fmac_f32 v54, v22, v58
  v_fmac_f32 v55, v22, v59
  v_fmac_f32 v52, v28, v60
  v_fmac_f32 v53, v28, v61
  v_fmac_f32 v54, v28, v62
  v_fmac_f32 v55, v28, v63
  v_fmac_f32 v52, v30, v64
  v_fmac_f32 v53, v30, v65
  v_fmac_f32 v54, v30, v66
  v_fmac_f32 v55, v30, v67
  v_mov_b32 v24, v55
  v_mov_b32 v55, s33
  buffer_store_dwordx4 v[52:55], v32, s[20:23], s47 offen sc1
  buffer_store_dwordx4 v[24:27], v32, s[20:23], s47 offen offset:16 sc1
  s_waitcnt lgkmcnt(0)
PS_7:
  s_nop 1
  s_waitcnt vmcnt(17)
  v_mov_b32 v20, v148
  v_mov_b32 v21, v149
  v_mov_b32 v22, v150
  v_mov_b32 v23, v151
  s_mov_b32 s51, 0
  s_branch QC_9
QR_8:
  s_add_u32 s47, s45, 16384
  v_subrev_u32 v20, s32, v75
  buffer_load_dwordx4 v[20:23], v20, s[20:23], s47 offen sc1
  s_waitcnt vmcnt(0)
QC_9:
  v_cmp_eq_u32 s[48:49], s33, v21
  v_cmp_eq_u32 s[54:55], s33, v23
  s_nop 1
  s_and_b64 s[48:49], s[48:49], s[54:55]
  s_cmp_eq_u64 s[48:49], -1
  s_cbranch_scc1 QO_10
  s_add_u32 s51, s51, 1
  s_cmp_gt_u32 s51, 40000
  s_cbranch_scc1 QO_10
  s_sleep 8
  s_branch QR_8
QO_10:
  v_subrev_u32 v28, s32, v75
  v_lshrrev_b32 v28, 1, v28
  ds_write2_b32 v28, v20, v22 offset0:128 offset1:129
  s_waitcnt lgkmcnt(0)
  v_and_b32 v28, 0x70, v1
  ds_read_b128 v[4:7], v28 offset:512
  ds_read_b128 v[8:11], v28 offset:640
  ds_read_b128 v[12:15], v28 offset:768
  ds_read_b128 v[16:19], v28 offset:896
  s_waitcnt lgkmcnt(0)
  v_mov_b32 v44, 0
  v_mov_b32 v45, 0
  v_mov_b32 v46, 0
  v_mov_b32 v47, 0
  v_mov_b32 v48, 0
  v_mov_b32 v49, 0
  v_mov_b32 v50, 0
  v_mov_b32 v51, 0
  v_mov_b32 v77, 0
  s_mov_b32 s37, s35
  v_mul_f32 v79, s35, v74
DL_11:
  s_waitcnt vmcnt(9)
  v_mfma_f32_16x16x32_bf16 v[20:23], v[84:87], v[4:7], 0
  v_mfma_f32_16x16x32_bf16 v[24:27], v[100:103], v[4:7], 0
  v_mfma_f32_16x16x32_bf16 v[20:23], v[88:91], v[8:11], v[20:23]
  v_mfma_f32_16x16x32_bf16 v[24:27], v[104:107], v[8:11], v[24:27]
  v_mfma_f32_16x16x32_bf16 v[20:23], v[92:95], v[12:15], v[20:23]
  v_mfma_f32_16x16x32_bf16 v[24:27], v[108:111], v[12:15], v[24:27]
  v_mfma_f32_16x16x32_bf16 v[20:23], v[96:99], v[16:19], v[20:23]
  v_mfma_f32_16x16x32_bf16 v[24:27], v[112:115], v[16:19], v[24:27]
  s_waitcnt vmcnt(8)
  v_readfirstlane_b32 s15, v80
  s_nop 1
  s_add_u32 s15, s15, 504
  s_cmp_ge_u32 s15, 1008
  s_cbranch_scc1 DF_12
  s_lshl_b32 s15, s15, 13
  s_add_u32 s15, s15, s13
  buffer_load_dwordx4 v[84:87], v1, s[4:7], s15 offen nt
  buffer_load_dwordx4 v[88:91], v1, s[4:7], s15 offen offset:128 nt
  buffer_load_dwordx4 v[92:95], v1, s[4:7], s15 offen offset:256 nt
  buffer_load_dwordx4 v[96:99], v1, s[4:7], s15 offen offset:384 nt
  buffer_load_dwordx4 v[100:103], v2, s[4:7], s15 offen nt
  buffer_load_dwordx4 v[104:107], v2, s[4:7], s15 offen offset:128 nt
  buffer_load_dwordx4 v[108:111], v2, s[4:7], s15 offen offset:256 nt
  buffer_load_dwordx4 v[112:115], v2, s[4:7], s15 offen offset:384 nt
  s_add_u32 s47, s14, 4096
  v_mov_b32 v80, 1
  s_mov_b64 exec, 1
  buffer_atomic_add v80, off, s[20:23], s47 sc0
  s_mov_b64 exec, -1
  v_permlane32_swap_b32 v20, v24
  v_permlane32_swap_b32 v21, v25
  v_permlane32_swap_b32 v22, v26
  v_permlane32_swap_b32 v23, v27
  v_add_f32_dpp v20, v24, v20 row_ror:8 row_mask:0xf bank_mask:0xf
  v_add_f32_dpp v21, v25, v21 row_ror:8 row_mask:0xf bank_mask:0xf
  v_add_f32_dpp v22, v26, v22 row_ror:8 row_mask:0xf bank_mask:0xf
  v_add_f32_dpp v23, v27, v23 row_ror:8 row_mask:0xf bank_mask:0xf
  v_cvt_pk_bf16_f32 v24, v20, v21
  v_cvt_pk_bf16_f32 v25, v22, v23
  v_perm_b32 v20, v24, s35, v72
  v_perm_b32 v21, v24, s35, v73
  v_perm_b32 v22, v25, s35, v72
  v_perm_b32 v23, v25, s35, v73
  v_max3_f32 v26, v20, v21, v22
  v_max3_f32 v26, v26, v23, s37
  s_nop 1
  v_max_f32_dpp v26, v26, v26 row_ror:8 row_mask:0xf bank_mask:0xf
  s_nop 1
  v_max_f32_dpp v26, v26, v26 row_bcast:15 row_mask:0xa bank_mask:0xf
  s_nop 1
  v_max_f32_dpp v26, v26, v26 row_bcast:31 row_mask:0xc bank_mask:0xf
  s_nop 0
  v_readlane_b32 s37, v26, 63
  s_nop 1
  v_mul_f32 v78, s37, v74
  v_fma_f32 v20, v20, s34, v78
  v_fma_f32 v21, v21, s34, v78
  v_fma_f32 v22, v22, s34, v78
  v_fma_f32 v23, v23, s34, v78
  v_sub_f32 v27, v78, v79
  v_exp_f32 v20, v20
  v_exp_f32 v21, v21
  v_exp_f32 v22, v22
  v_exp_f32 v23, v23
  v_exp_f32 v27, v27
  v_mov_b32 v79, v78
  v_add_f32 v26, v20, v21
  v_add_f32 v24, v22, v23
  v_cvt_pk_bf16_f32 v20, v20, v20
  v_cvt_pk_bf16_f32 v21, v21, v21
  v_cvt_pk_bf16_f32 v22, v22, v22
  v_cvt_pk_bf16_f32 v23, v23, v23
  v_add_f32 v26, v26, v24
  v_fma_f32 v77, v77, v27, v26
  v_mul_f32 v44, v27, v44
  v_mul_f32 v45, v27, v45
  v_mul_f32 v46, v27, v46
  v_mul_f32 v47, v27, v47
  v_mul_f32 v48, v27, v48
  v_mul_f32 v49, v27, v49
  v_mul_f32 v50, v27, v50
  v_mul_f32 v51, v27, v51
  v_and_b32 v28, v20, v68
  v_and_b32 v29, v20, v69
  v_and_b32 v30, v20, v70
  v_and_b32 v31, v20, v71
  v_and_b32 v32, v21, v68
  v_and_b32 v33, v21, v69
  v_and_b32 v34, v21, v70
  v_and_b32 v35, v21, v71
  s_waitcnt vmcnt(9)
  v_mfma_f32_16x16x32_bf16 v[44:47], v[116:119], v[28:31], v[44:47]
  v_mfma_f32_16x16x32_bf16 v[48:51], v[120:123], v[28:31], v[48:51]
  v_and_b32 v28, v22, v68
  v_and_b32 v29, v22, v69
  v_and_b32 v30, v22, v70
  v_and_b32 v31, v22, v71
  v_mfma_f32_16x16x32_bf16 v[44:47], v[124:127], v[32:35], v[44:47]
  v_mfma_f32_16x16x32_bf16 v[48:51], v[128:131], v[32:35], v[48:51]
  v_and_b32 v32, v23, v68
  v_and_b32 v33, v23, v69
  v_and_b32 v34, v23, v70
  v_and_b32 v35, v23, v71
  v_mfma_f32_16x16x32_bf16 v[44:47], v[132:135], v[28:31], v[44:47]
  v_mfma_f32_16x16x32_bf16 v[48:51], v[136:139], v[28:31], v[48:51]
  v_mfma_f32_16x16x32_bf16 v[44:47], v[140:143], v[32:35], v[44:47]
  v_mfma_f32_16x16x32_bf16 v[48:51], v[144:147], v[32:35], v[48:51]
  buffer_load_dwordx4 v[116:119], v3, s[8:11], s15 offen nt
  buffer_load_dwordx4 v[120:123], v3, s[8:11], s15 offen offset:256 nt
  buffer_load_dwordx4 v[124:127], v3, s[8:11], s15 offen offset:512 nt
  buffer_load_dwordx4 v[128:131], v3, s[8:11], s15 offen offset:768 nt
  buffer_load_dwordx4 v[132:135], v3, s[8:11], s15 offen offset:1024 nt
  buffer_load_dwordx4 v[136:139], v3, s[8:11], s15 offen offset:1280 nt
  buffer_load_dwordx4 v[140:143], v3, s[8:11], s15 offen offset:1536 nt
  buffer_load_dwordx4 v[144:147], v3, s[8:11], s15 offen offset:1792 nt
  s_branch DL_11
DF_12:
  s_add_u32 s47, s45, 32768
  v_subrev_u32 v28, s32, v75
  buffer_load_dwordx4 v[148:151], v28, s[20:23], s47 offen sc1
  s_add_u32 s30, s28, 3670016
  buffer_load_dwordx4 v[84:87], v1, s[4:7], s30 offen nt
  buffer_load_dwordx4 v[88:91], v1, s[4:7], s30 offen offset:128 nt
  buffer_load_dwordx4 v[92:95], v1, s[4:7], s30 offen offset:256 nt
  buffer_load_dwordx4 v[96:99], v1, s[4:7], s30 offen offset:384 nt
  buffer_load_dwordx4 v[100:103], v2, s[4:7], s30 offen nt
  buffer_load_dwordx4 v[104:107], v2, s[4:7], s30 offen offset:128 nt
  buffer_load_dwordx4 v[108:111], v2, s[4:7], s30 offen offset:256 nt
  buffer_load_dwordx4 v[112:115], v2, s[4:7], s30 offen offset:384 nt
  v_permlane32_swap_b32 v20, v24
  v_permlane32_swap_b32 v21, v25
  v_permlane32_swap_b32 v22, v26
  v_permlane32_swap_b32 v23, v27
  v_add_f32_dpp v20, v24, v20 row_ror:8 row_mask:0xf bank_mask:0xf
  v_add_f32_dpp v21, v25, v21 row_ror:8 row_mask:0xf bank_mask:0xf
  v_add_f32_dpp v22, v26, v22 row_ror:8 row_mask:0xf bank_mask:0xf
  v_add_f32_dpp v23, v27, v23 row_ror:8 row_mask:0xf bank_mask:0xf
  v_cvt_pk_bf16_f32 v24, v20, v21
  v_cvt_pk_bf16_f32 v25, v22, v23
  v_perm_b32 v20, v24, s35, v72
  v_perm_b32 v21, v24, s35, v73
  v_perm_b32 v22, v25, s35, v72
  v_perm_b32 v23, v25, s35, v73
  v_max3_f32 v26, v20, v21, v22
  v_max3_f32 v26, v26, v23, s37
  s_nop 1
  v_max_f32_dpp v26, v26, v26 row_ror:8 row_mask:0xf bank_mask:0xf
  s_nop 1
  v_max_f32_dpp v26, v26, v26 row_bcast:15 row_mask:0xa bank_mask:0xf
  s_nop 1
  v_max_f32_dpp v26, v26, v26 row_bcast:31 row_mask:0xc bank_mask:0xf
  s_nop 0
  v_readlane_b32 s37, v26, 63
  s_nop 1
  v_mul_f32 v78, s37, v74
  v_fma_f32 v20, v20, s34, v78
  v_fma_f32 v21, v21, s34, v78
  v_fma_f32 v22, v22, s34, v78
  v_fma_f32 v23, v23, s34, v78
  v_sub_f32 v27, v78, v79
  v_exp_f32 v20, v20
  v_exp_f32 v21, v21
  v_exp_f32 v22, v22
  v_exp_f32 v23, v23
  v_exp_f32 v27, v27
  v_add_f32 v26, v20, v21
  v_add_f32 v24, v22, v23
  v_cvt_pk_bf16_f32 v20, v20, v20
  v_cvt_pk_bf16_f32 v21, v21, v21
  v_cvt_pk_bf16_f32 v22, v22, v22
  v_cvt_pk_bf16_f32 v23, v23, v23
  v_add_f32 v26, v26, v24
  v_fma_f32 v77, v77, v27, v26
  v_mul_f32 v44, v27, v44
  v_mul_f32 v45, v27, v45
  v_mul_f32 v46, v27, v46
  v_mul_f32 v47, v27, v47
  v_mul_f32 v48, v27, v48
  v_mul_f32 v49, v27, v49
  v_mul_f32 v50, v27, v50
  v_mul_f32 v51, v27, v51
  v_and_b32 v28, v20, v68
  v_and_b32 v29, v20, v69
  v_and_b32 v30, v20, v70
  v_and_b32 v31, v20, v71
  v_and_b32 v32, v21, v68
  v_and_b32 v33, v21, v69
  v_and_b32 v34, v21, v70
  v_and_b32 v35, v21, v71
  s_waitcnt vmcnt(9)
  v_mfma_f32_16x16x32_bf16 v[44:47], v[116:119], v[28:31], v[44:47]
  v_mfma_f32_16x16x32_bf16 v[48:51], v[120:123], v[28:31], v[48:51]
  v_and_b32 v28, v22, v68
  v_and_b32 v29, v22, v69
  v_and_b32 v30, v22, v70
  v_and_b32 v31, v22, v71
  v_mfma_f32_16x16x32_bf16 v[44:47], v[124:127], v[32:35], v[44:47]
  v_mfma_f32_16x16x32_bf16 v[48:51], v[128:131], v[32:35], v[48:51]
  v_and_b32 v32, v23, v68
  v_and_b32 v33, v23, v69
  v_and_b32 v34, v23, v70
  v_and_b32 v35, v23, v71
  v_mfma_f32_16x16x32_bf16 v[44:47], v[132:135], v[28:31], v[44:47]
  v_mfma_f32_16x16x32_bf16 v[48:51], v[136:139], v[28:31], v[48:51]
  v_mfma_f32_16x16x32_bf16 v[44:47], v[140:143], v[32:35], v[44:47]
  v_mfma_f32_16x16x32_bf16 v[48:51], v[144:147], v[32:35], v[48:51]
  s_add_u32 s31, s28, 3670016
  buffer_load_dwordx4 v[116:119], v3, s[8:11], s31 offen nt
  buffer_load_dwordx4 v[120:123], v3, s[8:11], s31 offen offset:256 nt
  buffer_load_dwordx4 v[124:127], v3, s[8:11], s31 offen offset:512 nt
  buffer_load_dwordx4 v[128:131], v3, s[8:11], s31 offen offset:768 nt
  buffer_load_dwordx4 v[132:135], v3, s[8:11], s31 offen offset:1024 nt
  buffer_load_dwordx4 v[136:139], v3, s[8:11], s31 offen offset:1280 nt
  buffer_load_dwordx4 v[140:143], v3, s[8:11], s31 offen offset:1536 nt
  buffer_load_dwordx4 v[144:147], v3, s[8:11], s31 offen offset:1792 nt
  s_waitcnt vmcnt(16)
  v_mov_b32 v20, v148
  v_mov_b32 v21, v149
  v_mov_b32 v22, v150
  v_mov_b32 v23, v151
  s_mov_b32 s51, 0
  s_branch QC_14
QR_13:
  s_add_u32 s47, s45, 32768
  v_subrev_u32 v20, s32, v75
  buffer_load_dwordx4 v[20:23], v20, s[20:23], s47 offen sc1
  s_waitcnt vmcnt(0)
QC_14:
  v_cmp_eq_u32 s[48:49], s33, v21
  v_cmp_eq_u32 s[54:55], s33, v23
  s_nop 1
  s_and_b64 s[48:49], s[48:49], s[54:55]
  s_cmp_eq_u64 s[48:49], -1
  s_cbranch_scc1 QO_15
  s_add_u32 s51, s51, 1
  s_cmp_gt_u32 s51, 40000
  s_cbranch_scc1 QO_15
  s_sleep 8
  s_branch QR_13
QO_15:
  v_subrev_u32 v28, s32, v75
  v_lshrrev_b32 v28, 1, v28
  ds_write2_b32 v28, v20, v22 offset0:0 offset1:1
  s_waitcnt lgkmcnt(0)
  v_and_b32 v28, 0x70, v1
  ds_read_b128 v[4:7], v28 offset:0
  ds_read_b128 v[8:11], v28 offset:128
  ds_read_b128 v[12:15], v28 offset:256
  ds_read_b128 v[16:19], v28 offset:384
  s_waitcnt lgkmcnt(0)
  s_add_u32 s30, s29, 0
  buffer_load_dwordx4 v[148:151], v1, s[4:7], s30 offen nt
  ds_read_b128 v[52:55], v75 offset:0
  ds_read_b128 v[56:59], v75 offset:4096
  ds_read_b128 v[60:63], v75 offset:1024
  ds_read_b128 v[64:67], v75 offset:5120
  s_waitcnt lgkmcnt(3)
  v_mfma_f32_16x16x32_bf16 v[20:23], v[52:55], v[4:7], 0
  ds_read_b128 v[52:55], v75 offset:2048
  s_waitcnt lgkmcnt(3)
  v_mfma_f32_16x16x32_bf16 v[24:27], v[56:59], v[4:7], 0
  ds_read_b128 v[56:59], v75 offset:6144
  s_waitcnt lgkmcnt(3)
  v_mfma_f32_16x16x32_bf16 v[20:23], v[60:63], v[8:11], v[20:23]
  ds_read_b128 v[60:63], v75 offset:3072
  s_waitcnt lgkmcnt(3)
  v_mfma_f32_16x16x32_bf16 v[24:27], v[64:67], v[8:11], v[24:27]
  ds_read_b128 v[64:67], v75 offset:7168
  s_waitcnt lgkmcnt(3)
  v_mfma_f32_16x16x32_bf16 v[20:23], v[52:55], v[12:15], v[20:23]
  s_waitcnt lgkmcnt(2)
  v_mfma_f32_16x16x32_bf16 v[24:27], v[56:59], v[12:15], v[24:27]
  s_waitcnt lgkmcnt(1)
  v_mfma_f32_16x16x32_bf16 v[20:23], v[60:63], v[16:19], v[20:23]
  s_waitcnt lgkmcnt(0)
  v_mfma_f32_16x16x32_bf16 v[24:27], v[64:67], v[16:19], v[24:27]
  s_add_u32 m0, s32, 0xffffff80
  s_nop 0
  buffer_load_dwordx4 v1, s[4:7], s30 offen offset:128 nt lds
  s_add_u32 m0, s32, 0x300
  s_nop 0
  buffer_load_dwordx4 v1, s[4:7], s30 offen offset:256 nt lds
  s_add_u32 m0, s32, 0x680
  s_nop 0
  buffer_load_dwordx4 v1, s[4:7], s30 offen offset:384 nt lds
  s_add_u32 m0, s32, 0xc00
  s_nop 0
  buffer_load_dwordx4 v2, s[4:7], s30 offen nt lds
  s_add_u32 m0, s32, 0xf80
  s_nop 0
  buffer_load_dwordx4 v2, s[4:7], s30 offen offset:128 nt lds
  s_add_u32 m0, s32, 0x1300
  s_nop 0
  buffer_load_dwordx4 v2, s[4:7], s30 offen offset:256 nt lds
  s_add_u32 m0, s32, 0x1680
  s_nop 0
  buffer_load_dwordx4 v2, s[4:7], s30 offen offset:384 nt lds
  s_waitcnt vmcnt(23)
  s_add_u32 s31, s29, 0
  s_add_u32 m0, s32, 0x1c00
  s_nop 0
  buffer_load_dwordx4 v3, s[8:11], s31 offen nt lds
  v_permlane32_swap_b32 v20, v24
  v_permlane32_swap_b32 v21, v25
  v_permlane32_swap_b32 v22, v26
  v_permlane32_swap_b32 v23, v27
  v_add_f32_dpp v20, v24, v20 row_ror:8 row_mask:0xf bank_mask:0xf
  v_add_f32_dpp v21, v25, v21 row_ror:8 row_mask:0xf bank_mask:0xf
  v_add_f32_dpp v22, v26, v22 row_ror:8 row_mask:0xf bank_mask:0xf
  v_add_f32_dpp v23, v27, v23 row_ror:8 row_mask:0xf bank_mask:0xf
  v_cvt_pk_bf16_f32 v24, v20, v21
  v_cvt_pk_bf16_f32 v25, v22, v23
  v_perm_b32 v20, v24, s35, v72
  v_perm_b32 v21, v24, s35, v73
  v_perm_b32 v22, v25, s35, v72
  v_perm_b32 v23, v25, s35, v73
  v_max3_f32 v26, v20, v21, v22
  v_max_f32 v26, v26, v23
  s_nop 1
  v_max_f32_dpp v26, v26, v26 row_ror:8 row_mask:0xf bank_mask:0xf
  s_nop 1
  v_max_f32_dpp v26, v26, v26 row_bcast:15 row_mask:0xa bank_mask:0xf
  s_nop 1
  v_max_f32_dpp v26, v26, v26 row_bcast:31 row_mask:0xc bank_mask:0xf
  s_nop 0
  v_readlane_b32 s36, v26, 63
  s_nop 1
  v_mul_f32 v79, s36, v74
  v_fma_f32 v20, v20, s34, v79
  v_fma_f32 v21, v21, s34, v79
  v_fma_f32 v22, v22, s34, v79
  v_fma_f32 v23, v23, s34, v79
  v_exp_f32 v20, v20
  v_exp_f32 v21, v21
  v_exp_f32 v22, v22
  v_exp_f32 v23, v23
  v_add_f32 v26, v20, v21
  v_add_f32 v24, v22, v23
  v_cvt_pk_bf16_f32 v20, v20, v20
  v_cvt_pk_bf16_f32 v21, v21, v21
  v_cvt_pk_bf16_f32 v22, v22, v22
  v_cvt_pk_bf16_f32 v23, v23, v23
  v_add_f32 v76, v26, v24
  v_and_b32 v28, v20, v68
  v_and_b32 v29, v20, v69
  v_and_b32 v30, v20, v70
  v_and_b32 v31, v20, v71
  v_and_b32 v32, v21, v68
  v_and_b32 v33, v21, v69
  v_and_b32 v34, v21, v70
  v_and_b32 v35, v21, v71
  ds_read_b128 v[52:55], v75 offset:8192
  ds_read_b128 v[56:59], v75 offset:9216
  ds_read_b128 v[60:63], v75 offset:10240
  ds_read_b128 v[64:67], v75 offset:11264
  s_waitcnt lgkmcnt(3)
  v_mfma_f32_16x16x32_bf16 v[36:39], v[52:55], v[28:31], 0
  ds_read_b128 v[52:55], v75 offset:12288
  s_waitcnt lgkmcnt(3)
  v_mfma_f32_16x16x32_bf16 v[40:43], v[56:59], v[28:31], 0
  ds_read_b128 v[56:59], v75 offset:13312
  v_and_b32 v28, v22, v68
  v_and_b32 v29, v22, v69
  v_and_b32 v30, v22, v70
  v_and_b32 v31, v22, v71
  s_waitcnt lgkmcnt(3)
  v_mfma_f32_16x16x32_bf16 v[36:39], v[60:63], v[32:35], v[36:39]
  ds_read_b128 v[60:63], v75 offset:14336
  s_waitcnt lgkmcnt(3)
  v_mfma_f32_16x16x32_bf16 v[40:43], v[64:67], v[32:35], v[40:43]
  ds_read_b128 v[64:67], v75 offset:15360
  v_and_b32 v32, v23, v68
  v_and_b32 v33, v23, v69
  v_and_b32 v34, v23, v70
  v_and_b32 v35, v23, v71
  s_waitcnt lgkmcnt(3)
  v_mfma_f32_16x16x32_bf16 v[36:39], v[52:55], v[28:31], v[36:39]
  s_waitcnt lgkmcnt(2)
  v_mfma_f32_16x16x32_bf16 v[40:43], v[56:59], v[28:31], v[40:43]
  s_waitcnt lgkmcnt(1)
  v_mfma_f32_16x16x32_bf16 v[36:39], v[60:63], v[32:35], v[36:39]
  s_waitcnt lgkmcnt(0)
  v_mfma_f32_16x16x32_bf16 v[40:43], v[64:67], v[32:35], v[40:43]
  s_waitcnt vmcnt(16)
  s_add_u32 m0, s32, 0x1f00
  s_nop 0
  buffer_load_dwordx4 v3, s[8:11], s31 offen offset:256 nt lds
  s_add_u32 m0, s32, 0x2200
  s_nop 0
  buffer_load_dwordx4 v3, s[8:11], s31 offen offset:512 nt lds
  s_add_u32 m0, s32, 0x2500
  s_nop 0
  buffer_load_dwordx4 v3, s[8:11], s31 offen offset:768 nt lds
  s_add_u32 m0, s32, 0x2800
  s_nop 0
  buffer_load_dwordx4 v3, s[8:11], s31 offen offset:1024 nt lds
  s_add_u32 m0, s32, 0x2b00
  s_nop 0
  buffer_load_dwordx4 v3, s[8:11], s31 offen offset:1280 nt lds
  s_add_u32 m0, s32, 0x2e00
  s_nop 0
  buffer_load_dwordx4 v3, s[8:11], s31 offen offset:1536 nt lds
  s_add_u32 m0, s32, 0x3100
  s_nop 0
  buffer_load_dwordx4 v3, s[8:11], s31 offen offset:1792 nt lds
  s_add_u32 s30, s29, 458752
  s_add_u32 m0, s32, 0x3c00
  s_nop 0
  buffer_load_dwordx4 v1, s[4:7], s30 offen nt lds
  ds_read_b128 v[52:55], v75 offset:16384
  ds_read_b128 v[56:59], v75 offset:20480
  ds_read_b128 v[60:63], v75 offset:17408
  ds_read_b128 v[64:67], v75 offset:21504
  s_waitcnt lgkmcnt(3)
  v_mfma_f32_16x16x32_bf16 v[20:23], v[52:55], v[4:7], 0
  ds_read_b128 v[52:55], v75 offset:18432
  s_waitcnt lgkmcnt(3)
  v_mfma_f32_16x16x32_bf16 v[24:27], v[56:59], v[4:7], 0
  ds_read_b128 v[56:59], v75 offset:22528
  s_waitcnt lgkmcnt(3)
  v_mfma_f32_16x16x32_bf16 v[20:23], v[60:63], v[8:11], v[20:23]
  ds_read_b128 v[60:63], v75 offset:19456
  s_waitcnt lgkmcnt(3)
  v_mfma_f32_16x16x32_bf16 v[24:27], v[64:67], v[8:11], v[24:27]
  ds_read_b128 v[64:67], v75 offset:23552
  s_waitcnt lgkmcnt(3)
  v_mfma_f32_16x16x32_bf16 v[20:23], v[52:55], v[12:15], v[20:23]
  s_waitcnt lgkmcnt(2)
  v_mfma_f32_16x16x32_bf16 v[24:27], v[56:59], v[12:15], v[24:27]
  s_waitcnt lgkmcnt(1)
  v_mfma_f32_16x16x32_bf16 v[20:23], v[60:63], v[16:19], v[20:23]
  s_waitcnt lgkmcnt(0)
  v_mfma_f32_16x16x32_bf16 v[24:27], v[64:67], v[16:19], v[24:27]
  s_waitcnt vmcnt(16)
  s_add_u32 m0, s32, 0x3f80
  s_nop 0
  buffer_load_dwordx4 v1, s[4:7], s30 offen offset:128 nt lds
  s_add_u32 m0, s32, 0x4300
  s_nop 0
  buffer_load_dwordx4 v1, s[4:7], s30 offen offset:256 nt lds
  s_add_u32 m0, s32, 0x4680
  s_nop 0
  buffer_load_dwordx4 v1, s[4:7], s30 offen offset:384 nt lds
  s_add_u32 m0, s32, 0x4c00
  s_nop 0
  buffer_load_dwordx4 v2, s[4:7], s30 offen nt lds
  s_add_u32 m0, s32, 0x4f80
  s_nop 0
  buffer_load_dwordx4 v2, s[4:7], s30 offen offset:128 nt lds
  s_add_u32 m0, s32, 0x5300
  s_nop 0
  buffer_load_dwordx4 v2, s[4:7], s30 offen offset:256 nt lds
  s_add_u32 m0, s32, 0x5680
  s_nop 0
  buffer_load_dwordx4 v2, s[4:7], s30 offen offset:384 nt lds
  s_add_u32 s31, s29, 458752
  s_add_u32 m0, s32, 0x5c00
  s_nop 0
  buffer_load_dwordx4 v3, s[8:11], s31 offen nt lds
  v_permlane32_swap_b32 v20, v24
  v_permlane32_swap_b32 v21, v25
  v_permlane32_swap_b32 v22, v26
  v_permlane32_swap_b32 v23, v27
  v_add_f32_dpp v20, v24, v20 row_ror:8 row_mask:0xf bank_mask:0xf
  v_add_f32_dpp v21, v25, v21 row_ror:8 row_mask:0xf bank_mask:0xf
  v_add_f32_dpp v22, v26, v22 row_ror:8 row_mask:0xf bank_mask:0xf
  v_add_f32_dpp v23, v27, v23 row_ror:8 row_mask:0xf bank_mask:0xf
  v_cvt_pk_bf16_f32 v24, v20, v21
  v_cvt_pk_bf16_f32 v25, v22, v23
  v_perm_b32 v20, v24, s35, v72
  v_perm_b32 v21, v24, s35, v73
  v_perm_b32 v22, v25, s35, v72
  v_perm_b32 v23, v25, s35, v73
  v_max3_f32 v26, v20, v21, v22
  v_max3_f32 v26, v26, v23, s36
  s_nop 1
  v_max_f32_dpp v26, v26, v26 row_ror:8 row_mask:0xf bank_mask:0xf
  s_nop 1
  v_max_f32_dpp v26, v26, v26 row_bcast:15 row_mask:0xa bank_mask:0xf
  s_nop 1
  v_max_f32_dpp v26, v26, v26 row_bcast:31 row_mask:0xc bank_mask:0xf
  s_nop 0
  v_readlane_b32 s36, v26, 63
  s_nop 1
  v_mul_f32 v0, s36, v74
  v_fma_f32 v20, v20, s34, v0
  v_fma_f32 v21, v21, s34, v0
  v_fma_f32 v22, v22, s34, v0
  v_fma_f32 v23, v23, s34, v0
  v_sub_f32 v27, v0, v79
  v_exp_f32 v20, v20
  v_exp_f32 v21, v21
  v_exp_f32 v22, v22
  v_exp_f32 v23, v23
  v_exp_f32 v27, v27
  v_add_f32 v26, v20, v21
  v_add_f32 v24, v22, v23
  v_cvt_pk_bf16_f32 v20, v20, v20
  v_cvt_pk_bf16_f32 v21, v21, v21
  v_cvt_pk_bf16_f32 v22, v22, v22
  v_cvt_pk_bf16_f32 v23, v23, v23
  v_add_f32 v26, v26, v24
  v_fma_f32 v76, v76, v27, v26
  v_mul_f32 v36, v27, v36
  v_mul_f32 v37, v27, v37
  v_mul_f32 v38, v27, v38
  v_mul_f32 v39, v27, v39
  v_mul_f32 v40, v27, v40
  v_mul_f32 v41, v27, v41
  v_mul_f32 v42, v27, v42
  v_mul_f32 v43, v27, v43
  v_and_b32 v28, v20, v68
  v_and_b32 v29, v20, v69
  v_and_b32 v30, v20, v70
  v_and_b32 v31, v20, v71
  v_and_b32 v32, v21, v68
  v_and_b32 v33, v21, v69
  v_and_b32 v34, v21, v70
  v_and_b32 v35, v21, v71
  ds_read_b128 v[52:55], v75 offset:24576
  ds_read_b128 v[56:59], v75 offset:25600
  ds_read_b128 v[60:63], v75 offset:26624
  ds_read_b128 v[64:67], v75 offset:27648
  s_waitcnt lgkmcnt(3)
  v_mfma_f32_16x16x32_bf16 v[36:39], v[52:55], v[28:31], v[36:39]
  ds_read_b128 v[52:55], v75 offset:28672
  s_waitcnt lgkmcnt(3)
  v_mfma_f32_16x16x32_bf16 v[40:43], v[56:59], v[28:31], v[40:43]
  ds_read_b128 v[56:59], v75 offset:29696
  v_and_b32 v28, v22, v68
  v_and_b32 v29, v22, v69
  v_and_b32 v30, v22, v70
  v_and_b32 v31, v22, v71
  s_waitcnt lgkmcnt(3)
  v_mfma_f32_16x16x32_bf16 v[36:39], v[60:63], v[32:35], v[36:39]
  ds_read_b128 v[60:63], v75 offset:30720
  s_waitcnt lgkmcnt(3)
  v_mfma_f32_16x16x32_bf16 v[40:43], v[64:67], v[32:35], v[40:43]
  ds_read_b128 v[64:67], v75 offset:31744
  v_and_b32 v32, v23, v68
  v_and_b32 v33, v23, v69
  v_and_b32 v34, v23, v70
  v_and_b32 v35, v23, v71
  s_waitcnt lgkmcnt(3)
  v_mfma_f32_16x16x32_bf16 v[36:39], v[52:55], v[28:31], v[36:39]
  s_waitcnt lgkmcnt(2)
  v_mfma_f32_16x16x32_bf16 v[40:43], v[56:59], v[28:31], v[40:43]
  s_waitcnt lgkmcnt(1)
  v_mfma_f32_16x16x32_bf16 v[36:39], v[60:63], v[32:35], v[36:39]
  s_waitcnt lgkmcnt(0)
  v_mfma_f32_16x16x32_bf16 v[40:43], v[64:67], v[32:35], v[40:43]
  s_waitcnt vmcnt(16)
  s_add_u32 m0, s32, 0x5f00
  s_nop 0
  buffer_load_dwordx4 v3, s[8:11], s31 offen offset:256 nt lds
  s_add_u32 m0, s32, 0x6200
  s_nop 0
  buffer_load_dwordx4 v3, s[8:11], s31 offen offset:512 nt lds
  s_add_u32 m0, s32, 0x6500
  s_nop 0
  buffer_load_dwordx4 v3, s[8:11], s31 offen offset:768 nt lds
  s_add_u32 m0, s32, 0x6800
  s_nop 0
  buffer_load_dwordx4 v3, s[8:11], s31 offen offset:1024 nt lds
  s_add_u32 m0, s32, 0x6b00
  s_nop 0
  buffer_load_dwordx4 v3, s[8:11], s31 offen offset:1280 nt lds
  s_add_u32 m0, s32, 0x6e00
  s_nop 0
  buffer_load_dwordx4 v3, s[8:11], s31 offen offset:1536 nt lds
  s_add_u32 m0, s32, 0x7100
  s_nop 0
  buffer_load_dwordx4 v3, s[8:11], s31 offen offset:1792 nt lds
  s_add_u32 s30, s29, 917504
  s_add_u32 m0, s32, 0x7c00
  s_nop 0
  buffer_load_dwordx4 v1, s[4:7], s30 offen nt lds
  ds_read_b128 v[52:55], v75 offset:32768
  ds_read_b128 v[56:59], v75 offset:36864
  ds_read_b128 v[60:63], v75 offset:33792
  ds_read_b128 v[64:67], v75 offset:37888
  s_waitcnt lgkmcnt(3)
  v_mfma_f32_16x16x32_bf16 v[20:23], v[52:55], v[4:7], 0
  ds_read_b128 v[52:55], v75 offset:34816
  s_waitcnt lgkmcnt(3)
  v_mfma_f32_16x16x32_bf16 v[24:27], v[56:59], v[4:7], 0
  ds_read_b128 v[56:59], v75 offset:35840
  s_waitcnt lgkmcnt(3)
  v_mfma_f32_16x16x32_bf16 v[20:23], v[60:63], v[8:11], v[20:23]
  s_waitcnt lgkmcnt(2)
  v_mfma_f32_16x16x32_bf16 v[24:27], v[64:67], v[8:11], v[24:27]
  s_waitcnt lgkmcnt(1)
  v_mfma_f32_16x16x32_bf16 v[20:23], v[52:55], v[12:15], v[20:23]
  v_mfma_f32_16x16x32_bf16 v[24:27], a[0:3], v[12:15], v[24:27]
  s_waitcnt lgkmcnt(0)
  v_mfma_f32_16x16x32_bf16 v[20:23], v[56:59], v[16:19], v[20:23]
  v_mfma_f32_16x16x32_bf16 v[24:27], a[4:7], v[16:19], v[24:27]
  s_waitcnt vmcnt(16)
  s_add_u32 m0, s32, 0x7f80
  s_nop 0
  buffer_load_dwordx4 v1, s[4:7], s30 offen offset:128 nt lds
  s_add_u32 m0, s32, 0x8300
  s_nop 0
  buffer_load_dwordx4 v1, s[4:7], s30 offen offset:256 nt lds
  s_add_u32 m0, s32, 0x8680
  s_nop 0
  buffer_load_dwordx4 v1, s[4:7], s30 offen offset:384 nt lds
  s_add_u32 m0, s32, 0x8c00
  s_nop 0
  buffer_load_dwordx4 v2, s[4:7], s30 offen nt lds
  s_add_u32 m0, s32, 0x8f80
  s_nop 0
  buffer_load_dwordx4 v2, s[4:7], s30 offen offset:128 nt lds
  s_add_u32 m0, s32, 0x9300
  s_nop 0
  buffer_load_dwordx4 v2, s[4:7], s30 offen offset:256 nt lds
  buffer_load_dwordx4 a[0:3], v2, s[4:7], s30 offen offset:384 nt
  s_add_u32 s31, s29, 917504
  buffer_load_dwordx4 a[4:7], v3, s[8:11], s31 offen nt
  v_permlane32_swap_b32 v20, v24
  v_permlane32_swap_b32 v21, v25
  v_permlane32_swap_b32 v22, v26
  v_permlane32_swap_b32 v23, v27
  v_add_f32_dpp v20, v24, v20 row_ror:8 row_mask:0xf bank_mask:0xf
  v_add_f32_dpp v21, v25, v21 row_ror:8 row_mask:0xf bank_mask:0xf
  v_add_f32_dpp v22, v26, v22 row_ror:8 row_mask:0xf bank_mask:0xf
  v_add_f32_dpp v23, v27, v23 row_ror:8 row_mask:0xf bank_mask:0xf
  v_cvt_pk_bf16_f32 v24, v20, v21
  v_cvt_pk_bf16_f32 v25, v22, v23
  v_perm_b32 v20, v24, s35, v72
  v_perm_b32 v21, v24, s35, v73
  v_perm_b32 v22, v25, s35, v72
  v_perm_b32 v23, v25, s35, v73
  v_max3_f32 v26, v20, v21, v22
  v_max3_f32 v26, v26, v23, s36
  s_nop 1
  v_max_f32_dpp v26, v26, v26 row_ror:8 row_mask:0xf bank_mask:0xf
  s_nop 1
  v_max_f32_dpp v26, v26, v26 row_bcast:15 row_mask:0xa bank_mask:0xf
  s_nop 1
  v_max_f32_dpp v26, v26, v26 row_bcast:31 row_mask:0xc bank_mask:0xf
  s_nop 0
  v_readlane_b32 s36, v26, 63
  s_nop 1
  v_mul_f32 v79, s36, v74
  v_fma_f32 v20, v20, s34, v79
  v_fma_f32 v21, v21, s34, v79
  v_fma_f32 v22, v22, s34, v79
  v_fma_f32 v23, v23, s34, v79
  v_sub_f32 v27, v79, v0
  v_exp_f32 v20, v20
  v_exp_f32 v21, v21
  v_exp_f32 v22, v22
  v_exp_f32 v23, v23
  v_exp_f32 v27, v27
  v_add_f32 v26, v20, v21
  v_add_f32 v24, v22, v23
  v_cvt_pk_bf16_f32 v20, v20, v20
  v_cvt_pk_bf16_f32 v21, v21, v21
  v_cvt_pk_bf16_f32 v22, v22, v22
  v_cvt_pk_bf16_f32 v23, v23, v23
  v_add_f32 v26, v26, v24
  v_fma_f32 v76, v76, v27, v26
  v_mul_f32 v36, v27, v36
  v_mul_f32 v37, v27, v37
  v_mul_f32 v38, v27, v38
  v_mul_f32 v39, v27, v39
  v_mul_f32 v40, v27, v40
  v_mul_f32 v41, v27, v41
  v_mul_f32 v42, v27, v42
  v_mul_f32 v43, v27, v43
  v_and_b32 v28, v20, v68
  v_and_b32 v29, v20, v69
  v_and_b32 v30, v20, v70
  v_and_b32 v31, v20, v71
  v_and_b32 v32, v21, v68
  v_and_b32 v33, v21, v69
  v_and_b32 v34, v21, v70
  v_and_b32 v35, v21, v71
  v_mfma_f32_16x16x32_bf16 v[36:39], a[8:11], v[28:31], v[36:39]
  v_mfma_f32_16x16x32_bf16 v[40:43], a[12:15], v[28:31], v[40:43]
  v_and_b32 v28, v22, v68
  v_and_b32 v29, v22, v69
  v_and_b32 v30, v22, v70
  v_and_b32 v31, v22, v71
  v_mfma_f32_16x16x32_bf16 v[36:39], a[16:19], v[32:35], v[36:39]
  v_mfma_f32_16x16x32_bf16 v[40:43], a[20:23], v[32:35], v[40:43]
  v_and_b32 v32, v23, v68
  v_and_b32 v33, v23, v69
  v_and_b32 v34, v23, v70
  v_and_b32 v35, v23, v71
  v_mfma_f32_16x16x32_bf16 v[36:39], a[24:27], v[28:31], v[36:39]
  v_mfma_f32_16x16x32_bf16 v[40:43], a[28:31], v[28:31], v[40:43]
  v_mfma_f32_16x16x32_bf16 v[36:39], a[32:35], v[32:35], v[36:39]
  v_mfma_f32_16x16x32_bf16 v[40:43], a[36:39], v[32:35], v[40:43]
  s_waitcnt vmcnt(16)
  buffer_load_dwordx4 a[8:11], v3, s[8:11], s31 offen offset:256 nt
  buffer_load_dwordx4 a[12:15], v3, s[8:11], s31 offen offset:512 nt
  buffer_load_dwordx4 a[16:19], v3, s[8:11], s31 offen offset:768 nt
  buffer_load_dwordx4 a[20:23], v3, s[8:11], s31 offen offset:1024 nt
  buffer_load_dwordx4 a[24:27], v3, s[8:11], s31 offen offset:1280 nt
  buffer_load_dwordx4 a[28:31], v3, s[8:11], s31 offen offset:1536 nt
  buffer_load_dwordx4 a[32:35], v3, s[8:11], s31 offen offset:1792 nt
  s_add_u32 s30, s29, 1376256
  buffer_load_dwordx4 a[36:39], v1, s[4:7], s30 offen nt
  v_mfma_f32_16x16x32_bf16 v[20:23], a[40:43], v[4:7], 0
  v_mfma_f32_16x16x32_bf16 v[24:27], a[56:59], v[4:7], 0
  v_mfma_f32_16x16x32_bf16 v[20:23], a[44:47], v[8:11], v[20:23]
  v_mfma_f32_16x16x32_bf16 v[24:27], a[60:63], v[8:11], v[24:27]
  v_mfma_f32_16x16x32_bf16 v[20:23], a[48:51], v[12:15], v[20:23]
  v_mfma_f32_16x16x32_bf16 v[24:27], a[64:67], v[12:15], v[24:27]
  v_mfma_f32_16x16x32_bf16 v[20:23], a[52:55], v[16:19], v[20:23]
  v_mfma_f32_16x16x32_bf16 v[24:27], a[68:71], v[16:19], v[24:27]
  s_waitcnt vmcnt(16)
  buffer_load_dwordx4 a[40:43], v1, s[4:7], s30 offen offset:128 nt
  buffer_load_dwordx4 a[44:47], v1, s[4:7], s30 offen offset:256 nt
  buffer_load_dwordx4 a[48:51], v1, s[4:7], s30 offen offset:384 nt
  buffer_load_dwordx4 a[52:55], v2, s[4:7], s30 offen nt
  buffer_load_dwordx4 a[56:59], v2, s[4:7], s30 offen offset:128 nt
  buffer_load_dwordx4 a[60:63], v2, s[4:7], s30 offen offset:256 nt
  buffer_load_dwordx4 a[64:67], v2, s[4:7], s30 offen offset:384 nt
  s_add_u32 s31, s29, 1376256
  buffer_load_dwordx4 a[68:71], v3, s[8:11], s31 offen nt
  v_permlane32_swap_b32 v20, v24
  v_permlane32_swap_b32 v21, v25
  v_permlane32_swap_b32 v22, v26
  v_permlane32_swap_b32 v23, v27
  v_add_f32_dpp v20, v24, v20 row_ror:8 row_mask:0xf bank_mask:0xf
  v_add_f32_dpp v21, v25, v21 row_ror:8 row_mask:0xf bank_mask:0xf
  v_add_f32_dpp v22, v26, v22 row_ror:8 row_mask:0xf bank_mask:0xf
  v_add_f32_dpp v23, v27, v23 row_ror:8 row_mask:0xf bank_mask:0xf
  v_cvt_pk_bf16_f32 v24, v20, v21
  v_cvt_pk_bf16_f32 v25, v22, v23
  v_perm_b32 v20, v24, s35, v72
  v_perm_b32 v21, v24, s35, v73
  v_perm_b32 v22, v25, s35, v72
  v_perm_b32 v23, v25, s35, v73
  v_max3_f32 v26, v20, v21, v22
  v_max3_f32 v26, v26, v23, s36
  s_nop 1
  v_max_f32_dpp v26, v26, v26 row_ror:8 row_mask:0xf bank_mask:0xf
  s_nop 1
  v_max_f32_dpp v26, v26, v26 row_bcast:15 row_mask:0xa bank_mask:0xf
  s_nop 1
  v_max_f32_dpp v26, v26, v26 row_bcast:31 row_mask:0xc bank_mask:0xf
  s_nop 0
  v_readlane_b32 s36, v26, 63
  s_nop 1
  v_mul_f32 v0, s36, v74
  v_fma_f32 v20, v20, s34, v0
  v_fma_f32 v21, v21, s34, v0
  v_fma_f32 v22, v22, s34, v0
  v_fma_f32 v23, v23, s34, v0
  v_sub_f32 v27, v0, v79
  v_exp_f32 v20, v20
  v_exp_f32 v21, v21
  v_exp_f32 v22, v22
  v_exp_f32 v23, v23
  v_exp_f32 v27, v27
  v_add_f32 v26, v20, v21
  v_add_f32 v24, v22, v23
  v_cvt_pk_bf16_f32 v20, v20, v20
  v_cvt_pk_bf16_f32 v21, v21, v21
  v_cvt_pk_bf16_f32 v22, v22, v22
  v_cvt_pk_bf16_f32 v23, v23, v23
  v_add_f32 v26, v26, v24
  v_fma_f32 v76, v76, v27, v26
  v_mul_f32 v36, v27, v36
  v_mul_f32 v37, v27, v37
  v_mul_f32 v38, v27, v38
  v_mul_f32 v39, v27, v39
  v_mul_f32 v40, v27, v40
  v_mul_f32 v41, v27, v41
  v_mul_f32 v42, v27, v42
  v_mul_f32 v43, v27, v43
  v_and_b32 v28, v20, v68
  v_and_b32 v29, v20, v69
  v_and_b32 v30, v20, v70
  v_and_b32 v31, v20, v71
  v_and_b32 v32, v21, v68
  v_and_b32 v33, v21, v69
  v_and_b32 v34, v21, v70
  v_and_b32 v35, v21, v71
  v_mfma_f32_16x16x32_bf16 v[36:39], a[72:75], v[28:31], v[36:39]
  v_mfma_f32_16x16x32_bf16 v[40:43], a[76:79], v[28:31], v[40:43]
  v_and_b32 v28, v22, v68
  v_and_b32 v29, v22, v69
  v_and_b32 v30, v22, v70
  v_and_b32 v31, v22, v71
  v_mfma_f32_16x16x32_bf16 v[36:39], a[80:83], v[32:35], v[36:39]
  v_mfma_f32_16x16x32_bf16 v[40:43], a[84:87], v[32:35], v[40:43]
  v_and_b32 v32, v23, v68
  v_and_b32 v33, v23, v69
  v_and_b32 v34, v23, v70
  v_and_b32 v35, v23, v71
  v_mfma_f32_16x16x32_bf16 v[36:39], a[88:91], v[28:31], v[36:39]
  v_mfma_f32_16x16x32_bf16 v[40:43], a[92:95], v[28:31], v[40:43]
  v_mfma_f32_16x16x32_bf16 v[36:39], a[96:99], v[32:35], v[36:39]
  v_mfma_f32_16x16x32_bf16 v[40:43], a[100:103], v[32:35], v[40:43]
  s_waitcnt vmcnt(16)
  buffer_load_dwordx4 a[72:75], v3, s[8:11], s31 offen offset:256 nt
  buffer_load_dwordx4 a[76:79], v3, s[8:11], s31 offen offset:512 nt
  buffer_load_dwordx4 a[80:83], v3, s[8:11], s31 offen offset:768 nt
  buffer_load_dwordx4 a[84:87], v3, s[8:11], s31 offen offset:1024 nt
  buffer_load_dwordx4 a[88:91], v3, s[8:11], s31 offen offset:1280 nt
  buffer_load_dwordx4 a[92:95], v3, s[8:11], s31 offen offset:1536 nt
  buffer_load_dwordx4 a[96:99], v3, s[8:11], s31 offen offset:1792 nt
  s_add_u32 s30, s29, 1835008
  buffer_load_dwordx4 a[100:103], v1, s[4:7], s30 offen nt
  v_mfma_f32_16x16x32_bf16 v[20:23], a[104:107], v[4:7], 0
  v_mfma_f32_16x16x32_bf16 v[24:27], a[120:123], v[4:7], 0
  v_mfma_f32_16x16x32_bf16 v[20:23], a[108:111], v[8:11], v[20:23]
  v_mfma_f32_16x16x32_bf16 v[24:27], a[124:127], v[8:11], v[24:27]
  v_mfma_f32_16x16x32_bf16 v[20:23], a[112:115], v[12:15], v[20:23]
  v_mfma_f32_16x16x32_bf16 v[24:27], a[128:131], v[12:15], v[24:27]
  v_mfma_f32_16x16x32_bf16 v[20:23], a[116:119], v[16:19], v[20:23]
  v_mfma_f32_16x16x32_bf16 v[24:27], a[132:135], v[16:19], v[24:27]
  s_waitcnt vmcnt(16)
  buffer_load_dwordx4 a[104:107], v1, s[4:7], s30 offen offset:128 nt
  buffer_load_dwordx4 a[108:111], v1, s[4:7], s30 offen offset:256 nt
  buffer_load_dwordx4 a[112:115], v1, s[4:7], s30 offen offset:384 nt
  buffer_load_dwordx4 a[116:119], v2, s[4:7], s30 offen nt
  buffer_load_dwordx4 a[120:123], v2, s[4:7], s30 offen offset:128 nt
  buffer_load_dwordx4 a[124:127], v2, s[4:7], s30 offen offset:256 nt
  buffer_load_dwordx4 a[128:131], v2, s[4:7], s30 offen offset:384 nt
  s_add_u32 s31, s29, 1835008
  buffer_load_dwordx4 a[132:135], v3, s[8:11], s31 offen nt
  v_permlane32_swap_b32 v20, v24
  v_permlane32_swap_b32 v21, v25
  v_permlane32_swap_b32 v22, v26
  v_permlane32_swap_b32 v23, v27
  v_add_f32_dpp v20, v24, v20 row_ror:8 row_mask:0xf bank_mask:0xf
  v_add_f32_dpp v21, v25, v21 row_ror:8 row_mask:0xf bank_mask:0xf
  v_add_f32_dpp v22, v26, v22 row_ror:8 row_mask:0xf bank_mask:0xf
  v_add_f32_dpp v23, v27, v23 row_ror:8 row_mask:0xf bank_mask:0xf
  v_cvt_pk_bf16_f32 v24, v20, v21
  v_cvt_pk_bf16_f32 v25, v22, v23
  v_perm_b32 v20, v24, s35, v72
  v_perm_b32 v21, v24, s35, v73
  v_perm_b32 v22, v25, s35, v72
  v_perm_b32 v23, v25, s35, v73
  v_max3_f32 v26, v20, v21, v22
  v_max3_f32 v26, v26, v23, s36
  s_nop 1
  v_max_f32_dpp v26, v26, v26 row_ror:8 row_mask:0xf bank_mask:0xf
  s_nop 1
  v_max_f32_dpp v26, v26, v26 row_bcast:15 row_mask:0xa bank_mask:0xf
  s_nop 1
  v_max_f32_dpp v26, v26, v26 row_bcast:31 row_mask:0xc bank_mask:0xf
  s_nop 0
  v_readlane_b32 s36, v26, 63
  s_nop 1
  v_mul_f32 v79, s36, v74
  v_fma_f32 v20, v20, s34, v79
  v_fma_f32 v21, v21, s34, v79
  v_fma_f32 v22, v22, s34, v79
  v_fma_f32 v23, v23, s34, v79
  v_sub_f32 v27, v79, v0
  v_exp_f32 v20, v20
  v_exp_f32 v21, v21
  v_exp_f32 v22, v22
  v_exp_f32 v23, v23
  v_exp_f32 v27, v27
  v_add_f32 v26, v20, v21
  v_add_f32 v24, v22, v23
  v_cvt_pk_bf16_f32 v20, v20, v20
  v_cvt_pk_bf16_f32 v21, v21, v21
  v_cvt_pk_bf16_f32 v22, v22, v22
  v_cvt_pk_bf16_f32 v23, v23, v23
  v_add_f32 v26, v26, v24
  v_fma_f32 v76, v76, v27, v26
  v_mul_f32 v36, v27, v36
  v_mul_f32 v37, v27, v37
  v_mul_f32 v38, v27, v38
  v_mul_f32 v39, v27, v39
  v_mul_f32 v40, v27, v40
  v_mul_f32 v41, v27, v41
  v_mul_f32 v42, v27, v42
  v_mul_f32 v43, v27, v43
  v_and_b32 v28, v20, v68
  v_and_b32 v29, v20, v69
  v_and_b32 v30, v20, v70
  v_and_b32 v31, v20, v71
  v_and_b32 v32, v21, v68
  v_and_b32 v33, v21, v69
  v_and_b32 v34, v21, v70
  v_and_b32 v35, v21, v71
  v_mfma_f32_16x16x32_bf16 v[36:39], a[136:139], v[28:31], v[36:39]
  v_mfma_f32_16x16x32_bf16 v[40:43], a[140:143], v[28:31], v[40:43]
  v_and_b32 v28, v22, v68
  v_and_b32 v29, v22, v69
  v_and_b32 v30, v22, v70
  v_and_b32 v31, v22, v71
  v_mfma_f32_16x16x32_bf16 v[36:39], a[144:147], v[32:35], v[36:39]
  v_mfma_f32_16x16x32_bf16 v[40:43], a[148:151], v[32:35], v[40:43]
  v_and_b32 v32, v23, v68
  v_and_b32 v33, v23, v69
  v_and_b32 v34, v23, v70
  v_and_b32 v35, v23, v71
  v_mfma_f32_16x16x32_bf16 v[36:39], a[152:155], v[28:31], v[36:39]
  v_mfma_f32_16x16x32_bf16 v[40:43], a[156:159], v[28:31], v[40:43]
  v_mfma_f32_16x16x32_bf16 v[36:39], a[160:163], v[32:35], v[36:39]
  v_mfma_f32_16x16x32_bf16 v[40:43], a[164:167], v[32:35], v[40:43]
  s_waitcnt vmcnt(16)
  buffer_load_dwordx4 a[136:139], v3, s[8:11], s31 offen offset:256 nt
  buffer_load_dwordx4 a[140:143], v3, s[8:11], s31 offen offset:512 nt
  buffer_load_dwordx4 a[144:147], v3, s[8:11], s31 offen offset:768 nt
  buffer_load_dwordx4 a[148:151], v3, s[8:11], s31 offen offset:1024 nt
  buffer_load_dwordx4 a[152:155], v3, s[8:11], s31 offen offset:1280 nt
  buffer_load_dwordx4 a[156:159], v3, s[8:11], s31 offen offset:1536 nt
  buffer_load_dwordx4 a[160:163], v3, s[8:11], s31 offen offset:1792 nt
  s_add_u32 s30, s29, 2293760
  buffer_load_dwordx4 a[164:167], v1, s[4:7], s30 offen nt
  v_mfma_f32_16x16x32_bf16 v[20:23], a[168:171], v[4:7], 0
  v_mfma_f32_16x16x32_bf16 v[24:27], a[184:187], v[4:7], 0
  v_mfma_f32_16x16x32_bf16 v[20:23], a[172:175], v[8:11], v[20:23]
  v_mfma_f32_16x16x32_bf16 v[24:27], a[188:191], v[8:11], v[24:27]
  v_mfma_f32_16x16x32_bf16 v[20:23], a[176:179], v[12:15], v[20:23]
  v_mfma_f32_16x16x32_bf16 v[24:27], a[192:195], v[12:15], v[24:27]
  v_mfma_f32_16x16x32_bf16 v[20:23], a[180:183], v[16:19], v[20:23]
  v_mfma_f32_16x16x32_bf16 v[24:27], a[196:199], v[16:19], v[24:27]
  s_waitcnt vmcnt(16)
  buffer_load_dwordx4 a[168:171], v1, s[4:7], s30 offen offset:128 nt
  buffer_load_dwordx4 a[172:175], v1, s[4:7], s30 offen offset:256 nt
  buffer_load_dwordx4 a[176:179], v1, s[4:7], s30 offen offset:384 nt
  buffer_load_dwordx4 a[180:183], v2, s[4:7], s30 offen nt
  buffer_load_dwordx4 a[184:187], v2, s[4:7], s30 offen offset:128 nt
  buffer_load_dwordx4 a[188:191], v2, s[4:7], s30 offen offset:256 nt
  buffer_load_dwordx4 a[192:195], v2, s[4:7], s30 offen offset:384 nt
  s_add_u32 s31, s29, 2293760
  buffer_load_dwordx4 a[196:199], v3, s[8:11], s31 offen nt
  v_permlane32_swap_b32 v20, v24
  v_permlane32_swap_b32 v21, v25
  v_permlane32_swap_b32 v22, v26
  v_permlane32_swap_b32 v23, v27
  v_add_f32_dpp v20, v24, v20 row_ror:8 row_mask:0xf bank_mask:0xf
  v_add_f32_dpp v21, v25, v21 row_ror:8 row_mask:0xf bank_mask:0xf
  v_add_f32_dpp v22, v26, v22 row_ror:8 row_mask:0xf bank_mask:0xf
  v_add_f32_dpp v23, v27, v23 row_ror:8 row_mask:0xf bank_mask:0xf
  v_cvt_pk_bf16_f32 v24, v20, v21
  v_cvt_pk_bf16_f32 v25, v22, v23
  v_perm_b32 v20, v24, s35, v72
  v_perm_b32 v21, v24, s35, v73
  v_perm_b32 v22, v25, s35, v72
  v_perm_b32 v23, v25, s35, v73
  v_max3_f32 v26, v20, v21, v22
  v_max3_f32 v26, v26, v23, s36
  s_nop 1
  v_max_f32_dpp v26, v26, v26 row_ror:8 row_mask:0xf bank_mask:0xf
  s_nop 1
  v_max_f32_dpp v26, v26, v26 row_bcast:15 row_mask:0xa bank_mask:0xf
  s_nop 1
  v_max_f32_dpp v26, v26, v26 row_bcast:31 row_mask:0xc bank_mask:0xf
  s_nop 0
  v_readlane_b32 s36, v26, 63
  s_nop 1
  v_mul_f32 v0, s36, v74
  v_fma_f32 v20, v20, s34, v0
  v_fma_f32 v21, v21, s34, v0
  v_fma_f32 v22, v22, s34, v0
  v_fma_f32 v23, v23, s34, v0
  v_sub_f32 v27, v0, v79
  v_exp_f32 v20, v20
  v_exp_f32 v21, v21
  v_exp_f32 v22, v22
  v_exp_f32 v23, v23
  v_exp_f32 v27, v27
  v_add_f32 v26, v20, v21
  v_add_f32 v24, v22, v23
  v_cvt_pk_bf16_f32 v20, v20, v20
  v_cvt_pk_bf16_f32 v21, v21, v21
  v_cvt_pk_bf16_f32 v22, v22, v22
  v_cvt_pk_bf16_f32 v23, v23, v23
  v_add_f32 v26, v26, v24
  v_fma_f32 v76, v76, v27, v26
  v_mul_f32 v36, v27, v36
  v_mul_f32 v37, v27, v37
  v_mul_f32 v38, v27, v38
  v_mul_f32 v39, v27, v39
  v_mul_f32 v40, v27, v40
  v_mul_f32 v41, v27, v41
  v_mul_f32 v42, v27, v42
  v_mul_f32 v43, v27, v43
  v_and_b32 v28, v20, v68
  v_and_b32 v29, v20, v69
  v_and_b32 v30, v20, v70
  v_and_b32 v31, v20, v71
  v_and_b32 v32, v21, v68
  v_and_b32 v33, v21, v69
  v_and_b32 v34, v21, v70
  v_and_b32 v35, v21, v71
  v_mfma_f32_16x16x32_bf16 v[36:39], a[200:203], v[28:31], v[36:39]
  v_mfma_f32_16x16x32_bf16 v[40:43], a[204:207], v[28:31], v[40:43]
  v_and_b32 v28, v22, v68
  v_and_b32 v29, v22, v69
  v_and_b32 v30, v22, v70
  v_and_b32 v31, v22, v71
  v_mfma_f32_16x16x32_bf16 v[36:39], a[208:211], v[32:35], v[36:39]
  v_mfma_f32_16x16x32_bf16 v[40:43], a[212:215], v[32:35], v[40:43]
  v_and_b32 v32, v23, v68
  v_and_b32 v33, v23, v69
  v_and_b32 v34, v23, v70
  v_and_b32 v35, v23, v71
  v_mfma_f32_16x16x32_bf16 v[36:39], a[216:219], v[28:31], v[36:39]
  v_mfma_f32_16x16x32_bf16 v[40:43], a[220:223], v[28:31], v[40:43]
  v_mfma_f32_16x16x32_bf16 v[36:39], a[224:227], v[32:35], v[36:39]
  v_mfma_f32_16x16x32_bf16 v[40:43], a[228:231], v[32:35], v[40:43]
  s_waitcnt vmcnt(16)
  buffer_load_dwordx4 a[200:203], v3, s[8:11], s31 offen offset:256 nt
  buffer_load_dwordx4 a[204:207], v3, s[8:11], s31 offen offset:512 nt
  buffer_load_dwordx4 a[208:211], v3, s[8:11], s31 offen offset:768 nt
  buffer_load_dwordx4 a[212:215], v3, s[8:11], s31 offen offset:1024 nt
  buffer_load_dwordx4 a[216:219], v3, s[8:11], s31 offen offset:1280 nt
  buffer_load_dwordx4 a[220:223], v3, s[8:11], s31 offen offset:1536 nt
  buffer_load_dwordx4 a[224:227], v3, s[8:11], s31 offen offset:1792 nt
  s_add_u32 s30, s29, 2752512
  buffer_load_dwordx4 a[228:231], v1, s[4:7], s30 offen nt
  v_mfma_f32_16x16x32_bf16 v[20:23], a[232:235], v[4:7], 0
  v_mfma_f32_16x16x32_bf16 v[24:27], a[248:251], v[4:7], 0
  v_mfma_f32_16x16x32_bf16 v[20:23], a[236:239], v[8:11], v[20:23]
  v_mfma_f32_16x16x32_bf16 v[24:27], a[252:255], v[8:11], v[24:27]
  v_mfma_f32_16x16x32_bf16 v[20:23], a[240:243], v[12:15], v[20:23]
  v_mfma_f32_16x16x32_bf16 v[24:27], v[152:155], v[12:15], v[24:27]
  v_mfma_f32_16x16x32_bf16 v[20:23], a[244:247], v[16:19], v[20:23]
  v_mfma_f32_16x16x32_bf16 v[24:27], v[156:159], v[16:19], v[24:27]
  s_waitcnt vmcnt(16)
  buffer_load_dwordx4 a[232:235], v1, s[4:7], s30 offen offset:128 nt
  buffer_load_dwordx4 a[236:239], v1, s[4:7], s30 offen offset:256 nt
  buffer_load_dwordx4 a[240:243], v1, s[4:7], s30 offen offset:384 nt
  buffer_load_dwordx4 a[244:247], v2, s[4:7], s30 offen nt
  buffer_load_dwordx4 a[248:251], v2, s[4:7], s30 offen offset:128 nt
  buffer_load_dwordx4 a[252:255], v2, s[4:7], s30 offen offset:256 nt
  buffer_load_dwordx4 v[152:155], v2, s[4:7], s30 offen offset:384 nt
  s_add_u32 s31, s29, 2752512
  buffer_load_dwordx4 v[156:159], v3, s[8:11], s31 offen nt
  v_permlane32_swap_b32 v20, v24
  v_permlane32_swap_b32 v21, v25
  v_permlane32_swap_b32 v22, v26
  v_permlane32_swap_b32 v23, v27
  v_add_f32_dpp v20, v24, v20 row_ror:8 row_mask:0xf bank_mask:0xf
  v_add_f32_dpp v21, v25, v21 row_ror:8 row_mask:0xf bank_mask:0xf
  v_add_f32_dpp v22, v26, v22 row_ror:8 row_mask:0xf bank_mask:0xf
  v_add_f32_dpp v23, v27, v23 row_ror:8 row_mask:0xf bank_mask:0xf
  v_cvt_pk_bf16_f32 v24, v20, v21
  v_cvt_pk_bf16_f32 v25, v22, v23
  v_perm_b32 v20, v24, s35, v72
  v_perm_b32 v21, v24, s35, v73
  v_perm_b32 v22, v25, s35, v72
  v_perm_b32 v23, v25, s35, v73
  v_max3_f32 v26, v20, v21, v22
  v_max3_f32 v26, v26, v23, s36
  s_nop 1
  v_max_f32_dpp v26, v26, v26 row_ror:8 row_mask:0xf bank_mask:0xf
  s_nop 1
  v_max_f32_dpp v26, v26, v26 row_bcast:15 row_mask:0xa bank_mask:0xf
  s_nop 1
  v_max_f32_dpp v26, v26, v26 row_bcast:31 row_mask:0xc bank_mask:0xf
  s_nop 0
  v_readlane_b32 s36, v26, 63
  s_nop 1
  v_mul_f32 v79, s36, v74
  v_fma_f32 v20, v20, s34, v79
  v_fma_f32 v21, v21, s34, v79
  v_fma_f32 v22, v22, s34, v79
  v_fma_f32 v23, v23, s34, v79
  v_sub_f32 v27, v79, v0
  v_exp_f32 v20, v20
  v_exp_f32 v21, v21
  v_exp_f32 v22, v22
  v_exp_f32 v23, v23
  v_exp_f32 v27, v27
  v_add_f32 v26, v20, v21
  v_add_f32 v24, v22, v23
  v_cvt_pk_bf16_f32 v20, v20, v20
  v_cvt_pk_bf16_f32 v21, v21, v21
  v_cvt_pk_bf16_f32 v22, v22, v22
  v_cvt_pk_bf16_f32 v23, v23, v23
  v_add_f32 v26, v26, v24
  v_fma_f32 v76, v76, v27, v26
  v_mul_f32 v36, v27, v36
  v_mul_f32 v37, v27, v37
  v_mul_f32 v38, v27, v38
  v_mul_f32 v39, v27, v39
  v_mul_f32 v40, v27, v40
  v_mul_f32 v41, v27, v41
  v_mul_f32 v42, v27, v42
  v_mul_f32 v43, v27, v43
  v_and_b32 v28, v20, v68
  v_and_b32 v29, v20, v69
  v_and_b32 v30, v20, v70
  v_and_b32 v31, v20, v71
  v_and_b32 v32, v21, v68
  v_and_b32 v33, v21, v69
  v_and_b32 v34, v21, v70
  v_and_b32 v35, v21, v71
  v_mfma_f32_16x16x32_bf16 v[36:39], v[160:163], v[28:31], v[36:39]
  v_mfma_f32_16x16x32_bf16 v[40:43], v[164:167], v[28:31], v[40:43]
  v_and_b32 v28, v22, v68
  v_and_b32 v29, v22, v69
  v_and_b32 v30, v22, v70
  v_and_b32 v31, v22, v71
  v_mfma_f32_16x16x32_bf16 v[36:39], v[168:171], v[32:35], v[36:39]
  v_mfma_f32_16x16x32_bf16 v[40:43], v[172:175], v[32:35], v[40:43]
  v_and_b32 v32, v23, v68
  v_and_b32 v33, v23, v69
  v_and_b32 v34, v23, v70
  v_and_b32 v35, v23, v71
  v_mfma_f32_16x16x32_bf16 v[36:39], v[176:179], v[28:31], v[36:39]
  v_mfma_f32_16x16x32_bf16 v[40:43], v[180:183], v[28:31], v[40:43]
  v_mfma_f32_16x16x32_bf16 v[36:39], v[184:187], v[32:35], v[36:39]
  v_mfma_f32_16x16x32_bf16 v[40:43], v[188:191], v[32:35], v[40:43]
  s_waitcnt vmcnt(16)
  buffer_load_dwordx4 v[160:163], v3, s[8:11], s31 offen offset:256 nt
  buffer_load_dwordx4 v[164:167], v3, s[8:11], s31 offen offset:512 nt
  buffer_load_dwordx4 v[168:171], v3, s[8:11], s31 offen offset:768 nt
  buffer_load_dwordx4 v[172:175], v3, s[8:11], s31 offen offset:1024 nt
  buffer_load_dwordx4 v[176:179], v3, s[8:11], s31 offen offset:1280 nt
  buffer_load_dwordx4 v[180:183], v3, s[8:11], s31 offen offset:1536 nt
  buffer_load_dwordx4 v[184:187], v3, s[8:11], s31 offen offset:1792 nt
  s_add_u32 s30, s29, 3211264
  buffer_load_dwordx4 v[188:191], v1, s[4:7], s30 offen nt
  v_mfma_f32_16x16x32_bf16 v[20:23], v[192:195], v[4:7], 0
  v_mfma_f32_16x16x32_bf16 v[24:27], v[208:211], v[4:7], 0
  v_mfma_f32_16x16x32_bf16 v[20:23], v[196:199], v[8:11], v[20:23]
  v_mfma_f32_16x16x32_bf16 v[24:27], v[212:215], v[8:11], v[24:27]
  v_mfma_f32_16x16x32_bf16 v[20:23], v[200:203], v[12:15], v[20:23]
  v_mfma_f32_16x16x32_bf16 v[24:27], v[216:219], v[12:15], v[24:27]
  v_mfma_f32_16x16x32_bf16 v[20:23], v[204:207], v[16:19], v[20:23]
  v_mfma_f32_16x16x32_bf16 v[24:27], v[220:223], v[16:19], v[24:27]
  s_waitcnt vmcnt(16)
  buffer_load_dwordx4 v[192:195], v1, s[4:7], s30 offen offset:128 nt
  buffer_load_dwordx4 v[196:199], v1, s[4:7], s30 offen offset:256 nt
  buffer_load_dwordx4 v[200:203], v1, s[4:7], s30 offen offset:384 nt
  buffer_load_dwordx4 v[204:207], v2, s[4:7], s30 offen nt
  buffer_load_dwordx4 v[208:211], v2, s[4:7], s30 offen offset:128 nt
  buffer_load_dwordx4 v[212:215], v2, s[4:7], s30 offen offset:256 nt
  buffer_load_dwordx4 v[216:219], v2, s[4:7], s30 offen offset:384 nt
  s_add_u32 s31, s29, 3211264
  buffer_load_dwordx4 v[220:223], v3, s[8:11], s31 offen nt
  v_permlane32_swap_b32 v20, v24
  v_permlane32_swap_b32 v21, v25
  v_permlane32_swap_b32 v22, v26
  v_permlane32_swap_b32 v23, v27
  v_add_f32_dpp v20, v24, v20 row_ror:8 row_mask:0xf bank_mask:0xf
  v_add_f32_dpp v21, v25, v21 row_ror:8 row_mask:0xf bank_mask:0xf
  v_add_f32_dpp v22, v26, v22 row_ror:8 row_mask:0xf bank_mask:0xf
  v_add_f32_dpp v23, v27, v23 row_ror:8 row_mask:0xf bank_mask:0xf
  v_cvt_pk_bf16_f32 v24, v20, v21
  v_cvt_pk_bf16_f32 v25, v22, v23
  v_perm_b32 v20, v24, s35, v72
  v_perm_b32 v21, v24, s35, v73
  v_perm_b32 v22, v25, s35, v72
  v_perm_b32 v23, v25, s35, v73
  v_max3_f32 v26, v20, v21, v22
  v_max3_f32 v26, v26, v23, s36
  s_nop 1
  v_max_f32_dpp v26, v26, v26 row_ror:8 row_mask:0xf bank_mask:0xf
  s_nop 1
  v_max_f32_dpp v26, v26, v26 row_bcast:15 row_mask:0xa bank_mask:0xf
  s_nop 1
  v_max_f32_dpp v26, v26, v26 row_bcast:31 row_mask:0xc bank_mask:0xf
  s_nop 0
  v_readlane_b32 s36, v26, 63
  s_nop 1
  v_mul_f32 v0, s36, v74
  v_fma_f32 v20, v20, s34, v0
  v_fma_f32 v21, v21, s34, v0
  v_fma_f32 v22, v22, s34, v0
  v_fma_f32 v23, v23, s34, v0
  v_sub_f32 v27, v0, v79
  v_exp_f32 v20, v20
  v_exp_f32 v21, v21
  v_exp_f32 v22, v22
  v_exp_f32 v23, v23
  v_exp_f32 v27, v27
  v_add_f32 v26, v20, v21
  v_add_f32 v24, v22, v23
  v_cvt_pk_bf16_f32 v20, v20, v20
  v_cvt_pk_bf16_f32 v21, v21, v21
  v_cvt_pk_bf16_f32 v22, v22, v22
  v_cvt_pk_bf16_f32 v23, v23, v23
  v_add_f32 v26, v26, v24
  v_fma_f32 v76, v76, v27, v26
  v_mul_f32 v36, v27, v36
  v_mul_f32 v37, v27, v37
  v_mul_f32 v38, v27, v38
  v_mul_f32 v39, v27, v39
  v_mul_f32 v40, v27, v40
  v_mul_f32 v41, v27, v41
  v_mul_f32 v42, v27, v42
  v_mul_f32 v43, v27, v43
  v_and_b32 v28, v20, v68
  v_and_b32 v29, v20, v69
  v_and_b32 v30, v20, v70
  v_and_b32 v31, v20, v71
  v_and_b32 v32, v21, v68
  v_and_b32 v33, v21, v69
  v_and_b32 v34, v21, v70
  v_and_b32 v35, v21, v71
  v_mfma_f32_16x16x32_bf16 v[36:39], v[224:227], v[28:31], v[36:39]
  v_mfma_f32_16x16x32_bf16 v[40:43], v[228:231], v[28:31], v[40:43]
  v_and_b32 v28, v22, v68
  v_and_b32 v29, v22, v69
  v_and_b32 v30, v22, v70
  v_and_b32 v31, v22, v71
  v_mfma_f32_16x16x32_bf16 v[36:39], v[232:235], v[32:35], v[36:39]
  v_mfma_f32_16x16x32_bf16 v[40:43], v[236:239], v[32:35], v[40:43]
  v_and_b32 v32, v23, v68
  v_and_b32 v33, v23, v69
  v_and_b32 v34, v23, v70
  v_and_b32 v35, v23, v71
  v_mfma_f32_16x16x32_bf16 v[36:39], v[240:243], v[28:31], v[36:39]
  v_mfma_f32_16x16x32_bf16 v[40:43], v[244:247], v[28:31], v[40:43]
  v_mfma_f32_16x16x32_bf16 v[36:39], v[248:251], v[32:35], v[36:39]
  v_mfma_f32_16x16x32_bf16 v[40:43], v[252:255], v[32:35], v[40:43]
  s_waitcnt vmcnt(16)
  buffer_load_dwordx4 v[224:227], v3, s[8:11], s31 offen offset:256 nt
  buffer_load_dwordx4 v[228:231], v3, s[8:11], s31 offen offset:512 nt
  buffer_load_dwordx4 v[232:235], v3, s[8:11], s31 offen offset:768 nt
  buffer_load_dwordx4 v[236:239], v3, s[8:11], s31 offen offset:1024 nt
  buffer_load_dwordx4 v[240:243], v3, s[8:11], s31 offen offset:1280 nt
  buffer_load_dwordx4 v[244:247], v3, s[8:11], s31 offen offset:1536 nt
  buffer_load_dwordx4 v[248:251], v3, s[8:11], s31 offen offset:1792 nt
  v_mfma_f32_16x16x32_bf16 v[20:23], v[84:87], v[4:7], 0
  v_mfma_f32_16x16x32_bf16 v[24:27], v[100:103], v[4:7], 0
  v_mfma_f32_16x16x32_bf16 v[20:23], v[88:91], v[8:11], v[20:23]
  v_mfma_f32_16x16x32_bf16 v[24:27], v[104:107], v[8:11], v[24:27]
  v_mfma_f32_16x16x32_bf16 v[20:23], v[92:95], v[12:15], v[20:23]
  v_mfma_f32_16x16x32_bf16 v[24:27], v[108:111], v[12:15], v[24:27]
  v_mfma_f32_16x16x32_bf16 v[20:23], v[96:99], v[16:19], v[20:23]
  v_mfma_f32_16x16x32_bf16 v[24:27], v[112:115], v[16:19], v[24:27]
  s_add_u32 s30, s28, 4128768
  buffer_load_dwordx4 v[84:87], v1, s[4:7], s30 offen nt
  s_waitcnt vmcnt(16)
  buffer_load_dwordx4 v[88:91], v1, s[4:7], s30 offen offset:128 nt
  buffer_load_dwordx4 v[92:95], v1, s[4:7], s30 offen offset:256 nt
  buffer_load_dwordx4 v[96:99], v1, s[4:7], s30 offen offset:384 nt
  buffer_load_dwordx4 v[100:103], v2, s[4:7], s30 offen nt
  buffer_load_dwordx4 v[104:107], v2, s[4:7], s30 offen offset:128 nt
  buffer_load_dwordx4 v[108:111], v2, s[4:7], s30 offen offset:256 nt
  buffer_load_dwordx4 v[112:115], v2, s[4:7], s30 offen offset:384 nt
  s_add_u32 s47, s14, 8192
  v_mov_b32 v80, 1
  s_mov_b64 exec, 1
  buffer_atomic_add v80, off, s[20:23], s47 sc0
  s_mov_b64 exec, -1
  v_permlane32_swap_b32 v20, v24
  v_permlane32_swap_b32 v21, v25
  v_permlane32_swap_b32 v22, v26
  v_permlane32_swap_b32 v23, v27
  v_add_f32_dpp v20, v24, v20 row_ror:8 row_mask:0xf bank_mask:0xf
  v_add_f32_dpp v21, v25, v21 row_ror:8 row_mask:0xf bank_mask:0xf
  v_add_f32_dpp v22, v26, v22 row_ror:8 row_mask:0xf bank_mask:0xf
  v_add_f32_dpp v23, v27, v23 row_ror:8 row_mask:0xf bank_mask:0xf
  v_cvt_pk_bf16_f32 v24, v20, v21
  v_cvt_pk_bf16_f32 v25, v22, v23
  v_perm_b32 v20, v24, s35, v72
  v_perm_b32 v21, v24, s35, v73
  v_perm_b32 v22, v25, s35, v72
  v_perm_b32 v23, v25, s35, v73
  v_max3_f32 v26, v20, v21, v22
  v_max3_f32 v26, v26, v23, s36
  s_nop 1
  v_max_f32_dpp v26, v26, v26 row_ror:8 row_mask:0xf bank_mask:0xf
  s_nop 1
  v_max_f32_dpp v26, v26, v26 row_bcast:15 row_mask:0xa bank_mask:0xf
  s_nop 1
  v_max_f32_dpp v26, v26, v26 row_bcast:31 row_mask:0xc bank_mask:0xf
  s_nop 0
  v_readlane_b32 s36, v26, 63
  s_nop 1
  v_mul_f32 v79, s36, v74
  v_fma_f32 v20, v20, s34, v79
  v_fma_f32 v21, v21, s34, v79
  v_fma_f32 v22, v22, s34, v79
  v_fma_f32 v23, v23, s34, v79
  v_sub_f32 v27, v79, v0
  v_exp_f32 v20, v20
  v_exp_f32 v21, v21
  v_exp_f32 v22, v22
  v_exp_f32 v23, v23
  v_exp_f32 v27, v27
  v_add_f32 v26, v20, v21
  v_add_f32 v24, v22, v23
  v_cvt_pk_bf16_f32 v20, v20, v20
  v_cvt_pk_bf16_f32 v21, v21, v21
  v_cvt_pk_bf16_f32 v22, v22, v22
  v_cvt_pk_bf16_f32 v23, v23, v23
  v_add_f32 v26, v26, v24
  v_fma_f32 v76, v76, v27, v26
  v_mul_f32 v36, v27, v36
  v_mul_f32 v37, v27, v37
  v_mul_f32 v38, v27, v38
  v_mul_f32 v39, v27, v39
  v_mul_f32 v40, v27, v40
  v_mul_f32 v41, v27, v41
  v_mul_f32 v42, v27, v42
  v_mul_f32 v43, v27, v43
  v_and_b32 v28, v20, v68
  v_and_b32 v29, v20, v69
  v_and_b32 v30, v20, v70
  v_and_b32 v31, v20, v71
  v_and_b32 v32, v21, v68
  v_and_b32 v33, v21, v69
  v_and_b32 v34, v21, v70
  v_and_b32 v35, v21, v71
  v_mfma_f32_16x16x32_bf16 v[36:39], v[116:119], v[28:31], v[36:39]
  v_mfma_f32_16x16x32_bf16 v[40:43], v[120:123], v[28:31], v[40:43]
  v_and_b32 v28, v22, v68
  v_and_b32 v29, v22, v69
  v_and_b32 v30, v22, v70
  v_and_b32 v31, v22, v71
  v_mfma_f32_16x16x32_bf16 v[36:39], v[124:127], v[32:35], v[36:39]
  v_mfma_f32_16x16x32_bf16 v[40:43], v[128:131], v[32:35], v[40:43]
  v_and_b32 v32, v23, v68
  v_and_b32 v33, v23, v69
  v_and_b32 v34, v23, v70
  v_and_b32 v35, v23, v71
  v_mfma_f32_16x16x32_bf16 v[36:39], v[132:135], v[28:31], v[36:39]
  v_mfma_f32_16x16x32_bf16 v[40:43], v[136:139], v[28:31], v[40:43]
  v_mfma_f32_16x16x32_bf16 v[36:39], v[140:143], v[32:35], v[36:39]
  v_mfma_f32_16x16x32_bf16 v[40:43], v[144:147], v[32:35], v[40:43]
  s_waitcnt vmcnt(16)
  s_add_u32 s31, s28, 4128768
  buffer_load_dwordx4 v[116:119], v3, s[8:11], s31 offen nt
  buffer_load_dwordx4 v[120:123], v3, s[8:11], s31 offen offset:256 nt
  buffer_load_dwordx4 v[124:127], v3, s[8:11], s31 offen offset:512 nt
  buffer_load_dwordx4 v[128:131], v3, s[8:11], s31 offen offset:768 nt
  buffer_load_dwordx4 v[132:135], v3, s[8:11], s31 offen offset:1024 nt
  buffer_load_dwordx4 v[136:139], v3, s[8:11], s31 offen offset:1280 nt
  buffer_load_dwordx4 v[140:143], v3, s[8:11], s31 offen offset:1536 nt
  buffer_load_dwordx4 v[144:147], v3, s[8:11], s31 offen offset:1792 nt
  v_and_b32 v28, 0x70, v1
  ds_read_b128 v[4:7], v28 offset:512
  ds_read_b128 v[8:11], v28 offset:640
  ds_read_b128 v[12:15], v28 offset:768
  ds_read_b128 v[16:19], v28 offset:896
  s_waitcnt lgkmcnt(0)
  ds_read_b128 v[52:55], v75 offset:3072
  ds_read_b128 v[56:59], v75 offset:0
  ds_read_b128 v[60:63], v75 offset:4096
  ds_read_b128 v[64:67], v75 offset:1024
  v_mfma_f32_16x16x32_bf16 v[20:23], v[148:151], v[4:7], 0
  s_waitcnt lgkmcnt(3)
  v_mfma_f32_16x16x32_bf16 v[24:27], v[52:55], v[4:7], 0
  ds_read_b128 v[52:55], v75 offset:5120
  s_waitcnt lgkmcnt(3)
  v_mfma_f32_16x16x32_bf16 v[20:23], v[56:59], v[8:11], v[20:23]
  ds_read_b128 v[56:59], v75 offset:2048
  s_waitcnt lgkmcnt(3)
  v_mfma_f32_16x16x32_bf16 v[24:27], v[60:63], v[8:11], v[24:27]
  ds_read_b128 v[60:63], v75 offset:6144
  s_waitcnt lgkmcnt(3)
  v_mfma_f32_16x16x32_bf16 v[20:23], v[64:67], v[12:15], v[20:23]
  s_waitcnt lgkmcnt(2)
  v_mfma_f32_16x16x32_bf16 v[24:27], v[52:55], v[12:15], v[24:27]
  s_waitcnt lgkmcnt(1)
  v_mfma_f32_16x16x32_bf16 v[20:23], v[56:59], v[16:19], v[20:23]
  s_waitcnt lgkmcnt(0)
  v_mfma_f32_16x16x32_bf16 v[24:27], v[60:63], v[16:19], v[24:27]
  s_nop 7
  v_permlane32_swap_b32 v20, v24
  v_permlane32_swap_b32 v21, v25
  v_permlane32_swap_b32 v22, v26
  v_permlane32_swap_b32 v23, v27
  v_add_f32_dpp v20, v24, v20 row_ror:8 row_mask:0xf bank_mask:0xf
  v_add_f32_dpp v21, v25, v21 row_ror:8 row_mask:0xf bank_mask:0xf
  v_add_f32_dpp v22, v26, v22 row_ror:8 row_mask:0xf bank_mask:0xf
  v_add_f32_dpp v23, v27, v23 row_ror:8 row_mask:0xf bank_mask:0xf
  v_cvt_pk_bf16_f32 v24, v20, v21
  v_cvt_pk_bf16_f32 v25, v22, v23
  v_perm_b32 v20, v24, s35, v72
  v_perm_b32 v21, v24, s35, v73
  v_perm_b32 v22, v25, s35, v72
  v_perm_b32 v23, v25, s35, v73
  v_max3_f32 v26, v20, v21, v22
  v_max3_f32 v26, v26, v23, s37
  s_nop 1
  v_max_f32_dpp v26, v26, v26 row_ror:8 row_mask:0xf bank_mask:0xf
  s_nop 1
  v_max_f32_dpp v26, v26, v26 row_bcast:15 row_mask:0xa bank_mask:0xf
  s_nop 1
  v_max_f32_dpp v26, v26, v26 row_bcast:31 row_mask:0xc bank_mask:0xf
  s_nop 0
  v_readlane_b32 s37, v26, 63
  s_nop 1
  v_mul_f32 v0, s37, v74
  v_fma_f32 v20, v20, s34, v0
  v_fma_f32 v21, v21, s34, v0
  v_fma_f32 v22, v22, s34, v0
  v_fma_f32 v23, v23, s34, v0
  v_sub_f32 v27, v0, v78
  v_exp_f32 v20, v20
  v_exp_f32 v21, v21
  v_exp_f32 v22, v22
  v_exp_f32 v23, v23
  v_exp_f32 v27, v27
  v_add_f32 v26, v20, v21
  v_add_f32 v24, v22, v23
  v_cvt_pk_bf16_f32 v20, v20, v20
  v_cvt_pk_bf16_f32 v21, v21, v21
  v_cvt_pk_bf16_f32 v22, v22, v22
  v_cvt_pk_bf16_f32 v23, v23, v23
  v_add_f32 v26, v26, v24
  v_fma_f32 v77, v77, v27, v26
  v_mul_f32 v44, v27, v44
  v_mul_f32 v45, v27, v45
  v_mul_f32 v46, v27, v46
  v_mul_f32 v47, v27, v47
  v_mul_f32 v48, v27, v48
  v_mul_f32 v49, v27, v49
  v_mul_f32 v50, v27, v50
  v_mul_f32 v51, v27, v51
  v_and_b32 v28, v20, v68
  v_and_b32 v29, v20, v69
  v_and_b32 v30, v20, v70
  v_and_b32 v31, v20, v71
  v_and_b32 v32, v21, v68
  v_and_b32 v33, v21, v69
  v_and_b32 v34, v21, v70
  v_and_b32 v35, v21, v71
  ds_read_b128 v[52:55], v75 offset:7168
  ds_read_b128 v[56:59], v75 offset:8192
  ds_read_b128 v[60:63], v75 offset:9216
  ds_read_b128 v[64:67], v75 offset:10240
  s_waitcnt lgkmcnt(3)
  v_mfma_f32_16x16x32_bf16 v[44:47], v[52:55], v[28:31], v[44:47]
  ds_read_b128 v[52:55], v75 offset:11264
  s_waitcnt lgkmcnt(3)
  v_mfma_f32_16x16x32_bf16 v[48:51], v[56:59], v[28:31], v[48:51]
  ds_read_b128 v[56:59], v75 offset:12288
  v_and_b32 v28, v22, v68
  v_and_b32 v29, v22, v69
  v_and_b32 v30, v22, v70
  v_and_b32 v31, v22, v71
  s_waitcnt lgkmcnt(3)
  v_mfma_f32_16x16x32_bf16 v[44:47], v[60:63], v[32:35], v[44:47]
  ds_read_b128 v[60:63], v75 offset:13312
  s_waitcnt lgkmcnt(3)
  v_mfma_f32_16x16x32_bf16 v[48:51], v[64:67], v[32:35], v[48:51]
  ds_read_b128 v[64:67], v75 offset:14336
  v_and_b32 v32, v23, v68
  v_and_b32 v33, v23, v69
  v_and_b32 v34, v23, v70
  v_and_b32 v35, v23, v71
  s_waitcnt lgkmcnt(3)
  v_mfma_f32_16x16x32_bf16 v[44:47], v[52:55], v[28:31], v[44:47]
  s_waitcnt lgkmcnt(2)
  v_mfma_f32_16x16x32_bf16 v[48:51], v[56:59], v[28:31], v[48:51]
  s_waitcnt lgkmcnt(1)
  v_mfma_f32_16x16x32_bf16 v[44:47], v[60:63], v[32:35], v[44:47]
  s_waitcnt lgkmcnt(0)
  v_mfma_f32_16x16x32_bf16 v[48:51], v[64:67], v[32:35], v[48:51]
  ds_read_b128 v[52:55], v75 offset:15360
  ds_read_b128 v[56:59], v75 offset:19456
  ds_read_b128 v[60:63], v75 offset:16384
  ds_read_b128 v[64:67], v75 offset:20480
  s_waitcnt lgkmcnt(3)
  v_mfma_f32_16x16x32_bf16 v[20:23], v[52:55], v[4:7], 0
  ds_read_b128 v[52:55], v75 offset:17408
  s_waitcnt lgkmcnt(3)
  v_mfma_f32_16x16x32_bf16 v[24:27], v[56:59], v[4:7], 0
  ds_read_b128 v[56:59], v75 offset:21504
  s_waitcnt lgkmcnt(3)
  v_mfma_f32_16x16x32_bf16 v[20:23], v[60:63], v[8:11], v[20:23]
  ds_read_b128 v[60:63], v75 offset:18432
  s_waitcnt lgkmcnt(3)
  v_mfma_f32_16x16x32_bf16 v[24:27], v[64:67], v[8:11], v[24:27]
  ds_read_b128 v[64:67], v75 offset:22528
  s_waitcnt lgkmcnt(3)
  v_mfma_f32_16x16x32_bf16 v[20:23], v[52:55], v[12:15], v[20:23]
  s_waitcnt lgkmcnt(2)
  v_mfma_f32_16x16x32_bf16 v[24:27], v[56:59], v[12:15], v[24:27]
  s_waitcnt lgkmcnt(1)
  v_mfma_f32_16x16x32_bf16 v[20:23], v[60:63], v[16:19], v[20:23]
  s_waitcnt lgkmcnt(0)
  v_mfma_f32_16x16x32_bf16 v[24:27], v[64:67], v[16:19], v[24:27]
  s_nop 7
  v_permlane32_swap_b32 v20, v24
  v_permlane32_swap_b32 v21, v25
  v_permlane32_swap_b32 v22, v26
  v_permlane32_swap_b32 v23, v27
  v_add_f32_dpp v20, v24, v20 row_ror:8 row_mask:0xf bank_mask:0xf
  v_add_f32_dpp v21, v25, v21 row_ror:8 row_mask:0xf bank_mask:0xf
  v_add_f32_dpp v22, v26, v22 row_ror:8 row_mask:0xf bank_mask:0xf
  v_add_f32_dpp v23, v27, v23 row_ror:8 row_mask:0xf bank_mask:0xf
  v_cvt_pk_bf16_f32 v24, v20, v21
  v_cvt_pk_bf16_f32 v25, v22, v23
  v_perm_b32 v20, v24, s35, v72
  v_perm_b32 v21, v24, s35, v73
  v_perm_b32 v22, v25, s35, v72
  v_perm_b32 v23, v25, s35, v73
  v_max3_f32 v26, v20, v21, v22
  v_max3_f32 v26, v26, v23, s37
  s_nop 1
  v_max_f32_dpp v26, v26, v26 row_ror:8 row_mask:0xf bank_mask:0xf
  s_nop 1
  v_max_f32_dpp v26, v26, v26 row_bcast:15 row_mask:0xa bank_mask:0xf
  s_nop 1
  v_max_f32_dpp v26, v26, v26 row_bcast:31 row_mask:0xc bank_mask:0xf
  s_nop 0
  v_readlane_b32 s37, v26, 63
  s_nop 1
  v_mul_f32 v78, s37, v74
  v_fma_f32 v20, v20, s34, v78
  v_fma_f32 v21, v21, s34, v78
  v_fma_f32 v22, v22, s34, v78
  v_fma_f32 v23, v23, s34, v78
  v_sub_f32 v27, v78, v0
  v_exp_f32 v20, v20
  v_exp_f32 v21, v21
  v_exp_f32 v22, v22
  v_exp_f32 v23, v23
  v_exp_f32 v27, v27
  v_add_f32 v26, v20, v21
  v_add_f32 v24, v22, v23
  v_cvt_pk_bf16_f32 v20, v20, v20
  v_cvt_pk_bf16_f32 v21, v21, v21
  v_cvt_pk_bf16_f32 v22, v22, v22
  v_cvt_pk_bf16_f32 v23, v23, v23
  v_add_f32 v26, v26, v24
  v_fma_f32 v77, v77, v27, v26
  v_mul_f32 v44, v27, v44
  v_mul_f32 v45, v27, v45
  v_mul_f32 v46, v27, v46
  v_mul_f32 v47, v27, v47
  v_mul_f32 v48, v27, v48
  v_mul_f32 v49, v27, v49
  v_mul_f32 v50, v27, v50
  v_mul_f32 v51, v27, v51
  v_and_b32 v28, v20, v68
  v_and_b32 v29, v20, v69
  v_and_b32 v30, v20, v70
  v_and_b32 v31, v20, v71
  v_and_b32 v32, v21, v68
  v_and_b32 v33, v21, v69
  v_and_b32 v34, v21, v70
  v_and_b32 v35, v21, v71
  ds_read_b128 v[52:55], v75 offset:23552
  ds_read_b128 v[56:59], v75 offset:24576
  ds_read_b128 v[60:63], v75 offset:25600
  ds_read_b128 v[64:67], v75 offset:26624
  s_waitcnt lgkmcnt(3)
  v_mfma_f32_16x16x32_bf16 v[44:47], v[52:55], v[28:31], v[44:47]
  ds_read_b128 v[52:55], v75 offset:27648
  s_waitcnt lgkmcnt(3)
  v_mfma_f32_16x16x32_bf16 v[48:51], v[56:59], v[28:31], v[48:51]
  ds_read_b128 v[56:59], v75 offset:28672
  v_and_b32 v28, v22, v68
  v_and_b32 v29, v22, v69
  v_and_b32 v30, v22, v70
  v_and_b32 v31, v22, v71
  s_waitcnt lgkmcnt(3)
  v_mfma_f32_16x16x32_bf16 v[44:47], v[60:63], v[32:35], v[44:47]
  ds_read_b128 v[60:63], v75 offset:29696
  s_waitcnt lgkmcnt(3)
  v_mfma_f32_16x16x32_bf16 v[48:51], v[64:67], v[32:35], v[48:51]
  ds_read_b128 v[64:67], v75 offset:30720
  v_and_b32 v32, v23, v68
  v_and_b32 v33, v23, v69
  v_and_b32 v34, v23, v70
  v_and_b32 v35, v23, v71
  s_waitcnt lgkmcnt(3)
  v_mfma_f32_16x16x32_bf16 v[44:47], v[52:55], v[28:31], v[44:47]
  s_waitcnt lgkmcnt(2)
  v_mfma_f32_16x16x32_bf16 v[48:51], v[56:59], v[28:31], v[48:51]
  s_waitcnt lgkmcnt(1)
  v_mfma_f32_16x16x32_bf16 v[44:47], v[60:63], v[32:35], v[44:47]
  s_waitcnt lgkmcnt(0)
  v_mfma_f32_16x16x32_bf16 v[48:51], v[64:67], v[32:35], v[48:51]
  ds_read_b128 v[52:55], v75 offset:31744
  ds_read_b128 v[56:59], v75 offset:35840
  ds_read_b128 v[60:63], v75 offset:32768
  ds_read_b128 v[64:67], v75 offset:36864
  s_waitcnt lgkmcnt(3)
  v_mfma_f32_16x16x32_bf16 v[20:23], v[52:55], v[4:7], 0
  ds_read_b128 v[52:55], v75 offset:33792
  s_waitcnt lgkmcnt(3)
  v_mfma_f32_16x16x32_bf16 v[24:27], v[56:59], v[4:7], 0
  ds_read_b128 v[56:59], v75 offset:37888
  s_waitcnt lgkmcnt(3)
  v_mfma_f32_16x16x32_bf16 v[20:23], v[60:63], v[8:11], v[20:23]
  ds_read_b128 v[60:63], v75 offset:34816
  s_waitcnt lgkmcnt(3)
  v_mfma_f32_16x16x32_bf16 v[24:27], v[64:67], v[8:11], v[24:27]
  s_waitcnt lgkmcnt(2)
  v_mfma_f32_16x16x32_bf16 v[20:23], v[52:55], v[12:15], v[20:23]
  s_waitcnt lgkmcnt(1)
  v_mfma_f32_16x16x32_bf16 v[24:27], v[56:59], v[12:15], v[24:27]
  s_waitcnt lgkmcnt(0)
  v_mfma_f32_16x16x32_bf16 v[20:23], v[60:63], v[16:19], v[20:23]
  v_mfma_f32_16x16x32_bf16 v[24:27], a[0:3], v[16:19], v[24:27]
  s_nop 7
  v_permlane32_swap_b32 v20, v24
  v_permlane32_swap_b32 v21, v25
  v_permlane32_swap_b32 v22, v26
  v_permlane32_swap_b32 v23, v27
  v_add_f32_dpp v20, v24, v20 row_ror:8 row_mask:0xf bank_mask:0xf
  v_add_f32_dpp v21, v25, v21 row_ror:8 row_mask:0xf bank_mask:0xf
  v_add_f32_dpp v22, v26, v22 row_ror:8 row_mask:0xf bank_mask:0xf
  v_add_f32_dpp v23, v27, v23 row_ror:8 row_mask:0xf bank_mask:0xf
  v_cvt_pk_bf16_f32 v24, v20, v21
  v_cvt_pk_bf16_f32 v25, v22, v23
  v_perm_b32 v20, v24, s35, v72
  v_perm_b32 v21, v24, s35, v73
  v_perm_b32 v22, v25, s35, v72
  v_perm_b32 v23, v25, s35, v73
  v_max3_f32 v26, v20, v21, v22
  v_max3_f32 v26, v26, v23, s37
  s_nop 1
  v_max_f32_dpp v26, v26, v26 row_ror:8 row_mask:0xf bank_mask:0xf
  s_nop 1
  v_max_f32_dpp v26, v26, v26 row_bcast:15 row_mask:0xa bank_mask:0xf
  s_nop 1
  v_max_f32_dpp v26, v26, v26 row_bcast:31 row_mask:0xc bank_mask:0xf
  s_nop 0
  v_readlane_b32 s37, v26, 63
  s_nop 1
  v_mul_f32 v0, s37, v74
  v_fma_f32 v20, v20, s34, v0
  v_fma_f32 v21, v21, s34, v0
  v_fma_f32 v22, v22, s34, v0
  v_fma_f32 v23, v23, s34, v0
  v_sub_f32 v27, v0, v78
  v_exp_f32 v20, v20
  v_exp_f32 v21, v21
  v_exp_f32 v22, v22
  v_exp_f32 v23, v23
  v_exp_f32 v27, v27
  v_add_f32 v26, v20, v21
  v_add_f32 v24, v22, v23
  v_cvt_pk_bf16_f32 v20, v20, v20
  v_cvt_pk_bf16_f32 v21, v21, v21
  v_cvt_pk_bf16_f32 v22, v22, v22
  v_cvt_pk_bf16_f32 v23, v23, v23
  v_add_f32 v26, v26, v24
  v_fma_f32 v77, v77, v27, v26
  v_mul_f32 v44, v27, v44
  v_mul_f32 v45, v27, v45
  v_mul_f32 v46, v27, v46
  v_mul_f32 v47, v27, v47
  v_mul_f32 v48, v27, v48
  v_mul_f32 v49, v27, v49
  v_mul_f32 v50, v27, v50
  v_mul_f32 v51, v27, v51
  v_and_b32 v28, v20, v68
  v_and_b32 v29, v20, v69
  v_and_b32 v30, v20, v70
  v_and_b32 v31, v20, v71
  v_and_b32 v32, v21, v68
  v_and_b32 v33, v21, v69
  v_and_b32 v34, v21, v70
  v_and_b32 v35, v21, v71
  v_mfma_f32_16x16x32_bf16 v[44:47], a[4:7], v[28:31], v[44:47]
  v_mfma_f32_16x16x32_bf16 v[48:51], a[8:11], v[28:31], v[48:51]
  v_and_b32 v28, v22, v68
  v_and_b32 v29, v22, v69
  v_and_b32 v30, v22, v70
  v_and_b32 v31, v22, v71
  v_mfma_f32_16x16x32_bf16 v[44:47], a[12:15], v[32:35], v[44:47]
  v_mfma_f32_16x16x32_bf16 v[48:51], a[16:19], v[32:35], v[48:51]
  v_and_b32 v32, v23, v68
  v_and_b32 v33, v23, v69
  v_and_b32 v34, v23, v70
  v_and_b32 v35, v23, v71
  v_mfma_f32_16x16x32_bf16 v[44:47], a[20:23], v[28:31], v[44:47]
  v_mfma_f32_16x16x32_bf16 v[48:51], a[24:27], v[28:31], v[48:51]
  v_mfma_f32_16x16x32_bf16 v[44:47], a[28:31], v[32:35], v[44:47]
  v_mfma_f32_16x16x32_bf16 v[48:51], a[32:35], v[32:35], v[48:51]
  v_mfma_f32_16x16x32_bf16 v[20:23], a[36:39], v[4:7], 0
  v_mfma_f32_16x16x32_bf16 v[24:27], a[52:55], v[4:7], 0
  v_mfma_f32_16x16x32_bf16 v[20:23], a[40:43], v[8:11], v[20:23]
  v_mfma_f32_16x16x32_bf16 v[24:27], a[56:59], v[8:11], v[24:27]
  v_mfma_f32_16x16x32_bf16 v[20:23], a[44:47], v[12:15], v[20:23]
  v_mfma_f32_16x16x32_bf16 v[24:27], a[60:63], v[12:15], v[24:27]
  v_mfma_f32_16x16x32_bf16 v[20:23], a[48:51], v[16:19], v[20:23]
  v_mfma_f32_16x16x32_bf16 v[24:27], a[64:67], v[16:19], v[24:27]
  s_nop 7
  v_permlane32_swap_b32 v20, v24
  v_permlane32_swap_b32 v21, v25
  v_permlane32_swap_b32 v22, v26
  v_permlane32_swap_b32 v23, v27
  v_add_f32_dpp v20, v24, v20 row_ror:8 row_mask:0xf bank_mask:0xf
  v_add_f32_dpp v21, v25, v21 row_ror:8 row_mask:0xf bank_mask:0xf
  v_add_f32_dpp v22, v26, v22 row_ror:8 row_mask:0xf bank_mask:0xf
  v_add_f32_dpp v23, v27, v23 row_ror:8 row_mask:0xf bank_mask:0xf
  v_cvt_pk_bf16_f32 v24, v20, v21
  v_cvt_pk_bf16_f32 v25, v22, v23
  v_perm_b32 v20, v24, s35, v72
  v_perm_b32 v21, v24, s35, v73
  v_perm_b32 v22, v25, s35, v72
  v_perm_b32 v23, v25, s35, v73
  v_max3_f32 v26, v20, v21, v22
  v_max3_f32 v26, v26, v23, s37
  s_nop 1
  v_max_f32_dpp v26, v26, v26 row_ror:8 row_mask:0xf bank_mask:0xf
  s_nop 1
  v_max_f32_dpp v26, v26, v26 row_bcast:15 row_mask:0xa bank_mask:0xf
  s_nop 1
  v_max_f32_dpp v26, v26, v26 row_bcast:31 row_mask:0xc bank_mask:0xf
  s_nop 0
  v_readlane_b32 s37, v26, 63
  s_nop 1
  v_mul_f32 v78, s37, v74
  v_fma_f32 v20, v20, s34, v78
  v_fma_f32 v21, v21, s34, v78
  v_fma_f32 v22, v22, s34, v78
  v_fma_f32 v23, v23, s34, v78
  v_sub_f32 v27, v78, v0
  v_exp_f32 v20, v20
  v_exp_f32 v21, v21
  v_exp_f32 v22, v22
  v_exp_f32 v23, v23
  v_exp_f32 v27, v27
  v_add_f32 v26, v20, v21
  v_add_f32 v24, v22, v23
  v_cvt_pk_bf16_f32 v20, v20, v20
  v_cvt_pk_bf16_f32 v21, v21, v21
  v_cvt_pk_bf16_f32 v22, v22, v22
  v_cvt_pk_bf16_f32 v23, v23, v23
  v_add_f32 v26, v26, v24
  v_fma_f32 v77, v77, v27, v26
  v_mul_f32 v44, v27, v44
  v_mul_f32 v45, v27, v45
  v_mul_f32 v46, v27, v46
  v_mul_f32 v47, v27, v47
  v_mul_f32 v48, v27, v48
  v_mul_f32 v49, v27, v49
  v_mul_f32 v50, v27, v50
  v_mul_f32 v51, v27, v51
  v_and_b32 v28, v20, v68
  v_and_b32 v29, v20, v69
  v_and_b32 v30, v20, v70
  v_and_b32 v31, v20, v71
  v_and_b32 v32, v21, v68
  v_and_b32 v33, v21, v69
  v_and_b32 v34, v21, v70
  v_and_b32 v35, v21, v71
  v_mfma_f32_16x16x32_bf16 v[44:47], a[68:71], v[28:31], v[44:47]
  v_mfma_f32_16x16x32_bf16 v[48:51], a[72:75], v[28:31], v[48:51]
  v_and_b32 v28, v22, v68
  v_and_b32 v29, v22, v69
  v_and_b32 v30, v22, v70
  v_and_b32 v31, v22, v71
  v_mfma_f32_16x16x32_bf16 v[44:47], a[76:79], v[32:35], v[44:47]
  v_mfma_f32_16x16x32_bf16 v[48:51], a[80:83], v[32:35], v[48:51]
  v_and_b32 v32, v23, v68
  v_and_b32 v33, v23, v69
  v_and_b32 v34, v23, v70
  v_and_b32 v35, v23, v71
  v_mfma_f32_16x16x32_bf16 v[44:47], a[84:87], v[28:31], v[44:47]
  v_mfma_f32_16x16x32_bf16 v[48:51], a[88:91], v[28:31], v[48:51]
  v_mfma_f32_16x16x32_bf16 v[44:47], a[92:95], v[32:35], v[44:47]
  v_mfma_f32_16x16x32_bf16 v[48:51], a[96:99], v[32:35], v[48:51]
  v_mfma_f32_16x16x32_bf16 v[20:23], a[100:103], v[4:7], 0
  v_mfma_f32_16x16x32_bf16 v[24:27], a[116:119], v[4:7], 0
  v_mfma_f32_16x16x32_bf16 v[20:23], a[104:107], v[8:11], v[20:23]
  v_mfma_f32_16x16x32_bf16 v[24:27], a[120:123], v[8:11], v[24:27]
  v_mfma_f32_16x16x32_bf16 v[20:23], a[108:111], v[12:15], v[20:23]
  v_mfma_f32_16x16x32_bf16 v[24:27], a[124:127], v[12:15], v[24:27]
  v_mfma_f32_16x16x32_bf16 v[20:23], a[112:115], v[16:19], v[20:23]
  v_mfma_f32_16x16x32_bf16 v[24:27], a[128:131], v[16:19], v[24:27]
  s_nop 7
  v_permlane32_swap_b32 v20, v24
  v_permlane32_swap_b32 v21, v25
  v_permlane32_swap_b32 v22, v26
  v_permlane32_swap_b32 v23, v27
  v_add_f32_dpp v20, v24, v20 row_ror:8 row_mask:0xf bank_mask:0xf
  v_add_f32_dpp v21, v25, v21 row_ror:8 row_mask:0xf bank_mask:0xf
  v_add_f32_dpp v22, v26, v22 row_ror:8 row_mask:0xf bank_mask:0xf
  v_add_f32_dpp v23, v27, v23 row_ror:8 row_mask:0xf bank_mask:0xf
  v_cvt_pk_bf16_f32 v24, v20, v21
  v_cvt_pk_bf16_f32 v25, v22, v23
  v_perm_b32 v20, v24, s35, v72
  v_perm_b32 v21, v24, s35, v73
  v_perm_b32 v22, v25, s35, v72
  v_perm_b32 v23, v25, s35, v73
  v_max3_f32 v26, v20, v21, v22
  v_max3_f32 v26, v26, v23, s37
  s_nop 1
  v_max_f32_dpp v26, v26, v26 row_ror:8 row_mask:0xf bank_mask:0xf
  s_nop 1
  v_max_f32_dpp v26, v26, v26 row_bcast:15 row_mask:0xa bank_mask:0xf
  s_nop 1
  v_max_f32_dpp v26, v26, v26 row_bcast:31 row_mask:0xc bank_mask:0xf
  s_nop 0
  v_readlane_b32 s37, v26, 63
  s_nop 1
  v_mul_f32 v0, s37, v74
  v_fma_f32 v20, v20, s34, v0
  v_fma_f32 v21, v21, s34, v0
  v_fma_f32 v22, v22, s34, v0
  v_fma_f32 v23, v23, s34, v0
  v_sub_f32 v27, v0, v78
  v_exp_f32 v20, v20
  v_exp_f32 v21, v21
  v_exp_f32 v22, v22
  v_exp_f32 v23, v23
  v_exp_f32 v27, v27
  v_add_f32 v26, v20, v21
  v_add_f32 v24, v22, v23
  v_cvt_pk_bf16_f32 v20, v20, v20
  v_cvt_pk_bf16_f32 v21, v21, v21
  v_cvt_pk_bf16_f32 v22, v22, v22
  v_cvt_pk_bf16_f32 v23, v23, v23
  v_add_f32 v26, v26, v24
  v_fma_f32 v77, v77, v27, v26
  v_mul_f32 v44, v27, v44
  v_mul_f32 v45, v27, v45
  v_mul_f32 v46, v27, v46
  v_mul_f32 v47, v27, v47
  v_mul_f32 v48, v27, v48
  v_mul_f32 v49, v27, v49
  v_mul_f32 v50, v27, v50
  v_mul_f32 v51, v27, v51
  v_and_b32 v28, v20, v68
  v_and_b32 v29, v20, v69
  v_and_b32 v30, v20, v70
  v_and_b32 v31, v20, v71
  v_and_b32 v32, v21, v68
  v_and_b32 v33, v21, v69
  v_and_b32 v34, v21, v70
  v_and_b32 v35, v21, v71
  v_mfma_f32_16x16x32_bf16 v[44:47], a[132:135], v[28:31], v[44:47]
  v_mfma_f32_16x16x32_bf16 v[48:51], a[136:139], v[28:31], v[48:51]
  v_and_b32 v28, v22, v68
  v_and_b32 v29, v22, v69
  v_and_b32 v30, v22, v70
  v_and_b32 v31, v22, v71
  v_mfma_f32_16x16x32_bf16 v[44:47], a[140:143], v[32:35], v[44:47]
  v_mfma_f32_16x16x32_bf16 v[48:51], a[144:147], v[32:35], v[48:51]
  v_and_b32 v32, v23, v68
  v_and_b32 v33, v23, v69
  v_and_b32 v34, v23, v70
  v_and_b32 v35, v23, v71
  v_mfma_f32_16x16x32_bf16 v[44:47], a[148:151], v[28:31], v[44:47]
  v_mfma_f32_16x16x32_bf16 v[48:51], a[152:155], v[28:31], v[48:51]
  v_mfma_f32_16x16x32_bf16 v[44:47], a[156:159], v[32:35], v[44:47]
  v_mfma_f32_16x16x32_bf16 v[48:51], a[160:163], v[32:35], v[48:51]
  v_mfma_f32_16x16x32_bf16 v[20:23], a[164:167], v[4:7], 0
  v_mfma_f32_16x16x32_bf16 v[24:27], a[180:183], v[4:7], 0
  v_mfma_f32_16x16x32_bf16 v[20:23], a[168:171], v[8:11], v[20:23]
  v_mfma_f32_16x16x32_bf16 v[24:27], a[184:187], v[8:11], v[24:27]
  v_mfma_f32_16x16x32_bf16 v[20:23], a[172:175], v[12:15], v[20:23]
  v_mfma_f32_16x16x32_bf16 v[24:27], a[188:191], v[12:15], v[24:27]
  v_mfma_f32_16x16x32_bf16 v[20:23], a[176:179], v[16:19], v[20:23]
  v_mfma_f32_16x16x32_bf16 v[24:27], a[192:195], v[16:19], v[24:27]
  s_nop 7
  v_permlane32_swap_b32 v20, v24
  v_permlane32_swap_b32 v21, v25
  v_permlane32_swap_b32 v22, v26
  v_permlane32_swap_b32 v23, v27
  v_add_f32_dpp v20, v24, v20 row_ror:8 row_mask:0xf bank_mask:0xf
  v_add_f32_dpp v21, v25, v21 row_ror:8 row_mask:0xf bank_mask:0xf
  v_add_f32_dpp v22, v26, v22 row_ror:8 row_mask:0xf bank_mask:0xf
  v_add_f32_dpp v23, v27, v23 row_ror:8 row_mask:0xf bank_mask:0xf
  v_cvt_pk_bf16_f32 v24, v20, v21
  v_cvt_pk_bf16_f32 v25, v22, v23
  v_perm_b32 v20, v24, s35, v72
  v_perm_b32 v21, v24, s35, v73
  v_perm_b32 v22, v25, s35, v72
  v_perm_b32 v23, v25, s35, v73
  v_max3_f32 v26, v20, v21, v22
  v_max3_f32 v26, v26, v23, s37
  s_nop 1
  v_max_f32_dpp v26, v26, v26 row_ror:8 row_mask:0xf bank_mask:0xf
  s_nop 1
  v_max_f32_dpp v26, v26, v26 row_bcast:15 row_mask:0xa bank_mask:0xf
  s_nop 1
  v_max_f32_dpp v26, v26, v26 row_bcast:31 row_mask:0xc bank_mask:0xf
  s_nop 0
  v_readlane_b32 s37, v26, 63
  s_nop 1
  v_mul_f32 v78, s37, v74
  v_fma_f32 v20, v20, s34, v78
  v_fma_f32 v21, v21, s34, v78
  v_fma_f32 v22, v22, s34, v78
  v_fma_f32 v23, v23, s34, v78
  v_sub_f32 v27, v78, v0
  v_exp_f32 v20, v20
  v_exp_f32 v21, v21
  v_exp_f32 v22, v22
  v_exp_f32 v23, v23
  v_exp_f32 v27, v27
  v_add_f32 v26, v20, v21
  v_add_f32 v24, v22, v23
  v_cvt_pk_bf16_f32 v20, v20, v20
  v_cvt_pk_bf16_f32 v21, v21, v21
  v_cvt_pk_bf16_f32 v22, v22, v22
  v_cvt_pk_bf16_f32 v23, v23, v23
  v_add_f32 v26, v26, v24
  v_fma_f32 v77, v77, v27, v26
  v_mul_f32 v44, v27, v44
  v_mul_f32 v45, v27, v45
  v_mul_f32 v46, v27, v46
  v_mul_f32 v47, v27, v47
  v_mul_f32 v48, v27, v48
  v_mul_f32 v49, v27, v49
  v_mul_f32 v50, v27, v50
  v_mul_f32 v51, v27, v51
  v_and_b32 v28, v20, v68
  v_and_b32 v29, v20, v69
  v_and_b32 v30, v20, v70
  v_and_b32 v31, v20, v71
  v_and_b32 v32, v21, v68
  v_and_b32 v33, v21, v69
  v_and_b32 v34, v21, v70
  v_and_b32 v35, v21, v71
  v_mfma_f32_16x16x32_bf16 v[44:47], a[196:199], v[28:31], v[44:47]
  v_mfma_f32_16x16x32_bf16 v[48:51], a[200:203], v[28:31], v[48:51]
  v_and_b32 v28, v22, v68
  v_and_b32 v29, v22, v69
  v_and_b32 v30, v22, v70
  v_and_b32 v31, v22, v71
  v_mfma_f32_16x16x32_bf16 v[44:47], a[204:207], v[32:35], v[44:47]
  v_mfma_f32_16x16x32_bf16 v[48:51], a[208:211], v[32:35], v[48:51]
  v_and_b32 v32, v23, v68
  v_and_b32 v33, v23, v69
  v_and_b32 v34, v23, v70
  v_and_b32 v35, v23, v71
  v_mfma_f32_16x16x32_bf16 v[44:47], a[212:215], v[28:31], v[44:47]
  v_mfma_f32_16x16x32_bf16 v[48:51], a[216:219], v[28:31], v[48:51]
  v_mfma_f32_16x16x32_bf16 v[44:47], a[220:223], v[32:35], v[44:47]
  v_mfma_f32_16x16x32_bf16 v[48:51], a[224:227], v[32:35], v[48:51]
  v_mfma_f32_16x16x32_bf16 v[20:23], a[228:231], v[4:7], 0
  v_mfma_f32_16x16x32_bf16 v[24:27], a[244:247], v[4:7], 0
  v_mfma_f32_16x16x32_bf16 v[20:23], a[232:235], v[8:11], v[20:23]
  v_mfma_f32_16x16x32_bf16 v[24:27], a[248:251], v[8:11], v[24:27]
  v_mfma_f32_16x16x32_bf16 v[20:23], a[236:239], v[12:15], v[20:23]
  v_mfma_f32_16x16x32_bf16 v[24:27], a[252:255], v[12:15], v[24:27]
  v_mfma_f32_16x16x32_bf16 v[20:23], a[240:243], v[16:19], v[20:23]
  v_mfma_f32_16x16x32_bf16 v[24:27], v[152:155], v[16:19], v[24:27]
  s_nop 7
  v_permlane32_swap_b32 v20, v24
  v_permlane32_swap_b32 v21, v25
  v_permlane32_swap_b32 v22, v26
  v_permlane32_swap_b32 v23, v27
  v_add_f32_dpp v20, v24, v20 row_ror:8 row_mask:0xf bank_mask:0xf
  v_add_f32_dpp v21, v25, v21 row_ror:8 row_mask:0xf bank_mask:0xf
  v_add_f32_dpp v22, v26, v22 row_ror:8 row_mask:0xf bank_mask:0xf
  v_add_f32_dpp v23, v27, v23 row_ror:8 row_mask:0xf bank_mask:0xf
  v_cvt_pk_bf16_f32 v24, v20, v21
  v_cvt_pk_bf16_f32 v25, v22, v23
  v_perm_b32 v20, v24, s35, v72
  v_perm_b32 v21, v24, s35, v73
  v_perm_b32 v22, v25, s35, v72
  v_perm_b32 v23, v25, s35, v73
  v_max3_f32 v26, v20, v21, v22
  v_max3_f32 v26, v26, v23, s37
  s_nop 1
  v_max_f32_dpp v26, v26, v26 row_ror:8 row_mask:0xf bank_mask:0xf
  s_nop 1
  v_max_f32_dpp v26, v26, v26 row_bcast:15 row_mask:0xa bank_mask:0xf
  s_nop 1
  v_max_f32_dpp v26, v26, v26 row_bcast:31 row_mask:0xc bank_mask:0xf
  s_nop 0
  v_readlane_b32 s37, v26, 63
  s_nop 1
  v_mul_f32 v0, s37, v74
  v_fma_f32 v20, v20, s34, v0
  v_fma_f32 v21, v21, s34, v0
  v_fma_f32 v22, v22, s34, v0
  v_fma_f32 v23, v23, s34, v0
  v_sub_f32 v27, v0, v78
  v_exp_f32 v20, v20
  v_exp_f32 v21, v21
  v_exp_f32 v22, v22
  v_exp_f32 v23, v23
  v_exp_f32 v27, v27
  v_add_f32 v26, v20, v21
  v_add_f32 v24, v22, v23
  v_cvt_pk_bf16_f32 v20, v20, v20
  v_cvt_pk_bf16_f32 v21, v21, v21
  v_cvt_pk_bf16_f32 v22, v22, v22
  v_cvt_pk_bf16_f32 v23, v23, v23
  v_add_f32 v26, v26, v24
  v_fma_f32 v77, v77, v27, v26
  v_mul_f32 v44, v27, v44
  v_mul_f32 v45, v27, v45
  v_mul_f32 v46, v27, v46
  v_mul_f32 v47, v27, v47
  v_mul_f32 v48, v27, v48
  v_mul_f32 v49, v27, v49
  v_mul_f32 v50, v27, v50
  v_mul_f32 v51, v27, v51
  v_and_b32 v28, v20, v68
  v_and_b32 v29, v20, v69
  v_and_b32 v30, v20, v70
  v_and_b32 v31, v20, v71
  v_and_b32 v32, v21, v68
  v_and_b32 v33, v21, v69
  v_and_b32 v34, v21, v70
  v_and_b32 v35, v21, v71
  v_mfma_f32_16x16x32_bf16 v[44:47], v[156:159], v[28:31], v[44:47]
  v_mfma_f32_16x16x32_bf16 v[48:51], v[160:163], v[28:31], v[48:51]
  v_and_b32 v28, v22, v68
  v_and_b32 v29, v22, v69
  v_and_b32 v30, v22, v70
  v_and_b32 v31, v22, v71
  v_mfma_f32_16x16x32_bf16 v[44:47], v[164:167], v[32:35], v[44:47]
  v_mfma_f32_16x16x32_bf16 v[48:51], v[168:171], v[32:35], v[48:51]
  v_and_b32 v32, v23, v68
  v_and_b32 v33, v23, v69
  v_and_b32 v34, v23, v70
  v_and_b32 v35, v23, v71
  v_mfma_f32_16x16x32_bf16 v[44:47], v[172:175], v[28:31], v[44:47]
  v_mfma_f32_16x16x32_bf16 v[48:51], v[176:179], v[28:31], v[48:51]
  v_mfma_f32_16x16x32_bf16 v[44:47], v[180:183], v[32:35], v[44:47]
  v_mfma_f32_16x16x32_bf16 v[48:51], v[184:187], v[32:35], v[48:51]
  v_mfma_f32_16x16x32_bf16 v[20:23], v[188:191], v[4:7], 0
  v_mfma_f32_16x16x32_bf16 v[24:27], v[204:207], v[4:7], 0
  v_mfma_f32_16x16x32_bf16 v[20:23], v[192:195], v[8:11], v[20:23]
  v_mfma_f32_16x16x32_bf16 v[24:27], v[208:211], v[8:11], v[24:27]
  v_mfma_f32_16x16x32_bf16 v[20:23], v[196:199], v[12:15], v[20:23]
  v_mfma_f32_16x16x32_bf16 v[24:27], v[212:215], v[12:15], v[24:27]
  v_mfma_f32_16x16x32_bf16 v[20:23], v[200:203], v[16:19], v[20:23]
  v_mfma_f32_16x16x32_bf16 v[24:27], v[216:219], v[16:19], v[24:27]
  s_nop 7
  v_permlane32_swap_b32 v20, v24
  v_permlane32_swap_b32 v21, v25
  v_permlane32_swap_b32 v22, v26
  v_permlane32_swap_b32 v23, v27
  v_add_f32_dpp v20, v24, v20 row_ror:8 row_mask:0xf bank_mask:0xf
  v_add_f32_dpp v21, v25, v21 row_ror:8 row_mask:0xf bank_mask:0xf
  v_add_f32_dpp v22, v26, v22 row_ror:8 row_mask:0xf bank_mask:0xf
  v_add_f32_dpp v23, v27, v23 row_ror:8 row_mask:0xf bank_mask:0xf
  v_cvt_pk_bf16_f32 v24, v20, v21
  v_cvt_pk_bf16_f32 v25, v22, v23
  v_perm_b32 v20, v24, s35, v72
  v_perm_b32 v21, v24, s35, v73
  v_perm_b32 v22, v25, s35, v72
  v_perm_b32 v23, v25, s35, v73
  v_max3_f32 v26, v20, v21, v22
  v_max3_f32 v26, v26, v23, s37
  s_nop 1
  v_max_f32_dpp v26, v26, v26 row_ror:8 row_mask:0xf bank_mask:0xf
  s_nop 1
  v_max_f32_dpp v26, v26, v26 row_bcast:15 row_mask:0xa bank_mask:0xf
  s_nop 1
  v_max_f32_dpp v26, v26, v26 row_bcast:31 row_mask:0xc bank_mask:0xf
  s_nop 0
  v_readlane_b32 s37, v26, 63
  s_nop 1
  v_mul_f32 v78, s37, v74
  v_fma_f32 v20, v20, s34, v78
  v_fma_f32 v21, v21, s34, v78
  v_fma_f32 v22, v22, s34, v78
  v_fma_f32 v23, v23, s34, v78
  v_sub_f32 v27, v78, v0
  v_exp_f32 v20, v20
  v_exp_f32 v21, v21
  v_exp_f32 v22, v22
  v_exp_f32 v23, v23
  v_exp_f32 v27, v27
  v_add_f32 v26, v20, v21
  v_add_f32 v24, v22, v23
  v_cvt_pk_bf16_f32 v20, v20, v20
  v_cvt_pk_bf16_f32 v21, v21, v21
  v_cvt_pk_bf16_f32 v22, v22, v22
  v_cvt_pk_bf16_f32 v23, v23, v23
  v_add_f32 v26, v26, v24
  v_fma_f32 v77, v77, v27, v26
  v_mul_f32 v44, v27, v44
  v_mul_f32 v45, v27, v45
  v_mul_f32 v46, v27, v46
  v_mul_f32 v47, v27, v47
  v_mul_f32 v48, v27, v48
  v_mul_f32 v49, v27, v49
  v_mul_f32 v50, v27, v50
  v_mul_f32 v51, v27, v51
  v_and_b32 v28, v20, v68
  v_and_b32 v29, v20, v69
  v_and_b32 v30, v20, v70
  v_and_b32 v31, v20, v71
  v_and_b32 v32, v21, v68
  v_and_b32 v33, v21, v69
  v_and_b32 v34, v21, v70
  v_and_b32 v35, v21, v71
  s_waitcnt vmcnt(17)
  v_mfma_f32_16x16x32_bf16 v[44:47], v[220:223], v[28:31], v[44:47]
  v_mfma_f32_16x16x32_bf16 v[48:51], v[224:227], v[28:31], v[48:51]
  v_and_b32 v28, v22, v68
  v_and_b32 v29, v22, v69
  v_and_b32 v30, v22, v70
  v_and_b32 v31, v22, v71
  v_mfma_f32_16x16x32_bf16 v[44:47], v[228:231], v[32:35], v[44:47]
  v_mfma_f32_16x16x32_bf16 v[48:51], v[232:235], v[32:35], v[48:51]
  v_and_b32 v32, v23, v68
  v_and_b32 v33, v23, v69
  v_and_b32 v34, v23, v70
  v_and_b32 v35, v23, v71
  v_mfma_f32_16x16x32_bf16 v[44:47], v[236:239], v[28:31], v[44:47]
  v_mfma_f32_16x16x32_bf16 v[48:51], v[240:243], v[28:31], v[48:51]
  v_mfma_f32_16x16x32_bf16 v[44:47], v[244:247], v[32:35], v[44:47]
  v_mfma_f32_16x16x32_bf16 v[48:51], v[248:251], v[32:35], v[48:51]
  v_subrev_u32 v27, s32, v75
  s_mov_b32 s51, 0
PW_16:
  v_mov_b32 v24, 1088
  ds_read_b32 v24, v24
  s_waitcnt lgkmcnt(0)
  v_readfirstlane_b32 s47, v24
  s_add_u32 s51, s51, 1
  s_cmp_gt_u32 s51, 320000
  s_cselect_b32 s47, 5, s47
  s_cmp_lt_u32 s47, 5
  s_cbranch_scc1 PW_16
  v_cndmask_b32 v28, v44, v48, s[40:41]
  v_cndmask_b32 v32, v48, v44, s[40:41]
  v_cndmask_b32 v29, v45, v49, s[40:41]
  v_cndmask_b32 v33, v49, v45, s[40:41]
  v_cndmask_b32 v30, v46, v50, s[40:41]
  v_cndmask_b32 v34, v50, v46, s[40:41]
  v_cndmask_b32 v31, v47, v51, s[40:41]
  v_cndmask_b32 v35, v51, v47, s[40:41]
  v_add_f32_dpp v77, v77, v77 row_ror:8 row_mask:0xf bank_mask:0xf
  v_add_f32_dpp v28, v32, v28 row_ror:8 row_mask:0xf bank_mask:0xf
  v_add_f32_dpp v29, v33, v29 row_ror:8 row_mask:0xf bank_mask:0xf
  v_add_f32_dpp v30, v34, v30 row_ror:8 row_mask:0xf bank_mask:0xf
  v_add_f32_dpp v31, v35, v31 row_ror:8 row_mask:0xf bank_mask:0xf
  v_mov_b32 v24, v77
  s_nop 1
  v_permlane16_swap_b32 v77, v24
  v_add_f32 v77, v77, v24
  v_mov_b32 v24, v77
  s_nop 1
  v_permlane32_swap_b32 v77, v24
  v_add_f32 v25, v77, v24
  v_sub_f32 v24, 0, v78
  s_lshl_b32 s47, s42, 10
  v_add_u32 v32, s47, v27
  ds_write_b128 v32, v[28:31] offset:2048
  s_lshl_b32 s47, s42, 3
  v_mov_b32 v33, s47
  ds_write_b64 v33, v[24:25] offset:1024
  v_mov_b32 v34, 1092
  v_mov_b32 v35, 1
  s_waitcnt lgkmcnt(0)
  s_mov_b64 exec, 1
  ds_add_rtn_u32 v33, v34, v35
  s_waitcnt lgkmcnt(0)
  v_readfirstlane_b32 s47, v33
  s_mov_b64 exec, -1
  s_nop 0
  s_cmp_eq_u32 s47, 3
  s_cbranch_scc0 PS_17
  ds_read_b128 v[52:55], v27 offset:2048
  ds_read_b128 v[56:59], v27 offset:3072
  ds_read_b128 v[60:63], v27 offset:4096
  ds_read_b128 v[64:67], v27 offset:5120
  v_mov_b32 v32, 0
  ds_read_b128 v[20:23], v32 offset:1024
  ds_read_b128 v[28:31], v32 offset:1040
  v_and_b32 v32, 0x70, v27
  v_lshlrev_b32 v32, 1, v32
  v_and_b32 v33, 0x80, v27
  v_lshl_or_b32 v32, v33, 3, v32
  v_and_b32 v33, 0x300, v27
  v_or_b32 v32, v32, v33
  s_add_u32 s47, s46, 524288
  s_waitcnt lgkmcnt(0)
  s_mov_b64 exec, 1
  ds_add_u32 v34, v35
  s_mov_b64 exec, -1
  v_max3_f32 v25, v20, v22, v28
  v_max_f32 v25, v25, v30
  v_sub_f32 v20, v20, v25
  v_sub_f32 v22, v22, v25
  v_sub_f32 v28, v28, v25
  v_sub_f32 v30, v30, v25
  v_exp_f32 v20, v20
  v_exp_f32 v22, v22
  v_exp_f32 v28, v28
  v_exp_f32 v30, v30
  v_mov_b32 v27, s33
  v_mul_f32 v26, v20, v21
  v_fmac_f32 v26, v22, v23
  v_fmac_f32 v26, v28, v29
  v_fmac_f32 v26, v30, v31
  v_mul_f32 v52, v20, v52
  v_mul_f32 v53, v20, v53
  v_mul_f32 v54, v20, v54
  v_mul_f32 v55, v20, v55
  v_fmac_f32 v52, v22, v56
  v_fmac_f32 v53, v22, v57
  v_fmac_f32 v54, v22, v58
  v_fmac_f32 v55, v22, v59
  v_fmac_f32 v52, v28, v60
  v_fmac_f32 v53, v28, v61
  v_fmac_f32 v54, v28, v62
  v_fmac_f32 v55, v28, v63
  v_fmac_f32 v52, v30, v64
  v_fmac_f32 v53, v30, v65
  v_fmac_f32 v54, v30, v66
  v_fmac_f32 v55, v30, v67
  v_mov_b32 v24, v55
  v_mov_b32 v55, s33
  buffer_store_dwordx4 v[52:55], v32, s[20:23], s47 offen sc1
  buffer_store_dwordx4 v[24:27], v32, s[20:23], s47 offen offset:16 sc1
  s_waitcnt lgkmcnt(0)
PS_17:
  s_nop 1
  v_and_b32 v28, 0x70, v1
  ds_read_b128 v[4:7], v28 offset:0
  ds_read_b128 v[8:11], v28 offset:128
  ds_read_b128 v[12:15], v28 offset:256
  ds_read_b128 v[16:19], v28 offset:384
  s_waitcnt lgkmcnt(0)
DL_18:
  s_waitcnt vmcnt(9)
  v_mfma_f32_16x16x32_bf16 v[20:23], v[84:87], v[4:7], 0
  v_mfma_f32_16x16x32_bf16 v[24:27], v[100:103], v[4:7], 0
  v_mfma_f32_16x16x32_bf16 v[20:23], v[88:91], v[8:11], v[20:23]
  v_mfma_f32_16x16x32_bf16 v[24:27], v[104:107], v[8:11], v[24:27]
  v_mfma_f32_16x16x32_bf16 v[20:23], v[92:95], v[12:15], v[20:23]
  v_mfma_f32_16x16x32_bf16 v[24:27], v[108:111], v[12:15], v[24:27]
  v_mfma_f32_16x16x32_bf16 v[20:23], v[96:99], v[16:19], v[20:23]
  v_mfma_f32_16x16x32_bf16 v[24:27], v[112:115], v[16:19], v[24:27]
  s_waitcnt vmcnt(8)
  v_readfirstlane_b32 s15, v80
  s_nop 1
  s_add_u32 s15, s15, 560
  s_cmp_ge_u32 s15, 1008
  s_cbranch_scc1 DF_19
  s_lshl_b32 s15, s15, 13
  s_add_u32 s15, s15, s12
  buffer_load_dwordx4 v[84:87], v1, s[4:7], s15 offen nt
  buffer_load_dwordx4 v[88:91], v1, s[4:7], s15 offen offset:128 nt
  buffer_load_dwordx4 v[92:95], v1, s[4:7], s15 offen offset:256 nt
  buffer_load_dwordx4 v[96:99], v1, s[4:7], s15 offen offset:384 nt
  buffer_load_dwordx4 v[100:103], v2, s[4:7], s15 offen nt
  buffer_load_dwordx4 v[104:107], v2, s[4:7], s15 offen offset:128 nt
  buffer_load_dwordx4 v[108:111], v2, s[4:7], s15 offen offset:256 nt
  buffer_load_dwordx4 v[112:115], v2, s[4:7], s15 offen offset:384 nt
  s_add_u32 s47, s14, 8192
  v_mov_b32 v80, 1
  s_mov_b64 exec, 1
  buffer_atomic_add v80, off, s[20:23], s47 sc0
  s_mov_b64 exec, -1
  v_permlane32_swap_b32 v20, v24
  v_permlane32_swap_b32 v21, v25
  v_permlane32_swap_b32 v22, v26
  v_permlane32_swap_b32 v23, v27
  v_add_f32_dpp v20, v24, v20 row_ror:8 row_mask:0xf bank_mask:0xf
  v_add_f32_dpp v21, v25, v21 row_ror:8 row_mask:0xf bank_mask:0xf
  v_add_f32_dpp v22, v26, v22 row_ror:8 row_mask:0xf bank_mask:0xf
  v_add_f32_dpp v23, v27, v23 row_ror:8 row_mask:0xf bank_mask:0xf
  v_cvt_pk_bf16_f32 v24, v20, v21
  v_cvt_pk_bf16_f32 v25, v22, v23
  v_perm_b32 v20, v24, s35, v72
  v_perm_b32 v21, v24, s35, v73
  v_perm_b32 v22, v25, s35, v72
  v_perm_b32 v23, v25, s35, v73
  v_max3_f32 v26, v20, v21, v22
  v_max3_f32 v26, v26, v23, s36
  s_nop 1
  v_max_f32_dpp v26, v26, v26 row_ror:8 row_mask:0xf bank_mask:0xf
  s_nop 1
  v_max_f32_dpp v26, v26, v26 row_bcast:15 row_mask:0xa bank_mask:0xf
  s_nop 1
  v_max_f32_dpp v26, v26, v26 row_bcast:31 row_mask:0xc bank_mask:0xf
  s_nop 0
  v_readlane_b32 s36, v26, 63
  s_nop 1
  v_mul_f32 v0, s36, v74
  v_fma_f32 v20, v20, s34, v0
  v_fma_f32 v21, v21, s34, v0
  v_fma_f32 v22, v22, s34, v0
  v_fma_f32 v23, v23, s34, v0
  v_sub_f32 v27, v0, v79
  v_exp_f32 v20, v20
  v_exp_f32 v21, v21
  v_exp_f32 v22, v22
  v_exp_f32 v23, v23
  v_exp_f32 v27, v27
  v_mov_b32 v79, v0
  v_add_f32 v26, v20, v21
  v_add_f32 v24, v22, v23
  v_cvt_pk_bf16_f32 v20, v20, v20
  v_cvt_pk_bf16_f32 v21, v21, v21
  v_cvt_pk_bf16_f32 v22, v22, v22
  v_cvt_pk_bf16_f32 v23, v23, v23
  v_add_f32 v26, v26, v24
  v_fma_f32 v76, v76, v27, v26
  v_mul_f32 v36, v27, v36
  v_mul_f32 v37, v27, v37
  v_mul_f32 v38, v27, v38
  v_mul_f32 v39, v27, v39
  v_mul_f32 v40, v27, v40
  v_mul_f32 v41, v27, v41
  v_mul_f32 v42, v27, v42
  v_mul_f32 v43, v27, v43
  v_and_b32 v28, v20, v68
  v_and_b32 v29, v20, v69
  v_and_b32 v30, v20, v70
  v_and_b32 v31, v20, v71
  v_and_b32 v32, v21, v68
  v_and_b32 v33, v21, v69
  v_and_b32 v34, v21, v70
  v_and_b32 v35, v21, v71
  s_waitcnt vmcnt(9)
  v_mfma_f32_16x16x32_bf16 v[36:39], v[116:119], v[28:31], v[36:39]
  v_mfma_f32_16x16x32_bf16 v[40:43], v[120:123], v[28:31], v[40:43]
  v_and_b32 v28, v22, v68
  v_and_b32 v29, v22, v69
  v_and_b32 v30, v22, v70
  v_and_b32 v31, v22, v71
  v_mfma_f32_16x16x32_bf16 v[36:39], v[124:127], v[32:35], v[36:39]
  v_mfma_f32_16x16x32_bf16 v[40:43], v[128:131], v[32:35], v[40:43]
  v_and_b32 v32, v23, v68
  v_and_b32 v33, v23, v69
  v_and_b32 v34, v23, v70
  v_and_b32 v35, v23, v71
  v_mfma_f32_16x16x32_bf16 v[36:39], v[132:135], v[28:31], v[36:39]
  v_mfma_f32_16x16x32_bf16 v[40:43], v[136:139], v[28:31], v[40:43]
  v_mfma_f32_16x16x32_bf16 v[36:39], v[140:143], v[32:35], v[36:39]
  v_mfma_f32_16x16x32_bf16 v[40:43], v[144:147], v[32:35], v[40:43]
  buffer_load_dwordx4 v[116:119], v3, s[8:11], s15 offen nt
  buffer_load_dwordx4 v[120:123], v3, s[8:11], s15 offen offset:256 nt
  buffer_load_dwordx4 v[124:127], v3, s[8:11], s15 offen offset:512 nt
  buffer_load_dwordx4 v[128:131], v3, s[8:11], s15 offen offset:768 nt
  buffer_load_dwordx4 v[132:135], v3, s[8:11], s15 offen offset:1024 nt
  buffer_load_dwordx4 v[136:139], v3, s[8:11], s15 offen offset:1280 nt
  buffer_load_dwordx4 v[140:143], v3, s[8:11], s15 offen offset:1536 nt
  buffer_load_dwordx4 v[144:147], v3, s[8:11], s15 offen offset:1792 nt
  s_branch DL_18
DF_19:
  s_add_u32 s47, s45, 49152
  v_subrev_u32 v28, s32, v75
  buffer_load_dwordx4 v[252:255], v28, s[20:23], s47 offen sc1
  s_add_u32 s30, s29, 3670016
  buffer_load_dwordx4 v[84:87], v1, s[4:7], s30 offen nt
  buffer_load_dwordx4 v[88:91], v1, s[4:7], s30 offen offset:128 nt
  buffer_load_dwordx4 v[92:95], v1, s[4:7], s30 offen offset:256 nt
  buffer_load_dwordx4 v[96:99], v1, s[4:7], s30 offen offset:384 nt
  buffer_load_dwordx4 v[100:103], v2, s[4:7], s30 offen nt
  buffer_load_dwordx4 v[104:107], v2, s[4:7], s30 offen offset:128 nt
  buffer_load_dwordx4 v[108:111], v2, s[4:7], s30 offen offset:256 nt
  buffer_load_dwordx4 v[112:115], v2, s[4:7], s30 offen offset:384 nt
  v_permlane32_swap_b32 v20, v24
  v_permlane32_swap_b32 v21, v25
  v_permlane32_swap_b32 v22, v26
  v_permlane32_swap_b32 v23, v27
  v_add_f32_dpp v20, v24, v20 row_ror:8 row_mask:0xf bank_mask:0xf
  v_add_f32_dpp v21, v25, v21 row_ror:8 row_mask:0xf bank_mask:0xf
  v_add_f32_dpp v22, v26, v22 row_ror:8 row_mask:0xf bank_mask:0xf
  v_add_f32_dpp v23, v27, v23 row_ror:8 row_mask:0xf bank_mask:0xf
  v_cvt_pk_bf16_f32 v24, v20, v21
  v_cvt_pk_bf16_f32 v25, v22, v23
  v_perm_b32 v20, v24, s35, v72
  v_perm_b32 v21, v24, s35, v73
  v_perm_b32 v22, v25, s35, v72
  v_perm_b32 v23, v25, s35, v73
  v_max3_f32 v26, v20, v21, v22
  v_max3_f32 v26, v26, v23, s36
  s_nop 1
  v_max_f32_dpp v26, v26, v26 row_ror:8 row_mask:0xf bank_mask:0xf
  s_nop 1
  v_max_f32_dpp v26, v26, v26 row_bcast:15 row_mask:0xa bank_mask:0xf
  s_nop 1
  v_max_f32_dpp v26, v26, v26 row_bcast:31 row_mask:0xc bank_mask:0xf
  s_nop 0
  v_readlane_b32 s36, v26, 63
  s_nop 1
  v_mul_f32 v0, s36, v74
  v_fma_f32 v20, v20, s34, v0
  v_fma_f32 v21, v21, s34, v0
  v_fma_f32 v22, v22, s34, v0
  v_fma_f32 v23, v23, s34, v0
  v_sub_f32 v27, v0, v79
  v_exp_f32 v20, v20
  v_exp_f32 v21, v21
  v_exp_f32 v22, v22
  v_exp_f32 v23, v23
  v_exp_f32 v27, v27
  v_add_f32 v26, v20, v21
  v_add_f32 v24, v22, v23
  v_cvt_pk_bf16_f32 v20, v20, v20
  v_cvt_pk_bf16_f32 v21, v21, v21
  v_cvt_pk_bf16_f32 v22, v22, v22
  v_cvt_pk_bf16_f32 v23, v23, v23
  v_add_f32 v26, v26, v24
  v_fma_f32 v76, v76, v27, v26
  v_mul_f32 v36, v27, v36
  v_mul_f32 v37, v27, v37
  v_mul_f32 v38, v27, v38
  v_mul_f32 v39, v27, v39
  v_mul_f32 v40, v27, v40
  v_mul_f32 v41, v27, v41
  v_mul_f32 v42, v27, v42
  v_mul_f32 v43, v27, v43
  v_and_b32 v28, v20, v68
  v_and_b32 v29, v20, v69
  v_and_b32 v30, v20, v70
  v_and_b32 v31, v20, v71
  v_and_b32 v32, v21, v68
  v_and_b32 v33, v21, v69
  v_and_b32 v34, v21, v70
  v_and_b32 v35, v21, v71
  s_waitcnt vmcnt(9)
  v_mfma_f32_16x16x32_bf16 v[36:39], v[116:119], v[28:31], v[36:39]
  v_mfma_f32_16x16x32_bf16 v[40:43], v[120:123], v[28:31], v[40:43]
  v_and_b32 v28, v22, v68
  v_and_b32 v29, v22, v69
  v_and_b32 v30, v22, v70
  v_and_b32 v31, v22, v71
  v_mfma_f32_16x16x32_bf16 v[36:39], v[124:127], v[32:35], v[36:39]
  v_mfma_f32_16x16x32_bf16 v[40:43], v[128:131], v[32:35], v[40:43]
  v_and_b32 v32, v23, v68
  v_and_b32 v33, v23, v69
  v_and_b32 v34, v23, v70
  v_and_b32 v35, v23, v71
  v_mfma_f32_16x16x32_bf16 v[36:39], v[132:135], v[28:31], v[36:39]
  v_mfma_f32_16x16x32_bf16 v[40:43], v[136:139], v[28:31], v[40:43]
  v_mfma_f32_16x16x32_bf16 v[36:39], v[140:143], v[32:35], v[36:39]
  v_mfma_f32_16x16x32_bf16 v[40:43], v[144:147], v[32:35], v[40:43]
  s_add_u32 s31, s29, 3670016
  buffer_load_dwordx4 v[116:119], v3, s[8:11], s31 offen nt
  buffer_load_dwordx4 v[120:123], v3, s[8:11], s31 offen offset:256 nt
  buffer_load_dwordx4 v[124:127], v3, s[8:11], s31 offen offset:512 nt
  buffer_load_dwordx4 v[128:131], v3, s[8:11], s31 offen offset:768 nt
  buffer_load_dwordx4 v[132:135], v3, s[8:11], s31 offen offset:1024 nt
  buffer_load_dwordx4 v[136:139], v3, s[8:11], s31 offen offset:1280 nt
  buffer_load_dwordx4 v[140:143], v3, s[8:11], s31 offen offset:1536 nt
  buffer_load_dwordx4 v[144:147], v3, s[8:11], s31 offen offset:1792 nt
  v_subrev_u32 v27, s32, v75
  s_mov_b32 s51, 0
PW_20:
  v_mov_b32 v24, 1092
  ds_read_b32 v24, v24
  s_waitcnt lgkmcnt(0)
  v_readfirstlane_b32 s47, v24
  s_add_u32 s51, s51, 1
  s_cmp_gt_u32 s51, 320000
  s_cselect_b32 s47, 5, s47
  s_cmp_lt_u32 s47, 5
  s_cbranch_scc1 PW_20
  v_cndmask_b32 v28, v36, v40, s[40:41]
  v_cndmask_b32 v32, v40, v36, s[40:41]
  v_cndmask_b32 v29, v37, v41, s[40:41]
  v_cndmask_b32 v33, v41, v37, s[40:41]
  v_cndmask_b32 v30, v38, v42, s[40:41]
  v_cndmask_b32 v34, v42, v38, s[40:41]
  v_cndmask_b32 v31, v39, v43, s[40:41]
  v_cndmask_b32 v35, v43, v39, s[40:41]
  v_add_f32_dpp v76, v76, v76 row_ror:8 row_mask:0xf bank_mask:0xf
  v_add_f32_dpp v28, v32, v28 row_ror:8 row_mask:0xf bank_mask:0xf
  v_add_f32_dpp v29, v33, v29 row_ror:8 row_mask:0xf bank_mask:0xf
  v_add_f32_dpp v30, v34, v30 row_ror:8 row_mask:0xf bank_mask:0xf
  v_add_f32_dpp v31, v35, v31 row_ror:8 row_mask:0xf bank_mask:0xf
  v_mov_b32 v24, v76
  s_nop 1
  v_permlane16_swap_b32 v76, v24
  v_add_f32 v76, v76, v24
  v_mov_b32 v24, v76
  s_nop 1
  v_permlane32_swap_b32 v76, v24
  v_add_f32 v25, v76, v24
  v_sub_f32 v24, 0, v0
  s_lshl_b32 s47, s42, 10
  v_add_u32 v32, s47, v27
  ds_write_b128 v32, v[28:31] offset:2048
  s_lshl_b32 s47, s42, 3
  v_mov_b32 v33, s47
  ds_write_b64 v33, v[24:25] offset:1024
  v_mov_b32 v34, 1096
  v_mov_b32 v35, 1
  s_waitcnt lgkmcnt(0)
  s_mov_b64 exec, 1
  ds_add_rtn_u32 v33, v34, v35
  s_waitcnt lgkmcnt(0)
  v_readfirstlane_b32 s47, v33
  s_mov_b64 exec, -1
  s_nop 0
  s_cmp_eq_u32 s47, 3
  s_cbranch_scc0 PS_21
  ds_read_b128 v[52:55], v27 offset:2048
  ds_read_b128 v[56:59], v27 offset:3072
  ds_read_b128 v[60:63], v27 offset:4096
  ds_read_b128 v[64:67], v27 offset:5120
  v_mov_b32 v32, 0
  ds_read_b128 v[20:23], v32 offset:1024
  ds_read_b128 v[28:31], v32 offset:1040
  v_and_b32 v32, 0x70, v27
  v_lshlrev_b32 v32, 1, v32
  v_and_b32 v33, 0x80, v27
  v_lshl_or_b32 v32, v33, 3, v32
  v_and_b32 v33, 0x300, v27
  v_or_b32 v32, v32, v33
  s_add_u32 s47, s46, 1048576
  s_waitcnt lgkmcnt(0)
  s_mov_b64 exec, 1
  ds_add_u32 v34, v35
  s_mov_b64 exec, -1
  v_max3_f32 v25, v20, v22, v28
  v_max_f32 v25, v25, v30
  v_sub_f32 v20, v20, v25
  v_sub_f32 v22, v22, v25
  v_sub_f32 v28, v28, v25
  v_sub_f32 v30, v30, v25
  v_exp_f32 v20, v20
  v_exp_f32 v22, v22
  v_exp_f32 v28, v28
  v_exp_f32 v30, v30
  v_mov_b32 v27, s33
  v_mul_f32 v26, v20, v21
  v_fmac_f32 v26, v22, v23
  v_fmac_f32 v26, v28, v29
  v_fmac_f32 v26, v30, v31
  v_mul_f32 v52, v20, v52
  v_mul_f32 v53, v20, v53
  v_mul_f32 v54, v20, v54
  v_mul_f32 v55, v20, v55
  v_fmac_f32 v52, v22, v56
  v_fmac_f32 v53, v22, v57
  v_fmac_f32 v54, v22, v58
  v_fmac_f32 v55, v22, v59
  v_fmac_f32 v52, v28, v60
  v_fmac_f32 v53, v28, v61
  v_fmac_f32 v54, v28, v62
  v_fmac_f32 v55, v28, v63
  v_fmac_f32 v52, v30, v64
  v_fmac_f32 v53, v30, v65
  v_fmac_f32 v54, v30, v66
  v_fmac_f32 v55, v30, v67
  v_mov_b32 v24, v55
  v_mov_b32 v55, s33
  buffer_store_dwordx4 v[52:55], v32, s[20:23], s47 offen sc1
  buffer_store_dwordx4 v[24:27], v32, s[20:23], s47 offen offset:16 sc1
  s_waitcnt lgkmcnt(0)
PS_21:
  s_nop 1
  s_waitcnt vmcnt(16)
  v_mov_b32 v20, v252
  v_mov_b32 v21, v253
  v_mov_b32 v22, v254
  v_mov_b32 v23, v255
  s_mov_b32 s51, 0
  s_branch QC_23
QR_22:
  s_add_u32 s47, s45, 49152
  v_subrev_u32 v20, s32, v75
  buffer_load_dwordx4 v[20:23], v20, s[20:23], s47 offen sc1
  s_waitcnt vmcnt(0)
QC_23:
  v_cmp_eq_u32 s[48:49], s33, v21
  v_cmp_eq_u32 s[54:55], s33, v23
  s_nop 1
  s_and_b64 s[48:49], s[48:49], s[54:55]
  s_cmp_eq_u64 s[48:49], -1
  s_cbranch_scc1 QO_24
  s_add_u32 s51, s51, 1
  s_cmp_gt_u32 s51, 40000
  s_cbranch_scc1 QO_24
  s_sleep 8
  s_branch QR_22
QO_24:
  v_subrev_u32 v28, s32, v75
  v_lshrrev_b32 v28, 1, v28
  ds_write2_b32 v28, v20, v22 offset0:128 offset1:129
  s_waitcnt lgkmcnt(0)
  v_and_b32 v28, 0x70, v1
  ds_read_b128 v[4:7], v28 offset:512
  ds_read_b128 v[8:11], v28 offset:640
  ds_read_b128 v[12:15], v28 offset:768
  ds_read_b128 v[16:19], v28 offset:896
  s_waitcnt lgkmcnt(0)
  s_add_u32 s30, s29, 4128768
  buffer_load_dwordx4 v[252:255], v1, s[4:7], s30 offen nt
  ds_read_b128 v[52:55], v75 offset:3072
  ds_read_b128 v[56:59], v75 offset:0
  ds_read_b128 v[60:63], v75 offset:4096
  ds_read_b128 v[64:67], v75 offset:1024
  v_mfma_f32_16x16x32_bf16 v[20:23], v[148:151], v[4:7], 0
  s_waitcnt lgkmcnt(3)
  v_mfma_f32_16x16x32_bf16 v[24:27], v[52:55], v[4:7], 0
  ds_read_b128 v[52:55], v75 offset:5120
  s_waitcnt lgkmcnt(3)
  v_mfma_f32_16x16x32_bf16 v[20:23], v[56:59], v[8:11], v[20:23]
  ds_read_b128 v[56:59], v75 offset:2048
  s_waitcnt lgkmcnt(3)
  v_mfma_f32_16x16x32_bf16 v[24:27], v[60:63], v[8:11], v[24:27]
  ds_read_b128 v[60:63], v75 offset:6144
  s_waitcnt lgkmcnt(3)
  v_mfma_f32_16x16x32_bf16 v[20:23], v[64:67], v[12:15], v[20:23]
  s_waitcnt lgkmcnt(2)
  v_mfma_f32_16x16x32_bf16 v[24:27], v[52:55], v[12:15], v[24:27]
  s_waitcnt lgkmcnt(1)
  v_mfma_f32_16x16x32_bf16 v[20:23], v[56:59], v[16:19], v[20:23]
  s_waitcnt lgkmcnt(0)
  v_mfma_f32_16x16x32_bf16 v[24:27], v[60:63], v[16:19], v[24:27]
  buffer_load_dwordx4 v[148:151], v1, s[4:7], s30 offen offset:128 nt
  s_add_u32 m0, s32, 0xffffff00
  s_nop 0
  buffer_load_dwordx4 v1, s[4:7], s30 offen offset:256 nt lds
  s_add_u32 m0, s32, 0x280
  s_nop 0
  buffer_load_dwordx4 v1, s[4:7], s30 offen offset:384 nt lds
  s_add_u32 m0, s32, 0x800
  s_nop 0
  buffer_load_dwordx4 v2, s[4:7], s30 offen nt lds
  s_add_u32 m0, s32, 0xb80
  s_nop 0
  buffer_load_dwordx4 v2, s[4:7], s30 offen offset:128 nt lds
  s_add_u32 m0, s32, 0xf00
  s_nop 0
  buffer_load_dwordx4 v2, s[4:7], s30 offen offset:256 nt lds
  s_add_u32 m0, s32, 0x1280
  s_nop 0
  buffer_load_dwordx4 v2, s[4:7], s30 offen offset:384 nt lds
  s_waitcnt vmcnt(23)
  s_add_u32 s31, s29, 4128768
  s_add_u32 m0, s32, 0x1800
  s_nop 0
  buffer_load_dwordx4 v3, s[8:11], s31 offen nt lds
  v_permlane32_swap_b32 v20, v24
  v_permlane32_swap_b32 v21, v25
  v_permlane32_swap_b32 v22, v26
  v_permlane32_swap_b32 v23, v27
  v_add_f32_dpp v20, v24, v20 row_ror:8 row_mask:0xf bank_mask:0xf
  v_add_f32_dpp v21, v25, v21 row_ror:8 row_mask:0xf bank_mask:0xf
  v_add_f32_dpp v22, v26, v22 row_ror:8 row_mask:0xf bank_mask:0xf
  v_add_f32_dpp v23, v27, v23 row_ror:8 row_mask:0xf bank_mask:0xf
  v_cvt_pk_bf16_f32 v24, v20, v21
  v_cvt_pk_bf16_f32 v25, v22, v23
  v_perm_b32 v20, v24, s35, v72
  v_perm_b32 v21, v24, s35, v73
  v_perm_b32 v22, v25, s35, v72
  v_perm_b32 v23, v25, s35, v73
  v_max3_f32 v26, v20, v21, v22
  v_max_f32 v26, v26, v23
  s_nop 1
  v_max_f32_dpp v26, v26, v26 row_ror:8 row_mask:0xf bank_mask:0xf
  s_nop 1
  v_max_f32_dpp v26, v26, v26 row_bcast:15 row_mask:0xa bank_mask:0xf
  s_nop 1
  v_max_f32_dpp v26, v26, v26 row_bcast:31 row_mask:0xc bank_mask:0xf
  s_nop 0
  v_readlane_b32 s37, v26, 63
  s_nop 1
  v_mul_f32 v79, s37, v74
  v_fma_f32 v20, v20, s34, v79
  v_fma_f32 v21, v21, s34, v79
  v_fma_f32 v22, v22, s34, v79
  v_fma_f32 v23, v23, s34, v79
  v_exp_f32 v20, v20
  v_exp_f32 v21, v21
  v_exp_f32 v22, v22
  v_exp_f32 v23, v23
  v_add_f32 v26, v20, v21
  v_add_f32 v24, v22, v23
  v_cvt_pk_bf16_f32 v20, v20, v20
  v_cvt_pk_bf16_f32 v21, v21, v21
  v_cvt_pk_bf16_f32 v22, v22, v22
  v_cvt_pk_bf16_f32 v23, v23, v23
  v_add_f32 v77, v26, v24
  v_and_b32 v28, v20, v68
  v_and_b32 v29, v20, v69
  v_and_b32 v30, v20, v70
  v_and_b32 v31, v20, v71
  v_and_b32 v32, v21, v68
  v_and_b32 v33, v21, v69
  v_and_b32 v34, v21, v70
  v_and_b32 v35, v21, v71
  ds_read_b128 v[52:55], v75 offset:7168
  ds_read_b128 v[56:59], v75 offset:8192
  ds_read_b128 v[60:63], v75 offset:9216
  ds_read_b128 v[64:67], v75 offset:10240
  s_waitcnt lgkmcnt(3)
  v_mfma_f32_16x16x32_bf16 v[44:47], v[52:55], v[28:31], 0
  ds_read_b128 v[52:55], v75 offset:11264
  s_waitcnt lgkmcnt(3)
  v_mfma_f32_16x16x32_bf16 v[48:51], v[56:59], v[28:31], 0
  ds_read_b128 v[56:59], v75 offset:12288
  v_and_b32 v28, v22, v68
  v_and_b32 v29, v22, v69
  v_and_b32 v30, v22, v70
  v_and_b32 v31, v22, v71
  s_waitcnt lgkmcnt(3)
  v_mfma_f32_16x16x32_bf16 v[44:47], v[60:63], v[32:35], v[44:47]
  ds_read_b128 v[60:63], v75 offset:13312
  s_waitcnt lgkmcnt(3)
  v_mfma_f32_16x16x32_bf16 v[48:51], v[64:67], v[32:35], v[48:51]
  ds_read_b128 v[64:67], v75 offset:14336
  v_and_b32 v32, v23, v68
  v_and_b32 v33, v23, v69
  v_and_b32 v34, v23, v70
  v_and_b32 v35, v23, v71
  s_waitcnt lgkmcnt(3)
  v_mfma_f32_16x16x32_bf16 v[44:47], v[52:55], v[28:31], v[44:47]
  s_waitcnt lgkmcnt(2)
  v_mfma_f32_16x16x32_bf16 v[48:51], v[56:59], v[28:31], v[48:51]
  s_waitcnt lgkmcnt(1)
  v_mfma_f32_16x16x32_bf16 v[44:47], v[60:63], v[32:35], v[44:47]
  s_waitcnt lgkmcnt(0)
  v_mfma_f32_16x16x32_bf16 v[48:51], v[64:67], v[32:35], v[48:51]
  s_waitcnt vmcnt(16)
  s_add_u32 m0, s32, 0x1b00
  s_nop 0
  buffer_load_dwordx4 v3, s[8:11], s31 offen offset:256 nt lds
  s_add_u32 m0, s32, 0x1e00
  s_nop 0
  buffer_load_dwordx4 v3, s[8:11], s31 offen offset:512 nt lds
  s_add_u32 m0, s32, 0x2100
  s_nop 0
  buffer_load_dwordx4 v3, s[8:11], s31 offen offset:768 nt lds
  s_add_u32 m0, s32, 0x2400
  s_nop 0
  buffer_load_dwordx4 v3, s[8:11], s31 offen offset:1024 nt lds
  s_add_u32 m0, s32, 0x2700
  s_nop 0
  buffer_load_dwordx4 v3, s[8:11], s31 offen offset:1280 nt lds
  s_add_u32 m0, s32, 0x2a00
  s_nop 0
  buffer_load_dwordx4 v3, s[8:11], s31 offen offset:1536 nt lds
  s_add_u32 m0, s32, 0x2d00
  s_nop 0
  buffer_load_dwordx4 v3, s[8:11], s31 offen offset:1792 nt lds
  s_add_u32 s30, s29, 4587520
  s_add_u32 m0, s32, 0x3800
  s_nop 0
  buffer_load_dwordx4 v1, s[4:7], s30 offen nt lds
  ds_read_b128 v[52:55], v75 offset:15360
  ds_read_b128 v[56:59], v75 offset:19456
  ds_read_b128 v[60:63], v75 offset:16384
  ds_read_b128 v[64:67], v75 offset:20480
  s_waitcnt lgkmcnt(3)
  v_mfma_f32_16x16x32_bf16 v[20:23], v[52:55], v[4:7], 0
  ds_read_b128 v[52:55], v75 offset:17408
  s_waitcnt lgkmcnt(3)
  v_mfma_f32_16x16x32_bf16 v[24:27], v[56:59], v[4:7], 0
  ds_read_b128 v[56:59], v75 offset:21504
  s_waitcnt lgkmcnt(3)
  v_mfma_f32_16x16x32_bf16 v[20:23], v[60:63], v[8:11], v[20:23]
  ds_read_b128 v[60:63], v75 offset:18432
  s_waitcnt lgkmcnt(3)
  v_mfma_f32_16x16x32_bf16 v[24:27], v[64:67], v[8:11], v[24:27]
  ds_read_b128 v[64:67], v75 offset:22528
  s_waitcnt lgkmcnt(3)
  v_mfma_f32_16x16x32_bf16 v[20:23], v[52:55], v[12:15], v[20:23]
  s_waitcnt lgkmcnt(2)
  v_mfma_f32_16x16x32_bf16 v[24:27], v[56:59], v[12:15], v[24:27]
  s_waitcnt lgkmcnt(1)
  v_mfma_f32_16x16x32_bf16 v[20:23], v[60:63], v[16:19], v[20:23]
  s_waitcnt lgkmcnt(0)
  v_mfma_f32_16x16x32_bf16 v[24:27], v[64:67], v[16:19], v[24:27]
  s_waitcnt vmcnt(16)
  s_add_u32 m0, s32, 0x3b80
  s_nop 0
  buffer_load_dwordx4 v1, s[4:7], s30 offen offset:128 nt lds
  s_add_u32 m0, s32, 0x3f00
  s_nop 0
  buffer_load_dwordx4 v1, s[4:7], s30 offen offset:256 nt lds
  s_add_u32 m0, s32, 0x4280
  s_nop 0
  buffer_load_dwordx4 v1, s[4:7], s30 offen offset:384 nt lds
  s_add_u32 m0, s32, 0x4800
  s_nop 0
  buffer_load_dwordx4 v2, s[4:7], s30 offen nt lds
  s_add_u32 m0, s32, 0x4b80
  s_nop 0
  buffer_load_dwordx4 v2, s[4:7], s30 offen offset:128 nt lds
  s_add_u32 m0, s32, 0x4f00
  s_nop 0
  buffer_load_dwordx4 v2, s[4:7], s30 offen offset:256 nt lds
  s_add_u32 m0, s32, 0x5280
  s_nop 0
  buffer_load_dwordx4 v2, s[4:7], s30 offen offset:384 nt lds
  s_add_u32 s31, s29, 4587520
  s_add_u32 m0, s32, 0x5800
  s_nop 0
  buffer_load_dwordx4 v3, s[8:11], s31 offen nt lds
  v_permlane32_swap_b32 v20, v24
  v_permlane32_swap_b32 v21, v25
  v_permlane32_swap_b32 v22, v26
  v_permlane32_swap_b32 v23, v27
  v_add_f32_dpp v20, v24, v20 row_ror:8 row_mask:0xf bank_mask:0xf
  v_add_f32_dpp v21, v25, v21 row_ror:8 row_mask:0xf bank_mask:0xf
  v_add_f32_dpp v22, v26, v22 row_ror:8 row_mask:0xf bank_mask:0xf
  v_add_f32_dpp v23, v27, v23 row_ror:8 row_mask:0xf bank_mask:0xf
  v_cvt_pk_bf16_f32 v24, v20, v21
  v_cvt_pk_bf16_f32 v25, v22, v23
  v_perm_b32 v20, v24, s35, v72
  v_perm_b32 v21, v24, s35, v73
  v_perm_b32 v22, v25, s35, v72
  v_perm_b32 v23, v25, s35, v73
  v_max3_f32 v26, v20, v21, v22
  v_max3_f32 v26, v26, v23, s37
  s_nop 1
  v_max_f32_dpp v26, v26, v26 row_ror:8 row_mask:0xf bank_mask:0xf
  s_nop 1
  v_max_f32_dpp v26, v26, v26 row_bcast:15 row_mask:0xa bank_mask:0xf
  s_nop 1
  v_max_f32_dpp v26, v26, v26 row_bcast:31 row_mask:0xc bank_mask:0xf
  s_nop 0
  v_readlane_b32 s37, v26, 63
  s_nop 1
  v_mul_f32 v78, s37, v74
  v_fma_f32 v20, v20, s34, v78
  v_fma_f32 v21, v21, s34, v78
  v_fma_f32 v22, v22, s34, v78
  v_fma_f32 v23, v23, s34, v78
  v_sub_f32 v27, v78, v79
  v_exp_f32 v20, v20
  v_exp_f32 v21, v21
  v_exp_f32 v22, v22
  v_exp_f32 v23, v23
  v_exp_f32 v27, v27
  v_add_f32 v26, v20, v21
  v_add_f32 v24, v22, v23
  v_cvt_pk_bf16_f32 v20, v20, v20
  v_cvt_pk_bf16_f32 v21, v21, v21
  v_cvt_pk_bf16_f32 v22, v22, v22
  v_cvt_pk_bf16_f32 v23, v23, v23
  v_add_f32 v26, v26, v24
  v_fma_f32 v77, v77, v27, v26
  v_mul_f32 v44, v27, v44
  v_mul_f32 v45, v27, v45
  v_mul_f32 v46, v27, v46
  v_mul_f32 v47, v27, v47
  v_mul_f32 v48, v27, v48
  v_mul_f32 v49, v27, v49
  v_mul_f32 v50, v27, v50
  v_mul_f32 v51, v27, v51
  v_and_b32 v28, v20, v68
  v_and_b32 v29, v20, v69
  v_and_b32 v30, v20, v70
  v_and_b32 v31, v20, v71
  v_and_b32 v32, v21, v68
  v_and_b32 v33, v21, v69
  v_and_b32 v34, v21, v70
  v_and_b32 v35, v21, v71
  ds_read_b128 v[52:55], v75 offset:23552
  ds_read_b128 v[56:59], v75 offset:24576
  ds_read_b128 v[60:63], v75 offset:25600
  ds_read_b128 v[64:67], v75 offset:26624
  s_waitcnt lgkmcnt(3)
  v_mfma_f32_16x16x32_bf16 v[44:47], v[52:55], v[28:31], v[44:47]
  ds_read_b128 v[52:55], v75 offset:27648
  s_waitcnt lgkmcnt(3)
  v_mfma_f32_16x16x32_bf16 v[48:51], v[56:59], v[28:31], v[48:51]
  ds_read_b128 v[56:59], v75 offset:28672
  v_and_b32 v28, v22, v68
  v_and_b32 v29, v22, v69
  v_and_b32 v30, v22, v70
  v_and_b32 v31, v22, v71
  s_waitcnt lgkmcnt(3)
  v_mfma_f32_16x16x32_bf16 v[44:47], v[60:63], v[32:35], v[44:47]
  ds_read_b128 v[60:63], v75 offset:29696
  s_waitcnt lgkmcnt(3)
  v_mfma_f32_16x16x32_bf16 v[48:51], v[64:67], v[32:35], v[48:51]
  ds_read_b128 v[64:67], v75 offset:30720
  v_and_b32 v32, v23, v68
  v_and_b32 v33, v23, v69
  v_and_b32 v34, v23, v70
  v_and_b32 v35, v23, v71
  s_waitcnt lgkmcnt(3)
  v_mfma_f32_16x16x32_bf16 v[44:47], v[52:55], v[28:31], v[44:47]
  s_waitcnt lgkmcnt(2)
  v_mfma_f32_16x16x32_bf16 v[48:51], v[56:59], v[28:31], v[48:51]
  s_waitcnt lgkmcnt(1)
  v_mfma_f32_16x16x32_bf16 v[44:47], v[60:63], v[32:35], v[44:47]
  s_waitcnt lgkmcnt(0)
  v_mfma_f32_16x16x32_bf16 v[48:51], v[64:67], v[32:35], v[48:51]
  s_waitcnt vmcnt(16)
  s_add_u32 m0, s32, 0x5b00
  s_nop 0
  buffer_load_dwordx4 v3, s[8:11], s31 offen offset:256 nt lds
  s_add_u32 m0, s32, 0x5e00
  s_nop 0
  buffer_load_dwordx4 v3, s[8:11], s31 offen offset:512 nt lds
  s_add_u32 m0, s32, 0x6100
  s_nop 0
  buffer_load_dwordx4 v3, s[8:11], s31 offen offset:768 nt lds
  s_add_u32 m0, s32, 0x6400
  s_nop 0
  buffer_load_dwordx4 v3, s[8:11], s31 offen offset:1024 nt lds
  s_add_u32 m0, s32, 0x6700
  s_nop 0
  buffer_load_dwordx4 v3, s[8:11], s31 offen offset:1280 nt lds
  s_add_u32 m0, s32, 0x6a00
  s_nop 0
  buffer_load_dwordx4 v3, s[8:11], s31 offen offset:1536 nt lds
  s_add_u32 m0, s32, 0x6d00
  s_nop 0
  buffer_load_dwordx4 v3, s[8:11], s31 offen offset:1792 nt lds
  ds_read_b128 v[52:55], v75 offset:31744
  ds_read_b128 v[56:59], v75 offset:35840
  ds_read_b128 v[60:63], v75 offset:32768
  ds_read_b128 v[64:67], v75 offset:36864
  s_waitcnt lgkmcnt(3)
  v_mfma_f32_16x16x32_bf16 v[20:23], v[52:55], v[4:7], 0
  ds_read_b128 v[52:55], v75 offset:33792
  s_waitcnt lgkmcnt(3)
  v_mfma_f32_16x16x32_bf16 v[24:27], v[56:59], v[4:7], 0
  ds_read_b128 v[56:59], v75 offset:37888
  s_waitcnt lgkmcnt(3)
  v_mfma_f32_16x16x32_bf16 v[20:23], v[60:63], v[8:11], v[20:23]
  ds_read_b128 v[60:63], v75 offset:34816
  s_waitcnt lgkmcnt(3)
  v_mfma_f32_16x16x32_bf16 v[24:27], v[64:67], v[8:11], v[24:27]
  s_waitcnt lgkmcnt(2)
  v_mfma_f32_16x16x32_bf16 v[20:23], v[52:55], v[12:15], v[20:23]
  s_waitcnt lgkmcnt(1)
  v_mfma_f32_16x16x32_bf16 v[24:27], v[56:59], v[12:15], v[24:27]
  s_waitcnt lgkmcnt(0)
  v_mfma_f32_16x16x32_bf16 v[20:23], v[60:63], v[16:19], v[20:23]
  v_mfma_f32_16x16x32_bf16 v[24:27], a[0:3], v[16:19], v[24:27]
  s_nop 7
  v_permlane32_swap_b32 v20, v24
  v_permlane32_swap_b32 v21, v25
  v_permlane32_swap_b32 v22, v26
  v_permlane32_swap_b32 v23, v27
  v_add_f32_dpp v20, v24, v20 row_ror:8 row_mask:0xf bank_mask:0xf
  v_add_f32_dpp v21, v25, v21 row_ror:8 row_mask:0xf bank_mask:0xf
  v_add_f32_dpp v22, v26, v22 row_ror:8 row_mask:0xf bank_mask:0xf
  v_add_f32_dpp v23, v27, v23 row_ror:8 row_mask:0xf bank_mask:0xf
  v_cvt_pk_bf16_f32 v24, v20, v21
  v_cvt_pk_bf16_f32 v25, v22, v23
  v_perm_b32 v20, v24, s35, v72
  v_perm_b32 v21, v24, s35, v73
  v_perm_b32 v22, v25, s35, v72
  v_perm_b32 v23, v25, s35, v73
  v_max3_f32 v26, v20, v21, v22
  v_max3_f32 v26, v26, v23, s37
  s_nop 1
  v_max_f32_dpp v26, v26, v26 row_ror:8 row_mask:0xf bank_mask:0xf
  s_nop 1
  v_max_f32_dpp v26, v26, v26 row_bcast:15 row_mask:0xa bank_mask:0xf
  s_nop 1
  v_max_f32_dpp v26, v26, v26 row_bcast:31 row_mask:0xc bank_mask:0xf
  s_nop 0
  v_readlane_b32 s37, v26, 63
  s_nop 1
  v_mul_f32 v79, s37, v74
  v_fma_f32 v20, v20, s34, v79
  v_fma_f32 v21, v21, s34, v79
  v_fma_f32 v22, v22, s34, v79
  v_fma_f32 v23, v23, s34, v79
  v_sub_f32 v27, v79, v78
  v_exp_f32 v20, v20
  v_exp_f32 v21, v21
  v_exp_f32 v22, v22
  v_exp_f32 v23, v23
  v_exp_f32 v27, v27
  v_add_f32 v26, v20, v21
  v_add_f32 v24, v22, v23
  v_cvt_pk_bf16_f32 v20, v20, v20
  v_cvt_pk_bf16_f32 v21, v21, v21
  v_cvt_pk_bf16_f32 v22, v22, v22
  v_cvt_pk_bf16_f32 v23, v23, v23
  v_add_f32 v26, v26, v24
  v_fma_f32 v77, v77, v27, v26
  v_mul_f32 v44, v27, v44
  v_mul_f32 v45, v27, v45
  v_mul_f32 v46, v27, v46
  v_mul_f32 v47, v27, v47
  v_mul_f32 v48, v27, v48
  v_mul_f32 v49, v27, v49
  v_mul_f32 v50, v27, v50
  v_mul_f32 v51, v27, v51
  v_and_b32 v28, v20, v68
  v_and_b32 v29, v20, v69
  v_and_b32 v30, v20, v70
  v_and_b32 v31, v20, v71
  v_and_b32 v32, v21, v68
  v_and_b32 v33, v21, v69
  v_and_b32 v34, v21, v70
  v_and_b32 v35, v21, v71
  v_mfma_f32_16x16x32_bf16 v[44:47], a[4:7], v[28:31], v[44:47]
  v_mfma_f32_16x16x32_bf16 v[48:51], a[8:11], v[28:31], v[48:51]
  v_and_b32 v28, v22, v68
  v_and_b32 v29, v22, v69
  v_and_b32 v30, v22, v70
  v_and_b32 v31, v22, v71
  v_mfma_f32_16x16x32_bf16 v[44:47], a[12:15], v[32:35], v[44:47]
  v_mfma_f32_16x16x32_bf16 v[48:51], a[16:19], v[32:35], v[48:51]
  v_and_b32 v32, v23, v68
  v_and_b32 v33, v23, v69
  v_and_b32 v34, v23, v70
  v_and_b32 v35, v23, v71
  v_mfma_f32_16x16x32_bf16 v[44:47], a[20:23], v[28:31], v[44:47]
  v_mfma_f32_16x16x32_bf16 v[48:51], a[24:27], v[28:31], v[48:51]
  v_mfma_f32_16x16x32_bf16 v[44:47], a[28:31], v[32:35], v[44:47]
  v_mfma_f32_16x16x32_bf16 v[48:51], a[32:35], v[32:35], v[48:51]
  v_mfma_f32_16x16x32_bf16 v[20:23], a[36:39], v[4:7], 0
  v_mfma_f32_16x16x32_bf16 v[24:27], a[52:55], v[4:7], 0
  v_mfma_f32_16x16x32_bf16 v[20:23], a[40:43], v[8:11], v[20:23]
  v_mfma_f32_16x16x32_bf16 v[24:27], a[56:59], v[8:11], v[24:27]
  v_mfma_f32_16x16x32_bf16 v[20:23], a[44:47], v[12:15], v[20:23]
  v_mfma_f32_16x16x32_bf16 v[24:27], a[60:63], v[12:15], v[24:27]
  v_mfma_f32_16x16x32_bf16 v[20:23], a[48:51], v[16:19], v[20:23]
  v_mfma_f32_16x16x32_bf16 v[24:27], a[64:67], v[16:19], v[24:27]
  s_nop 7
  v_permlane32_swap_b32 v20, v24
  v_permlane32_swap_b32 v21, v25
  v_permlane32_swap_b32 v22, v26
  v_permlane32_swap_b32 v23, v27
  v_add_f32_dpp v20, v24, v20 row_ror:8 row_mask:0xf bank_mask:0xf
  v_add_f32_dpp v21, v25, v21 row_ror:8 row_mask:0xf bank_mask:0xf
  v_add_f32_dpp v22, v26, v22 row_ror:8 row_mask:0xf bank_mask:0xf
  v_add_f32_dpp v23, v27, v23 row_ror:8 row_mask:0xf bank_mask:0xf
  v_cvt_pk_bf16_f32 v24, v20, v21
  v_cvt_pk_bf16_f32 v25, v22, v23
  v_perm_b32 v20, v24, s35, v72
  v_perm_b32 v21, v24, s35, v73
  v_perm_b32 v22, v25, s35, v72
  v_perm_b32 v23, v25, s35, v73
  v_max3_f32 v26, v20, v21, v22
  v_max3_f32 v26, v26, v23, s37
  s_nop 1
  v_max_f32_dpp v26, v26, v26 row_ror:8 row_mask:0xf bank_mask:0xf
  s_nop 1
  v_max_f32_dpp v26, v26, v26 row_bcast:15 row_mask:0xa bank_mask:0xf
  s_nop 1
  v_max_f32_dpp v26, v26, v26 row_bcast:31 row_mask:0xc bank_mask:0xf
  s_nop 0
  v_readlane_b32 s37, v26, 63
  s_nop 1
  v_mul_f32 v78, s37, v74
  v_fma_f32 v20, v20, s34, v78
  v_fma_f32 v21, v21, s34, v78
  v_fma_f32 v22, v22, s34, v78
  v_fma_f32 v23, v23, s34, v78
  v_sub_f32 v27, v78, v79
  v_exp_f32 v20, v20
  v_exp_f32 v21, v21
  v_exp_f32 v22, v22
  v_exp_f32 v23, v23
  v_exp_f32 v27, v27
  v_add_f32 v26, v20, v21
  v_add_f32 v24, v22, v23
  v_cvt_pk_bf16_f32 v20, v20, v20
  v_cvt_pk_bf16_f32 v21, v21, v21
  v_cvt_pk_bf16_f32 v22, v22, v22
  v_cvt_pk_bf16_f32 v23, v23, v23
  v_add_f32 v26, v26, v24
  v_fma_f32 v77, v77, v27, v26
  v_mul_f32 v44, v27, v44
  v_mul_f32 v45, v27, v45
  v_mul_f32 v46, v27, v46
  v_mul_f32 v47, v27, v47
  v_mul_f32 v48, v27, v48
  v_mul_f32 v49, v27, v49
  v_mul_f32 v50, v27, v50
  v_mul_f32 v51, v27, v51
  v_and_b32 v28, v20, v68
  v_and_b32 v29, v20, v69
  v_and_b32 v30, v20, v70
  v_and_b32 v31, v20, v71
  v_and_b32 v32, v21, v68
  v_and_b32 v33, v21, v69
  v_and_b32 v34, v21, v70
  v_and_b32 v35, v21, v71
  v_mfma_f32_16x16x32_bf16 v[44:47], a[68:71], v[28:31], v[44:47]
  v_mfma_f32_16x16x32_bf16 v[48:51], a[72:75], v[28:31], v[48:51]
  v_and_b32 v28, v22, v68
  v_and_b32 v29, v22, v69
  v_and_b32 v30, v22, v70
  v_and_b32 v31, v22, v71
  v_mfma_f32_16x16x32_bf16 v[44:47], a[76:79], v[32:35], v[44:47]
  v_mfma_f32_16x16x32_bf16 v[48:51], a[80:83], v[32:35], v[48:51]
  v_and_b32 v32, v23, v68
  v_and_b32 v33, v23, v69
  v_and_b32 v34, v23, v70
  v_and_b32 v35, v23, v71
  v_mfma_f32_16x16x32_bf16 v[44:47], a[84:87], v[28:31], v[44:47]
  v_mfma_f32_16x16x32_bf16 v[48:51], a[88:91], v[28:31], v[48:51]
  v_mfma_f32_16x16x32_bf16 v[44:47], a[92:95], v[32:35], v[44:47]
  v_mfma_f32_16x16x32_bf16 v[48:51], a[96:99], v[32:35], v[48:51]
  v_mfma_f32_16x16x32_bf16 v[20:23], a[100:103], v[4:7], 0
  v_mfma_f32_16x16x32_bf16 v[24:27], a[116:119], v[4:7], 0
  v_mfma_f32_16x16x32_bf16 v[20:23], a[104:107], v[8:11], v[20:23]
  v_mfma_f32_16x16x32_bf16 v[24:27], a[120:123], v[8:11], v[24:27]
  v_mfma_f32_16x16x32_bf16 v[20:23], a[108:111], v[12:15], v[20:23]
  v_mfma_f32_16x16x32_bf16 v[24:27], a[124:127], v[12:15], v[24:27]
  v_mfma_f32_16x16x32_bf16 v[20:23], a[112:115], v[16:19], v[20:23]
  v_mfma_f32_16x16x32_bf16 v[24:27], a[128:131], v[16:19], v[24:27]
  s_nop 7
  v_permlane32_swap_b32 v20, v24
  v_permlane32_swap_b32 v21, v25
  v_permlane32_swap_b32 v22, v26
  v_permlane32_swap_b32 v23, v27
  v_add_f32_dpp v20, v24, v20 row_ror:8 row_mask:0xf bank_mask:0xf
  v_add_f32_dpp v21, v25, v21 row_ror:8 row_mask:0xf bank_mask:0xf
  v_add_f32_dpp v22, v26, v22 row_ror:8 row_mask:0xf bank_mask:0xf
  v_add_f32_dpp v23, v27, v23 row_ror:8 row_mask:0xf bank_mask:0xf
  v_cvt_pk_bf16_f32 v24, v20, v21
  v_cvt_pk_bf16_f32 v25, v22, v23
  v_perm_b32 v20, v24, s35, v72
  v_perm_b32 v21, v24, s35, v73
  v_perm_b32 v22, v25, s35, v72
  v_perm_b32 v23, v25, s35, v73
  v_max3_f32 v26, v20, v21, v22
  v_max3_f32 v26, v26, v23, s37
  s_nop 1
  v_max_f32_dpp v26, v26, v26 row_ror:8 row_mask:0xf bank_mask:0xf
  s_nop 1
  v_max_f32_dpp v26, v26, v26 row_bcast:15 row_mask:0xa bank_mask:0xf
  s_nop 1
  v_max_f32_dpp v26, v26, v26 row_bcast:31 row_mask:0xc bank_mask:0xf
  s_nop 0
  v_readlane_b32 s37, v26, 63
  s_nop 1
  v_mul_f32 v79, s37, v74
  v_fma_f32 v20, v20, s34, v79
  v_fma_f32 v21, v21, s34, v79
  v_fma_f32 v22, v22, s34, v79
  v_fma_f32 v23, v23, s34, v79
  v_sub_f32 v27, v79, v78
  v_exp_f32 v20, v20
  v_exp_f32 v21, v21
  v_exp_f32 v22, v22
  v_exp_f32 v23, v23
  v_exp_f32 v27, v27
  v_add_f32 v26, v20, v21
  v_add_f32 v24, v22, v23
  v_cvt_pk_bf16_f32 v20, v20, v20
  v_cvt_pk_bf16_f32 v21, v21, v21
  v_cvt_pk_bf16_f32 v22, v22, v22
  v_cvt_pk_bf16_f32 v23, v23, v23
  v_add_f32 v26, v26, v24
  v_fma_f32 v77, v77, v27, v26
  v_mul_f32 v44, v27, v44
  v_mul_f32 v45, v27, v45
  v_mul_f32 v46, v27, v46
  v_mul_f32 v47, v27, v47
  v_mul_f32 v48, v27, v48
  v_mul_f32 v49, v27, v49
  v_mul_f32 v50, v27, v50
  v_mul_f32 v51, v27, v51
  v_and_b32 v28, v20, v68
  v_and_b32 v29, v20, v69
  v_and_b32 v30, v20, v70
  v_and_b32 v31, v20, v71
  v_and_b32 v32, v21, v68
  v_and_b32 v33, v21, v69
  v_and_b32 v34, v21, v70
  v_and_b32 v35, v21, v71
  v_mfma_f32_16x16x32_bf16 v[44:47], a[132:135], v[28:31], v[44:47]
  v_mfma_f32_16x16x32_bf16 v[48:51], a[136:139], v[28:31], v[48:51]
  v_and_b32 v28, v22, v68
  v_and_b32 v29, v22, v69
  v_and_b32 v30, v22, v70
  v_and_b32 v31, v22, v71
  v_mfma_f32_16x16x32_bf16 v[44:47], a[140:143], v[32:35], v[44:47]
  v_mfma_f32_16x16x32_bf16 v[48:51], a[144:147], v[32:35], v[48:51]
  v_and_b32 v32, v23, v68
  v_and_b32 v33, v23, v69
  v_and_b32 v34, v23, v70
  v_and_b32 v35, v23, v71
  v_mfma_f32_16x16x32_bf16 v[44:47], a[148:151], v[28:31], v[44:47]
  v_mfma_f32_16x16x32_bf16 v[48:51], a[152:155], v[28:31], v[48:51]
  v_mfma_f32_16x16x32_bf16 v[44:47], a[156:159], v[32:35], v[44:47]
  v_mfma_f32_16x16x32_bf16 v[48:51], a[160:163], v[32:35], v[48:51]
  v_mfma_f32_16x16x32_bf16 v[20:23], a[164:167], v[4:7], 0
  v_mfma_f32_16x16x32_bf16 v[24:27], a[180:183], v[4:7], 0
  v_mfma_f32_16x16x32_bf16 v[20:23], a[168:171], v[8:11], v[20:23]
  v_mfma_f32_16x16x32_bf16 v[24:27], a[184:187], v[8:11], v[24:27]
  v_mfma_f32_16x16x32_bf16 v[20:23], a[172:175], v[12:15], v[20:23]
  v_mfma_f32_16x16x32_bf16 v[24:27], a[188:191], v[12:15], v[24:27]
  v_mfma_f32_16x16x32_bf16 v[20:23], a[176:179], v[16:19], v[20:23]
  v_mfma_f32_16x16x32_bf16 v[24:27], a[192:195], v[16:19], v[24:27]
  s_nop 7
  v_permlane32_swap_b32 v20, v24
  v_permlane32_swap_b32 v21, v25
  v_permlane32_swap_b32 v22, v26
  v_permlane32_swap_b32 v23, v27
  v_add_f32_dpp v20, v24, v20 row_ror:8 row_mask:0xf bank_mask:0xf
  v_add_f32_dpp v21, v25, v21 row_ror:8 row_mask:0xf bank_mask:0xf
  v_add_f32_dpp v22, v26, v22 row_ror:8 row_mask:0xf bank_mask:0xf
  v_add_f32_dpp v23, v27, v23 row_ror:8 row_mask:0xf bank_mask:0xf
  v_cvt_pk_bf16_f32 v24, v20, v21
  v_cvt_pk_bf16_f32 v25, v22, v23
  v_perm_b32 v20, v24, s35, v72
  v_perm_b32 v21, v24, s35, v73
  v_perm_b32 v22, v25, s35, v72
  v_perm_b32 v23, v25, s35, v73
  v_max3_f32 v26, v20, v21, v22
  v_max3_f32 v26, v26, v23, s37
  s_nop 1
  v_max_f32_dpp v26, v26, v26 row_ror:8 row_mask:0xf bank_mask:0xf
  s_nop 1
  v_max_f32_dpp v26, v26, v26 row_bcast:15 row_mask:0xa bank_mask:0xf
  s_nop 1
  v_max_f32_dpp v26, v26, v26 row_bcast:31 row_mask:0xc bank_mask:0xf
  s_nop 0
  v_readlane_b32 s37, v26, 63
  s_nop 1
  v_mul_f32 v78, s37, v74
  v_fma_f32 v20, v20, s34, v78
  v_fma_f32 v21, v21, s34, v78
  v_fma_f32 v22, v22, s34, v78
  v_fma_f32 v23, v23, s34, v78
  v_sub_f32 v27, v78, v79
  v_exp_f32 v20, v20
  v_exp_f32 v21, v21
  v_exp_f32 v22, v22
  v_exp_f32 v23, v23
  v_exp_f32 v27, v27
  v_add_f32 v26, v20, v21
  v_add_f32 v24, v22, v23
  v_cvt_pk_bf16_f32 v20, v20, v20
  v_cvt_pk_bf16_f32 v21, v21, v21
  v_cvt_pk_bf16_f32 v22, v22, v22
  v_cvt_pk_bf16_f32 v23, v23, v23
  v_add_f32 v26, v26, v24
  v_fma_f32 v77, v77, v27, v26
  v_mul_f32 v44, v27, v44
  v_mul_f32 v45, v27, v45
  v_mul_f32 v46, v27, v46
  v_mul_f32 v47, v27, v47
  v_mul_f32 v48, v27, v48
  v_mul_f32 v49, v27, v49
  v_mul_f32 v50, v27, v50
  v_mul_f32 v51, v27, v51
  v_and_b32 v28, v20, v68
  v_and_b32 v29, v20, v69
  v_and_b32 v30, v20, v70
  v_and_b32 v31, v20, v71
  v_and_b32 v32, v21, v68
  v_and_b32 v33, v21, v69
  v_and_b32 v34, v21, v70
  v_and_b32 v35, v21, v71
  v_mfma_f32_16x16x32_bf16 v[44:47], a[196:199], v[28:31], v[44:47]
  v_mfma_f32_16x16x32_bf16 v[48:51], a[200:203], v[28:31], v[48:51]
  v_and_b32 v28, v22, v68
  v_and_b32 v29, v22, v69
  v_and_b32 v30, v22, v70
  v_and_b32 v31, v22, v71
  v_mfma_f32_16x16x32_bf16 v[44:47], a[204:207], v[32:35], v[44:47]
  v_mfma_f32_16x16x32_bf16 v[48:51], a[208:211], v[32:35], v[48:51]
  v_and_b32 v32, v23, v68
  v_and_b32 v33, v23, v69
  v_and_b32 v34, v23, v70
  v_and_b32 v35, v23, v71
  v_mfma_f32_16x16x32_bf16 v[44:47], a[212:215], v[28:31], v[44:47]
  v_mfma_f32_16x16x32_bf16 v[48:51], a[216:219], v[28:31], v[48:51]
  v_mfma_f32_16x16x32_bf16 v[44:47], a[220:223], v[32:35], v[44:47]
  v_mfma_f32_16x16x32_bf16 v[48:51], a[224:227], v[32:35], v[48:51]
  v_mfma_f32_16x16x32_bf16 v[20:23], a[228:231], v[4:7], 0
  v_mfma_f32_16x16x32_bf16 v[24:27], a[244:247], v[4:7], 0
  v_mfma_f32_16x16x32_bf16 v[20:23], a[232:235], v[8:11], v[20:23]
  v_mfma_f32_16x16x32_bf16 v[24:27], a[248:251], v[8:11], v[24:27]
  v_mfma_f32_16x16x32_bf16 v[20:23], a[236:239], v[12:15], v[20:23]
  v_mfma_f32_16x16x32_bf16 v[24:27], a[252:255], v[12:15], v[24:27]
  v_mfma_f32_16x16x32_bf16 v[20:23], a[240:243], v[16:19], v[20:23]
  v_mfma_f32_16x16x32_bf16 v[24:27], v[152:155], v[16:19], v[24:27]
  s_nop 7
  v_permlane32_swap_b32 v20, v24
  v_permlane32_swap_b32 v21, v25
  v_permlane32_swap_b32 v22, v26
  v_permlane32_swap_b32 v23, v27
  v_add_f32_dpp v20, v24, v20 row_ror:8 row_mask:0xf bank_mask:0xf
  v_add_f32_dpp v21, v25, v21 row_ror:8 row_mask:0xf bank_mask:0xf
  v_add_f32_dpp v22, v26, v22 row_ror:8 row_mask:0xf bank_mask:0xf
  v_add_f32_dpp v23, v27, v23 row_ror:8 row_mask:0xf bank_mask:0xf
  v_cvt_pk_bf16_f32 v24, v20, v21
  v_cvt_pk_bf16_f32 v25, v22, v23
  v_perm_b32 v20, v24, s35, v72
  v_perm_b32 v21, v24, s35, v73
  v_perm_b32 v22, v25, s35, v72
  v_perm_b32 v23, v25, s35, v73
  v_max3_f32 v26, v20, v21, v22
  v_max3_f32 v26, v26, v23, s37
  s_nop 1
  v_max_f32_dpp v26, v26, v26 row_ror:8 row_mask:0xf bank_mask:0xf
  s_nop 1
  v_max_f32_dpp v26, v26, v26 row_bcast:15 row_mask:0xa bank_mask:0xf
  s_nop 1
  v_max_f32_dpp v26, v26, v26 row_bcast:31 row_mask:0xc bank_mask:0xf
  s_nop 0
  v_readlane_b32 s37, v26, 63
  s_nop 1
  v_mul_f32 v79, s37, v74
  v_fma_f32 v20, v20, s34, v79
  v_fma_f32 v21, v21, s34, v79
  v_fma_f32 v22, v22, s34, v79
  v_fma_f32 v23, v23, s34, v79
  v_sub_f32 v27, v79, v78
  v_exp_f32 v20, v20
  v_exp_f32 v21, v21
  v_exp_f32 v22, v22
  v_exp_f32 v23, v23
  v_exp_f32 v27, v27
  v_add_f32 v26, v20, v21
  v_add_f32 v24, v22, v23
  v_cvt_pk_bf16_f32 v20, v20, v20
  v_cvt_pk_bf16_f32 v21, v21, v21
  v_cvt_pk_bf16_f32 v22, v22, v22
  v_cvt_pk_bf16_f32 v23, v23, v23
  v_add_f32 v26, v26, v24
  v_fma_f32 v77, v77, v27, v26
  v_mul_f32 v44, v27, v44
  v_mul_f32 v45, v27, v45
  v_mul_f32 v46, v27, v46
  v_mul_f32 v47, v27, v47
  v_mul_f32 v48, v27, v48
  v_mul_f32 v49, v27, v49
  v_mul_f32 v50, v27, v50
  v_mul_f32 v51, v27, v51
  v_and_b32 v28, v20, v68
  v_and_b32 v29, v20, v69
  v_and_b32 v30, v20, v70
  v_and_b32 v31, v20, v71
  v_and_b32 v32, v21, v68
  v_and_b32 v33, v21, v69
  v_and_b32 v34, v21, v70
  v_and_b32 v35, v21, v71
  v_mfma_f32_16x16x32_bf16 v[44:47], v[156:159], v[28:31], v[44:47]
  v_mfma_f32_16x16x32_bf16 v[48:51], v[160:163], v[28:31], v[48:51]
  v_and_b32 v28, v22, v68
  v_and_b32 v29, v22, v69
  v_and_b32 v30, v22, v70
  v_and_b32 v31, v22, v71
  v_mfma_f32_16x16x32_bf16 v[44:47], v[164:167], v[32:35], v[44:47]
  v_mfma_f32_16x16x32_bf16 v[48:51], v[168:171], v[32:35], v[48:51]
  v_and_b32 v32, v23, v68
  v_and_b32 v33, v23, v69
  v_and_b32 v34, v23, v70
  v_and_b32 v35, v23, v71
  v_mfma_f32_16x16x32_bf16 v[44:47], v[172:175], v[28:31], v[44:47]
  v_mfma_f32_16x16x32_bf16 v[48:51], v[176:179], v[28:31], v[48:51]
  v_mfma_f32_16x16x32_bf16 v[44:47], v[180:183], v[32:35], v[44:47]
  v_mfma_f32_16x16x32_bf16 v[48:51], v[184:187], v[32:35], v[48:51]
  v_mfma_f32_16x16x32_bf16 v[20:23], v[188:191], v[4:7], 0
  v_mfma_f32_16x16x32_bf16 v[24:27], v[204:207], v[4:7], 0
  v_mfma_f32_16x16x32_bf16 v[20:23], v[192:195], v[8:11], v[20:23]
  v_mfma_f32_16x16x32_bf16 v[24:27], v[208:211], v[8:11], v[24:27]
  v_mfma_f32_16x16x32_bf16 v[20:23], v[196:199], v[12:15], v[20:23]
  v_mfma_f32_16x16x32_bf16 v[24:27], v[212:215], v[12:15], v[24:27]
  v_mfma_f32_16x16x32_bf16 v[20:23], v[200:203], v[16:19], v[20:23]
  v_mfma_f32_16x16x32_bf16 v[24:27], v[216:219], v[16:19], v[24:27]
  s_nop 7
  v_permlane32_swap_b32 v20, v24
  v_permlane32_swap_b32 v21, v25
  v_permlane32_swap_b32 v22, v26
  v_permlane32_swap_b32 v23, v27
  v_add_f32_dpp v20, v24, v20 row_ror:8 row_mask:0xf bank_mask:0xf
  v_add_f32_dpp v21, v25, v21 row_ror:8 row_mask:0xf bank_mask:0xf
  v_add_f32_dpp v22, v26, v22 row_ror:8 row_mask:0xf bank_mask:0xf
  v_add_f32_dpp v23, v27, v23 row_ror:8 row_mask:0xf bank_mask:0xf
  v_cvt_pk_bf16_f32 v24, v20, v21
  v_cvt_pk_bf16_f32 v25, v22, v23
  v_perm_b32 v20, v24, s35, v72
  v_perm_b32 v21, v24, s35, v73
  v_perm_b32 v22, v25, s35, v72
  v_perm_b32 v23, v25, s35, v73
  v_max3_f32 v26, v20, v21, v22
  v_max3_f32 v26, v26, v23, s37
  s_nop 1
  v_max_f32_dpp v26, v26, v26 row_ror:8 row_mask:0xf bank_mask:0xf
  s_nop 1
  v_max_f32_dpp v26, v26, v26 row_bcast:15 row_mask:0xa bank_mask:0xf
  s_nop 1
  v_max_f32_dpp v26, v26, v26 row_bcast:31 row_mask:0xc bank_mask:0xf
  s_nop 0
  v_readlane_b32 s37, v26, 63
  s_nop 1
  v_mul_f32 v78, s37, v74
  v_fma_f32 v20, v20, s34, v78
  v_fma_f32 v21, v21, s34, v78
  v_fma_f32 v22, v22, s34, v78
  v_fma_f32 v23, v23, s34, v78
  v_sub_f32 v27, v78, v79
  v_exp_f32 v20, v20
  v_exp_f32 v21, v21
  v_exp_f32 v22, v22
  v_exp_f32 v23, v23
  v_exp_f32 v27, v27
  v_add_f32 v26, v20, v21
  v_add_f32 v24, v22, v23
  v_cvt_pk_bf16_f32 v20, v20, v20
  v_cvt_pk_bf16_f32 v21, v21, v21
  v_cvt_pk_bf16_f32 v22, v22, v22
  v_cvt_pk_bf16_f32 v23, v23, v23
  v_add_f32 v26, v26, v24
  v_fma_f32 v77, v77, v27, v26
  v_mul_f32 v44, v27, v44
  v_mul_f32 v45, v27, v45
  v_mul_f32 v46, v27, v46
  v_mul_f32 v47, v27, v47
  v_mul_f32 v48, v27, v48
  v_mul_f32 v49, v27, v49
  v_mul_f32 v50, v27, v50
  v_mul_f32 v51, v27, v51
  v_and_b32 v28, v20, v68
  v_and_b32 v29, v20, v69
  v_and_b32 v30, v20, v70
  v_and_b32 v31, v20, v71
  v_and_b32 v32, v21, v68
  v_and_b32 v33, v21, v69
  v_and_b32 v34, v21, v70
  v_and_b32 v35, v21, v71
  v_mfma_f32_16x16x32_bf16 v[44:47], v[220:223], v[28:31], v[44:47]
  v_mfma_f32_16x16x32_bf16 v[48:51], v[224:227], v[28:31], v[48:51]
  v_and_b32 v28, v22, v68
  v_and_b32 v29, v22, v69
  v_and_b32 v30, v22, v70
  v_and_b32 v31, v22, v71
  v_mfma_f32_16x16x32_bf16 v[44:47], v[228:231], v[32:35], v[44:47]
  v_mfma_f32_16x16x32_bf16 v[48:51], v[232:235], v[32:35], v[48:51]
  v_and_b32 v32, v23, v68
  v_and_b32 v33, v23, v69
  v_and_b32 v34, v23, v70
  v_and_b32 v35, v23, v71
  v_mfma_f32_16x16x32_bf16 v[44:47], v[236:239], v[28:31], v[44:47]
  v_mfma_f32_16x16x32_bf16 v[48:51], v[240:243], v[28:31], v[48:51]
  v_mfma_f32_16x16x32_bf16 v[44:47], v[244:247], v[32:35], v[44:47]
  v_mfma_f32_16x16x32_bf16 v[48:51], v[248:251], v[32:35], v[48:51]
  v_mfma_f32_16x16x32_bf16 v[20:23], v[84:87], v[4:7], 0
  v_mfma_f32_16x16x32_bf16 v[24:27], v[100:103], v[4:7], 0
  v_mfma_f32_16x16x32_bf16 v[20:23], v[88:91], v[8:11], v[20:23]
  v_mfma_f32_16x16x32_bf16 v[24:27], v[104:107], v[8:11], v[24:27]
  v_mfma_f32_16x16x32_bf16 v[20:23], v[92:95], v[12:15], v[20:23]
  v_mfma_f32_16x16x32_bf16 v[24:27], v[108:111], v[12:15], v[24:27]
  v_mfma_f32_16x16x32_bf16 v[20:23], v[96:99], v[16:19], v[20:23]
  v_mfma_f32_16x16x32_bf16 v[24:27], v[112:115], v[16:19], v[24:27]
  s_add_u32 s30, s29, 5046272
  buffer_load_dwordx4 v[84:87], v1, s[4:7], s30 offen nt
  s_waitcnt vmcnt(16)
  buffer_load_dwordx4 v[88:91], v1, s[4:7], s30 offen offset:128 nt
  buffer_load_dwordx4 v[92:95], v1, s[4:7], s30 offen offset:256 nt
  buffer_load_dwordx4 v[96:99], v1, s[4:7], s30 offen offset:384 nt
  buffer_load_dwordx4 v[100:103], v2, s[4:7], s30 offen nt
  buffer_load_dwordx4 v[104:107], v2, s[4:7], s30 offen offset:128 nt
  buffer_load_dwordx4 v[108:111], v2, s[4:7], s30 offen offset:256 nt
  buffer_load_dwordx4 v[112:115], v2, s[4:7], s30 offen offset:384 nt
  s_add_u32 s47, s14, 12288
  v_mov_b32 v80, 1
  s_mov_b64 exec, 1
  buffer_atomic_add v80, off, s[20:23], s47 sc0
  s_mov_b64 exec, -1
  v_permlane32_swap_b32 v20, v24
  v_permlane32_swap_b32 v21, v25
  v_permlane32_swap_b32 v22, v26
  v_permlane32_swap_b32 v23, v27
  v_add_f32_dpp v20, v24, v20 row_ror:8 row_mask:0xf bank_mask:0xf
  v_add_f32_dpp v21, v25, v21 row_ror:8 row_mask:0xf bank_mask:0xf
  v_add_f32_dpp v22, v26, v22 row_ror:8 row_mask:0xf bank_mask:0xf
  v_add_f32_dpp v23, v27, v23 row_ror:8 row_mask:0xf bank_mask:0xf
  v_cvt_pk_bf16_f32 v24, v20, v21
  v_cvt_pk_bf16_f32 v25, v22, v23
  v_perm_b32 v20, v24, s35, v72
  v_perm_b32 v21, v24, s35, v73
  v_perm_b32 v22, v25, s35, v72
  v_perm_b32 v23, v25, s35, v73
  v_max3_f32 v26, v20, v21, v22
  v_max3_f32 v26, v26, v23, s37
  s_nop 1
  v_max_f32_dpp v26, v26, v26 row_ror:8 row_mask:0xf bank_mask:0xf
  s_nop 1
  v_max_f32_dpp v26, v26, v26 row_bcast:15 row_mask:0xa bank_mask:0xf
  s_nop 1
  v_max_f32_dpp v26, v26, v26 row_bcast:31 row_mask:0xc bank_mask:0xf
  s_nop 0
  v_readlane_b32 s37, v26, 63
  s_nop 1
  v_mul_f32 v79, s37, v74
  v_fma_f32 v20, v20, s34, v79
  v_fma_f32 v21, v21, s34, v79
  v_fma_f32 v22, v22, s34, v79
  v_fma_f32 v23, v23, s34, v79
  v_sub_f32 v27, v79, v78
  v_exp_f32 v20, v20
  v_exp_f32 v21, v21
  v_exp_f32 v22, v22
  v_exp_f32 v23, v23
  v_exp_f32 v27, v27
  v_add_f32 v26, v20, v21
  v_add_f32 v24, v22, v23
  v_cvt_pk_bf16_f32 v20, v20, v20
  v_cvt_pk_bf16_f32 v21, v21, v21
  v_cvt_pk_bf16_f32 v22, v22, v22
  v_cvt_pk_bf16_f32 v23, v23, v23
  v_add_f32 v26, v26, v24
  v_fma_f32 v77, v77, v27, v26
  v_mul_f32 v44, v27, v44
  v_mul_f32 v45, v27, v45
  v_mul_f32 v46, v27, v46
  v_mul_f32 v47, v27, v47
  v_mul_f32 v48, v27, v48
  v_mul_f32 v49, v27, v49
  v_mul_f32 v50, v27, v50
  v_mul_f32 v51, v27, v51
  v_and_b32 v28, v20, v68
  v_and_b32 v29, v20, v69
  v_and_b32 v30, v20, v70
  v_and_b32 v31, v20, v71
  v_and_b32 v32, v21, v68
  v_and_b32 v33, v21, v69
  v_and_b32 v34, v21, v70
  v_and_b32 v35, v21, v71
  v_mfma_f32_16x16x32_bf16 v[44:47], v[116:119], v[28:31], v[44:47]
  v_mfma_f32_16x16x32_bf16 v[48:51], v[120:123], v[28:31], v[48:51]
  v_and_b32 v28, v22, v68
  v_and_b32 v29, v22, v69
  v_and_b32 v30, v22, v70
  v_and_b32 v31, v22, v71
  v_mfma_f32_16x16x32_bf16 v[44:47], v[124:127], v[32:35], v[44:47]
  v_mfma_f32_16x16x32_bf16 v[48:51], v[128:131], v[32:35], v[48:51]
  v_and_b32 v32, v23, v68
  v_and_b32 v33, v23, v69
  v_and_b32 v34, v23, v70
  v_and_b32 v35, v23, v71
  v_mfma_f32_16x16x32_bf16 v[44:47], v[132:135], v[28:31], v[44:47]
  v_mfma_f32_16x16x32_bf16 v[48:51], v[136:139], v[28:31], v[48:51]
  v_mfma_f32_16x16x32_bf16 v[44:47], v[140:143], v[32:35], v[44:47]
  v_mfma_f32_16x16x32_bf16 v[48:51], v[144:147], v[32:35], v[48:51]
  s_waitcnt vmcnt(16)
  s_add_u32 s31, s29, 5046272
  buffer_load_dwordx4 v[116:119], v3, s[8:11], s31 offen nt
  buffer_load_dwordx4 v[120:123], v3, s[8:11], s31 offen offset:256 nt
  buffer_load_dwordx4 v[124:127], v3, s[8:11], s31 offen offset:512 nt
  buffer_load_dwordx4 v[128:131], v3, s[8:11], s31 offen offset:768 nt
  buffer_load_dwordx4 v[132:135], v3, s[8:11], s31 offen offset:1024 nt
  buffer_load_dwordx4 v[136:139], v3, s[8:11], s31 offen offset:1280 nt
  buffer_load_dwordx4 v[140:143], v3, s[8:11], s31 offen offset:1536 nt
  buffer_load_dwordx4 v[144:147], v3, s[8:11], s31 offen offset:1792 nt
  ds_read_b128 v[52:55], v75 offset:2048
  ds_read_b128 v[56:59], v75 offset:3072
  ds_read_b128 v[60:63], v75 offset:0
  ds_read_b128 v[64:67], v75 offset:4096
  v_mfma_f32_16x16x32_bf16 v[20:23], v[252:255], v[4:7], 0
  s_waitcnt lgkmcnt(3)
  v_mfma_f32_16x16x32_bf16 v[24:27], v[52:55], v[4:7], 0
  ds_read_b128 v[52:55], v75 offset:1024
  v_mfma_f32_16x16x32_bf16 v[20:23], v[148:151], v[8:11], v[20:23]
  s_waitcnt lgkmcnt(3)
  v_mfma_f32_16x16x32_bf16 v[24:27], v[56:59], v[8:11], v[24:27]
  ds_read_b128 v[56:59], v75 offset:5120
  s_waitcnt lgkmcnt(3)
  v_mfma_f32_16x16x32_bf16 v[20:23], v[60:63], v[12:15], v[20:23]
  s_waitcnt lgkmcnt(2)
  v_mfma_f32_16x16x32_bf16 v[24:27], v[64:67], v[12:15], v[24:27]
  s_waitcnt lgkmcnt(1)
  v_mfma_f32_16x16x32_bf16 v[20:23], v[52:55], v[16:19], v[20:23]
  s_waitcnt lgkmcnt(0)
  v_mfma_f32_16x16x32_bf16 v[24:27], v[56:59], v[16:19], v[24:27]
  s_nop 7
  v_permlane32_swap_b32 v20, v24
  v_permlane32_swap_b32 v21, v25
  v_permlane32_swap_b32 v22, v26
  v_permlane32_swap_b32 v23, v27
  v_add_f32_dpp v20, v24, v20 row_ror:8 row_mask:0xf bank_mask:0xf
  v_add_f32_dpp v21, v25, v21 row_ror:8 row_mask:0xf bank_mask:0xf
  v_add_f32_dpp v22, v26, v22 row_ror:8 row_mask:0xf bank_mask:0xf
  v_add_f32_dpp v23, v27, v23 row_ror:8 row_mask:0xf bank_mask:0xf
  v_cvt_pk_bf16_f32 v24, v20, v21
  v_cvt_pk_bf16_f32 v25, v22, v23
  v_perm_b32 v20, v24, s35, v72
  v_perm_b32 v21, v24, s35, v73
  v_perm_b32 v22, v25, s35, v72
  v_perm_b32 v23, v25, s35, v73
  v_max3_f32 v26, v20, v21, v22
  v_max3_f32 v26, v26, v23, s37
  s_nop 1
  v_max_f32_dpp v26, v26, v26 row_ror:8 row_mask:0xf bank_mask:0xf
  s_nop 1
  v_max_f32_dpp v26, v26, v26 row_bcast:15 row_mask:0xa bank_mask:0xf
  s_nop 1
  v_max_f32_dpp v26, v26, v26 row_bcast:31 row_mask:0xc bank_mask:0xf
  s_nop 0
  v_readlane_b32 s37, v26, 63
  s_nop 1
  v_mul_f32 v78, s37, v74
  v_fma_f32 v20, v20, s34, v78
  v_fma_f32 v21, v21, s34, v78
  v_fma_f32 v22, v22, s34, v78
  v_fma_f32 v23, v23, s34, v78
  v_sub_f32 v27, v78, v79
  v_exp_f32 v20, v20
  v_exp_f32 v21, v21
  v_exp_f32 v22, v22
  v_exp_f32 v23, v23
  v_exp_f32 v27, v27
  v_add_f32 v26, v20, v21
  v_add_f32 v24, v22, v23
  v_cvt_pk_bf16_f32 v20, v20, v20
  v_cvt_pk_bf16_f32 v21, v21, v21
  v_cvt_pk_bf16_f32 v22, v22, v22
  v_cvt_pk_bf16_f32 v23, v23, v23
  v_add_f32 v26, v26, v24
  v_fma_f32 v77, v77, v27, v26
  v_mul_f32 v44, v27, v44
  v_mul_f32 v45, v27, v45
  v_mul_f32 v46, v27, v46
  v_mul_f32 v47, v27, v47
  v_mul_f32 v48, v27, v48
  v_mul_f32 v49, v27, v49
  v_mul_f32 v50, v27, v50
  v_mul_f32 v51, v27, v51
  v_and_b32 v28, v20, v68
  v_and_b32 v29, v20, v69
  v_and_b32 v30, v20, v70
  v_and_b32 v31, v20, v71
  v_and_b32 v32, v21, v68
  v_and_b32 v33, v21, v69
  v_and_b32 v34, v21, v70
  v_and_b32 v35, v21, v71
  ds_read_b128 v[52:55], v75 offset:6144
  ds_read_b128 v[56:59], v75 offset:7168
  ds_read_b128 v[60:63], v75 offset:8192
  ds_read_b128 v[64:67], v75 offset:9216
  s_waitcnt lgkmcnt(3)
  v_mfma_f32_16x16x32_bf16 v[44:47], v[52:55], v[28:31], v[44:47]
  ds_read_b128 v[52:55], v75 offset:10240
  s_waitcnt lgkmcnt(3)
  v_mfma_f32_16x16x32_bf16 v[48:51], v[56:59], v[28:31], v[48:51]
  ds_read_b128 v[56:59], v75 offset:11264
  v_and_b32 v28, v22, v68
  v_and_b32 v29, v22, v69
  v_and_b32 v30, v22, v70
  v_and_b32 v31, v22, v71
  s_waitcnt lgkmcnt(3)
  v_mfma_f32_16x16x32_bf16 v[44:47], v[60:63], v[32:35], v[44:47]
  ds_read_b128 v[60:63], v75 offset:12288
  s_waitcnt lgkmcnt(3)
  v_mfma_f32_16x16x32_bf16 v[48:51], v[64:67], v[32:35], v[48:51]
  ds_read_b128 v[64:67], v75 offset:13312
  v_and_b32 v32, v23, v68
  v_and_b32 v33, v23, v69
  v_and_b32 v34, v23, v70
  v_and_b32 v35, v23, v71
  s_waitcnt lgkmcnt(3)
  v_mfma_f32_16x16x32_bf16 v[44:47], v[52:55], v[28:31], v[44:47]
  s_waitcnt lgkmcnt(2)
  v_mfma_f32_16x16x32_bf16 v[48:51], v[56:59], v[28:31], v[48:51]
  s_waitcnt lgkmcnt(1)
  v_mfma_f32_16x16x32_bf16 v[44:47], v[60:63], v[32:35], v[44:47]
  s_waitcnt lgkmcnt(0)
  v_mfma_f32_16x16x32_bf16 v[48:51], v[64:67], v[32:35], v[48:51]
  ds_read_b128 v[52:55], v75 offset:14336
  ds_read_b128 v[56:59], v75 offset:18432
  ds_read_b128 v[60:63], v75 offset:15360
  ds_read_b128 v[64:67], v75 offset:19456
  s_waitcnt lgkmcnt(3)
  v_mfma_f32_16x16x32_bf16 v[20:23], v[52:55], v[4:7], 0
  ds_read_b128 v[52:55], v75 offset:16384
  s_waitcnt lgkmcnt(3)
  v_mfma_f32_16x16x32_bf16 v[24:27], v[56:59], v[4:7], 0
  ds_read_b128 v[56:59], v75 offset:20480
  s_waitcnt lgkmcnt(3)
  v_mfma_f32_16x16x32_bf16 v[20:23], v[60:63], v[8:11], v[20:23]
  ds_read_b128 v[60:63], v75 offset:17408
  s_waitcnt lgkmcnt(3)
  v_mfma_f32_16x16x32_bf16 v[24:27], v[64:67], v[8:11], v[24:27]
  ds_read_b128 v[64:67], v75 offset:21504
  s_waitcnt lgkmcnt(3)
  v_mfma_f32_16x16x32_bf16 v[20:23], v[52:55], v[12:15], v[20:23]
  s_waitcnt lgkmcnt(2)
  v_mfma_f32_16x16x32_bf16 v[24:27], v[56:59], v[12:15], v[24:27]
  s_waitcnt lgkmcnt(1)
  v_mfma_f32_16x16x32_bf16 v[20:23], v[60:63], v[16:19], v[20:23]
  s_waitcnt lgkmcnt(0)
  v_mfma_f32_16x16x32_bf16 v[24:27], v[64:67], v[16:19], v[24:27]
  s_nop 7
  v_permlane32_swap_b32 v20, v24
  v_permlane32_swap_b32 v21, v25
  v_permlane32_swap_b32 v22, v26
  v_permlane32_swap_b32 v23, v27
  v_add_f32_dpp v20, v24, v20 row_ror:8 row_mask:0xf bank_mask:0xf
  v_add_f32_dpp v21, v25, v21 row_ror:8 row_mask:0xf bank_mask:0xf
  v_add_f32_dpp v22, v26, v22 row_ror:8 row_mask:0xf bank_mask:0xf
  v_add_f32_dpp v23, v27, v23 row_ror:8 row_mask:0xf bank_mask:0xf
  v_cvt_pk_bf16_f32 v24, v20, v21
  v_cvt_pk_bf16_f32 v25, v22, v23
  v_perm_b32 v20, v24, s35, v72
  v_perm_b32 v21, v24, s35, v73
  v_perm_b32 v22, v25, s35, v72
  v_perm_b32 v23, v25, s35, v73
  v_max3_f32 v26, v20, v21, v22
  v_max3_f32 v26, v26, v23, s37
  s_nop 1
  v_max_f32_dpp v26, v26, v26 row_ror:8 row_mask:0xf bank_mask:0xf
  s_nop 1
  v_max_f32_dpp v26, v26, v26 row_bcast:15 row_mask:0xa bank_mask:0xf
  s_nop 1
  v_max_f32_dpp v26, v26, v26 row_bcast:31 row_mask:0xc bank_mask:0xf
  s_nop 0
  v_readlane_b32 s37, v26, 63
  s_nop 1
  v_mul_f32 v79, s37, v74
  v_fma_f32 v20, v20, s34, v79
  v_fma_f32 v21, v21, s34, v79
  v_fma_f32 v22, v22, s34, v79
  v_fma_f32 v23, v23, s34, v79
  v_sub_f32 v27, v79, v78
  v_exp_f32 v20, v20
  v_exp_f32 v21, v21
  v_exp_f32 v22, v22
  v_exp_f32 v23, v23
  v_exp_f32 v27, v27
  v_add_f32 v26, v20, v21
  v_add_f32 v24, v22, v23
  v_cvt_pk_bf16_f32 v20, v20, v20
  v_cvt_pk_bf16_f32 v21, v21, v21
  v_cvt_pk_bf16_f32 v22, v22, v22
  v_cvt_pk_bf16_f32 v23, v23, v23
  v_add_f32 v26, v26, v24
  v_fma_f32 v77, v77, v27, v26
  v_mul_f32 v44, v27, v44
  v_mul_f32 v45, v27, v45
  v_mul_f32 v46, v27, v46
  v_mul_f32 v47, v27, v47
  v_mul_f32 v48, v27, v48
  v_mul_f32 v49, v27, v49
  v_mul_f32 v50, v27, v50
  v_mul_f32 v51, v27, v51
  v_and_b32 v28, v20, v68
  v_and_b32 v29, v20, v69
  v_and_b32 v30, v20, v70
  v_and_b32 v31, v20, v71
  v_and_b32 v32, v21, v68
  v_and_b32 v33, v21, v69
  v_and_b32 v34, v21, v70
  v_and_b32 v35, v21, v71
  s_waitcnt vmcnt(17)
  ds_read_b128 v[52:55], v75 offset:22528
  ds_read_b128 v[56:59], v75 offset:23552
  ds_read_b128 v[60:63], v75 offset:24576
  ds_read_b128 v[64:67], v75 offset:25600
  s_waitcnt lgkmcnt(3)
  v_mfma_f32_16x16x32_bf16 v[44:47], v[52:55], v[28:31], v[44:47]
  ds_read_b128 v[52:55], v75 offset:26624
  s_waitcnt lgkmcnt(3)
  v_mfma_f32_16x16x32_bf16 v[48:51], v[56:59], v[28:31], v[48:51]
  ds_read_b128 v[56:59], v75 offset:27648
  v_and_b32 v28, v22, v68
  v_and_b32 v29, v22, v69
  v_and_b32 v30, v22, v70
  v_and_b32 v31, v22, v71
  s_waitcnt lgkmcnt(3)
  v_mfma_f32_16x16x32_bf16 v[44:47], v[60:63], v[32:35], v[44:47]
  ds_read_b128 v[60:63], v75 offset:28672
  s_waitcnt lgkmcnt(3)
  v_mfma_f32_16x16x32_bf16 v[48:51], v[64:67], v[32:35], v[48:51]
  ds_read_b128 v[64:67], v75 offset:29696
  v_and_b32 v32, v23, v68
  v_and_b32 v33, v23, v69
  v_and_b32 v34, v23, v70
  v_and_b32 v35, v23, v71
  s_waitcnt lgkmcnt(3)
  v_mfma_f32_16x16x32_bf16 v[44:47], v[52:55], v[28:31], v[44:47]
  s_waitcnt lgkmcnt(2)
  v_mfma_f32_16x16x32_bf16 v[48:51], v[56:59], v[28:31], v[48:51]
  s_waitcnt lgkmcnt(1)
  v_mfma_f32_16x16x32_bf16 v[44:47], v[60:63], v[32:35], v[44:47]
  s_waitcnt lgkmcnt(0)
  v_mfma_f32_16x16x32_bf16 v[48:51], v[64:67], v[32:35], v[48:51]
DL_25:
  s_waitcnt vmcnt(9)
  v_mfma_f32_16x16x32_bf16 v[20:23], v[84:87], v[4:7], 0
  v_mfma_f32_16x16x32_bf16 v[24:27], v[100:103], v[4:7], 0
  v_mfma_f32_16x16x32_bf16 v[20:23], v[88:91], v[8:11], v[20:23]
  v_mfma_f32_16x16x32_bf16 v[24:27], v[104:107], v[8:11], v[24:27]
  v_mfma_f32_16x16x32_bf16 v[20:23], v[92:95], v[12:15], v[20:23]
  v_mfma_f32_16x16x32_bf16 v[24:27], v[108:111], v[12:15], v[24:27]
  v_mfma_f32_16x16x32_bf16 v[20:23], v[96:99], v[16:19], v[20:23]
  v_mfma_f32_16x16x32_bf16 v[24:27], v[112:115], v[16:19], v[24:27]
  s_waitcnt vmcnt(8)
  v_readfirstlane_b32 s15, v80
  s_nop 1
  s_add_u32 s15, s15, 672
  s_cmp_ge_u32 s15, 1008
  s_cbranch_scc1 DF_26
  s_lshl_b32 s15, s15, 13
  s_add_u32 s15, s15, s13
  buffer_load_dwordx4 v[84:87], v1, s[4:7], s15 offen nt
  buffer_load_dwordx4 v[88:91], v1, s[4:7], s15 offen offset:128 nt
  buffer_load_dwordx4 v[92:95], v1, s[4:7], s15 offen offset:256 nt
  buffer_load_dwordx4 v[96:99], v1, s[4:7], s15 offen offset:384 nt
  buffer_load_dwordx4 v[100:103], v2, s[4:7], s15 offen nt
  buffer_load_dwordx4 v[104:107], v2, s[4:7], s15 offen offset:128 nt
  buffer_load_dwordx4 v[108:111], v2, s[4:7], s15 offen offset:256 nt
  buffer_load_dwordx4 v[112:115], v2, s[4:7], s15 offen offset:384 nt
  s_add_u32 s47, s14, 12288
  v_mov_b32 v80, 1
  s_mov_b64 exec, 1
  buffer_atomic_add v80, off, s[20:23], s47 sc0
  s_mov_b64 exec, -1
  v_permlane32_swap_b32 v20, v24
  v_permlane32_swap_b32 v21, v25
  v_permlane32_swap_b32 v22, v26
  v_permlane32_swap_b32 v23, v27
  v_add_f32_dpp v20, v24, v20 row_ror:8 row_mask:0xf bank_mask:0xf
  v_add_f32_dpp v21, v25, v21 row_ror:8 row_mask:0xf bank_mask:0xf
  v_add_f32_dpp v22, v26, v22 row_ror:8 row_mask:0xf bank_mask:0xf
  v_add_f32_dpp v23, v27, v23 row_ror:8 row_mask:0xf bank_mask:0xf
  v_cvt_pk_bf16_f32 v24, v20, v21
  v_cvt_pk_bf16_f32 v25, v22, v23
  v_perm_b32 v20, v24, s35, v72
  v_perm_b32 v21, v24, s35, v73
  v_perm_b32 v22, v25, s35, v72
  v_perm_b32 v23, v25, s35, v73
  v_max3_f32 v26, v20, v21, v22
  v_max3_f32 v26, v26, v23, s37
  s_nop 1
  v_max_f32_dpp v26, v26, v26 row_ror:8 row_mask:0xf bank_mask:0xf
  s_nop 1
  v_max_f32_dpp v26, v26, v26 row_bcast:15 row_mask:0xa bank_mask:0xf
  s_nop 1
  v_max_f32_dpp v26, v26, v26 row_bcast:31 row_mask:0xc bank_mask:0xf
  s_nop 0
  v_readlane_b32 s37, v26, 63
  s_nop 1
  v_mul_f32 v78, s37, v74
  v_fma_f32 v20, v20, s34, v78
  v_fma_f32 v21, v21, s34, v78
  v_fma_f32 v22, v22, s34, v78
  v_fma_f32 v23, v23, s34, v78
  v_sub_f32 v27, v78, v79
  v_exp_f32 v20, v20
  v_exp_f32 v21, v21
  v_exp_f32 v22, v22
  v_exp_f32 v23, v23
  v_exp_f32 v27, v27
  v_mov_b32 v79, v78
  v_add_f32 v26, v20, v21
  v_add_f32 v24, v22, v23
  v_cvt_pk_bf16_f32 v20, v20, v20
  v_cvt_pk_bf16_f32 v21, v21, v21
  v_cvt_pk_bf16_f32 v22, v22, v22
  v_cvt_pk_bf16_f32 v23, v23, v23
  v_add_f32 v26, v26, v24
  v_fma_f32 v77, v77, v27, v26
  v_mul_f32 v44, v27, v44
  v_mul_f32 v45, v27, v45
  v_mul_f32 v46, v27, v46
  v_mul_f32 v47, v27, v47
  v_mul_f32 v48, v27, v48
  v_mul_f32 v49, v27, v49
  v_mul_f32 v50, v27, v50
  v_mul_f32 v51, v27, v51
  v_and_b32 v28, v20, v68
  v_and_b32 v29, v20, v69
  v_and_b32 v30, v20, v70
  v_and_b32 v31, v20, v71
  v_and_b32 v32, v21, v68
  v_and_b32 v33, v21, v69
  v_and_b32 v34, v21, v70
  v_and_b32 v35, v21, v71
  s_waitcnt vmcnt(9)
  v_mfma_f32_16x16x32_bf16 v[44:47], v[116:119], v[28:31], v[44:47]
  v_mfma_f32_16x16x32_bf16 v[48:51], v[120:123], v[28:31], v[48:51]
  v_and_b32 v28, v22, v68
  v_and_b32 v29, v22, v69
  v_and_b32 v30, v22, v70
  v_and_b32 v31, v22, v71
  v_mfma_f32_16x16x32_bf16 v[44:47], v[124:127], v[32:35], v[44:47]
  v_mfma_f32_16x16x32_bf16 v[48:51], v[128:131], v[32:35], v[48:51]
  v_and_b32 v32, v23, v68
  v_and_b32 v33, v23, v69
  v_and_b32 v34, v23, v70
  v_and_b32 v35, v23, v71
  v_mfma_f32_16x16x32_bf16 v[44:47], v[132:135], v[28:31], v[44:47]
  v_mfma_f32_16x16x32_bf16 v[48:51], v[136:139], v[28:31], v[48:51]
  v_mfma_f32_16x16x32_bf16 v[44:47], v[140:143], v[32:35], v[44:47]
  v_mfma_f32_16x16x32_bf16 v[48:51], v[144:147], v[32:35], v[48:51]
  buffer_load_dwordx4 v[116:119], v3, s[8:11], s15 offen nt
  buffer_load_dwordx4 v[120:123], v3, s[8:11], s15 offen offset:256 nt
  buffer_load_dwordx4 v[124:127], v3, s[8:11], s15 offen offset:512 nt
  buffer_load_dwordx4 v[128:131], v3, s[8:11], s15 offen offset:768 nt
  buffer_load_dwordx4 v[132:135], v3, s[8:11], s15 offen offset:1024 nt
  buffer_load_dwordx4 v[136:139], v3, s[8:11], s15 offen offset:1280 nt
  buffer_load_dwordx4 v[140:143], v3, s[8:11], s15 offen offset:1536 nt
  buffer_load_dwordx4 v[144:147], v3, s[8:11], s15 offen offset:1792 nt
  s_branch DL_25
DF_26:
  s_nop 0
  v_permlane32_swap_b32 v20, v24
  v_permlane32_swap_b32 v21, v25
  v_permlane32_swap_b32 v22, v26
  v_permlane32_swap_b32 v23, v27
  v_add_f32_dpp v20, v24, v20 row_ror:8 row_mask:0xf bank_mask:0xf
  v_add_f32_dpp v21, v25, v21 row_ror:8 row_mask:0xf bank_mask:0xf
  v_add_f32_dpp v22, v26, v22 row_ror:8 row_mask:0xf bank_mask:0xf
  v_add_f32_dpp v23, v27, v23 row_ror:8 row_mask:0xf bank_mask:0xf
  v_cvt_pk_bf16_f32 v24, v20, v21
  v_cvt_pk_bf16_f32 v25, v22, v23
  v_perm_b32 v20, v24, s35, v72
  v_perm_b32 v21, v24, s35, v73
  v_perm_b32 v22, v25, s35, v72
  v_perm_b32 v23, v25, s35, v73
  v_max3_f32 v26, v20, v21, v22
  v_max3_f32 v26, v26, v23, s37
  s_nop 1
  v_max_f32_dpp v26, v26, v26 row_ror:8 row_mask:0xf bank_mask:0xf
  s_nop 1
  v_max_f32_dpp v26, v26, v26 row_bcast:15 row_mask:0xa bank_mask:0xf
  s_nop 1
  v_max_f32_dpp v26, v26, v26 row_bcast:31 row_mask:0xc bank_mask:0xf
  s_nop 0
  v_readlane_b32 s37, v26, 63
  s_nop 1
  v_mul_f32 v78, s37, v74
  v_fma_f32 v20, v20, s34, v78
  v_fma_f32 v21, v21, s34, v78
  v_fma_f32 v22, v22, s34, v78
  v_fma_f32 v23, v23, s34, v78
  v_sub_f32 v27, v78, v79
  v_exp_f32 v20, v20
  v_exp_f32 v21, v21
  v_exp_f32 v22, v22
  v_exp_f32 v23, v23
  v_exp_f32 v27, v27
  v_add_f32 v26, v20, v21
  v_add_f32 v24, v22, v23
  v_cvt_pk_bf16_f32 v20, v20, v20
  v_cvt_pk_bf16_f32 v21, v21, v21
  v_cvt_pk_bf16_f32 v22, v22, v22
  v_cvt_pk_bf16_f32 v23, v23, v23
  v_add_f32 v26, v26, v24
  v_fma_f32 v77, v77, v27, v26
  v_mul_f32 v44, v27, v44
  v_mul_f32 v45, v27, v45
  v_mul_f32 v46, v27, v46
  v_mul_f32 v47, v27, v47
  v_mul_f32 v48, v27, v48
  v_mul_f32 v49, v27, v49
  v_mul_f32 v50, v27, v50
  v_mul_f32 v51, v27, v51
  v_and_b32 v28, v20, v68
  v_and_b32 v29, v20, v69
  v_and_b32 v30, v20, v70
  v_and_b32 v31, v20, v71
  v_and_b32 v32, v21, v68
  v_and_b32 v33, v21, v69
  v_and_b32 v34, v21, v70
  v_and_b32 v35, v21, v71
  s_waitcnt vmcnt(0)
  v_mfma_f32_16x16x32_bf16 v[44:47], v[116:119], v[28:31], v[44:47]
  v_mfma_f32_16x16x32_bf16 v[48:51], v[120:123], v[28:31], v[48:51]
  v_and_b32 v28, v22, v68
  v_and_b32 v29, v22, v69
  v_and_b32 v30, v22, v70
  v_and_b32 v31, v22, v71
  v_mfma_f32_16x16x32_bf16 v[44:47], v[124:127], v[32:35], v[44:47]
  v_mfma_f32_16x16x32_bf16 v[48:51], v[128:131], v[32:35], v[48:51]
  v_and_b32 v32, v23, v68
  v_and_b32 v33, v23, v69
  v_and_b32 v34, v23, v70
  v_and_b32 v35, v23, v71
  v_mfma_f32_16x16x32_bf16 v[44:47], v[132:135], v[28:31], v[44:47]
  v_mfma_f32_16x16x32_bf16 v[48:51], v[136:139], v[28:31], v[48:51]
  v_mfma_f32_16x16x32_bf16 v[44:47], v[140:143], v[32:35], v[44:47]
  v_mfma_f32_16x16x32_bf16 v[48:51], v[144:147], v[32:35], v[48:51]
  v_subrev_u32 v27, s32, v75
  s_mov_b32 s51, 0
PW_27:
  v_mov_b32 v24, 1096
  ds_read_b32 v24, v24
  s_waitcnt lgkmcnt(0)
  v_readfirstlane_b32 s47, v24
  s_add_u32 s51, s51, 1
  s_cmp_gt_u32 s51, 320000
  s_cselect_b32 s47, 5, s47
  s_cmp_lt_u32 s47, 5
  s_cbranch_scc1 PW_27
  v_cndmask_b32 v28, v44, v48, s[40:41]
  v_cndmask_b32 v32, v48, v44, s[40:41]
  v_cndmask_b32 v29, v45, v49, s[40:41]
  v_cndmask_b32 v33, v49, v45, s[40:41]
  v_cndmask_b32 v30, v46, v50, s[40:41]
  v_cndmask_b32 v34, v50, v46, s[40:41]
  v_cndmask_b32 v31, v47, v51, s[40:41]
  v_cndmask_b32 v35, v51, v47, s[40:41]
  v_add_f32_dpp v77, v77, v77 row_ror:8 row_mask:0xf bank_mask:0xf
  v_add_f32_dpp v28, v32, v28 row_ror:8 row_mask:0xf bank_mask:0xf
  v_add_f32_dpp v29, v33, v29 row_ror:8 row_mask:0xf bank_mask:0xf
  v_add_f32_dpp v30, v34, v30 row_ror:8 row_mask:0xf bank_mask:0xf
  v_add_f32_dpp v31, v35, v31 row_ror:8 row_mask:0xf bank_mask:0xf
  v_mov_b32 v24, v77
  s_nop 1
  v_permlane16_swap_b32 v77, v24
  v_add_f32 v77, v77, v24
  v_mov_b32 v24, v77
  s_nop 1
  v_permlane32_swap_b32 v77, v24
  v_add_f32 v25, v77, v24
  v_sub_f32 v24, 0, v78
  s_lshl_b32 s47, s42, 10
  v_add_u32 v32, s47, v27
  ds_write_b128 v32, v[28:31] offset:2048
  s_lshl_b32 s47, s42, 3
  v_mov_b32 v33, s47
  ds_write_b64 v33, v[24:25] offset:1024
  v_mov_b32 v34, 1100
  v_mov_b32 v35, 1
  s_waitcnt lgkmcnt(0)
  s_mov_b64 exec, 1
  ds_add_rtn_u32 v33, v34, v35
  s_waitcnt lgkmcnt(0)
  v_readfirstlane_b32 s47, v33
  s_mov_b64 exec, -1
  s_nop 0
  s_cmp_eq_u32 s47, 3
  s_cbranch_scc0 PS_28
  ds_read_b128 v[52:55], v27 offset:2048
  ds_read_b128 v[56:59], v27 offset:3072
  ds_read_b128 v[60:63], v27 offset:4096
  ds_read_b128 v[64:67], v27 offset:5120
  v_mov_b32 v32, 0
  ds_read_b128 v[20:23], v32 offset:1024
  ds_read_b128 v[28:31], v32 offset:1040
  v_and_b32 v32, 0x70, v27
  v_lshlrev_b32 v32, 1, v32
  v_and_b32 v33, 0x80, v27
  v_lshl_or_b32 v32, v33, 3, v32
  v_and_b32 v33, 0x300, v27
  v_or_b32 v32, v32, v33
  s_add_u32 s47, s46, 1572864
  s_waitcnt lgkmcnt(0)
  s_mov_b64 exec, 1
  ds_add_u32 v34, v35
  s_mov_b64 exec, -1
  v_max3_f32 v25, v20, v22, v28
  v_max_f32 v25, v25, v30
  v_sub_f32 v20, v20, v25
  v_sub_f32 v22, v22, v25
  v_sub_f32 v28, v28, v25
  v_sub_f32 v30, v30, v25
  v_exp_f32 v20, v20
  v_exp_f32 v22, v22
  v_exp_f32 v28, v28
  v_exp_f32 v30, v30
  v_mov_b32 v27, s33
  v_mul_f32 v26, v20, v21
  v_fmac_f32 v26, v22, v23
  v_fmac_f32 v26, v28, v29
  v_fmac_f32 v26, v30, v31
  v_mul_f32 v52, v20, v52
  v_mul_f32 v53, v20, v53
  v_mul_f32 v54, v20, v54
  v_mul_f32 v55, v20, v55
  v_fmac_f32 v52, v22, v56
  v_fmac_f32 v53, v22, v57
  v_fmac_f32 v54, v22, v58
  v_fmac_f32 v55, v22, v59
  v_fmac_f32 v52, v28, v60
  v_fmac_f32 v53, v28, v61
  v_fmac_f32 v54, v28, v62
  v_fmac_f32 v55, v28, v63
  v_fmac_f32 v52, v30, v64
  v_fmac_f32 v53, v30, v65
  v_fmac_f32 v54, v30, v66
  v_fmac_f32 v55, v30, v67
  v_mov_b32 v24, v55
  v_mov_b32 v55, s33
  buffer_store_dwordx4 v[52:55], v32, s[20:23], s47 offen sc1
  buffer_store_dwordx4 v[24:27], v32, s[20:23], s47 offen offset:16 sc1
  s_waitcnt lgkmcnt(0)
PS_28:
  s_nop 1
  s_endpgm
L_exit:
  s_endpgm
.p2align 6
L_chain_tramp:
  s_cmp_ge_u32 s2, 16
  s_cbranch_scc1 L_chain2
  s_load_dwordx2 s[8:9], s[0:1], 24
  s_load_dwordx2 s[4:5], s[0:1], 0
  s_load_dwordx2 s[32:33], s[0:1], 88
  s_load_dwordx2 s[12:13], s[0:1], 32
  s_mov_b32 s40, s2
  v_lshrrev_b32 v1, 6, v0
  s_nop 0
  v_readfirstlane_b32 s41, v1
  v_and_b32 v0, 63, v0
  v_lshlrev_b32 v78, 4, v0
  v_lshrrev_b32 v84, 4, v0
  v_and_b32 v85, 0xf0, v78
  v_lshl_or_b32 v3, v84, 13, v85
  s_mov_b32 s6, 0x700
  s_mov_b32 s7, 0x00020000
  s_mov_b32 s10, 0x380000
  s_mov_b32 s11, 0x00020000
  s_mov_b32 s34, 0x500000
  s_mov_b32 s35, 0x00020000
  s_mov_b32 s14, 0x380000
  s_mov_b32 s15, 0x00020000
  s_mov_b32 s42, -2
  s_mul_i32 s44, s41, 7
  s_add_u32 s45, s44, 0
  s_and_b32 s46, s45, 1
  s_lshr_b32 s45, s45, 1
  s_lshl_b32 s45, s45, 3
  s_add_u32 s45, s45, s46
  s_lshl_b32 s60, s45, 2
  s_add_u32 s45, s44, 1
  s_and_b32 s46, s45, 1
  s_lshr_b32 s45, s45, 1
  s_lshl_b32 s45, s45, 3
  s_add_u32 s45, s45, s46
  s_lshl_b32 s61, s45, 2
  s_add_u32 s45, s44, 2
  s_and_b32 s46, s45, 1
  s_lshr_b32 s45, s45, 1
  s_lshl_b32 s45, s45, 3
  s_add_u32 s45, s45, s46
  s_lshl_b32 s62, s45, 2
  s_add_u32 s45, s44, 3
  s_and_b32 s46, s45, 1
  s_lshr_b32 s45, s45, 1
  s_lshl_b32 s45, s45, 3
  s_add_u32 s45, s45, s46
  s_lshl_b32 s63, s45, 2
  s_add_u32 s45, s44, 4
  s_and_b32 s46, s45, 1
  s_lshr_b32 s45, s45, 1
  s_lshl_b32 s45, s45, 3
  s_add_u32 s45, s45, s46
  s_lshl_b32 s64, s45, 2
  s_add_u32 s45, s44, 5
  s_and_b32 s46, s45, 1
  s_lshr_b32 s45, s45, 1
  s_lshl_b32 s45, s45, 3
  s_add_u32 s45, s45, s46
  s_lshl_b32 s65, s45, 2
  s_add_u32 s45, s44, 6
  s_and_b32 s46, s45, 1
  s_lshr_b32 s45, s45, 1
  s_lshl_b32 s45, s45, 3
  s_add_u32 s45, s45, s46
  s_lshl_b32 s66, s45, 2
  s_mul_i32 s67, s41, 7168
  s_add_u32 s67, s67, 29696
  s_lshl_b32 s46, s40, 9
  s_mul_i32 s44, s41, 112
  v_lshlrev_b32 v86, 1, v0
  v_add_u32 v86, s44, v86
  v_and_b32 v87, 0xffffffe0, v86
  v_and_b32 v88, 3, v86
  v_lshl_add_u32 v87, v88, 3, v87
  v_bfe_u32 v88, v86, 2, 3
  v_add_u32 v87, v87, v88
  v_lshlrev_b32 v0, 1, v87
  s_mov_b32 s52, -1
  s_mov_b32 s53, 0xffffff
  v_mov_b32 v72, 0
  v_mov_b32 v74, 0
  v_mov_b32 v73, 0
  v_mov_b32 v75, 0
  s_waitcnt lgkmcnt(0)
  s_load_dword s43, s[32:33], 0
  s_mov_b64 exec, s[52:53]
  buffer_load_ushort v72, v0, s[4:7], 0 offen
  buffer_load_ushort v73, v0, s[4:7], 0 offen offset:16
  buffer_load_ushort v74, v0, s[4:7], 0 offen offset:896
  buffer_load_ushort v75, v0, s[4:7], 0 offen offset:912
  s_mov_b64 exec, -1
  s_lshl_b32 s45, s60, 13
  s_add_u32 s45, s45, s46
  buffer_load_dwordx4 a[224:227], v3, s[8:11], s45 offen nt
  s_add_u32 s44, s45, 65536
  buffer_load_dwordx4 a[240:243], v3, s[8:11], s44 offen nt
  s_add_u32 s44, s45, 131072
  buffer_load_dwordx4 v[92:95], v3, s[8:11], s44 offen nt
  s_add_u32 s44, s45, 196608
  buffer_load_dwordx4 v[108:111], v3, s[8:11], s44 offen nt
  s_lshl_b32 s45, s61, 13
  s_add_u32 s45, s45, s46
  buffer_load_dwordx4 a[232:235], v3, s[8:11], s45 offen nt
  s_add_u32 s44, s45, 65536
  buffer_load_dwordx4 a[248:251], v3, s[8:11], s44 offen nt
  s_add_u32 s44, s45, 131072
  buffer_load_dwordx4 v[100:103], v3, s[8:11], s44 offen nt
  s_add_u32 s44, s45, 196608
  buffer_load_dwordx4 v[116:119], v3, s[8:11], s44 offen nt
  s_lshl_b32 s45, s62, 13
  s_add_u32 s45, s45, s46
  buffer_load_dwordx4 v[124:127], v3, s[8:11], s45 offen nt
  s_add_u32 s44, s45, 65536
  buffer_load_dwordx4 v[140:143], v3, s[8:11], s44 offen nt
  s_add_u32 s44, s45, 131072
  buffer_load_dwordx4 v[156:159], v3, s[8:11], s44 offen nt
  s_add_u32 s44, s45, 196608
  buffer_load_dwordx4 v[172:175], v3, s[8:11], s44 offen nt
  s_lshl_b32 s45, s63, 13
  s_add_u32 s45, s45, s46
  buffer_load_dwordx4 v[132:135], v3, s[8:11], s45 offen nt
  s_add_u32 s44, s45, 65536
  buffer_load_dwordx4 v[148:151], v3, s[8:11], s44 offen nt
  s_add_u32 s44, s45, 131072
  buffer_load_dwordx4 v[164:167], v3, s[8:11], s44 offen nt
  s_add_u32 s44, s45, 196608
  buffer_load_dwordx4 v[180:183], v3, s[8:11], s44 offen nt
  s_lshl_b32 s45, s64, 13
  s_add_u32 s45, s45, s46
  buffer_load_dwordx4 v[188:191], v3, s[8:11], s45 offen nt
  s_add_u32 s44, s45, 65536
  buffer_load_dwordx4 v[204:207], v3, s[8:11], s44 offen nt
  s_add_u32 s44, s45, 131072
  buffer_load_dwordx4 v[220:223], v3, s[8:11], s44 offen nt
  s_add_u32 s44, s45, 196608
  buffer_load_dwordx4 v[236:239], v3, s[8:11], s44 offen nt
  s_lshl_b32 s45, s65, 13
  s_add_u32 s45, s45, s46
  buffer_load_dwordx4 v[196:199], v3, s[8:11], s45 offen nt
  s_add_u32 s44, s45, 65536
  buffer_load_dwordx4 v[212:215], v3, s[8:11], s44 offen nt
  s_add_u32 s44, s45, 131072
  buffer_load_dwordx4 v[228:231], v3, s[8:11], s44 offen nt
  s_add_u32 s44, s45, 196608
  buffer_load_dwordx4 v[244:247], v3, s[8:11], s44 offen nt
  s_lshl_b32 s45, s66, 13
  s_add_u32 s45, s45, s46
  buffer_load_dwordx4 v[252:255], v3, s[8:11], s45 offen nt
  s_add_u32 s44, s45, 65536
  s_add_u32 m0, s67, 0x400
  s_nop 0
  buffer_load_dwordx4 v3, s[8:11], s44 offen nt lds
  s_add_u32 s44, s45, 131072
  s_add_u32 m0, s67, 0xc00
  s_nop 0
  buffer_load_dwordx4 v3, s[8:11], s44 offen nt lds
  s_add_u32 s44, s45, 196608
  s_add_u32 m0, s67, 0x1400
  s_nop 0
  buffer_load_dwordx4 v3, s[8:11], s44 offen nt lds
  v_lshlrev_b32 v86, 8, v78
  v_mov_b32 v87, 0
  s_lshl_b32 s44, s40, 8
  s_add_u32 s44, s44, 0x2000
  s_mov_b64 exec, 31
  buffer_store_dword v87, v86, s[32:35], s44 offen sc1
  s_mov_b64 exec, -1
  s_waitcnt lgkmcnt(0)
  s_add_u32 s43, s43, 1
  s_max_u32 s43, s43, 1
  v_lshrrev_b32 v88, 4, v78
  v_and_b32 v89, 8, v88
  v_cmp_ne_u32 s[50:51], 0, v89
  v_and_b32 v89, 1, v88
  v_cmp_ne_u32 s[54:55], 0, v89
  v_mov_b32 v89, 0xffff
  v_mov_b32 v90, 0xffff0000
  v_cndmask_b32 v89, v89, v90, s[54:55]
  v_bfe_u32 v90, v88, 1, 2
  v_cmp_eq_u32 s[54:55], 0, v90
  s_nop 1
  v_cndmask_b32 v68, 0, v89, s[54:55]
  v_cmp_eq_u32 s[54:55], 1, v90
  s_nop 1
  v_cndmask_b32 v69, 0, v89, s[54:55]
  v_cmp_eq_u32 s[54:55], 2, v90
  s_nop 1
  v_cndmask_b32 v70, 0, v89, s[54:55]
  v_cmp_eq_u32 s[54:55], 3, v90
  s_nop 1
  v_cndmask_b32 v71, 0, v89, s[54:55]
  v_bfe_u32 v89, v88, 3, 1
  v_and_b32 v90, 7, v88
  v_add_u32 v79, s67, v78
  v_lshl_add_u32 v80, v89, 2, v84
  v_lshlrev_b32 v80, 4, v80
  s_lshl_b32 s44, s41, 9
  v_add_u32 v80, s44, v80
  s_lshl_b32 s44, s41, 12
  v_lshlrev_b32 v91, 11, v89
  v_add_u32 v91, s44, v91
  v_lshl_add_u32 v91, v90, 4, v91
  v_lshl_add_u32 v81, v84, 7, v91
  v_lshlrev_b32 v82, 1, v89
  v_xor_b32 v82, v82, v84
  v_lshl_add_u32 v82, v82, 7, v91
  v_add_u32 v82, 1536, v82
  v_mul_u32_u24 v4, 3584, v84
  v_add_u32 v1, v4, v85
  v_mul_u32_u24 v77, 14336, v89
  v_add_u32 v2, v4, v77
  v_lshl_add_u32 v2, v90, 4, v2
  s_lshl_b32 s48, s40, 8
  s_lshl_b32 s44, s41, 6
  s_add_u32 s48, s48, s44
  s_mul_i32 s48, s48, 896
  s_lshl_b32 s69, s40, 2
  s_add_u32 s69, s69, s41
  s_lshl_b32 s68, s69, 8
  s_add_u32 s68, s68, 0x410000
  s_lshl_b32 s69, s69, 10
  s_waitcnt vmcnt(29)
  v_lshlrev_b32 v72, 16, v72
  v_lshlrev_b32 v74, 16, v74
  v_lshlrev_b32 v73, 16, v73
  v_lshlrev_b32 v75, 16, v75
CI_29:
  v_add_f32 v84, v72, v73
  v_mul_f32 v85, v72, v72
  v_fmac_f32 v85, v73, v73
  v_add_f32_dpp v84, v84, v84 row_ror:1 row_mask:0xf bank_mask:0xf
  s_nop 0
  v_add_f32_dpp v85, v85, v85 row_ror:1 row_mask:0xf bank_mask:0xf
  v_add_f32_dpp v84, v84, v84 row_ror:2 row_mask:0xf bank_mask:0xf
  s_nop 0
  v_add_f32_dpp v85, v85, v85 row_ror:2 row_mask:0xf bank_mask:0xf
  v_add_f32_dpp v84, v84, v84 row_ror:4 row_mask:0xf bank_mask:0xf
  s_nop 0
  v_add_f32_dpp v85, v85, v85 row_ror:4 row_mask:0xf bank_mask:0xf
  v_add_f32_dpp v84, v84, v84 row_ror:8 row_mask:0xf bank_mask:0xf
  s_nop 0
  v_add_f32_dpp v85, v85, v85 row_ror:8 row_mask:0xf bank_mask:0xf
  v_mov_b32 v86, v84
  v_mov_b32 v87, v85
  s_nop 0
  v_permlane16_swap_b32 v84, v86
  v_permlane16_swap_b32 v85, v87
  v_add_f32 v84, v84, v86
  v_add_f32 v85, v85, v87
  v_mov_b32 v86, v84
  v_mov_b32 v87, v85
  s_nop 0
  v_permlane32_swap_b32 v84, v86
  v_permlane32_swap_b32 v85, v87
  v_add_f32 v84, v84, v86
  v_add_f32 v85, v85, v87
  s_lshl_b32 s44, s41, 3
  v_mov_b32 v86, s44
  ds_write_b64 v86, v[84:85] offset:26624
  v_mov_b32 v86, 0
  v_lshrrev_b32 v90, 1, v78
  s_lshl_b32 s44, s41, 9
  v_add_u32 v90, s44, v90
  s_waitcnt lgkmcnt(0)
  s_barrier
  ds_read_b128 v[60:63], v86 offset:26624
  ds_read_b128 v[64:67], v86 offset:26640
  s_waitcnt lgkmcnt(0)
  v_add_f32 v84, v60, v62
  v_add_f32 v85, v61, v63
  v_add_f32 v86, v64, v66
  v_add_f32 v87, v65, v67
  v_add_f32 v84, v84, v86
  v_add_f32 v85, v85, v87
  v_mul_f32 v84, 0x3b124925, v84
  v_mul_f32 v85, 0x3b124925, v85
  v_fma_f32 v85, -v84, v84, v85
  v_max_f32 v85, 0, v85
  v_cvt_pk_bf16_f32 v87, v85, v85
  v_and_b32 v85, 0xffff0000, v87
  v_cvt_pk_bf16_f32 v86, v84, v84
  v_and_b32 v84, 0xffff0000, v86
  v_add_f32 v85, 0x3727c5ac, v85
  v_sub_f32 v88, v72, v84
  v_cvt_pk_bf16_f32 v87, v85, v85
  v_and_b32 v85, 0xffff0000, v87
  v_sub_f32 v89, v73, v84
  v_sqrt_f32 v85, v85
  v_cvt_pk_bf16_f32 v86, v88, v88
  v_and_b32 v88, 0xffff0000, v86
  v_cvt_pk_bf16_f32 v87, v85, v85
  v_and_b32 v85, 0xffff0000, v87
  v_rcp_f32 v85, v85
  v_cvt_pk_bf16_f32 v87, v89, v89
  v_and_b32 v89, 0xffff0000, v87
  v_mul_f32 v88, v88, v85
  v_mul_f32 v89, v89, v85
  v_cvt_pk_bf16_f32 v88, v88, v88
  v_cvt_pk_bf16_f32 v89, v89, v89
  v_cndmask_b32 v88, 0, v88, s[52:53]
  v_cndmask_b32 v89, 0, v89, s[52:53]
  ds_write_b64 v90, v[88:89] offset:24576
  v_and_b32 v84, 0x1ff, v81
  v_lshrrev_b32 v85, 11, v81
  v_lshl_or_b32 v84, v85, 10, v84
  v_lshrrev_b32 v86, 4, v78
  v_and_b32 v91, 3, v86
  v_bfe_u32 v85, v86, 2, 2
  s_lshl_b32 s44, s41, 5
  v_mov_b32 v87, s44
  v_lshl_add_u32 v88, v85, 3, v87
  v_add_u32 v88, v88, v91
  v_lshlrev_b32 v88, 2, v88
  v_add_u32 v88, 0x4000, v88
  v_lshl_add_u32 v89, v91, 3, v87
  v_lshl_add_u32 v89, v85, 1, v89
  v_lshlrev_b32 v89, 2, v89
  s_waitcnt vmcnt(0)
  ds_read_b128 v[60:63], v80 offset:24576
  ds_read_b128 v[64:67], v80 offset:24704
  s_waitcnt lgkmcnt(0)
  v_and_b32 v52, v60, v68
  v_and_b32 v53, v60, v69
  v_and_b32 v54, v60, v70
  v_and_b32 v55, v60, v71
  v_and_b32 v56, v61, v68
  v_and_b32 v57, v61, v69
  v_and_b32 v58, v61, v70
  v_and_b32 v59, v61, v71
  v_mfma_f32_16x16x32_bf16 v[4:7], a[224:227], v[52:55], 0
  v_mfma_f32_16x16x32_bf16 v[12:15], a[232:235], v[52:55], 0
  v_and_b32 v52, v62, v68
  v_and_b32 v53, v62, v69
  v_and_b32 v54, v62, v70
  v_and_b32 v55, v62, v71
  v_mfma_f32_16x16x32_bf16 v[4:7], a[240:243], v[56:59], v[4:7]
  v_mfma_f32_16x16x32_bf16 v[12:15], a[248:251], v[56:59], v[12:15]
  v_and_b32 v56, v63, v68
  v_and_b32 v57, v63, v69
  v_and_b32 v58, v63, v70
  v_and_b32 v59, v63, v71
  v_mfma_f32_16x16x32_bf16 v[4:7], v[92:95], v[52:55], v[4:7]
  v_mfma_f32_16x16x32_bf16 v[12:15], v[100:103], v[52:55], v[12:15]
  v_and_b32 v52, v64, v68
  v_and_b32 v53, v64, v69
  v_and_b32 v54, v64, v70
  v_and_b32 v55, v64, v71
  v_mfma_f32_16x16x32_bf16 v[4:7], v[108:111], v[56:59], v[4:7]
  v_mfma_f32_16x16x32_bf16 v[12:15], v[116:119], v[56:59], v[12:15]
  v_and_b32 v56, v65, v68
  v_and_b32 v57, v65, v69
  v_and_b32 v58, v65, v70
  v_and_b32 v59, v65, v71
  v_mfma_f32_16x16x32_bf16 v[4:7], v[124:127], v[52:55], v[4:7]
  v_mfma_f32_16x16x32_bf16 v[12:15], v[132:135], v[52:55], v[12:15]
  v_and_b32 v52, v66, v68
  v_and_b32 v53, v66, v69
  v_and_b32 v54, v66, v70
  v_and_b32 v55, v66, v71
  v_mfma_f32_16x16x32_bf16 v[4:7], v[140:143], v[56:59], v[4:7]
  v_mfma_f32_16x16x32_bf16 v[12:15], v[148:151], v[56:59], v[12:15]
  v_and_b32 v56, v67, v68
  v_and_b32 v57, v67, v69
  v_and_b32 v58, v67, v70
  v_and_b32 v59, v67, v71
  v_mfma_f32_16x16x32_bf16 v[4:7], v[156:159], v[52:55], v[4:7]
  v_mfma_f32_16x16x32_bf16 v[12:15], v[164:167], v[52:55], v[12:15]
  v_mfma_f32_16x16x32_bf16 v[4:7], v[172:175], v[56:59], v[4:7]
  v_mfma_f32_16x16x32_bf16 v[12:15], v[180:183], v[56:59], v[12:15]
  ds_read_b128 v[60:63], v80 offset:24832
  ds_read_b128 v[64:67], v80 offset:24960
  s_waitcnt lgkmcnt(0)
  ds_read_b128 v[36:39], v79 offset:1024
  ds_read_b128 v[40:43], v79 offset:3072
  ds_read_b128 v[44:47], v79 offset:5120
  v_and_b32 v52, v60, v68
  v_and_b32 v53, v60, v69
  v_and_b32 v54, v60, v70
  v_and_b32 v55, v60, v71
  v_and_b32 v56, v61, v68
  v_and_b32 v57, v61, v69
  v_and_b32 v58, v61, v70
  v_and_b32 v59, v61, v71
  v_mfma_f32_16x16x32_bf16 v[4:7], v[188:191], v[52:55], v[4:7]
  v_mfma_f32_16x16x32_bf16 v[12:15], v[196:199], v[52:55], v[12:15]
  v_and_b32 v52, v62, v68
  v_and_b32 v53, v62, v69
  v_and_b32 v54, v62, v70
  v_and_b32 v55, v62, v71
  v_mfma_f32_16x16x32_bf16 v[4:7], v[204:207], v[56:59], v[4:7]
  v_mfma_f32_16x16x32_bf16 v[12:15], v[212:215], v[56:59], v[12:15]
  v_and_b32 v56, v63, v68
  v_and_b32 v57, v63, v69
  v_and_b32 v58, v63, v70
  v_and_b32 v59, v63, v71
  v_mfma_f32_16x16x32_bf16 v[4:7], v[220:223], v[52:55], v[4:7]
  v_mfma_f32_16x16x32_bf16 v[12:15], v[228:231], v[52:55], v[12:15]
  v_and_b32 v52, v64, v68
  v_and_b32 v53, v64, v69
  v_and_b32 v54, v64, v70
  v_and_b32 v55, v64, v71
  v_mfma_f32_16x16x32_bf16 v[4:7], v[236:239], v[56:59], v[4:7]
  v_mfma_f32_16x16x32_bf16 v[12:15], v[244:247], v[56:59], v[12:15]
  v_and_b32 v56, v65, v68
  v_and_b32 v57, v65, v69
  v_and_b32 v58, v65, v70
  v_and_b32 v59, v65, v71
  v_mfma_f32_16x16x32_bf16 v[4:7], v[252:255], v[52:55], v[4:7]
  v_and_b32 v52, v66, v68
  v_and_b32 v53, v66, v69
  v_and_b32 v54, v66, v70
  v_and_b32 v55, v66, v71
  s_waitcnt lgkmcnt(2)
  v_mfma_f32_16x16x32_bf16 v[4:7], v[36:39], v[56:59], v[4:7]
  v_and_b32 v56, v67, v68
  v_and_b32 v57, v67, v69
  v_and_b32 v58, v67, v70
  v_and_b32 v59, v67, v71
  s_waitcnt lgkmcnt(1)
  v_mfma_f32_16x16x32_bf16 v[4:7], v[40:43], v[52:55], v[4:7]
  s_waitcnt lgkmcnt(0)
  v_mfma_f32_16x16x32_bf16 v[4:7], v[44:47], v[56:59], v[4:7]
  s_nop 7
  v_cndmask_b32 v4, v4, v12, s[50:51]
  v_cndmask_b32 v5, v5, v13, s[50:51]
  v_cndmask_b32 v6, v6, v14, s[50:51]
  v_cndmask_b32 v7, v7, v15, s[50:51]
  ds_write_b128 v84, v[4:7] offset:16384
  s_add_u32 s44, s42, 2
  s_lshl_b32 s44, s44, 4
  s_add_u32 s44, s44, s40
  s_lshl_b32 s44, s44, 10
  s_add_u32 s44, s44, 0x10000
  s_waitcnt lgkmcnt(0)
  s_barrier
  ds_read2_b32 v[4:5], v88 offset0:0 offset1:4
  v_add_u32 v90, 1024, v88
  ds_read2_b32 v[6:7], v90 offset0:0 offset1:4
  v_add_u32 v90, 2048, v88
  ds_read2_b32 v[8:9], v90 offset0:0 offset1:4
  v_add_u32 v90, 3072, v88
  ds_read2_b32 v[10:11], v90 offset0:0 offset1:4
  v_add_u32 v90, 4096, v88
  ds_read2_b32 v[12:13], v90 offset0:0 offset1:4
  v_add_u32 v90, 5120, v88
  ds_read2_b32 v[14:15], v90 offset0:0 offset1:4
  v_add_u32 v90, 6144, v88
  ds_read2_b32 v[16:17], v90 offset0:0 offset1:4
  v_add_u32 v90, 7168, v88
  ds_read2_b32 v[18:19], v90 offset0:0 offset1:4
  s_waitcnt lgkmcnt(0)
  v_add_f32 v4, v4, v12
  v_add_f32 v5, v5, v13
  v_add_f32 v6, v6, v14
  v_add_f32 v7, v7, v15
  v_add_f32 v8, v8, v16
  v_add_f32 v9, v9, v17
  v_add_f32 v10, v10, v18
  v_add_f32 v11, v11, v19
  v_add_f32 v4, v4, v8
  v_add_f32 v5, v5, v9
  v_add_f32 v6, v6, v10
  v_add_f32 v7, v7, v11
  v_add_f32 v4, v4, v6
  v_add_f32 v5, v5, v7
  v_cvt_pk_bf16_f32 v4, v4, v5
  v_mov_b32 v5, s43
  s_mov_b32 exec_hi, 0
  s_mov_b32 exec_lo, 0xffff
  buffer_store_dwordx2 v[4:5], v89, s[32:35], s44 offen sc1
  s_mov_b64 exec, -1
  v_swap_b32 v72, v74
  v_swap_b32 v73, v75
  s_add_u32 s42, s42, 1
  s_barrier
  s_cmp_lt_i32 s42, 0
  s_cbranch_scc1 CI_29
  s_load_dwordx2 s[76:77], s[0:1], 8
  s_load_dwordx2 s[80:81], s[0:1], 16
  s_mov_b32 s78, 0x10000000
  s_mov_b32 s79, 0x00020000
  s_mov_b32 s82, 0x10000000
  s_mov_b32 s83, 0x00020000
  s_lshl_b32 s84, s40, 23
  s_lshl_b32 s44, s41, 13
  s_add_u32 s84, s84, s44
  s_add_u32 s84, s84, 8257536
  s_add_u32 s85, s84, 0x8000000
  s_mul_i32 s88, s41, 25600
  s_add_u32 s88, s88, 58368
  s_mov_b32 s89, 0x3db8aa3b
  s_mov_b32 s90, 0xff7f0000
  s_lshl_b32 s93, s40, 10
  s_add_u32 s93, s93, 0x10000
  s_lshl_b32 s94, s40, 4
  s_add_u32 s94, s94, 14
  s_lshl_b32 s94, s94, 11
  s_add_u32 s94, s94, 0x100000
  s_getpc_b64 s[72:73]
PCH_30:
  s_sub_u32 s72, s72, (PCH_30 - interleave_layers__mha_block_cached__glu_gated_glu__decode_kernel)
  s_subb_u32 s73, s73, 0
  s_mov_b32 s74, (L_code_end - interleave_layers__mha_block_cached__glu_gated_glu__decode_kernel)
  s_mov_b32 s75, 0x00020000
  s_lshl_b32 s44, s41, 10
  buffer_load_dwordx4 v[4:7], v78, s[72:75], s44 offen
  s_add_u32 s44, s44, 4096
  buffer_load_dwordx4 v[8:11], v78, s[72:75], s44 offen
  s_add_u32 s44, s44, 4096
  buffer_load_dwordx4 v[12:15], v78, s[72:75], s44 offen
  s_add_u32 s44, s44, 4096
  buffer_load_dwordx4 v[16:19], v78, s[72:75], s44 offen
  s_add_u32 s44, s44, 4096
  buffer_load_dwordx4 v[20:23], v78, s[72:75], s44 offen
  s_add_u32 s44, s44, 4096
  buffer_load_dwordx4 v[24:27], v78, s[72:75], s44 offen
  s_add_u32 s44, s44, 4096
  buffer_load_dwordx4 v[28:31], v78, s[72:75], s44 offen
  s_add_u32 s44, s44, 4096
  buffer_load_dwordx4 v[32:35], v78, s[72:75], s44 offen
  s_add_u32 s44, s44, 4096
  buffer_load_dwordx4 v[36:39], v78, s[72:75], s44 offen
  s_add_u32 s44, s44, 4096
  buffer_load_dwordx4 v[40:43], v78, s[72:75], s44 offen
  s_add_u32 s44, s44, 4096
  buffer_load_dwordx4 v[44:47], v78, s[72:75], s44 offen
  s_add_u32 s44, s44, 4096
  buffer_load_dwordx4 v[48:51], v78, s[72:75], s44 offen
  s_add_u32 s44, s44, 4096
  buffer_load_dwordx4 v[4:7], v78, s[72:75], s44 offen
  s_add_u32 s44, s44, 4096
  buffer_load_dwordx4 v[8:11], v78, s[72:75], s44 offen
  s_add_u32 s44, s44, 4096
  buffer_load_dwordx4 v[12:15], v78, s[72:75], s44 offen
  s_add_u32 s44, s44, 4096
  buffer_load_dwordx4 v[16:19], v78, s[72:75], s44 offen
  s_add_u32 s44, s44, 4096
  buffer_load_dwordx4 v[20:23], v78, s[72:75], s44 offen
  s_add_u32 s44, s44, 4096
  buffer_load_dwordx4 v[24:27], v78, s[72:75], s44 offen
  s_add_u32 s44, s44, 4096
  s_waitcnt vmcnt(0)
  v_mov_b32 v8, 0
  v_mov_b32 v9, 0
  v_mov_b32 v10, 0
  v_mov_b32 v11, 0
  s_waitcnt lgkmcnt(0)
  s_lshl_b32 s44, s41, 19
  s_add_u32 s44, s44, s94
  buffer_store_dwordx4 v[8:11], v78, s[32:35], s44 offen sc1
  buffer_store_dwordx4 v[8:11], v78, s[32:35], s44 offen offset:1024 sc1
  v_mov_b32 v84, 28736
  ds_write_b128 v84, v[8:11]
  s_add_u32 s44, s69, 0x300000
  buffer_store_dwordx4 v[8:11], v78, s[32:35], s44 offen sc1
  s_add_u32 s44, s69, 0x310000
  buffer_store_dwordx4 v[8:11], v78, s[32:35], s44 offen sc1
  s_add_u32 s44, s69, 0x320000
  buffer_store_dwordx4 v[8:11], v78, s[32:35], s44 offen sc1
  s_add_u32 s44, s69, 0x330000
  buffer_store_dwordx4 v[8:11], v78, s[32:35], s44 offen sc1
  s_and_b32 s44, s41, 1
  s_lshl_b32 s44, s44, 4
  s_add_u32 s44, s44, s40
  s_lshl_b32 s44, s44, 10
  s_add_u32 s44, s44, 0x18000
  buffer_store_dwordx4 v[8:11], v78, s[32:35], s44 offen sc1
  s_add_u32 s44, s48, 0
  buffer_load_dwordx4 a[0:3], v1, s[12:15], s44 offen nt
  buffer_load_dwordx4 a[4:7], v1, s[12:15], s44 offen offset:256 nt
  buffer_load_dwordx4 a[8:11], v1, s[12:15], s44 offen offset:512 nt
  buffer_load_dwordx4 a[24:27], v2, s[12:15], s44 offen offset:768 nt
  s_add_u32 s44, s48, 14336
  buffer_load_dwordx4 a[12:15], v1, s[12:15], s44 offen nt
  buffer_load_dwordx4 a[16:19], v1, s[12:15], s44 offen offset:256 nt
  buffer_load_dwordx4 a[20:23], v1, s[12:15], s44 offen offset:512 nt
  s_add_u32 s44, s48, 896
  buffer_load_dwordx4 a[28:31], v1, s[12:15], s44 offen nt
  buffer_load_dwordx4 a[32:35], v1, s[12:15], s44 offen offset:256 nt
  buffer_load_dwordx4 a[36:39], v1, s[12:15], s44 offen offset:512 nt
  buffer_load_dwordx4 a[52:55], v2, s[12:15], s44 offen offset:768 nt
  s_add_u32 s44, s48, 15232
  buffer_load_dwordx4 a[40:43], v1, s[12:15], s44 offen nt
  buffer_load_dwordx4 a[44:47], v1, s[12:15], s44 offen offset:256 nt
  buffer_load_dwordx4 a[48:51], v1, s[12:15], s44 offen offset:512 nt
  s_add_u32 s44, s48, 1792
  buffer_load_dwordx4 a[56:59], v1, s[12:15], s44 offen nt
  buffer_load_dwordx4 a[60:63], v1, s[12:15], s44 offen offset:256 nt
  buffer_load_dwordx4 a[64:67], v1, s[12:15], s44 offen offset:512 nt
  buffer_load_dwordx4 a[80:83], v2, s[12:15], s44 offen offset:768 nt
  s_add_u32 s44, s48, 16128
  buffer_load_dwordx4 a[68:71], v1, s[12:15], s44 offen nt
  buffer_load_dwordx4 a[72:75], v1, s[12:15], s44 offen offset:256 nt
  buffer_load_dwordx4 a[76:79], v1, s[12:15], s44 offen offset:512 nt
  s_add_u32 s44, s48, 2688
  buffer_load_dwordx4 a[84:87], v1, s[12:15], s44 offen nt
  buffer_load_dwordx4 a[88:91], v1, s[12:15], s44 offen offset:256 nt
  buffer_load_dwordx4 a[92:95], v1, s[12:15], s44 offen offset:512 nt
  buffer_load_dwordx4 a[108:111], v2, s[12:15], s44 offen offset:768 nt
  s_add_u32 s44, s48, 17024
  buffer_load_dwordx4 a[96:99], v1, s[12:15], s44 offen nt
  buffer_load_dwordx4 a[100:103], v1, s[12:15], s44 offen offset:256 nt
  buffer_load_dwordx4 a[104:107], v1, s[12:15], s44 offen offset:512 nt
  s_add_u32 s44, s48, 28672
  buffer_load_dwordx4 a[112:115], v1, s[12:15], s44 offen nt
  buffer_load_dwordx4 a[116:119], v1, s[12:15], s44 offen offset:256 nt
  buffer_load_dwordx4 a[120:123], v1, s[12:15], s44 offen offset:512 nt
  buffer_load_dwordx4 a[136:139], v2, s[12:15], s44 offen offset:768 nt
  s_add_u32 s44, s48, 43008
  buffer_load_dwordx4 a[124:127], v1, s[12:15], s44 offen nt
  buffer_load_dwordx4 a[128:131], v1, s[12:15], s44 offen offset:256 nt
  buffer_load_dwordx4 a[132:135], v1, s[12:15], s44 offen offset:512 nt
  s_add_u32 s44, s48, 29568
  buffer_load_dwordx4 a[140:143], v1, s[12:15], s44 offen nt
  buffer_load_dwordx4 a[144:147], v1, s[12:15], s44 offen offset:256 nt
  buffer_load_dwordx4 a[148:151], v1, s[12:15], s44 offen offset:512 nt
  buffer_load_dwordx4 a[164:167], v2, s[12:15], s44 offen offset:768 nt
  s_add_u32 s44, s48, 43904
  buffer_load_dwordx4 a[152:155], v1, s[12:15], s44 offen nt
  buffer_load_dwordx4 a[156:159], v1, s[12:15], s44 offen offset:256 nt
  buffer_load_dwordx4 a[160:163], v1, s[12:15], s44 offen offset:512 nt
  s_add_u32 s44, s48, 30464
  buffer_load_dwordx4 a[168:171], v1, s[12:15], s44 offen nt
  buffer_load_dwordx4 a[172:175], v1, s[12:15], s44 offen offset:256 nt
  buffer_load_dwordx4 a[176:179], v1, s[12:15], s44 offen offset:512 nt
  buffer_load_dwordx4 a[192:195], v2, s[12:15], s44 offen offset:768 nt
  s_add_u32 s44, s48, 44800
  buffer_load_dwordx4 a[180:183], v1, s[12:15], s44 offen nt
  buffer_load_dwordx4 a[184:187], v1, s[12:15], s44 offen offset:256 nt
  buffer_load_dwordx4 a[188:191], v1, s[12:15], s44 offen offset:512 nt
  s_add_u32 s44, s48, 31360
  s_waitcnt vmcnt(40)
  buffer_load_dwordx4 a[196:199], v1, s[12:15], s44 offen nt
  buffer_load_dwordx4 a[200:203], v1, s[12:15], s44 offen offset:256 nt
  buffer_load_dwordx4 a[204:207], v1, s[12:15], s44 offen offset:512 nt
  buffer_load_dwordx4 a[220:223], v2, s[12:15], s44 offen offset:768 nt
  s_add_u32 s44, s48, 45696
  buffer_load_dwordx4 a[208:211], v1, s[12:15], s44 offen nt
  buffer_load_dwordx4 a[212:215], v1, s[12:15], s44 offen offset:256 nt
  buffer_load_dwordx4 a[216:219], v1, s[12:15], s44 offen offset:512 nt
  s_lshl_b32 s46, s40, 9
  s_lshl_b32 s45, s60, 13
  s_add_u32 s45, s45, s46
  buffer_load_dwordx4 a[228:231], v3, s[8:11], s45 offen offset:256 nt
  s_add_u32 s44, s45, 65536
  buffer_load_dwordx4 a[244:247], v3, s[8:11], s44 offen offset:256 nt
  s_add_u32 s44, s45, 131072
  buffer_load_dwordx4 v[96:99], v3, s[8:11], s44 offen offset:256 nt
  s_add_u32 s44, s45, 196608
  buffer_load_dwordx4 v[112:115], v3, s[8:11], s44 offen offset:256 nt
  s_lshl_b32 s45, s61, 13
  s_add_u32 s45, s45, s46
  buffer_load_dwordx4 a[236:239], v3, s[8:11], s45 offen offset:256 nt
  s_add_u32 s44, s45, 65536
  buffer_load_dwordx4 a[252:255], v3, s[8:11], s44 offen offset:256 nt
  s_add_u32 s44, s45, 131072
  buffer_load_dwordx4 v[104:107], v3, s[8:11], s44 offen offset:256 nt
  s_add_u32 s44, s45, 196608
  buffer_load_dwordx4 v[120:123], v3, s[8:11], s44 offen offset:256 nt
  s_lshl_b32 s45, s62, 13
  s_add_u32 s45, s45, s46
  buffer_load_dwordx4 v[128:131], v3, s[8:11], s45 offen offset:256 nt
  s_add_u32 s44, s45, 65536
  s_waitcnt vmcnt(40)
  buffer_load_dwordx4 v[144:147], v3, s[8:11], s44 offen offset:256 nt
  s_add_u32 s44, s45, 131072
  buffer_load_dwordx4 v[160:163], v3, s[8:11], s44 offen offset:256 nt
  s_add_u32 s44, s45, 196608
  buffer_load_dwordx4 v[176:179], v3, s[8:11], s44 offen offset:256 nt
  s_lshl_b32 s45, s63, 13
  s_add_u32 s45, s45, s46
  buffer_load_dwordx4 v[136:139], v3, s[8:11], s45 offen offset:256 nt
  s_add_u32 s44, s45, 65536
  buffer_load_dwordx4 v[152:155], v3, s[8:11], s44 offen offset:256 nt
  s_add_u32 s44, s45, 131072
  buffer_load_dwordx4 v[168:171], v3, s[8:11], s44 offen offset:256 nt
  s_add_u32 s44, s45, 196608
  buffer_load_dwordx4 v[184:187], v3, s[8:11], s44 offen offset:256 nt
  s_lshl_b32 s45, s64, 13
  s_add_u32 s45, s45, s46
  buffer_load_dwordx4 v[192:195], v3, s[8:11], s45 offen offset:256 nt
  s_add_u32 s44, s45, 65536
  buffer_load_dwordx4 v[208:211], v3, s[8:11], s44 offen offset:256 nt
  s_add_u32 s44, s45, 131072
  buffer_load_dwordx4 v[224:227], v3, s[8:11], s44 offen offset:256 nt
  s_add_u32 s44, s45, 196608
  buffer_load_dwordx4 v[240:243], v3, s[8:11], s44 offen offset:256 nt
  s_lshl_b32 s45, s65, 13
  s_add_u32 s45, s45, s46
  buffer_load_dwordx4 v[200:203], v3, s[8:11], s45 offen offset:256 nt
  s_add_u32 s44, s45, 65536
  buffer_load_dwordx4 v[216:219], v3, s[8:11], s44 offen offset:256 nt
  s_add_u32 s44, s45, 131072
  buffer_load_dwordx4 v[232:235], v3, s[8:11], s44 offen offset:256 nt
  s_add_u32 s44, s45, 196608
  buffer_load_dwordx4 v[248:251], v3, s[8:11], s44 offen offset:256 nt
  s_lshl_b32 s45, s66, 13
  s_add_u32 s45, s45, s46
  s_add_u32 m0, s67, 0xffffff00
  s_nop 0
  buffer_load_dwordx4 v3, s[8:11], s45 offen offset:256 nt lds
  s_add_u32 s44, s45, 65536
  s_waitcnt vmcnt(40)
  s_add_u32 m0, s67, 0x700
  s_nop 0
  buffer_load_dwordx4 v3, s[8:11], s44 offen offset:256 nt lds
  s_add_u32 s44, s45, 131072
  s_add_u32 m0, s67, 0xf00
  s_nop 0
  buffer_load_dwordx4 v3, s[8:11], s44 offen offset:256 nt lds
  s_add_u32 s44, s45, 196608
  s_add_u32 m0, s67, 0x1700
  s_nop 0
  buffer_load_dwordx4 v3, s[8:11], s44 offen offset:256 nt lds
  s_waitcnt vmcnt(0) lgkmcnt(0)
  s_barrier
  s_waitcnt vmcnt(0)
  v_and_b32 v60, 0x70, v78
  v_lshlrev_b32 v60, 5, v60
  v_and_b32 v20, 0x80, v78
  v_lshrrev_b32 v20, 1, v20
  v_or_b32 v60, v60, v20
  v_and_b32 v20, 0x300, v78
  v_lshrrev_b32 v21, 4, v20
  v_or_b32 v60, v60, v21
  v_xor_b32 v61, 0x1040, v60
  v_lshlrev_b32 v62, 3, v20
  v_and_b32 v20, 0xf0, v78
  v_or_b32 v62, v62, v20
  v_add_u32 v66, s88, v78
  v_mov_b32 v65, 0xbdb8aa3b
  v_lshrrev_b32 v21, 2, v78
  v_xor_b32 v21, v21, v78
  v_and_b32 v21, 0x80, v21
  v_cmp_eq_u32 s[54:55], 0, v21
  v_mov_b32 v20, 0x03020100
  v_mov_b32 v63, 0x05040c0c
  v_mov_b32 v64, 0x07060c0c
  v_cndmask_b32 v63, v20, v63, s[54:55]
  v_cndmask_b32 v64, v20, v64, s[54:55]
  s_add_u32 s86, s84, 0
  s_add_u32 m0, s88, 0x0
  s_nop 0
  buffer_load_dwordx4 v60, s[76:79], s86 offen nt lds
  s_add_u32 m0, s88, 0x380
  s_nop 0
  buffer_load_dwordx4 v60, s[76:79], s86 offen offset:128 nt lds
  s_add_u32 m0, s88, 0x700
  s_nop 0
  buffer_load_dwordx4 v60, s[76:79], s86 offen offset:256 nt lds
  s_add_u32 m0, s88, 0xa80
  s_nop 0
  buffer_load_dwordx4 v60, s[76:79], s86 offen offset:384 nt lds
  s_add_u32 m0, s88, 0x1000
  s_nop 0
  buffer_load_dwordx4 v61, s[76:79], s86 offen nt lds
  s_add_u32 m0, s88, 0x1380
  s_nop 0
  buffer_load_dwordx4 v61, s[76:79], s86 offen offset:128 nt lds
  s_add_u32 m0, s88, 0x1700
  s_nop 0
  buffer_load_dwordx4 v61, s[76:79], s86 offen offset:256 nt lds
  s_add_u32 m0, s88, 0x1a80
  s_nop 0
  buffer_load_dwordx4 v61, s[76:79], s86 offen offset:384 nt lds
  s_add_u32 s87, s84, 0
  s_add_u32 m0, s88, 0x2000
  s_nop 0
  buffer_load_dwordx4 v62, s[80:83], s87 offen nt lds
  s_add_u32 m0, s88, 0x2300
  s_nop 0
  buffer_load_dwordx4 v62, s[80:83], s87 offen offset:256 nt lds
  s_add_u32 m0, s88, 0x2600
  s_nop 0
  buffer_load_dwordx4 v62, s[80:83], s87 offen offset:512 nt lds
  s_add_u32 m0, s88, 0x2900
  s_nop 0
  buffer_load_dwordx4 v62, s[80:83], s87 offen offset:768 nt lds
  s_add_u32 m0, s88, 0x2c00
  s_nop 0
  buffer_load_dwordx4 v62, s[80:83], s87 offen offset:1024 nt lds
  s_add_u32 m0, s88, 0x2f00
  s_nop 0
  buffer_load_dwordx4 v62, s[80:83], s87 offen offset:1280 nt lds
  s_add_u32 m0, s88, 0x3200
  s_nop 0
  buffer_load_dwordx4 v62, s[80:83], s87 offen offset:1536 nt lds
  s_add_u32 m0, s88, 0x3500
  s_nop 0
  buffer_load_dwordx4 v62, s[80:83], s87 offen offset:1792 nt lds
  s_add_u32 s44, s93, 0
  v_subrev_u32 v52, s88, v66
  s_add_u32 m0, s88, 16384
  s_nop 0
  buffer_load_dwordx4 v52, s[32:35], s44 offen sc1 lds
  s_waitcnt vmcnt(0)
  ds_read_b128 v[20:23], v66 offset:16384
  s_waitcnt lgkmcnt(0)
  s_mov_b32 s49, 0
  s_branch QC_32
QR_31:
  s_add_u32 s44, s93, 0
  v_subrev_u32 v20, s88, v66
  buffer_load_dwordx4 v[20:23], v20, s[32:35], s44 offen sc1
  s_waitcnt vmcnt(0)
QC_32:
  v_cmp_eq_u32 s[54:55], s43, v21
  v_cmp_eq_u32 s[56:57], s43, v23
  s_nop 1
  s_and_b64 s[54:55], s[54:55], s[56:57]
  s_cmp_eq_u64 s[54:55], -1
  s_cbranch_scc1 QO_33
  s_add_u32 s49, s49, 1
  s_cmp_gt_u32 s49, 40000
  s_cbranch_scc1 QO_33
  s_sleep 8
  s_branch QR_31
QO_33:
  v_subrev_u32 v52, s88, v66
  v_lshrrev_b32 v52, 1, v52
  v_add_u32 v52, 27648, v52
  ds_write2_b32 v52, v20, v22 offset0:0 offset1:1
  s_waitcnt lgkmcnt(0)
  v_and_b32 v52, 0x70, v60
  ds_read_b128 v[4:7], v52 offset:27648
  ds_read_b128 v[8:11], v52 offset:27776
  ds_read_b128 v[12:15], v52 offset:27904
  ds_read_b128 v[16:19], v52 offset:28032
  s_waitcnt lgkmcnt(0)
  ds_read_b128 v[36:39], v66 offset:0
  ds_read_b128 v[40:43], v66 offset:4096
  ds_read_b128 v[44:47], v66 offset:1024
  ds_read_b128 v[48:51], v66 offset:5120
  s_waitcnt lgkmcnt(3)
  v_mfma_f32_16x16x32_bf16 v[20:23], v[36:39], v[4:7], 0
  ds_read_b128 v[36:39], v66 offset:2048
  s_waitcnt lgkmcnt(3)
  v_mfma_f32_16x16x32_bf16 v[24:27], v[40:43], v[4:7], 0
  ds_read_b128 v[40:43], v66 offset:6144
  s_waitcnt lgkmcnt(3)
  v_mfma_f32_16x16x32_bf16 v[20:23], v[44:47], v[8:11], v[20:23]
  ds_read_b128 v[44:47], v66 offset:3072
  s_waitcnt lgkmcnt(3)
  v_mfma_f32_16x16x32_bf16 v[24:27], v[48:51], v[8:11], v[24:27]
  ds_read_b128 v[48:51], v66 offset:7168
  s_waitcnt lgkmcnt(3)
  v_mfma_f32_16x16x32_bf16 v[20:23], v[36:39], v[12:15], v[20:23]
  s_waitcnt lgkmcnt(2)
  v_mfma_f32_16x16x32_bf16 v[24:27], v[40:43], v[12:15], v[24:27]
  s_waitcnt lgkmcnt(1)
  v_mfma_f32_16x16x32_bf16 v[20:23], v[44:47], v[16:19], v[20:23]
  s_waitcnt lgkmcnt(0)
  v_mfma_f32_16x16x32_bf16 v[24:27], v[48:51], v[16:19], v[24:27]
  s_nop 7
  v_permlane32_swap_b32 v20, v24
  v_permlane32_swap_b32 v21, v25
  v_permlane32_swap_b32 v22, v26
  v_permlane32_swap_b32 v23, v27
  v_add_f32_dpp v20, v24, v20 row_ror:8 row_mask:0xf bank_mask:0xf
  v_add_f32_dpp v21, v25, v21 row_ror:8 row_mask:0xf bank_mask:0xf
  v_add_f32_dpp v22, v26, v22 row_ror:8 row_mask:0xf bank_mask:0xf
  v_add_f32_dpp v23, v27, v23 row_ror:8 row_mask:0xf bank_mask:0xf
  v_cvt_pk_bf16_f32 v24, v20, v21
  v_cvt_pk_bf16_f32 v25, v22, v23
  v_perm_b32 v20, v24, s90, v63
  v_perm_b32 v21, v24, s90, v64
  v_perm_b32 v22, v25, s90, v63
  v_perm_b32 v23, v25, s90, v64
  v_max3_f32 v26, v20, v21, v22
  v_max_f32 v26, v26, v23
  s_nop 1
  v_max_f32_dpp v26, v26, v26 row_ror:8 row_mask:0xf bank_mask:0xf
  s_nop 1
  v_max_f32_dpp v26, v26, v26 row_bcast:15 row_mask:0xa bank_mask:0xf
  s_nop 1
  v_max_f32_dpp v26, v26, v26 row_bcast:31 row_mask:0xc bank_mask:0xf
  s_nop 0
  v_readlane_b32 s91, v26, 63
  s_nop 1
  v_mul_f32 v86, s91, v65
  v_fma_f32 v20, v20, s89, v86
  v_fma_f32 v21, v21, s89, v86
  v_fma_f32 v22, v22, s89, v86
  v_fma_f32 v23, v23, s89, v86
  v_exp_f32 v20, v20
  v_exp_f32 v21, v21
  v_exp_f32 v22, v22
  v_exp_f32 v23, v23
  v_add_f32 v26, v20, v21
  v_add_f32 v24, v22, v23
  v_cvt_pk_bf16_f32 v20, v20, v20
  v_cvt_pk_bf16_f32 v21, v21, v21
  v_cvt_pk_bf16_f32 v22, v22, v22
  v_cvt_pk_bf16_f32 v23, v23, v23
  v_add_f32 v67, v26, v24
  v_and_b32 v52, v20, v68
  v_and_b32 v53, v20, v69
  v_and_b32 v54, v20, v70
  v_and_b32 v55, v20, v71
  v_and_b32 v56, v21, v68
  v_and_b32 v57, v21, v69
  v_and_b32 v58, v21, v70
  v_and_b32 v59, v21, v71
  ds_read_b128 v[36:39], v66 offset:8192
  ds_read_b128 v[40:43], v66 offset:9216
  ds_read_b128 v[44:47], v66 offset:10240
  ds_read_b128 v[48:51], v66 offset:11264
  s_waitcnt lgkmcnt(3)
  v_mfma_f32_16x16x32_bf16 v[28:31], v[36:39], v[52:55], 0
  ds_read_b128 v[36:39], v66 offset:12288
  s_waitcnt lgkmcnt(3)
  v_mfma_f32_16x16x32_bf16 v[32:35], v[40:43], v[52:55], 0
  ds_read_b128 v[40:43], v66 offset:13312
  v_and_b32 v52, v22, v68
  v_and_b32 v53, v22, v69
  v_and_b32 v54, v22, v70
  v_and_b32 v55, v22, v71
  s_waitcnt lgkmcnt(3)
  v_mfma_f32_16x16x32_bf16 v[28:31], v[44:47], v[56:59], v[28:31]
  ds_read_b128 v[44:47], v66 offset:14336
  s_waitcnt lgkmcnt(3)
  v_mfma_f32_16x16x32_bf16 v[32:35], v[48:51], v[56:59], v[32:35]
  ds_read_b128 v[48:51], v66 offset:15360
  v_and_b32 v56, v23, v68
  v_and_b32 v57, v23, v69
  v_and_b32 v58, v23, v70
  v_and_b32 v59, v23, v71
  s_waitcnt lgkmcnt(3)
  v_mfma_f32_16x16x32_bf16 v[28:31], v[36:39], v[52:55], v[28:31]
  s_waitcnt lgkmcnt(2)
  v_mfma_f32_16x16x32_bf16 v[32:35], v[40:43], v[52:55], v[32:35]
  s_waitcnt lgkmcnt(1)
  v_mfma_f32_16x16x32_bf16 v[28:31], v[44:47], v[56:59], v[28:31]
  s_waitcnt lgkmcnt(0)
  v_mfma_f32_16x16x32_bf16 v[32:35], v[48:51], v[56:59], v[32:35]
  v_subrev_u32 v27, s88, v66
  s_nop 6
  v_cndmask_b32 v52, v28, v32, s[50:51]
  v_cndmask_b32 v56, v32, v28, s[50:51]
  v_cndmask_b32 v53, v29, v33, s[50:51]
  v_cndmask_b32 v57, v33, v29, s[50:51]
  v_cndmask_b32 v54, v30, v34, s[50:51]
  v_cndmask_b32 v58, v34, v30, s[50:51]
  v_cndmask_b32 v55, v31, v35, s[50:51]
  v_cndmask_b32 v59, v35, v31, s[50:51]
  v_add_f32_dpp v67, v67, v67 row_ror:8 row_mask:0xf bank_mask:0xf
  v_add_f32_dpp v52, v56, v52 row_ror:8 row_mask:0xf bank_mask:0xf
  v_add_f32_dpp v53, v57, v53 row_ror:8 row_mask:0xf bank_mask:0xf
  v_add_f32_dpp v54, v58, v54 row_ror:8 row_mask:0xf bank_mask:0xf
  v_add_f32_dpp v55, v59, v55 row_ror:8 row_mask:0xf bank_mask:0xf
  v_mov_b32 v24, v67
  s_nop 1
  v_permlane16_swap_b32 v67, v24
  v_add_f32 v67, v67, v24
  v_mov_b32 v24, v67
  s_nop 1
  v_permlane32_swap_b32 v67, v24
  v_add_f32 v25, v67, v24
  v_sub_f32 v24, 0, v86
  s_lshl_b32 s44, s41, 10
  v_add_u32 v56, s44, v27
  ds_write_b128 v56, v[52:55] offset:0
  s_lshl_b32 s44, s41, 3
  v_mov_b32 v57, s44
  ds_write_b64 v57, v[24:25] offset:28672
  v_mov_b32 v58, 28736
  v_mov_b32 v59, 1
  s_waitcnt lgkmcnt(0)
  s_mov_b64 exec, 1
  ds_add_rtn_u32 v57, v58, v59
  s_waitcnt lgkmcnt(0)
  v_readfirstlane_b32 s44, v57
  s_mov_b64 exec, -1
  s_nop 0
  s_cmp_eq_u32 s44, 3
  s_cbranch_scc0 PS_34
  ds_read_b128 v[36:39], v27 offset:0
  ds_read_b128 v[40:43], v27 offset:1024
  ds_read_b128 v[44:47], v27 offset:2048
  ds_read_b128 v[48:51], v27 offset:3072
  v_mov_b32 v56, 0
  ds_read_b128 v[20:23], v56 offset:28672
  ds_read_b128 v[52:55], v56 offset:28688
  v_and_b32 v56, 0x70, v27
  v_lshlrev_b32 v56, 1, v56
  v_and_b32 v57, 0x80, v27
  v_lshl_or_b32 v56, v57, 3, v56
  v_and_b32 v57, 0x300, v27
  v_or_b32 v56, v56, v57
  s_add_u32 s44, s94, 0
  s_waitcnt lgkmcnt(0)
  s_mov_b64 exec, 1
  ds_add_u32 v58, v59
  s_mov_b64 exec, -1
  v_max3_f32 v25, v20, v22, v52
  v_max_f32 v25, v25, v54
  v_sub_f32 v20, v20, v25
  v_sub_f32 v22, v22, v25
  v_sub_f32 v52, v52, v25
  v_sub_f32 v54, v54, v25
  v_exp_f32 v20, v20
  v_exp_f32 v22, v22
  v_exp_f32 v52, v52
  v_exp_f32 v54, v54
  v_mov_b32 v27, s43
  v_mul_f32 v26, v20, v21
  v_fmac_f32 v26, v22, v23
  v_fmac_f32 v26, v52, v53
  v_fmac_f32 v26, v54, v55
  v_mul_f32 v36, v20, v36
  v_mul_f32 v37, v20, v37
  v_mul_f32 v38, v20, v38
  v_mul_f32 v39, v20, v39
  v_fmac_f32 v36, v22, v40
  v_fmac_f32 v37, v22, v41
  v_fmac_f32 v38, v22, v42
  v_fmac_f32 v39, v22, v43
  v_fmac_f32 v36, v52, v44
  v_fmac_f32 v37, v52, v45
  v_fmac_f32 v38, v52, v46
  v_fmac_f32 v39, v52, v47
  v_fmac_f32 v36, v54, v48
  v_fmac_f32 v37, v54, v49
  v_fmac_f32 v38, v54, v50
  v_fmac_f32 v39, v54, v51
  v_mov_b32 v24, v39
  v_mov_b32 v39, s43
  buffer_store_dwordx4 v[36:39], v56, s[32:35], s44 offen sc1
  buffer_store_dwordx4 v[24:27], v56, s[32:35], s44 offen offset:16 sc1
  s_waitcnt lgkmcnt(0)
PS_34:
  s_nop 1
  s_waitcnt vmcnt(0) lgkmcnt(0)
  s_barrier
CL_35:
  s_lshl_b32 s45, s42, 4
  s_add_u32 s45, s45, s40
  s_lshl_b32 s45, s45, 15
  s_lshl_b32 s46, s41, 9
  s_add_u32 s45, s45, s46
  s_add_u32 s45, s45, 0x100000
  v_lshlrev_b32 v84, 7, v78
  s_mov_b32 s49, 0
  s_mov_b64 exec, 0xffff
PP_38:
  buffer_load_dword v85, v84, s[32:35], s45 offen offset:12 sc1
  s_waitcnt vmcnt(0)
  v_cmp_eq_u32 s[54:55], s43, v85
  s_nop 1
  s_bcnt1_i32_b64 s44, s[54:55]
  s_cmp_ge_u32 s44, 9
  s_cbranch_scc1 PG_39
  s_add_u32 s49, s49, 1
  s_cmp_gt_u32 s49, 40000
  s_cbranch_scc1 PG_39
  s_sleep 8
  s_branch PP_38
PG_39:
  s_mov_b64 exec, -1
  v_and_b32 v84, 0x300, v78
  v_lshlrev_b32 v84, 3, v84
  v_and_b32 v85, 0xf0, v78
  v_lshl_or_b32 v84, v85, 1, v84
  v_mov_b32 v28, 0
  v_mov_b32 v29, 0
  v_mov_b32 v30, 0
  v_mov_b32 v32, 0
  v_mov_b32 v34, 0
  v_mov_b32 v33, 0xff7f0000
  v_mov_b32 v31, s43
  v_mov_b32 v35, s43
  v_and_b32 v87, 0x80, v78
  v_bfe_u32 v85, v78, 4, 3
  v_lshl_or_b32 v87, v85, 2, v87
  s_lshl_b32 s44, s41, 9
  v_add_u32 v87, s44, v87
  s_mov_b32 s49, 0
  s_mov_b32 s56, 0xffffffff
  s_mov_b32 s57, 0xffffffff
PR_41:
  s_add_u32 s44, s45, 0
  buffer_load_dwordx4 v[4:7], v84, s[32:35], s44 offen sc1
  buffer_load_dwordx4 v[8:11], v84, s[32:35], s44 offen offset:16 sc1
  s_add_u32 s44, s45, 8192
  buffer_load_dwordx4 v[12:15], v84, s[32:35], s44 offen sc1
  buffer_load_dwordx4 v[16:19], v84, s[32:35], s44 offen offset:16 sc1
  s_add_u32 s44, s45, 16384
  buffer_load_dwordx4 v[20:23], v84, s[32:35], s44 offen sc1
  buffer_load_dwordx4 v[24:27], v84, s[32:35], s44 offen offset:16 sc1
  s_add_u32 s44, s45, 24576
  s_mov_b64 exec, s[56:57]
  buffer_load_dwordx4 v[28:31], v84, s[32:35], s44 offen sc1
  buffer_load_dwordx4 v[32:35], v84, s[32:35], s44 offen offset:16 sc1
  s_mov_b64 exec, -1
  s_waitcnt vmcnt(0)
  v_xor_b32 v85, s43, v7
  v_xor_b32 v86, s43, v11
  v_or_b32 v85, v85, v86
  v_xor_b32 v86, s43, v15
  v_or_b32 v85, v85, v86
  v_xor_b32 v86, s43, v19
  v_or_b32 v85, v85, v86
  v_xor_b32 v86, s43, v23
  v_or_b32 v85, v85, v86
  v_xor_b32 v86, s43, v27
  v_or_b32 v85, v85, v86
  v_xor_b32 v86, s43, v31
  v_or_b32 v85, v85, v86
  v_xor_b32 v86, s43, v35
  v_or_b32 v85, v85, v86
  v_cmp_ne_u32 s[54:55], 0, v85
  s_nop 1
  s_cmp_eq_u64 s[54:55], 0
  s_cbranch_scc1 PO_40
  s_add_u32 s49, s49, 1
  s_cmp_gt_u32 s49, 40000
  s_cbranch_scc1 PO_40
  s_sleep 1
  s_branch PR_41
PO_40:
  v_max3_f32 v84, v9, v17, v25
  v_max_f32 v84, v84, v33
  v_mov_b32 v85, v84
  s_nop 1
  v_permlane16_swap_b32 v84, v85
  v_max_f32 v84, v84, v85
  v_mov_b32 v85, v84
  s_nop 1
  v_permlane32_swap_b32 v84, v85
  v_max_f32 v84, v84, v85
  v_sub_f32 v9, v9, v84
  v_sub_f32 v17, v17, v84
  v_sub_f32 v25, v25, v84
  v_sub_f32 v33, v33, v84
  v_exp_f32 v9, v9
  v_exp_f32 v17, v17
  v_exp_f32 v25, v25
  v_exp_f32 v33, v33
  v_mul_f32 v36, v9, v4
  v_mul_f32 v37, v9, v5
  v_mul_f32 v38, v9, v6
  v_mul_f32 v39, v9, v8
  v_mul_f32 v40, v9, v10
  v_fmac_f32 v36, v17, v12
  v_fmac_f32 v37, v17, v13
  v_fmac_f32 v38, v17, v14
  v_fmac_f32 v39, v17, v16
  v_fmac_f32 v40, v17, v18
  v_fmac_f32 v36, v25, v20
  v_fmac_f32 v37, v25, v21
  v_fmac_f32 v38, v25, v22
  v_fmac_f32 v39, v25, v24
  v_fmac_f32 v40, v25, v26
  v_fmac_f32 v36, v33, v28
  v_fmac_f32 v37, v33, v29
  v_fmac_f32 v38, v33, v30
  v_fmac_f32 v39, v33, v32
  v_fmac_f32 v40, v33, v34
  v_mov_b32 v44, v36
  v_mov_b32 v45, v37
  v_mov_b32 v46, v38
  v_mov_b32 v47, v39
  v_mov_b32 v48, v40
  v_permlane16_swap_b32 v36, v44
  v_permlane16_swap_b32 v37, v45
  v_permlane16_swap_b32 v38, v46
  v_permlane16_swap_b32 v39, v47
  v_permlane16_swap_b32 v40, v48
  v_add_f32 v36, v36, v44
  v_add_f32 v37, v37, v45
  v_add_f32 v38, v38, v46
  v_add_f32 v39, v39, v47
  v_add_f32 v40, v40, v48
  v_mov_b32 v44, v36
  v_mov_b32 v45, v37
  v_mov_b32 v46, v38
  v_mov_b32 v47, v39
  v_mov_b32 v48, v40
  v_permlane32_swap_b32 v36, v44
  v_permlane32_swap_b32 v37, v45
  v_permlane32_swap_b32 v38, v46
  v_permlane32_swap_b32 v39, v47
  v_permlane32_swap_b32 v40, v48
  v_add_f32 v36, v36, v44
  v_add_f32 v37, v37, v45
  v_add_f32 v38, v38, v46
  v_add_f32 v39, v39, v47
  v_add_f32 v40, v40, v48
  v_rcp_f32 v40, v40
  s_nop 0
  v_mul_f32 v36, v36, v40
  v_mul_f32 v37, v37, v40
  v_mul_f32 v38, v38, v40
  v_mul_f32 v39, v39, v40
  v_cvt_pk_bf16_f32 v36, v36, v36
  ds_write_b32 v87, v36 offset:24576
  v_cvt_pk_bf16_f32 v37, v37, v37
  ds_write_b32 v87, v37 offset:24608
  v_cvt_pk_bf16_f32 v38, v38, v38
  ds_write_b32 v87, v38 offset:24640
  v_cvt_pk_bf16_f32 v39, v39, v39
  ds_write_b32 v87, v39 offset:24672
  ds_read_b128 v[60:63], v80 offset:24576
  ds_read_b128 v[64:67], v80 offset:24704
  s_waitcnt lgkmcnt(0)
  v_and_b32 v52, v60, v68
  v_and_b32 v53, v60, v69
  v_and_b32 v54, v60, v70
  v_and_b32 v55, v60, v71
  v_and_b32 v56, v61, v68
  v_and_b32 v57, v61, v69
  v_and_b32 v58, v61, v70
  v_and_b32 v59, v61, v71
  v_mfma_f32_16x16x32_bf16 v[4:7], a[0:3], v[52:55], 0
  v_mfma_f32_16x16x32_bf16 v[8:11], a[4:7], v[52:55], 0
  v_mfma_f32_16x16x32_bf16 v[12:15], a[8:11], v[52:55], 0
  v_mfma_f32_16x16x32_bf16 v[16:19], a[12:15], v[52:55], 0
  v_mfma_f32_16x16x32_bf16 v[20:23], a[16:19], v[52:55], 0
  v_mfma_f32_16x16x32_bf16 v[24:27], a[20:23], v[52:55], 0
  v_mfma_f32_16x16x32_bf16 v[28:31], a[24:27], v[52:55], 0
  v_and_b32 v52, v62, v68
  v_and_b32 v53, v62, v69
  v_and_b32 v54, v62, v70
  v_and_b32 v55, v62, v71
  v_mfma_f32_16x16x32_bf16 v[4:7], a[28:31], v[56:59], v[4:7]
  v_mfma_f32_16x16x32_bf16 v[8:11], a[32:35], v[56:59], v[8:11]
  v_mfma_f32_16x16x32_bf16 v[12:15], a[36:39], v[56:59], v[12:15]
  v_mfma_f32_16x16x32_bf16 v[16:19], a[40:43], v[56:59], v[16:19]
  v_mfma_f32_16x16x32_bf16 v[20:23], a[44:47], v[56:59], v[20:23]
  v_mfma_f32_16x16x32_bf16 v[24:27], a[48:51], v[56:59], v[24:27]
  v_mfma_f32_16x16x32_bf16 v[28:31], a[52:55], v[56:59], v[28:31]
  v_and_b32 v56, v63, v68
  v_and_b32 v57, v63, v69
  v_and_b32 v58, v63, v70
  v_and_b32 v59, v63, v71
  v_mfma_f32_16x16x32_bf16 v[4:7], a[56:59], v[52:55], v[4:7]
  v_mfma_f32_16x16x32_bf16 v[8:11], a[60:63], v[52:55], v[8:11]
  v_mfma_f32_16x16x32_bf16 v[12:15], a[64:67], v[52:55], v[12:15]
  v_mfma_f32_16x16x32_bf16 v[16:19], a[68:71], v[52:55], v[16:19]
  v_mfma_f32_16x16x32_bf16 v[20:23], a[72:75], v[52:55], v[20:23]
  v_mfma_f32_16x16x32_bf16 v[24:27], a[76:79], v[52:55], v[24:27]
  v_mfma_f32_16x16x32_bf16 v[28:31], a[80:83], v[52:55], v[28:31]
  v_and_b32 v52, v64, v68
  v_and_b32 v53, v64, v69
  v_and_b32 v54, v64, v70
  v_and_b32 v55, v64, v71
  v_mfma_f32_16x16x32_bf16 v[4:7], a[84:87], v[56:59], v[4:7]
  v_mfma_f32_16x16x32_bf16 v[8:11], a[88:91], v[56:59], v[8:11]
  v_mfma_f32_16x16x32_bf16 v[12:15], a[92:95], v[56:59], v[12:15]
  v_mfma_f32_16x16x32_bf16 v[16:19], a[96:99], v[56:59], v[16:19]
  v_mfma_f32_16x16x32_bf16 v[20:23], a[100:103], v[56:59], v[20:23]
  v_mfma_f32_16x16x32_bf16 v[24:27], a[104:107], v[56:59], v[24:27]
  v_mfma_f32_16x16x32_bf16 v[28:31], a[108:111], v[56:59], v[28:31]
  v_and_b32 v56, v65, v68
  v_and_b32 v57, v65, v69
  v_and_b32 v58, v65, v70
  v_and_b32 v59, v65, v71
  v_mfma_f32_16x16x32_bf16 v[4:7], a[112:115], v[52:55], v[4:7]
  v_mfma_f32_16x16x32_bf16 v[8:11], a[116:119], v[52:55], v[8:11]
  v_mfma_f32_16x16x32_bf16 v[12:15], a[120:123], v[52:55], v[12:15]
  v_mfma_f32_16x16x32_bf16 v[16:19], a[124:127], v[52:55], v[16:19]
  v_mfma_f32_16x16x32_bf16 v[20:23], a[128:131], v[52:55], v[20:23]
  v_mfma_f32_16x16x32_bf16 v[24:27], a[132:135], v[52:55], v[24:27]
  v_mfma_f32_16x16x32_bf16 v[28:31], a[136:139], v[52:55], v[28:31]
  v_and_b32 v52, v66, v68
  v_and_b32 v53, v66, v69
  v_and_b32 v54, v66, v70
  v_and_b32 v55, v66, v71
  v_mfma_f32_16x16x32_bf16 v[4:7], a[140:143], v[56:59], v[4:7]
  v_mfma_f32_16x16x32_bf16 v[8:11], a[144:147], v[56:59], v[8:11]
  v_mfma_f32_16x16x32_bf16 v[12:15], a[148:151], v[56:59], v[12:15]
  v_mfma_f32_16x16x32_bf16 v[16:19], a[152:155], v[56:59], v[16:19]
  v_mfma_f32_16x16x32_bf16 v[20:23], a[156:159], v[56:59], v[20:23]
  v_mfma_f32_16x16x32_bf16 v[24:27], a[160:163], v[56:59], v[24:27]
  v_mfma_f32_16x16x32_bf16 v[28:31], a[164:167], v[56:59], v[28:31]
  v_and_b32 v56, v67, v68
  v_and_b32 v57, v67, v69
  v_and_b32 v58, v67, v70
  v_and_b32 v59, v67, v71
  v_mfma_f32_16x16x32_bf16 v[4:7], a[168:171], v[52:55], v[4:7]
  v_mfma_f32_16x16x32_bf16 v[8:11], a[172:175], v[52:55], v[8:11]
  v_mfma_f32_16x16x32_bf16 v[12:15], a[176:179], v[52:55], v[12:15]
  v_mfma_f32_16x16x32_bf16 v[16:19], a[180:183], v[52:55], v[16:19]
  v_mfma_f32_16x16x32_bf16 v[20:23], a[184:187], v[52:55], v[20:23]
  v_mfma_f32_16x16x32_bf16 v[24:27], a[188:191], v[52:55], v[24:27]
  v_mfma_f32_16x16x32_bf16 v[28:31], a[192:195], v[52:55], v[28:31]
  v_mfma_f32_16x16x32_bf16 v[4:7], a[196:199], v[56:59], v[4:7]
  v_mfma_f32_16x16x32_bf16 v[8:11], a[200:203], v[56:59], v[8:11]
  v_mfma_f32_16x16x32_bf16 v[12:15], a[204:207], v[56:59], v[12:15]
  v_mfma_f32_16x16x32_bf16 v[16:19], a[208:211], v[56:59], v[16:19]
  v_mfma_f32_16x16x32_bf16 v[20:23], a[212:215], v[56:59], v[20:23]
  v_mfma_f32_16x16x32_bf16 v[24:27], a[216:219], v[56:59], v[24:27]
  v_mfma_f32_16x16x32_bf16 v[28:31], a[220:223], v[56:59], v[28:31]
  v_lshrrev_b32 v84, 1, v78
  s_mul_i32 s44, s41, 448
  v_add_u32 v84, s44, v84
  s_lshl_b32 s44, s42, 16
  s_add_u32 s44, s44, s69
  s_add_u32 s44, s44, 0x300000
  v_cndmask_b32 v4, v4, v16, s[50:51]
  v_cndmask_b32 v5, v5, v17, s[50:51]
  v_cndmask_b32 v6, v6, v18, s[50:51]
  v_cndmask_b32 v7, v7, v19, s[50:51]
  ds_write_b128 v81, v[4:7] offset:0
  v_cndmask_b32 v8, v8, v20, s[50:51]
  v_cndmask_b32 v9, v9, v21, s[50:51]
  v_cndmask_b32 v10, v10, v22, s[50:51]
  v_cndmask_b32 v11, v11, v23, s[50:51]
  ds_write_b128 v81, v[8:11] offset:512
  v_cndmask_b32 v12, v12, v24, s[50:51]
  v_cndmask_b32 v13, v13, v25, s[50:51]
  v_cndmask_b32 v14, v14, v26, s[50:51]
  v_cndmask_b32 v15, v15, v27, s[50:51]
  ds_write_b128 v81, v[12:15] offset:1024
  ds_write_b128 v82, v[28:31] offset:0
  s_waitcnt lgkmcnt(0)
  s_barrier
  ds_read_b64 v[4:5], v84 offset:0
  ds_read_b64 v[6:7], v84 offset:2048
  ds_read_b64 v[8:9], v84 offset:4096
  ds_read_b64 v[10:11], v84 offset:6144
  ds_read_b64 v[12:13], v84 offset:8192
  ds_read_b64 v[14:15], v84 offset:10240
  ds_read_b64 v[16:17], v84 offset:12288
  ds_read_b64 v[18:19], v84 offset:14336
  s_waitcnt lgkmcnt(4)
  v_add_f32 v4, v4, v8
  v_add_f32 v5, v5, v9
  v_add_f32 v6, v6, v10
  v_add_f32 v7, v7, v11
  s_waitcnt lgkmcnt(0)
  v_add_f32 v12, v12, v16
  v_add_f32 v13, v13, v17
  v_add_f32 v14, v14, v18
  v_add_f32 v15, v15, v19
  v_add_f32 v4, v4, v12
  v_add_f32 v5, v5, v13
  v_add_f32 v6, v6, v14
  v_add_f32 v7, v7, v15
  v_add_f32 v4, v4, v6
  v_add_f32 v5, v5, v7
  v_mov_b32 v6, s43
  s_mov_b64 exec, s[52:53]
  buffer_store_dwordx3 v[4:6], v78, s[32:35], s44 offen sc1
  s_mov_b64 exec, -1
  s_cmp_ge_i32 s42, 2
  s_cbranch_scc1 CX_36
  s_lshl_b32 s45, s42, 16
  s_lshl_b32 s46, s41, 10
  s_add_u32 s45, s45, s46
  s_add_u32 s45, s45, 0x300000
  s_mov_b32 s49, 0
  s_mov_b64 exec, s[52:53]
  s_mov_b32 s46, 0xffff
GR_42:
  s_bitcmp0_b32 s46, 0
  s_cbranch_scc1 GS_44
  s_add_u32 s44, s45, 0
  buffer_load_dwordx3 v[4:6], v78, s[32:35], s44 offen sc1
GS_44:
  s_bitcmp0_b32 s46, 1
  s_cbranch_scc1 GS_45
  s_add_u32 s44, s45, 4096
  buffer_load_dwordx3 v[8:10], v78, s[32:35], s44 offen sc1
GS_45:
  s_bitcmp0_b32 s46, 2
  s_cbranch_scc1 GS_46
  s_add_u32 s44, s45, 8192
  buffer_load_dwordx3 v[12:14], v78, s[32:35], s44 offen sc1
GS_46:
  s_bitcmp0_b32 s46, 3
  s_cbranch_scc1 GS_47
  s_add_u32 s44, s45, 12288
  buffer_load_dwordx3 v[16:18], v78, s[32:35], s44 offen sc1
GS_47:
  s_bitcmp0_b32 s46, 4
  s_cbranch_scc1 GS_48
  s_add_u32 s44, s45, 16384
  buffer_load_dwordx3 v[20:22], v78, s[32:35], s44 offen sc1
GS_48:
  s_bitcmp0_b32 s46, 5
  s_cbranch_scc1 GS_49
  s_add_u32 s44, s45, 20480
  buffer_load_dwordx3 v[24:26], v78, s[32:35], s44 offen sc1
GS_49:
  s_bitcmp0_b32 s46, 6
  s_cbranch_scc1 GS_50
  s_add_u32 s44, s45, 24576
  buffer_load_dwordx3 v[28:30], v78, s[32:35], s44 offen sc1
GS_50:
  s_bitcmp0_b32 s46, 7
  s_cbranch_scc1 GS_51
  s_add_u32 s44, s45, 28672
  buffer_load_dwordx3 v[32:34], v78, s[32:35], s44 offen sc1
GS_51:
  s_bitcmp0_b32 s46, 8
  s_cbranch_scc1 GS_52
  s_add_u32 s44, s45, 32768
  buffer_load_dwordx3 v[36:38], v78, s[32:35], s44 offen sc1
GS_52:
  s_bitcmp0_b32 s46, 9
  s_cbranch_scc1 GS_53
  s_add_u32 s44, s45, 36864
  buffer_load_dwordx3 v[40:42], v78, s[32:35], s44 offen sc1
GS_53:
  s_bitcmp0_b32 s46, 10
  s_cbranch_scc1 GS_54
  s_add_u32 s44, s45, 40960
  buffer_load_dwordx3 v[44:46], v78, s[32:35], s44 offen sc1
GS_54:
  s_bitcmp0_b32 s46, 11
  s_cbranch_scc1 GS_55
  s_add_u32 s44, s45, 45056
  buffer_load_dwordx3 v[48:50], v78, s[32:35], s44 offen sc1
GS_55:
  s_bitcmp0_b32 s46, 12
  s_cbranch_scc1 GS_56
  s_add_u32 s44, s45, 49152
  buffer_load_dwordx3 v[52:54], v78, s[32:35], s44 offen sc1
GS_56:
  s_bitcmp0_b32 s46, 13
  s_cbranch_scc1 GS_57
  s_add_u32 s44, s45, 53248
  buffer_load_dwordx3 v[56:58], v78, s[32:35], s44 offen sc1
GS_57:
  s_bitcmp0_b32 s46, 14
  s_cbranch_scc1 GS_58
  s_add_u32 s44, s45, 57344
  buffer_load_dwordx3 v[60:62], v78, s[32:35], s44 offen sc1
GS_58:
  s_bitcmp0_b32 s46, 15
  s_cbranch_scc1 GS_59
  s_add_u32 s44, s45, 61440
  buffer_load_dwordx3 v[64:66], v78, s[32:35], s44 offen sc1
GS_59:
  s_waitcnt vmcnt(0)
  v_max3_u32 v84, v6, v10, v14
  v_max3_u32 v84, v84, v18, v22
  v_max3_u32 v84, v84, v26, v30
  v_max3_u32 v84, v84, v34, v38
  v_max3_u32 v84, v84, v42, v46
  v_max3_u32 v84, v84, v50, v54
  v_max3_u32 v84, v84, v58, v62
  v_max3_u32 v84, v84, v66, s43
  v_min3_u32 v85, v6, v10, v14
  v_min3_u32 v85, v85, v18, v22
  v_min3_u32 v85, v85, v26, v30
  v_min3_u32 v85, v85, v34, v38
  v_min3_u32 v85, v85, v42, v46
  v_min3_u32 v85, v85, v50, v54
  v_min3_u32 v85, v85, v58, v62
  v_min3_u32 v85, v85, v66, s43
  v_cmp_ne_u32 s[54:55], v84, v85
  s_nop 1
  s_cmp_eq_u64 s[54:55], 0
  s_cbranch_scc1 GO_43
  s_mov_b32 s46, 0
  v_cmp_ne_u32 s[56:57], s43, v6
  v_cmp_ne_u32 s[54:55], s43, v10
  s_nop 0
  s_cmp_lg_u64 s[56:57], 0
  s_cselect_b32 s44, 1, 0
  s_or_b32 s46, s46, s44
  v_cmp_ne_u32 s[56:57], s43, v14
  s_cmp_lg_u64 s[54:55], 0
  s_cselect_b32 s44, 2, 0
  s_or_b32 s46, s46, s44
  v_cmp_ne_u32 s[54:55], s43, v18
  s_cmp_lg_u64 s[56:57], 0
  s_cselect_b32 s44, 4, 0
  s_or_b32 s46, s46, s44
  v_cmp_ne_u32 s[56:57], s43, v22
  s_cmp_lg_u64 s[54:55], 0
  s_cselect_b32 s44, 8, 0
  s_or_b32 s46, s46, s44
  v_cmp_ne_u32 s[54:55], s43, v26
  s_cmp_lg_u64 s[56:57], 0
  s_cselect_b32 s44, 16, 0
  s_or_b32 s46, s46, s44
  v_cmp_ne_u32 s[56:57], s43, v30
  s_cmp_lg_u64 s[54:55], 0
  s_cselect_b32 s44, 32, 0
  s_or_b32 s46, s46, s44
  v_cmp_ne_u32 s[54:55], s43, v34
  s_cmp_lg_u64 s[56:57], 0
  s_cselect_b32 s44, 64, 0
  s_or_b32 s46, s46, s44
  v_cmp_ne_u32 s[56:57], s43, v38
  s_cmp_lg_u64 s[54:55], 0
  s_cselect_b32 s44, 128, 0
  s_or_b32 s46, s46, s44
  v_cmp_ne_u32 s[54:55], s43, v42
  s_cmp_lg_u64 s[56:57], 0
  s_cselect_b32 s44, 256, 0
  s_or_b32 s46, s46, s44
  v_cmp_ne_u32 s[56:57], s43, v46
  s_cmp_lg_u64 s[54:55], 0
  s_cselect_b32 s44, 512, 0
  s_or_b32 s46, s46, s44
  v_cmp_ne_u32 s[54:55], s43, v50
  s_cmp_lg_u64 s[56:57], 0
  s_cselect_b32 s44, 1024, 0
  s_or_b32 s46, s46, s44
  v_cmp_ne_u32 s[56:57], s43, v54
  s_cmp_lg_u64 s[54:55], 0
  s_cselect_b32 s44, 2048, 0
  s_or_b32 s46, s46, s44
  v_cmp_ne_u32 s[54:55], s43, v58
  s_cmp_lg_u64 s[56:57], 0
  s_cselect_b32 s44, 4096, 0
  s_or_b32 s46, s46, s44
  v_cmp_ne_u32 s[56:57], s43, v62
  s_cmp_lg_u64 s[54:55], 0
  s_cselect_b32 s44, 8192, 0
  s_or_b32 s46, s46, s44
  v_cmp_ne_u32 s[54:55], s43, v66
  s_cmp_lg_u64 s[56:57], 0
  s_cselect_b32 s44, 16384, 0
  s_or_b32 s46, s46, s44
  s_cmp_lg_u64 s[54:55], 0
  s_cselect_b32 s44, 32768, 0
  s_or_b32 s46, s46, s44
  s_add_u32 s49, s49, 1
  s_cmp_gt_u32 s49, 40000
  s_cbranch_scc1 GO_43
  s_sleep 1
  s_branch GR_42
GO_43:
  s_mov_b64 exec, -1
  v_add_f32 v4, v4, v36
  v_add_f32 v5, v5, v37
  v_add_f32 v8, v8, v40
  v_add_f32 v9, v9, v41
  v_add_f32 v12, v12, v44
  v_add_f32 v13, v13, v45
  v_add_f32 v16, v16, v48
  v_add_f32 v17, v17, v49
  v_add_f32 v20, v20, v52
  v_add_f32 v21, v21, v53
  v_add_f32 v24, v24, v56
  v_add_f32 v25, v25, v57
  v_add_f32 v28, v28, v60
  v_add_f32 v29, v29, v61
  v_add_f32 v32, v32, v64
  v_add_f32 v33, v33, v65
  v_add_f32 v4, v4, v20
  v_add_f32 v5, v5, v21
  v_add_f32 v8, v8, v24
  v_add_f32 v9, v9, v25
  v_add_f32 v12, v12, v28
  v_add_f32 v13, v13, v29
  v_add_f32 v16, v16, v32
  v_add_f32 v17, v17, v33
  v_add_f32 v4, v4, v12
  v_add_f32 v5, v5, v13
  v_add_f32 v8, v8, v16
  v_add_f32 v9, v9, v17
  v_add_f32 v4, v4, v8
  v_add_f32 v5, v5, v9
  v_cvt_pk_bf16_f32 v84, v4, v4
  v_and_b32 v4, 0xffff0000, v84
  v_cvt_pk_bf16_f32 v85, v5, v5
  v_and_b32 v5, 0xffff0000, v85
  v_add_f32 v4, v72, v4
  v_add_f32 v5, v73, v5
  v_cvt_pk_bf16_f32 v84, v4, v4
  v_and_b32 v76, 0xffff0000, v84
  v_cvt_pk_bf16_f32 v85, v5, v5
  v_and_b32 v77, 0xffff0000, v85
  v_cndmask_b32 v76, 0, v76, s[52:53]
  v_cndmask_b32 v77, 0, v77, s[52:53]
  s_lshl_b32 s45, s42, 16
  s_lshl_b32 s46, s41, 10
  s_add_u32 s45, s45, s46
  s_add_u32 s45, s45, 0x340000
  v_lshlrev_b32 v84, 8, v78
  s_mov_b32 s49, 0
  s_mov_b64 exec, 0xffff
SP_62:
  buffer_load_dword v85, v84, s[32:35], s45 offen offset:8 sc1
  s_waitcnt vmcnt(0)
  v_cmp_eq_u32 s[54:55], s43, v85
  s_nop 1
  s_bcnt1_i32_b64 s44, s[54:55]
  s_cmp_ge_u32 s44, 1
  s_cbranch_scc1 SG_63
  s_add_u32 s49, s49, 1
  s_cmp_gt_u32 s49, 40000
  s_cbranch_scc1 SG_63
  s_sleep 8
  s_branch SP_62
SG_63:
  s_mov_b32 s49, 0
  s_mov_b64 exec, s[52:53]
  s_mov_b32 s46, 0xffff
GR_60:
  s_bitcmp0_b32 s46, 0
  s_cbranch_scc1 GS_64
  s_add_u32 s44, s45, 0
  buffer_load_dwordx3 v[4:6], v78, s[32:35], s44 offen sc1
GS_64:
  s_bitcmp0_b32 s46, 1
  s_cbranch_scc1 GS_65
  s_add_u32 s44, s45, 4096
  buffer_load_dwordx3 v[8:10], v78, s[32:35], s44 offen sc1
GS_65:
  s_bitcmp0_b32 s46, 2
  s_cbranch_scc1 GS_66
  s_add_u32 s44, s45, 8192
  buffer_load_dwordx3 v[12:14], v78, s[32:35], s44 offen sc1
GS_66:
  s_bitcmp0_b32 s46, 3
  s_cbranch_scc1 GS_67
  s_add_u32 s44, s45, 12288
  buffer_load_dwordx3 v[16:18], v78, s[32:35], s44 offen sc1
GS_67:
  s_bitcmp0_b32 s46, 4
  s_cbranch_scc1 GS_68
  s_add_u32 s44, s45, 16384
  buffer_load_dwordx3 v[20:22], v78, s[32:35], s44 offen sc1
GS_68:
  s_bitcmp0_b32 s46, 5
  s_cbranch_scc1 GS_69
  s_add_u32 s44, s45, 20480
  buffer_load_dwordx3 v[24:26], v78, s[32:35], s44 offen sc1
GS_69:
  s_bitcmp0_b32 s46, 6
  s_cbranch_scc1 GS_70
  s_add_u32 s44, s45, 24576
  buffer_load_dwordx3 v[28:30], v78, s[32:35], s44 offen sc1
GS_70:
  s_bitcmp0_b32 s46, 7
  s_cbranch_scc1 GS_71
  s_add_u32 s44, s45, 28672
  buffer_load_dwordx3 v[32:34], v78, s[32:35], s44 offen sc1
GS_71:
  s_bitcmp0_b32 s46, 8
  s_cbranch_scc1 GS_72
  s_add_u32 s44, s45, 32768
  buffer_load_dwordx3 v[36:38], v78, s[32:35], s44 offen sc1
GS_72:
  s_bitcmp0_b32 s46, 9
  s_cbranch_scc1 GS_73
  s_add_u32 s44, s45, 36864
  buffer_load_dwordx3 v[40:42], v78, s[32:35], s44 offen sc1
GS_73:
  s_bitcmp0_b32 s46, 10
  s_cbranch_scc1 GS_74
  s_add_u32 s44, s45, 40960
  buffer_load_dwordx3 v[44:46], v78, s[32:35], s44 offen sc1
GS_74:
  s_bitcmp0_b32 s46, 11
  s_cbranch_scc1 GS_75
  s_add_u32 s44, s45, 45056
  buffer_load_dwordx3 v[48:50], v78, s[32:35], s44 offen sc1
GS_75:
  s_bitcmp0_b32 s46, 12
  s_cbranch_scc1 GS_76
  s_add_u32 s44, s45, 49152
  buffer_load_dwordx3 v[52:54], v78, s[32:35], s44 offen sc1
GS_76:
  s_bitcmp0_b32 s46, 13
  s_cbranch_scc1 GS_77
  s_add_u32 s44, s45, 53248
  buffer_load_dwordx3 v[56:58], v78, s[32:35], s44 offen sc1
GS_77:
  s_bitcmp0_b32 s46, 14
  s_cbranch_scc1 GS_78
  s_add_u32 s44, s45, 57344
  buffer_load_dwordx3 v[60:62], v78, s[32:35], s44 offen sc1
GS_78:
  s_bitcmp0_b32 s46, 15
  s_cbranch_scc1 GS_79
  s_add_u32 s44, s45, 61440
  buffer_load_dwordx3 v[64:66], v78, s[32:35], s44 offen sc1
GS_79:
  s_waitcnt vmcnt(0)
  v_max3_u32 v84, v6, v10, v14
  v_max3_u32 v84, v84, v18, v22
  v_max3_u32 v84, v84, v26, v30
  v_max3_u32 v84, v84, v34, v38
  v_max3_u32 v84, v84, v42, v46
  v_max3_u32 v84, v84, v50, v54
  v_max3_u32 v84, v84, v58, v62
  v_max3_u32 v84, v84, v66, s43
  v_min3_u32 v85, v6, v10, v14
  v_min3_u32 v85, v85, v18, v22
  v_min3_u32 v85, v85, v26, v30
  v_min3_u32 v85, v85, v34, v38
  v_min3_u32 v85, v85, v42, v46
  v_min3_u32 v85, v85, v50, v54
  v_min3_u32 v85, v85, v58, v62
  v_min3_u32 v85, v85, v66, s43
  v_cmp_ne_u32 s[54:55], v84, v85
  s_nop 1
  s_cmp_eq_u64 s[54:55], 0
  s_cbranch_scc1 GO_61
  s_mov_b32 s46, 0
  v_cmp_ne_u32 s[56:57], s43, v6
  v_cmp_ne_u32 s[54:55], s43, v10
  s_nop 0
  s_cmp_lg_u64 s[56:57], 0
  s_cselect_b32 s44, 1, 0
  s_or_b32 s46, s46, s44
  v_cmp_ne_u32 s[56:57], s43, v14
  s_cmp_lg_u64 s[54:55], 0
  s_cselect_b32 s44, 2, 0
  s_or_b32 s46, s46, s44
  v_cmp_ne_u32 s[54:55], s43, v18
  s_cmp_lg_u64 s[56:57], 0
  s_cselect_b32 s44, 4, 0
  s_or_b32 s46, s46, s44
  v_cmp_ne_u32 s[56:57], s43, v22
  s_cmp_lg_u64 s[54:55], 0
  s_cselect_b32 s44, 8, 0
  s_or_b32 s46, s46, s44
  v_cmp_ne_u32 s[54:55], s43, v26
  s_cmp_lg_u64 s[56:57], 0
  s_cselect_b32 s44, 16, 0
  s_or_b32 s46, s46, s44
  v_cmp_ne_u32 s[56:57], s43, v30
  s_cmp_lg_u64 s[54:55], 0
  s_cselect_b32 s44, 32, 0
  s_or_b32 s46, s46, s44
  v_cmp_ne_u32 s[54:55], s43, v34
  s_cmp_lg_u64 s[56:57], 0
  s_cselect_b32 s44, 64, 0
  s_or_b32 s46, s46, s44
  v_cmp_ne_u32 s[56:57], s43, v38
  s_cmp_lg_u64 s[54:55], 0
  s_cselect_b32 s44, 128, 0
  s_or_b32 s46, s46, s44
  v_cmp_ne_u32 s[54:55], s43, v42
  s_cmp_lg_u64 s[56:57], 0
  s_cselect_b32 s44, 256, 0
  s_or_b32 s46, s46, s44
  v_cmp_ne_u32 s[56:57], s43, v46
  s_cmp_lg_u64 s[54:55], 0
  s_cselect_b32 s44, 512, 0
  s_or_b32 s46, s46, s44
  v_cmp_ne_u32 s[54:55], s43, v50
  s_cmp_lg_u64 s[56:57], 0
  s_cselect_b32 s44, 1024, 0
  s_or_b32 s46, s46, s44
  v_cmp_ne_u32 s[56:57], s43, v54
  s_cmp_lg_u64 s[54:55], 0
  s_cselect_b32 s44, 2048, 0
  s_or_b32 s46, s46, s44
  v_cmp_ne_u32 s[54:55], s43, v58
  s_cmp_lg_u64 s[56:57], 0
  s_cselect_b32 s44, 4096, 0
  s_or_b32 s46, s46, s44
  v_cmp_ne_u32 s[56:57], s43, v62
  s_cmp_lg_u64 s[54:55], 0
  s_cselect_b32 s44, 8192, 0
  s_or_b32 s46, s46, s44
  v_cmp_ne_u32 s[54:55], s43, v66
  s_cmp_lg_u64 s[56:57], 0
  s_cselect_b32 s44, 16384, 0
  s_or_b32 s46, s46, s44
  s_cmp_lg_u64 s[54:55], 0
  s_cselect_b32 s44, 32768, 0
  s_or_b32 s46, s46, s44
  s_add_u32 s49, s49, 1
  s_cmp_gt_u32 s49, 40000
  s_cbranch_scc1 GO_61
  s_sleep 1
  s_branch GR_60
GO_61:
  s_mov_b64 exec, -1
  v_add_f32 v4, v4, v36
  v_add_f32 v5, v5, v37
  v_add_f32 v8, v8, v40
  v_add_f32 v9, v9, v41
  v_add_f32 v12, v12, v44
  v_add_f32 v13, v13, v45
  v_add_f32 v16, v16, v48
  v_add_f32 v17, v17, v49
  v_add_f32 v20, v20, v52
  v_add_f32 v21, v21, v53
  v_add_f32 v24, v24, v56
  v_add_f32 v25, v25, v57
  v_add_f32 v28, v28, v60
  v_add_f32 v29, v29, v61
  v_add_f32 v32, v32, v64
  v_add_f32 v33, v33, v65
  v_add_f32 v4, v4, v20
  v_add_f32 v5, v5, v21
  v_add_f32 v8, v8, v24
  v_add_f32 v9, v9, v25
  v_add_f32 v12, v12, v28
  v_add_f32 v13, v13, v29
  v_add_f32 v16, v16, v32
  v_add_f32 v17, v17, v33
  v_add_f32 v4, v4, v12
  v_add_f32 v5, v5, v13
  v_add_f32 v8, v8, v16
  v_add_f32 v9, v9, v17
  v_add_f32 v4, v4, v8
  v_add_f32 v5, v5, v9
  v_cvt_pk_bf16_f32 v84, v4, v4
  v_and_b32 v4, 0xffff0000, v84
  v_cvt_pk_bf16_f32 v85, v5, v5
  v_and_b32 v5, 0xffff0000, v85
  v_add_f32 v4, v76, v4
  v_add_f32 v5, v77, v5
  v_cvt_pk_bf16_f32 v84, v4, v4
  v_and_b32 v72, 0xffff0000, v84
  v_cvt_pk_bf16_f32 v85, v5, v5
  v_and_b32 v73, 0xffff0000, v85
  v_cndmask_b32 v72, 0, v72, s[52:53]
  v_cndmask_b32 v73, 0, v73, s[52:53]
  v_add_f32 v84, v72, v73
  v_mul_f32 v85, v72, v72
  v_fmac_f32 v85, v73, v73
  v_add_f32_dpp v84, v84, v84 row_ror:1 row_mask:0xf bank_mask:0xf
  s_nop 0
  v_add_f32_dpp v85, v85, v85 row_ror:1 row_mask:0xf bank_mask:0xf
  v_add_f32_dpp v84, v84, v84 row_ror:2 row_mask:0xf bank_mask:0xf
  s_nop 0
  v_add_f32_dpp v85, v85, v85 row_ror:2 row_mask:0xf bank_mask:0xf
  v_add_f32_dpp v84, v84, v84 row_ror:4 row_mask:0xf bank_mask:0xf
  s_nop 0
  v_add_f32_dpp v85, v85, v85 row_ror:4 row_mask:0xf bank_mask:0xf
  v_add_f32_dpp v84, v84, v84 row_ror:8 row_mask:0xf bank_mask:0xf
  s_nop 0
  v_add_f32_dpp v85, v85, v85 row_ror:8 row_mask:0xf bank_mask:0xf
  v_mov_b32 v86, v84
  v_mov_b32 v87, v85
  s_nop 0
  v_permlane16_swap_b32 v84, v86
  v_permlane16_swap_b32 v85, v87
  v_add_f32 v84, v84, v86
  v_add_f32 v85, v85, v87
  v_mov_b32 v86, v84
  v_mov_b32 v87, v85
  s_nop 0
  v_permlane32_swap_b32 v84, v86
  v_permlane32_swap_b32 v85, v87
  v_add_f32 v84, v84, v86
  v_add_f32 v85, v85, v87
  s_lshl_b32 s44, s41, 3
  v_mov_b32 v86, s44
  ds_write_b64 v86, v[84:85] offset:26624
  v_mov_b32 v86, 0
  v_lshrrev_b32 v90, 1, v78
  s_lshl_b32 s44, s41, 9
  v_add_u32 v90, s44, v90
  s_waitcnt lgkmcnt(0)
  s_barrier
  ds_read_b128 v[60:63], v86 offset:26624
  ds_read_b128 v[64:67], v86 offset:26640
  s_waitcnt lgkmcnt(0)
  v_add_f32 v84, v60, v62
  v_add_f32 v85, v61, v63
  v_add_f32 v86, v64, v66
  v_add_f32 v87, v65, v67
  v_add_f32 v84, v84, v86
  v_add_f32 v85, v85, v87
  v_mul_f32 v84, 0x3b124925, v84
  v_mul_f32 v85, 0x3b124925, v85
  v_fma_f32 v85, -v84, v84, v85
  v_max_f32 v85, 0, v85
  v_cvt_pk_bf16_f32 v87, v85, v85
  v_and_b32 v85, 0xffff0000, v87
  v_cvt_pk_bf16_f32 v86, v84, v84
  v_and_b32 v84, 0xffff0000, v86
  v_add_f32 v85, 0x3727c5ac, v85
  v_sub_f32 v88, v72, v84
  v_cvt_pk_bf16_f32 v87, v85, v85
  v_and_b32 v85, 0xffff0000, v87
  v_sub_f32 v89, v73, v84
  v_sqrt_f32 v85, v85
  v_cvt_pk_bf16_f32 v86, v88, v88
  v_and_b32 v88, 0xffff0000, v86
  v_cvt_pk_bf16_f32 v87, v85, v85
  v_and_b32 v85, 0xffff0000, v87
  v_rcp_f32 v85, v85
  v_cvt_pk_bf16_f32 v87, v89, v89
  v_and_b32 v89, 0xffff0000, v87
  v_mul_f32 v88, v88, v85
  v_mul_f32 v89, v89, v85
  v_cvt_pk_bf16_f32 v88, v88, v88
  v_cvt_pk_bf16_f32 v89, v89, v89
  v_cndmask_b32 v88, 0, v88, s[52:53]
  v_cndmask_b32 v89, 0, v89, s[52:53]
  ds_write_b64 v90, v[88:89] offset:24576
  v_and_b32 v84, 0x1ff, v81
  v_lshrrev_b32 v85, 11, v81
  v_lshl_or_b32 v84, v85, 10, v84
  v_lshrrev_b32 v86, 4, v78
  v_and_b32 v91, 3, v86
  v_bfe_u32 v85, v86, 2, 2
  s_lshl_b32 s44, s41, 6
  v_bfe_u32 v86, v86, 4, 1
  v_lshlrev_b32 v87, 5, v86
  v_add_u32 v87, s44, v87
  v_lshl_add_u32 v88, v85, 3, v87
  v_add_u32 v88, v88, v91
  v_lshlrev_b32 v88, 2, v88
  v_add_u32 v88, 0x4000, v88
  v_lshl_add_u32 v89, v91, 3, v87
  v_lshl_add_u32 v89, v85, 1, v89
  v_lshlrev_b32 v89, 2, v89
  ds_read_b128 v[60:63], v80 offset:24576
  ds_read_b128 v[64:67], v80 offset:24704
  s_waitcnt lgkmcnt(0)
  v_and_b32 v52, v60, v68
  v_and_b32 v53, v60, v69
  v_and_b32 v54, v60, v70
  v_and_b32 v55, v60, v71
  v_and_b32 v56, v61, v68
  v_and_b32 v57, v61, v69
  v_and_b32 v58, v61, v70
  v_and_b32 v59, v61, v71
  v_mfma_f32_16x16x32_bf16 v[4:7], a[224:227], v[52:55], 0
  v_mfma_f32_16x16x32_bf16 v[8:11], a[228:231], v[52:55], 0
  v_mfma_f32_16x16x32_bf16 v[12:15], a[232:235], v[52:55], 0
  v_mfma_f32_16x16x32_bf16 v[16:19], a[236:239], v[52:55], 0
  v_and_b32 v52, v62, v68
  v_and_b32 v53, v62, v69
  v_and_b32 v54, v62, v70
  v_and_b32 v55, v62, v71
  v_mfma_f32_16x16x32_bf16 v[4:7], a[240:243], v[56:59], v[4:7]
  v_mfma_f32_16x16x32_bf16 v[8:11], a[244:247], v[56:59], v[8:11]
  v_mfma_f32_16x16x32_bf16 v[12:15], a[248:251], v[56:59], v[12:15]
  v_mfma_f32_16x16x32_bf16 v[16:19], a[252:255], v[56:59], v[16:19]
  v_and_b32 v56, v63, v68
  v_and_b32 v57, v63, v69
  v_and_b32 v58, v63, v70
  v_and_b32 v59, v63, v71
  v_mfma_f32_16x16x32_bf16 v[4:7], v[92:95], v[52:55], v[4:7]
  v_mfma_f32_16x16x32_bf16 v[8:11], v[96:99], v[52:55], v[8:11]
  v_mfma_f32_16x16x32_bf16 v[12:15], v[100:103], v[52:55], v[12:15]
  v_mfma_f32_16x16x32_bf16 v[16:19], v[104:107], v[52:55], v[16:19]
  v_and_b32 v52, v64, v68
  v_and_b32 v53, v64, v69
  v_and_b32 v54, v64, v70
  v_and_b32 v55, v64, v71
  v_mfma_f32_16x16x32_bf16 v[4:7], v[108:111], v[56:59], v[4:7]
  v_mfma_f32_16x16x32_bf16 v[8:11], v[112:115], v[56:59], v[8:11]
  v_mfma_f32_16x16x32_bf16 v[12:15], v[116:119], v[56:59], v[12:15]
  v_mfma_f32_16x16x32_bf16 v[16:19], v[120:123], v[56:59], v[16:19]
  v_and_b32 v56, v65, v68
  v_and_b32 v57, v65, v69
  v_and_b32 v58, v65, v70
  v_and_b32 v59, v65, v71
  v_mfma_f32_16x16x32_bf16 v[4:7], v[124:127], v[52:55], v[4:7]
  v_mfma_f32_16x16x32_bf16 v[8:11], v[128:131], v[52:55], v[8:11]
  v_mfma_f32_16x16x32_bf16 v[12:15], v[132:135], v[52:55], v[12:15]
  v_mfma_f32_16x16x32_bf16 v[16:19], v[136:139], v[52:55], v[16:19]
  v_and_b32 v52, v66, v68
  v_and_b32 v53, v66, v69
  v_and_b32 v54, v66, v70
  v_and_b32 v55, v66, v71
  v_mfma_f32_16x16x32_bf16 v[4:7], v[140:143], v[56:59], v[4:7]
  v_mfma_f32_16x16x32_bf16 v[8:11], v[144:147], v[56:59], v[8:11]
  v_mfma_f32_16x16x32_bf16 v[12:15], v[148:151], v[56:59], v[12:15]
  v_mfma_f32_16x16x32_bf16 v[16:19], v[152:155], v[56:59], v[16:19]
  v_and_b32 v56, v67, v68
  v_and_b32 v57, v67, v69
  v_and_b32 v58, v67, v70
  v_and_b32 v59, v67, v71
  v_mfma_f32_16x16x32_bf16 v[4:7], v[156:159], v[52:55], v[4:7]
  v_mfma_f32_16x16x32_bf16 v[8:11], v[160:163], v[52:55], v[8:11]
  v_mfma_f32_16x16x32_bf16 v[12:15], v[164:167], v[52:55], v[12:15]
  v_mfma_f32_16x16x32_bf16 v[16:19], v[168:171], v[52:55], v[16:19]
  v_mfma_f32_16x16x32_bf16 v[4:7], v[172:175], v[56:59], v[4:7]
  v_mfma_f32_16x16x32_bf16 v[8:11], v[176:179], v[56:59], v[8:11]
  v_mfma_f32_16x16x32_bf16 v[12:15], v[180:183], v[56:59], v[12:15]
  v_mfma_f32_16x16x32_bf16 v[16:19], v[184:187], v[56:59], v[16:19]
  ds_read_b128 v[60:63], v80 offset:24832
  ds_read_b128 v[64:67], v80 offset:24960
  s_waitcnt lgkmcnt(0)
  ds_read_b128 v[36:39], v79 offset:0
  ds_read_b128 v[40:43], v79 offset:1024
  ds_read_b128 v[44:47], v79 offset:2048
  ds_read_b128 v[48:51], v79 offset:3072
  v_and_b32 v52, v60, v68
  v_and_b32 v53, v60, v69
  v_and_b32 v54, v60, v70
  v_and_b32 v55, v60, v71
  v_and_b32 v56, v61, v68
  v_and_b32 v57, v61, v69
  v_and_b32 v58, v61, v70
  v_and_b32 v59, v61, v71
  v_mfma_f32_16x16x32_bf16 v[4:7], v[188:191], v[52:55], v[4:7]
  v_mfma_f32_16x16x32_bf16 v[8:11], v[192:195], v[52:55], v[8:11]
  v_mfma_f32_16x16x32_bf16 v[12:15], v[196:199], v[52:55], v[12:15]
  v_mfma_f32_16x16x32_bf16 v[16:19], v[200:203], v[52:55], v[16:19]
  v_and_b32 v52, v62, v68
  v_and_b32 v53, v62, v69
  v_and_b32 v54, v62, v70
  v_and_b32 v55, v62, v71
  v_mfma_f32_16x16x32_bf16 v[4:7], v[204:207], v[56:59], v[4:7]
  v_mfma_f32_16x16x32_bf16 v[8:11], v[208:211], v[56:59], v[8:11]
  v_mfma_f32_16x16x32_bf16 v[12:15], v[212:215], v[56:59], v[12:15]
  v_mfma_f32_16x16x32_bf16 v[16:19], v[216:219], v[56:59], v[16:19]
  v_and_b32 v56, v63, v68
  v_and_b32 v57, v63, v69
  v_and_b32 v58, v63, v70
  v_and_b32 v59, v63, v71
  v_mfma_f32_16x16x32_bf16 v[4:7], v[220:223], v[52:55], v[4:7]
  v_mfma_f32_16x16x32_bf16 v[8:11], v[224:227], v[52:55], v[8:11]
  v_mfma_f32_16x16x32_bf16 v[12:15], v[228:231], v[52:55], v[12:15]
  v_mfma_f32_16x16x32_bf16 v[16:19], v[232:235], v[52:55], v[16:19]
  v_and_b32 v52, v64, v68
  v_and_b32 v53, v64, v69
  v_and_b32 v54, v64, v70
  v_and_b32 v55, v64, v71
  v_mfma_f32_16x16x32_bf16 v[4:7], v[236:239], v[56:59], v[4:7]
  v_mfma_f32_16x16x32_bf16 v[8:11], v[240:243], v[56:59], v[8:11]
  v_mfma_f32_16x16x32_bf16 v[12:15], v[244:247], v[56:59], v[12:15]
  v_mfma_f32_16x16x32_bf16 v[16:19], v[248:251], v[56:59], v[16:19]
  v_and_b32 v56, v65, v68
  v_and_b32 v57, v65, v69
  v_and_b32 v58, v65, v70
  v_and_b32 v59, v65, v71
  v_mfma_f32_16x16x32_bf16 v[4:7], v[252:255], v[52:55], v[4:7]
  s_waitcnt lgkmcnt(3)
  v_mfma_f32_16x16x32_bf16 v[8:11], v[36:39], v[52:55], v[8:11]
  ds_read_b128 v[36:39], v79 offset:4096
  v_and_b32 v52, v66, v68
  v_and_b32 v53, v66, v69
  v_and_b32 v54, v66, v70
  v_and_b32 v55, v66, v71
  s_waitcnt lgkmcnt(3)
  v_mfma_f32_16x16x32_bf16 v[4:7], v[40:43], v[56:59], v[4:7]
  ds_read_b128 v[40:43], v79 offset:5120
  s_waitcnt lgkmcnt(3)
  v_mfma_f32_16x16x32_bf16 v[8:11], v[44:47], v[56:59], v[8:11]
  ds_read_b128 v[44:47], v79 offset:6144
  v_and_b32 v56, v67, v68
  v_and_b32 v57, v67, v69
  v_and_b32 v58, v67, v70
  v_and_b32 v59, v67, v71
  s_waitcnt lgkmcnt(3)
  v_mfma_f32_16x16x32_bf16 v[4:7], v[48:51], v[52:55], v[4:7]
  s_waitcnt lgkmcnt(2)
  v_mfma_f32_16x16x32_bf16 v[8:11], v[36:39], v[52:55], v[8:11]
  s_waitcnt lgkmcnt(1)
  v_mfma_f32_16x16x32_bf16 v[4:7], v[40:43], v[56:59], v[4:7]
  s_waitcnt lgkmcnt(0)
  v_mfma_f32_16x16x32_bf16 v[8:11], v[44:47], v[56:59], v[8:11]
  s_nop 5
  v_cndmask_b32 v4, v4, v12, s[50:51]
  v_cndmask_b32 v5, v5, v13, s[50:51]
  v_cndmask_b32 v6, v6, v14, s[50:51]
  v_cndmask_b32 v7, v7, v15, s[50:51]
  ds_write_b128 v84, v[4:7] offset:16384
  v_cndmask_b32 v8, v8, v16, s[50:51]
  v_cndmask_b32 v9, v9, v17, s[50:51]
  v_cndmask_b32 v10, v10, v18, s[50:51]
  v_cndmask_b32 v11, v11, v19, s[50:51]
  ds_write_b128 v84, v[8:11] offset:16896
  s_add_u32 s44, s42, 2
  s_lshl_b32 s44, s44, 4
  s_add_u32 s44, s44, s40
  s_lshl_b32 s44, s44, 10
  s_add_u32 s44, s44, 0x10000
  s_waitcnt lgkmcnt(0)
  s_barrier
  ds_read2_b32 v[4:5], v88 offset0:0 offset1:4
  v_add_u32 v90, 1024, v88
  ds_read2_b32 v[6:7], v90 offset0:0 offset1:4
  v_add_u32 v90, 2048, v88
  ds_read2_b32 v[8:9], v90 offset0:0 offset1:4
  v_add_u32 v90, 3072, v88
  ds_read2_b32 v[10:11], v90 offset0:0 offset1:4
  v_add_u32 v90, 4096, v88
  ds_read2_b32 v[12:13], v90 offset0:0 offset1:4
  v_add_u32 v90, 5120, v88
  ds_read2_b32 v[14:15], v90 offset0:0 offset1:4
  v_add_u32 v90, 6144, v88
  ds_read2_b32 v[16:17], v90 offset0:0 offset1:4
  v_add_u32 v90, 7168, v88
  ds_read2_b32 v[18:19], v90 offset0:0 offset1:4
  s_waitcnt lgkmcnt(0)
  v_add_f32 v4, v4, v12
  v_add_f32 v5, v5, v13
  v_add_f32 v6, v6, v14
  v_add_f32 v7, v7, v15
  v_add_f32 v8, v8, v16
  v_add_f32 v9, v9, v17
  v_add_f32 v10, v10, v18
  v_add_f32 v11, v11, v19
  v_add_f32 v4, v4, v8
  v_add_f32 v5, v5, v9
  v_add_f32 v6, v6, v10
  v_add_f32 v7, v7, v11
  v_add_f32 v4, v4, v6
  v_add_f32 v5, v5, v7
  v_cvt_pk_bf16_f32 v4, v4, v5
  v_mov_b32 v5, s43
  s_mov_b32 exec_hi, 0
  buffer_store_dwordx2 v[4:5], v89, s[32:35], s44 offen sc1
  s_mov_b64 exec, -1
CX_36:
  v_swap_b32 v72, v74
  v_swap_b32 v73, v75
  s_add_u32 s42, s42, 1
  s_cmp_ge_i32 s42, 4
  s_cbranch_scc1 CE_37
  s_waitcnt lgkmcnt(0)
  s_barrier
  s_cmp_gt_i32 s42, 2
  s_cbranch_scc1 CL_35
  s_cmp_eq_u32 s42, 2
  s_cbranch_scc1 MS_80
  s_waitcnt vmcnt(0)
  v_and_b32 v60, 0x70, v78
  v_lshlrev_b32 v60, 5, v60
  v_and_b32 v20, 0x80, v78
  v_lshrrev_b32 v20, 1, v20
  v_or_b32 v60, v60, v20
  v_and_b32 v20, 0x300, v78
  v_lshrrev_b32 v21, 4, v20
  v_or_b32 v60, v60, v21
  v_xor_b32 v61, 0x1040, v60
  v_lshlrev_b32 v62, 3, v20
  v_and_b32 v20, 0xf0, v78
  v_or_b32 v62, v62, v20
  v_add_u32 v66, s88, v78
  v_mov_b32 v65, 0xbdb8aa3b
  v_lshrrev_b32 v21, 2, v78
  v_xor_b32 v21, v21, v78
  v_and_b32 v21, 0x80, v21
  v_cmp_eq_u32 s[54:55], 0, v21
  v_mov_b32 v20, 0x03020100
  v_mov_b32 v63, 0x05040c0c
  v_mov_b32 v64, 0x07060c0c
  v_cndmask_b32 v63, v20, v63, s[54:55]
  v_cndmask_b32 v64, v20, v64, s[54:55]
  s_add_u32 s44, s93, 32768
  v_subrev_u32 v52, s88, v66
  s_add_u32 m0, s88, 17408
  s_nop 0
  buffer_load_dwordx4 v52, s[32:35], s44 offen sc1 lds
  s_waitcnt vmcnt(0)
  ds_read_b128 v[20:23], v66 offset:17408
  s_waitcnt lgkmcnt(0)
  s_mov_b32 s49, 0
  s_branch QC_82
QR_81:
  s_add_u32 s44, s93, 32768
  v_subrev_u32 v20, s88, v66
  buffer_load_dwordx4 v[20:23], v20, s[32:35], s44 offen sc1
  s_waitcnt vmcnt(0)
QC_82:
  v_cmp_eq_u32 s[54:55], s43, v21
  v_cmp_eq_u32 s[56:57], s43, v23
  s_nop 1
  s_and_b64 s[54:55], s[54:55], s[56:57]
  s_cmp_eq_u64 s[54:55], -1
  s_cbranch_scc1 QO_83
  s_add_u32 s49, s49, 1
  s_cmp_gt_u32 s49, 40000
  s_cbranch_scc1 QO_83
  s_sleep 8
  s_branch QR_81
QO_83:
  v_subrev_u32 v52, s88, v66
  v_lshrrev_b32 v52, 1, v52
  v_add_u32 v52, 27648, v52
  ds_write2_b32 v52, v20, v22 offset0:0 offset1:1
  s_waitcnt lgkmcnt(0)
  v_and_b32 v52, 0x70, v60
  ds_read_b128 v[4:7], v52 offset:27648
  ds_read_b128 v[8:11], v52 offset:27776
  ds_read_b128 v[12:15], v52 offset:27904
  ds_read_b128 v[16:19], v52 offset:28032
  s_waitcnt lgkmcnt(0)
  ds_read_b128 v[36:39], v66 offset:0
  ds_read_b128 v[40:43], v66 offset:4096
  ds_read_b128 v[44:47], v66 offset:1024
  ds_read_b128 v[48:51], v66 offset:5120
  s_waitcnt lgkmcnt(3)
  v_mfma_f32_16x16x32_bf16 v[20:23], v[36:39], v[4:7], 0
  ds_read_b128 v[36:39], v66 offset:2048
  s_waitcnt lgkmcnt(3)
  v_mfma_f32_16x16x32_bf16 v[24:27], v[40:43], v[4:7], 0
  ds_read_b128 v[40:43], v66 offset:6144
  s_waitcnt lgkmcnt(3)
  v_mfma_f32_16x16x32_bf16 v[20:23], v[44:47], v[8:11], v[20:23]
  ds_read_b128 v[44:47], v66 offset:3072
  s_waitcnt lgkmcnt(3)
  v_mfma_f32_16x16x32_bf16 v[24:27], v[48:51], v[8:11], v[24:27]
  ds_read_b128 v[48:51], v66 offset:7168
  s_waitcnt lgkmcnt(3)
  v_mfma_f32_16x16x32_bf16 v[20:23], v[36:39], v[12:15], v[20:23]
  s_waitcnt lgkmcnt(2)
  v_mfma_f32_16x16x32_bf16 v[24:27], v[40:43], v[12:15], v[24:27]
  s_waitcnt lgkmcnt(1)
  v_mfma_f32_16x16x32_bf16 v[20:23], v[44:47], v[16:19], v[20:23]
  s_waitcnt lgkmcnt(0)
  v_mfma_f32_16x16x32_bf16 v[24:27], v[48:51], v[16:19], v[24:27]
  s_add_u32 s86, s85, 0
  s_add_u32 m0, s88, 0x4800
  s_nop 0
  buffer_load_dwordx4 v60, s[76:79], s86 offen nt lds
  s_add_u32 m0, s88, 0x4b80
  s_nop 0
  buffer_load_dwordx4 v60, s[76:79], s86 offen offset:128 nt lds
  s_add_u32 m0, s88, 0x4f00
  s_nop 0
  buffer_load_dwordx4 v60, s[76:79], s86 offen offset:256 nt lds
  s_add_u32 m0, s88, 0x5280
  s_nop 0
  buffer_load_dwordx4 v60, s[76:79], s86 offen offset:384 nt lds
  s_add_u32 m0, s88, 0x5800
  s_nop 0
  buffer_load_dwordx4 v61, s[76:79], s86 offen nt lds
  s_add_u32 m0, s88, 0x5b80
  s_nop 0
  buffer_load_dwordx4 v61, s[76:79], s86 offen offset:128 nt lds
  s_add_u32 m0, s88, 0x5f00
  s_nop 0
  buffer_load_dwordx4 v61, s[76:79], s86 offen offset:256 nt lds
  s_add_u32 m0, s88, 0x3e80
  s_nop 0
  buffer_load_dwordx4 v61, s[76:79], s86 offen offset:384 nt lds
  s_add_u32 s87, s85, 0
  s_add_u32 m0, s88, 0x4400
  s_nop 0
  buffer_load_dwordx4 v62, s[80:83], s87 offen nt lds
  s_add_u32 m0, s88, 0xffffff00
  s_nop 0
  buffer_load_dwordx4 v62, s[80:83], s87 offen offset:256 nt lds
  s_add_u32 m0, s88, 0x200
  s_nop 0
  buffer_load_dwordx4 v62, s[80:83], s87 offen offset:512 nt lds
  s_add_u32 m0, s88, 0x500
  s_nop 0
  buffer_load_dwordx4 v62, s[80:83], s87 offen offset:768 nt lds
  s_add_u32 m0, s88, 0x800
  s_nop 0
  buffer_load_dwordx4 v62, s[80:83], s87 offen offset:1024 nt lds
  s_add_u32 m0, s88, 0xb00
  s_nop 0
  buffer_load_dwordx4 v62, s[80:83], s87 offen offset:1280 nt lds
  s_add_u32 m0, s88, 0xe00
  s_nop 0
  buffer_load_dwordx4 v62, s[80:83], s87 offen offset:1536 nt lds
  s_add_u32 m0, s88, 0x1100
  s_nop 0
  buffer_load_dwordx4 v62, s[80:83], s87 offen offset:1792 nt lds
  s_add_u32 s44, s93, 16384
  v_subrev_u32 v52, s88, v66
  s_add_u32 m0, s88, 7168
  s_nop 0
  buffer_load_dwordx4 v52, s[32:35], s44 offen sc1 lds
  v_permlane32_swap_b32 v20, v24
  v_permlane32_swap_b32 v21, v25
  v_permlane32_swap_b32 v22, v26
  v_permlane32_swap_b32 v23, v27
  v_add_f32_dpp v20, v24, v20 row_ror:8 row_mask:0xf bank_mask:0xf
  v_add_f32_dpp v21, v25, v21 row_ror:8 row_mask:0xf bank_mask:0xf
  v_add_f32_dpp v22, v26, v22 row_ror:8 row_mask:0xf bank_mask:0xf
  v_add_f32_dpp v23, v27, v23 row_ror:8 row_mask:0xf bank_mask:0xf
  v_cvt_pk_bf16_f32 v24, v20, v21
  v_cvt_pk_bf16_f32 v25, v22, v23
  v_perm_b32 v20, v24, s90, v63
  v_perm_b32 v21, v24, s90, v64
  v_perm_b32 v22, v25, s90, v63
  v_perm_b32 v23, v25, s90, v64
  v_max3_f32 v26, v20, v21, v22
  v_max_f32 v26, v26, v23
  s_nop 1
  v_max_f32_dpp v26, v26, v26 row_ror:8 row_mask:0xf bank_mask:0xf
  s_nop 1
  v_max_f32_dpp v26, v26, v26 row_bcast:15 row_mask:0xa bank_mask:0xf
  s_nop 1
  v_max_f32_dpp v26, v26, v26 row_bcast:31 row_mask:0xc bank_mask:0xf
  s_nop 0
  v_readlane_b32 s91, v26, 63
  s_nop 1
  v_mul_f32 v84, s91, v65
  v_fma_f32 v20, v20, s89, v84
  v_fma_f32 v21, v21, s89, v84
  v_fma_f32 v22, v22, s89, v84
  v_fma_f32 v23, v23, s89, v84
  v_exp_f32 v20, v20
  v_exp_f32 v21, v21
  v_exp_f32 v22, v22
  v_exp_f32 v23, v23
  v_add_f32 v26, v20, v21
  v_add_f32 v24, v22, v23
  v_cvt_pk_bf16_f32 v20, v20, v20
  v_cvt_pk_bf16_f32 v21, v21, v21
  v_cvt_pk_bf16_f32 v22, v22, v22
  v_cvt_pk_bf16_f32 v23, v23, v23
  v_add_f32 v67, v26, v24
  v_and_b32 v52, v20, v68
  v_and_b32 v53, v20, v69
  v_and_b32 v54, v20, v70
  v_and_b32 v55, v20, v71
  v_and_b32 v56, v21, v68
  v_and_b32 v57, v21, v69
  v_and_b32 v58, v21, v70
  v_and_b32 v59, v21, v71
  ds_read_b128 v[36:39], v66 offset:8192
  ds_read_b128 v[40:43], v66 offset:9216
  ds_read_b128 v[44:47], v66 offset:10240
  ds_read_b128 v[48:51], v66 offset:11264
  s_waitcnt lgkmcnt(3)
  v_mfma_f32_16x16x32_bf16 v[28:31], v[36:39], v[52:55], 0
  ds_read_b128 v[36:39], v66 offset:12288
  s_waitcnt lgkmcnt(3)
  v_mfma_f32_16x16x32_bf16 v[32:35], v[40:43], v[52:55], 0
  ds_read_b128 v[40:43], v66 offset:13312
  v_and_b32 v52, v22, v68
  v_and_b32 v53, v22, v69
  v_and_b32 v54, v22, v70
  v_and_b32 v55, v22, v71
  s_waitcnt lgkmcnt(3)
  v_mfma_f32_16x16x32_bf16 v[28:31], v[44:47], v[56:59], v[28:31]
  ds_read_b128 v[44:47], v66 offset:14336
  s_waitcnt lgkmcnt(3)
  v_mfma_f32_16x16x32_bf16 v[32:35], v[48:51], v[56:59], v[32:35]
  ds_read_b128 v[48:51], v66 offset:15360
  v_and_b32 v56, v23, v68
  v_and_b32 v57, v23, v69
  v_and_b32 v58, v23, v70
  v_and_b32 v59, v23, v71
  s_waitcnt lgkmcnt(3)
  v_mfma_f32_16x16x32_bf16 v[28:31], v[36:39], v[52:55], v[28:31]
  s_waitcnt lgkmcnt(2)
  v_mfma_f32_16x16x32_bf16 v[32:35], v[40:43], v[52:55], v[32:35]
  s_waitcnt lgkmcnt(1)
  v_mfma_f32_16x16x32_bf16 v[28:31], v[44:47], v[56:59], v[28:31]
  s_waitcnt lgkmcnt(0)
  v_mfma_f32_16x16x32_bf16 v[32:35], v[48:51], v[56:59], v[32:35]
  v_subrev_u32 v27, s88, v66
  s_nop 6
  v_cndmask_b32 v52, v28, v32, s[50:51]
  v_cndmask_b32 v56, v32, v28, s[50:51]
  v_cndmask_b32 v53, v29, v33, s[50:51]
  v_cndmask_b32 v57, v33, v29, s[50:51]
  v_cndmask_b32 v54, v30, v34, s[50:51]
  v_cndmask_b32 v58, v34, v30, s[50:51]
  v_cndmask_b32 v55, v31, v35, s[50:51]
  v_cndmask_b32 v59, v35, v31, s[50:51]
  v_add_f32_dpp v67, v67, v67 row_ror:8 row_mask:0xf bank_mask:0xf
  v_add_f32_dpp v52, v56, v52 row_ror:8 row_mask:0xf bank_mask:0xf
  v_add_f32_dpp v53, v57, v53 row_ror:8 row_mask:0xf bank_mask:0xf
  v_add_f32_dpp v54, v58, v54 row_ror:8 row_mask:0xf bank_mask:0xf
  v_add_f32_dpp v55, v59, v55 row_ror:8 row_mask:0xf bank_mask:0xf
  v_mov_b32 v24, v67
  s_nop 1
  v_permlane16_swap_b32 v67, v24
  v_add_f32 v67, v67, v24
  v_mov_b32 v24, v67
  s_nop 1
  v_permlane32_swap_b32 v67, v24
  v_add_f32 v25, v67, v24
  v_sub_f32 v24, 0, v84
  s_lshl_b32 s44, s41, 10
  v_add_u32 v56, s44, v27
  ds_write_b128 v56, v[52:55] offset:0
  s_lshl_b32 s44, s41, 3
  v_mov_b32 v57, s44
  ds_write_b64 v57, v[24:25] offset:28672
  v_mov_b32 v58, 28744
  v_mov_b32 v59, 1
  s_waitcnt lgkmcnt(0)
  s_mov_b64 exec, 1
  ds_add_rtn_u32 v57, v58, v59
  s_waitcnt lgkmcnt(0)
  v_readfirstlane_b32 s44, v57
  s_mov_b64 exec, -1
  s_nop 0
  s_cmp_eq_u32 s44, 3
  s_cbranch_scc0 PS_84
  ds_read_b128 v[36:39], v27 offset:0
  ds_read_b128 v[40:43], v27 offset:1024
  ds_read_b128 v[44:47], v27 offset:2048
  ds_read_b128 v[48:51], v27 offset:3072
  v_mov_b32 v56, 0
  ds_read_b128 v[20:23], v56 offset:28672
  ds_read_b128 v[52:55], v56 offset:28688
  v_and_b32 v56, 0x70, v27
  v_lshlrev_b32 v56, 1, v56
  v_and_b32 v57, 0x80, v27
  v_lshl_or_b32 v56, v57, 3, v56
  v_and_b32 v57, 0x300, v27
  v_or_b32 v56, v56, v57
  s_add_u32 s44, s94, 1048576
  s_waitcnt lgkmcnt(0)
  s_mov_b64 exec, 1
  ds_add_u32 v58, v59
  s_mov_b64 exec, -1
  v_max3_f32 v25, v20, v22, v52
  v_max_f32 v25, v25, v54
  v_sub_f32 v20, v20, v25
  v_sub_f32 v22, v22, v25
  v_sub_f32 v52, v52, v25
  v_sub_f32 v54, v54, v25
  v_exp_f32 v20, v20
  v_exp_f32 v22, v22
  v_exp_f32 v52, v52
  v_exp_f32 v54, v54
  v_mov_b32 v27, s43
  v_mul_f32 v26, v20, v21
  v_fmac_f32 v26, v22, v23
  v_fmac_f32 v26, v52, v53
  v_fmac_f32 v26, v54, v55
  v_mul_f32 v36, v20, v36
  v_mul_f32 v37, v20, v37
  v_mul_f32 v38, v20, v38
  v_mul_f32 v39, v20, v39
  v_fmac_f32 v36, v22, v40
  v_fmac_f32 v37, v22, v41
  v_fmac_f32 v38, v22, v42
  v_fmac_f32 v39, v22, v43
  v_fmac_f32 v36, v52, v44
  v_fmac_f32 v37, v52, v45
  v_fmac_f32 v38, v52, v46
  v_fmac_f32 v39, v52, v47
  v_fmac_f32 v36, v54, v48
  v_fmac_f32 v37, v54, v49
  v_fmac_f32 v38, v54, v50
  v_fmac_f32 v39, v54, v51
  v_mov_b32 v24, v39
  v_mov_b32 v39, s43
  buffer_store_dwordx4 v[36:39], v56, s[32:35], s44 offen sc1
  buffer_store_dwordx4 v[24:27], v56, s[32:35], s44 offen offset:16 sc1
  s_waitcnt lgkmcnt(0)
PS_84:
  s_nop 1
  s_waitcnt vmcnt(0) lgkmcnt(0)
  s_barrier
  ds_read_b128 v[20:23], v66 offset:7168
  s_waitcnt lgkmcnt(0)
  s_mov_b32 s49, 0
  s_branch QC_86
QR_85:
  s_add_u32 s44, s93, 16384
  v_subrev_u32 v20, s88, v66
  buffer_load_dwordx4 v[20:23], v20, s[32:35], s44 offen sc1
  s_waitcnt vmcnt(0)
QC_86:
  v_cmp_eq_u32 s[54:55], s43, v21
  v_cmp_eq_u32 s[56:57], s43, v23
  s_nop 1
  s_and_b64 s[54:55], s[54:55], s[56:57]
  s_cmp_eq_u64 s[54:55], -1
  s_cbranch_scc1 QO_87
  s_add_u32 s49, s49, 1
  s_cmp_gt_u32 s49, 40000
  s_cbranch_scc1 QO_87
  s_sleep 8
  s_branch QR_85
QO_87:
  v_subrev_u32 v52, s88, v66
  v_lshrrev_b32 v52, 1, v52
  v_add_u32 v52, 27648, v52
  ds_write2_b32 v52, v20, v22 offset0:128 offset1:129
  s_waitcnt lgkmcnt(0)
  v_and_b32 v52, 0x70, v60
  ds_read_b128 v[4:7], v52 offset:28160
  ds_read_b128 v[8:11], v52 offset:28288
  ds_read_b128 v[12:15], v52 offset:28416
  ds_read_b128 v[16:19], v52 offset:28544
  s_waitcnt lgkmcnt(0)
  ds_read_b128 v[36:39], v66 offset:18432
  ds_read_b128 v[40:43], v66 offset:22528
  ds_read_b128 v[44:47], v66 offset:19456
  ds_read_b128 v[48:51], v66 offset:23552
  s_waitcnt lgkmcnt(3)
  v_mfma_f32_16x16x32_bf16 v[20:23], v[36:39], v[4:7], 0
  ds_read_b128 v[36:39], v66 offset:20480
  s_waitcnt lgkmcnt(3)
  v_mfma_f32_16x16x32_bf16 v[24:27], v[40:43], v[4:7], 0
  ds_read_b128 v[40:43], v66 offset:24576
  s_waitcnt lgkmcnt(3)
  v_mfma_f32_16x16x32_bf16 v[20:23], v[44:47], v[8:11], v[20:23]
  ds_read_b128 v[44:47], v66 offset:21504
  s_waitcnt lgkmcnt(3)
  v_mfma_f32_16x16x32_bf16 v[24:27], v[48:51], v[8:11], v[24:27]
  ds_read_b128 v[48:51], v66 offset:16384
  s_waitcnt lgkmcnt(3)
  v_mfma_f32_16x16x32_bf16 v[20:23], v[36:39], v[12:15], v[20:23]
  s_waitcnt lgkmcnt(2)
  v_mfma_f32_16x16x32_bf16 v[24:27], v[40:43], v[12:15], v[24:27]
  s_waitcnt lgkmcnt(1)
  v_mfma_f32_16x16x32_bf16 v[20:23], v[44:47], v[16:19], v[20:23]
  s_waitcnt lgkmcnt(0)
  v_mfma_f32_16x16x32_bf16 v[24:27], v[48:51], v[16:19], v[24:27]
  s_nop 7
  v_permlane32_swap_b32 v20, v24
  v_permlane32_swap_b32 v21, v25
  v_permlane32_swap_b32 v22, v26
  v_permlane32_swap_b32 v23, v27
  v_add_f32_dpp v20, v24, v20 row_ror:8 row_mask:0xf bank_mask:0xf
  v_add_f32_dpp v21, v25, v21 row_ror:8 row_mask:0xf bank_mask:0xf
  v_add_f32_dpp v22, v26, v22 row_ror:8 row_mask:0xf bank_mask:0xf
  v_add_f32_dpp v23, v27, v23 row_ror:8 row_mask:0xf bank_mask:0xf
  v_cvt_pk_bf16_f32 v24, v20, v21
  v_cvt_pk_bf16_f32 v25, v22, v23
  v_perm_b32 v20, v24, s90, v63
  v_perm_b32 v21, v24, s90, v64
  v_perm_b32 v22, v25, s90, v63
  v_perm_b32 v23, v25, s90, v64
  v_max3_f32 v26, v20, v21, v22
  v_max_f32 v26, v26, v23
  s_nop 1
  v_max_f32_dpp v26, v26, v26 row_ror:8 row_mask:0xf bank_mask:0xf
  s_nop 1
  v_max_f32_dpp v26, v26, v26 row_bcast:15 row_mask:0xa bank_mask:0xf
  s_nop 1
  v_max_f32_dpp v26, v26, v26 row_bcast:31 row_mask:0xc bank_mask:0xf
  s_nop 0
  v_readlane_b32 s92, v26, 63
  s_nop 1
  v_mul_f32 v86, s92, v65
  v_fma_f32 v20, v20, s89, v86
  v_fma_f32 v21, v21, s89, v86
  v_fma_f32 v22, v22, s89, v86
  v_fma_f32 v23, v23, s89, v86
  v_exp_f32 v20, v20
  v_exp_f32 v21, v21
  v_exp_f32 v22, v22
  v_exp_f32 v23, v23
  v_add_f32 v26, v20, v21
  v_add_f32 v24, v22, v23
  v_cvt_pk_bf16_f32 v20, v20, v20
  v_cvt_pk_bf16_f32 v21, v21, v21
  v_cvt_pk_bf16_f32 v22, v22, v22
  v_cvt_pk_bf16_f32 v23, v23, v23
  v_add_f32 v67, v26, v24
  v_and_b32 v52, v20, v68
  v_and_b32 v53, v20, v69
  v_and_b32 v54, v20, v70
  v_and_b32 v55, v20, v71
  v_and_b32 v56, v21, v68
  v_and_b32 v57, v21, v69
  v_and_b32 v58, v21, v70
  v_and_b32 v59, v21, v71
  ds_read_b128 v[36:39], v66 offset:17408
  ds_read_b128 v[40:43], v66 offset:0
  ds_read_b128 v[44:47], v66 offset:1024
  ds_read_b128 v[48:51], v66 offset:2048
  s_waitcnt lgkmcnt(3)
  v_mfma_f32_16x16x32_bf16 v[28:31], v[36:39], v[52:55], 0
  ds_read_b128 v[36:39], v66 offset:3072
  s_waitcnt lgkmcnt(3)
  v_mfma_f32_16x16x32_bf16 v[32:35], v[40:43], v[52:55], 0
  ds_read_b128 v[40:43], v66 offset:4096
  v_and_b32 v52, v22, v68
  v_and_b32 v53, v22, v69
  v_and_b32 v54, v22, v70
  v_and_b32 v55, v22, v71
  s_waitcnt lgkmcnt(3)
  v_mfma_f32_16x16x32_bf16 v[28:31], v[44:47], v[56:59], v[28:31]
  ds_read_b128 v[44:47], v66 offset:5120
  s_waitcnt lgkmcnt(3)
  v_mfma_f32_16x16x32_bf16 v[32:35], v[48:51], v[56:59], v[32:35]
  ds_read_b128 v[48:51], v66 offset:6144
  v_and_b32 v56, v23, v68
  v_and_b32 v57, v23, v69
  v_and_b32 v58, v23, v70
  v_and_b32 v59, v23, v71
  s_waitcnt lgkmcnt(3)
  v_mfma_f32_16x16x32_bf16 v[28:31], v[36:39], v[52:55], v[28:31]
  s_waitcnt lgkmcnt(2)
  v_mfma_f32_16x16x32_bf16 v[32:35], v[40:43], v[52:55], v[32:35]
  s_waitcnt lgkmcnt(1)
  v_mfma_f32_16x16x32_bf16 v[28:31], v[44:47], v[56:59], v[28:31]
  s_waitcnt lgkmcnt(0)
  v_mfma_f32_16x16x32_bf16 v[32:35], v[48:51], v[56:59], v[32:35]
  v_subrev_u32 v27, s88, v66
  s_nop 6
  v_cndmask_b32 v52, v28, v32, s[50:51]
  v_cndmask_b32 v56, v32, v28, s[50:51]
  v_cndmask_b32 v53, v29, v33, s[50:51]
  v_cndmask_b32 v57, v33, v29, s[50:51]
  v_cndmask_b32 v54, v30, v34, s[50:51]
  v_cndmask_b32 v58, v34, v30, s[50:51]
  v_cndmask_b32 v55, v31, v35, s[50:51]
  v_cndmask_b32 v59, v35, v31, s[50:51]
  v_add_f32_dpp v67, v67, v67 row_ror:8 row_mask:0xf bank_mask:0xf
  v_add_f32_dpp v52, v56, v52 row_ror:8 row_mask:0xf bank_mask:0xf
  v_add_f32_dpp v53, v57, v53 row_ror:8 row_mask:0xf bank_mask:0xf
  v_add_f32_dpp v54, v58, v54 row_ror:8 row_mask:0xf bank_mask:0xf
  v_add_f32_dpp v55, v59, v55 row_ror:8 row_mask:0xf bank_mask:0xf
  v_mov_b32 v24, v67
  s_nop 1
  v_permlane16_swap_b32 v67, v24
  v_add_f32 v67, v67, v24
  v_mov_b32 v24, v67
  s_nop 1
  v_permlane32_swap_b32 v67, v24
  v_add_f32 v25, v67, v24
  v_sub_f32 v24, 0, v86
  s_lshl_b32 s44, s41, 10
  v_add_u32 v56, s44, v27
  ds_write_b128 v56, v[52:55] offset:0
  s_lshl_b32 s44, s41, 3
  v_mov_b32 v57, s44
  ds_write_b64 v57, v[24:25] offset:28672
  v_mov_b32 v58, 28740
  v_mov_b32 v59, 1
  s_waitcnt lgkmcnt(0)
  s_mov_b64 exec, 1
  ds_add_rtn_u32 v57, v58, v59
  s_waitcnt lgkmcnt(0)
  v_readfirstlane_b32 s44, v57
  s_mov_b64 exec, -1
  s_nop 0
  s_cmp_eq_u32 s44, 3
  s_cbranch_scc0 PS_88
  ds_read_b128 v[36:39], v27 offset:0
  ds_read_b128 v[40:43], v27 offset:1024
  ds_read_b128 v[44:47], v27 offset:2048
  ds_read_b128 v[48:51], v27 offset:3072
  v_mov_b32 v56, 0
  ds_read_b128 v[20:23], v56 offset:28672
  ds_read_b128 v[52:55], v56 offset:28688
  v_and_b32 v56, 0x70, v27
  v_lshlrev_b32 v56, 1, v56
  v_and_b32 v57, 0x80, v27
  v_lshl_or_b32 v56, v57, 3, v56
  v_and_b32 v57, 0x300, v27
  v_or_b32 v56, v56, v57
  s_add_u32 s44, s94, 524288
  s_waitcnt lgkmcnt(0)
  s_mov_b64 exec, 1
  ds_add_u32 v58, v59
  s_mov_b64 exec, -1
  v_max3_f32 v25, v20, v22, v52
  v_max_f32 v25, v25, v54
  v_sub_f32 v20, v20, v25
  v_sub_f32 v22, v22, v25
  v_sub_f32 v52, v52, v25
  v_sub_f32 v54, v54, v25
  v_exp_f32 v20, v20
  v_exp_f32 v22, v22
  v_exp_f32 v52, v52
  v_exp_f32 v54, v54
  v_mov_b32 v27, s43
  v_mul_f32 v26, v20, v21
  v_fmac_f32 v26, v22, v23
  v_fmac_f32 v26, v52, v53
  v_fmac_f32 v26, v54, v55
  v_mul_f32 v36, v20, v36
  v_mul_f32 v37, v20, v37
  v_mul_f32 v38, v20, v38
  v_mul_f32 v39, v20, v39
  v_fmac_f32 v36, v22, v40
  v_fmac_f32 v37, v22, v41
  v_fmac_f32 v38, v22, v42
  v_fmac_f32 v39, v22, v43
  v_fmac_f32 v36, v52, v44
  v_fmac_f32 v37, v52, v45
  v_fmac_f32 v38, v52, v46
  v_fmac_f32 v39, v52, v47
  v_fmac_f32 v36, v54, v48
  v_fmac_f32 v37, v54, v49
  v_fmac_f32 v38, v54, v50
  v_fmac_f32 v39, v54, v51
  v_mov_b32 v24, v39
  v_mov_b32 v39, s43
  buffer_store_dwordx4 v[36:39], v56, s[32:35], s44 offen sc1
  buffer_store_dwordx4 v[24:27], v56, s[32:35], s44 offen offset:16 sc1
  s_waitcnt lgkmcnt(0)
PS_88:
  s_nop 1
  s_waitcnt vmcnt(0) lgkmcnt(0)
  s_barrier
  s_branch CL_35
MS_80:
  s_waitcnt vmcnt(0)
  v_and_b32 v60, 0x70, v78
  v_lshlrev_b32 v60, 5, v60
  v_and_b32 v20, 0x80, v78
  v_lshrrev_b32 v20, 1, v20
  v_or_b32 v60, v60, v20
  v_and_b32 v20, 0x300, v78
  v_lshrrev_b32 v21, 4, v20
  v_or_b32 v60, v60, v21
  v_xor_b32 v61, 0x1040, v60
  v_lshlrev_b32 v62, 3, v20
  v_and_b32 v20, 0xf0, v78
  v_or_b32 v62, v62, v20
  v_add_u32 v66, s88, v78
  v_mov_b32 v65, 0xbdb8aa3b
  v_lshrrev_b32 v21, 2, v78
  v_xor_b32 v21, v21, v78
  v_and_b32 v21, 0x80, v21
  v_cmp_eq_u32 s[54:55], 0, v21
  v_mov_b32 v20, 0x03020100
  v_mov_b32 v63, 0x05040c0c
  v_mov_b32 v64, 0x07060c0c
  v_cndmask_b32 v63, v20, v63, s[54:55]
  v_cndmask_b32 v64, v20, v64, s[54:55]
  s_add_u32 s44, s93, 49152
  v_subrev_u32 v52, s88, v66
  s_add_u32 m0, s88, 8192
  s_nop 0
  buffer_load_dwordx4 v52, s[32:35], s44 offen sc1 lds
  s_waitcnt vmcnt(0)
  ds_read_b128 v[20:23], v66 offset:8192
  s_waitcnt lgkmcnt(0)
  s_mov_b32 s49, 0
  s_branch QC_90
QR_89:
  s_add_u32 s44, s93, 49152
  v_subrev_u32 v20, s88, v66
  buffer_load_dwordx4 v[20:23], v20, s[32:35], s44 offen sc1
  s_waitcnt vmcnt(0)
QC_90:
  v_cmp_eq_u32 s[54:55], s43, v21
  v_cmp_eq_u32 s[56:57], s43, v23
  s_nop 1
  s_and_b64 s[54:55], s[54:55], s[56:57]
  s_cmp_eq_u64 s[54:55], -1
  s_cbranch_scc1 QO_91
  s_add_u32 s49, s49, 1
  s_cmp_gt_u32 s49, 40000
  s_cbranch_scc1 QO_91
  s_sleep 8
  s_branch QR_89
QO_91:
  v_subrev_u32 v52, s88, v66
  v_lshrrev_b32 v52, 1, v52
  v_add_u32 v52, 27648, v52
  ds_write2_b32 v52, v20, v22 offset0:128 offset1:129
  s_waitcnt lgkmcnt(0)
  v_and_b32 v52, 0x70, v60
  ds_read_b128 v[4:7], v52 offset:28160
  ds_read_b128 v[8:11], v52 offset:28288
  ds_read_b128 v[12:15], v52 offset:28416
  ds_read_b128 v[16:19], v52 offset:28544
  s_waitcnt lgkmcnt(0)
  ds_read_b128 v[36:39], v66 offset:18432
  ds_read_b128 v[40:43], v66 offset:22528
  ds_read_b128 v[44:47], v66 offset:19456
  ds_read_b128 v[48:51], v66 offset:23552
  s_waitcnt lgkmcnt(3)
  v_mfma_f32_16x16x32_bf16 v[20:23], v[36:39], v[4:7], 0
  ds_read_b128 v[36:39], v66 offset:20480
  s_waitcnt lgkmcnt(3)
  v_mfma_f32_16x16x32_bf16 v[24:27], v[40:43], v[4:7], 0
  ds_read_b128 v[40:43], v66 offset:24576
  s_waitcnt lgkmcnt(3)
  v_mfma_f32_16x16x32_bf16 v[20:23], v[44:47], v[8:11], v[20:23]
  ds_read_b128 v[44:47], v66 offset:21504
  s_waitcnt lgkmcnt(3)
  v_mfma_f32_16x16x32_bf16 v[24:27], v[48:51], v[8:11], v[24:27]
  ds_read_b128 v[48:51], v66 offset:16384
  s_waitcnt lgkmcnt(3)
  v_mfma_f32_16x16x32_bf16 v[20:23], v[36:39], v[12:15], v[20:23]
  s_waitcnt lgkmcnt(2)
  v_mfma_f32_16x16x32_bf16 v[24:27], v[40:43], v[12:15], v[24:27]
  s_waitcnt lgkmcnt(1)
  v_mfma_f32_16x16x32_bf16 v[20:23], v[44:47], v[16:19], v[20:23]
  s_waitcnt lgkmcnt(0)
  v_mfma_f32_16x16x32_bf16 v[24:27], v[48:51], v[16:19], v[24:27]
  s_nop 7
  v_permlane32_swap_b32 v20, v24
  v_permlane32_swap_b32 v21, v25
  v_permlane32_swap_b32 v22, v26
  v_permlane32_swap_b32 v23, v27
  v_add_f32_dpp v20, v24, v20 row_ror:8 row_mask:0xf bank_mask:0xf
  v_add_f32_dpp v21, v25, v21 row_ror:8 row_mask:0xf bank_mask:0xf
  v_add_f32_dpp v22, v26, v22 row_ror:8 row_mask:0xf bank_mask:0xf
  v_add_f32_dpp v23, v27, v23 row_ror:8 row_mask:0xf bank_mask:0xf
  v_cvt_pk_bf16_f32 v24, v20, v21
  v_cvt_pk_bf16_f32 v25, v22, v23
  v_perm_b32 v20, v24, s90, v63
  v_perm_b32 v21, v24, s90, v64
  v_perm_b32 v22, v25, s90, v63
  v_perm_b32 v23, v25, s90, v64
  v_max3_f32 v26, v20, v21, v22
  v_max_f32 v26, v26, v23
  s_nop 1
  v_max_f32_dpp v26, v26, v26 row_ror:8 row_mask:0xf bank_mask:0xf
  s_nop 1
  v_max_f32_dpp v26, v26, v26 row_bcast:15 row_mask:0xa bank_mask:0xf
  s_nop 1
  v_max_f32_dpp v26, v26, v26 row_bcast:31 row_mask:0xc bank_mask:0xf
  s_nop 0
  v_readlane_b32 s92, v26, 63
  s_nop 1
  v_mul_f32 v85, s92, v65
  v_fma_f32 v20, v20, s89, v85
  v_fma_f32 v21, v21, s89, v85
  v_fma_f32 v22, v22, s89, v85
  v_fma_f32 v23, v23, s89, v85
  v_exp_f32 v20, v20
  v_exp_f32 v21, v21
  v_exp_f32 v22, v22
  v_exp_f32 v23, v23
  v_add_f32 v26, v20, v21
  v_add_f32 v24, v22, v23
  v_cvt_pk_bf16_f32 v20, v20, v20
  v_cvt_pk_bf16_f32 v21, v21, v21
  v_cvt_pk_bf16_f32 v22, v22, v22
  v_cvt_pk_bf16_f32 v23, v23, v23
  v_add_f32 v67, v26, v24
  v_and_b32 v52, v20, v68
  v_and_b32 v53, v20, v69
  v_and_b32 v54, v20, v70
  v_and_b32 v55, v20, v71
  v_and_b32 v56, v21, v68
  v_and_b32 v57, v21, v69
  v_and_b32 v58, v21, v70
  v_and_b32 v59, v21, v71
  ds_read_b128 v[36:39], v66 offset:17408
  ds_read_b128 v[40:43], v66 offset:0
  ds_read_b128 v[44:47], v66 offset:1024
  ds_read_b128 v[48:51], v66 offset:2048
  s_waitcnt lgkmcnt(3)
  v_mfma_f32_16x16x32_bf16 v[28:31], v[36:39], v[52:55], 0
  ds_read_b128 v[36:39], v66 offset:3072
  s_waitcnt lgkmcnt(3)
  v_mfma_f32_16x16x32_bf16 v[32:35], v[40:43], v[52:55], 0
  ds_read_b128 v[40:43], v66 offset:4096
  v_and_b32 v52, v22, v68
  v_and_b32 v53, v22, v69
  v_and_b32 v54, v22, v70
  v_and_b32 v55, v22, v71
  s_waitcnt lgkmcnt(3)
  v_mfma_f32_16x16x32_bf16 v[28:31], v[44:47], v[56:59], v[28:31]
  ds_read_b128 v[44:47], v66 offset:5120
  s_waitcnt lgkmcnt(3)
  v_mfma_f32_16x16x32_bf16 v[32:35], v[48:51], v[56:59], v[32:35]
  ds_read_b128 v[48:51], v66 offset:6144
  v_and_b32 v56, v23, v68
  v_and_b32 v57, v23, v69
  v_and_b32 v58, v23, v70
  v_and_b32 v59, v23, v71
  s_waitcnt lgkmcnt(3)
  v_mfma_f32_16x16x32_bf16 v[28:31], v[36:39], v[52:55], v[28:31]
  s_waitcnt lgkmcnt(2)
  v_mfma_f32_16x16x32_bf16 v[32:35], v[40:43], v[52:55], v[32:35]
  s_waitcnt lgkmcnt(1)
  v_mfma_f32_16x16x32_bf16 v[28:31], v[44:47], v[56:59], v[28:31]
  s_waitcnt lgkmcnt(0)
  v_mfma_f32_16x16x32_bf16 v[32:35], v[48:51], v[56:59], v[32:35]
  v_subrev_u32 v27, s88, v66
  s_nop 6
  v_cndmask_b32 v52, v28, v32, s[50:51]
  v_cndmask_b32 v56, v32, v28, s[50:51]
  v_cndmask_b32 v53, v29, v33, s[50:51]
  v_cndmask_b32 v57, v33, v29, s[50:51]
  v_cndmask_b32 v54, v30, v34, s[50:51]
  v_cndmask_b32 v58, v34, v30, s[50:51]
  v_cndmask_b32 v55, v31, v35, s[50:51]
  v_cndmask_b32 v59, v35, v31, s[50:51]
  v_add_f32_dpp v67, v67, v67 row_ror:8 row_mask:0xf bank_mask:0xf
  v_add_f32_dpp v52, v56, v52 row_ror:8 row_mask:0xf bank_mask:0xf
  v_add_f32_dpp v53, v57, v53 row_ror:8 row_mask:0xf bank_mask:0xf
  v_add_f32_dpp v54, v58, v54 row_ror:8 row_mask:0xf bank_mask:0xf
  v_add_f32_dpp v55, v59, v55 row_ror:8 row_mask:0xf bank_mask:0xf
  v_mov_b32 v24, v67
  s_nop 1
  v_permlane16_swap_b32 v67, v24
  v_add_f32 v67, v67, v24
  v_mov_b32 v24, v67
  s_nop 1
  v_permlane32_swap_b32 v67, v24
  v_add_f32 v25, v67, v24
  v_sub_f32 v24, 0, v85
  s_lshl_b32 s44, s41, 10
  v_add_u32 v56, s44, v27
  ds_write_b128 v56, v[52:55] offset:0
  s_lshl_b32 s44, s41, 3
  v_mov_b32 v57, s44
  ds_write_b64 v57, v[24:25] offset:28672
  v_mov_b32 v58, 28748
  v_mov_b32 v59, 1
  s_waitcnt lgkmcnt(0)
  s_mov_b64 exec, 1
  ds_add_rtn_u32 v57, v58, v59
  s_waitcnt lgkmcnt(0)
  v_readfirstlane_b32 s44, v57
  s_mov_b64 exec, -1
  s_nop 0
  s_cmp_eq_u32 s44, 3
  s_cbranch_scc0 PS_92
  ds_read_b128 v[36:39], v27 offset:0
  ds_read_b128 v[40:43], v27 offset:1024
  ds_read_b128 v[44:47], v27 offset:2048
  ds_read_b128 v[48:51], v27 offset:3072
  v_mov_b32 v56, 0
  ds_read_b128 v[20:23], v56 offset:28672
  ds_read_b128 v[52:55], v56 offset:28688
  v_and_b32 v56, 0x70, v27
  v_lshlrev_b32 v56, 1, v56
  v_and_b32 v57, 0x80, v27
  v_lshl_or_b32 v56, v57, 3, v56
  v_and_b32 v57, 0x300, v27
  v_or_b32 v56, v56, v57
  s_add_u32 s44, s94, 1572864
  s_waitcnt lgkmcnt(0)
  s_mov_b64 exec, 1
  ds_add_u32 v58, v59
  s_mov_b64 exec, -1
  v_max3_f32 v25, v20, v22, v52
  v_max_f32 v25, v25, v54
  v_sub_f32 v20, v20, v25
  v_sub_f32 v22, v22, v25
  v_sub_f32 v52, v52, v25
  v_sub_f32 v54, v54, v25
  v_exp_f32 v20, v20
  v_exp_f32 v22, v22
  v_exp_f32 v52, v52
  v_exp_f32 v54, v54
  v_mov_b32 v27, s43
  v_mul_f32 v26, v20, v21
  v_fmac_f32 v26, v22, v23
  v_fmac_f32 v26, v52, v53
  v_fmac_f32 v26, v54, v55
  v_mul_f32 v36, v20, v36
  v_mul_f32 v37, v20, v37
  v_mul_f32 v38, v20, v38
  v_mul_f32 v39, v20, v39
  v_fmac_f32 v36, v22, v40
  v_fmac_f32 v37, v22, v41
  v_fmac_f32 v38, v22, v42
  v_fmac_f32 v39, v22, v43
  v_fmac_f32 v36, v52, v44
  v_fmac_f32 v37, v52, v45
  v_fmac_f32 v38, v52, v46
  v_fmac_f32 v39, v52, v47
  v_fmac_f32 v36, v54, v48
  v_fmac_f32 v37, v54, v49
  v_fmac_f32 v38, v54, v50
  v_fmac_f32 v39, v54, v51
  v_mov_b32 v24, v39
  v_mov_b32 v39, s43
  buffer_store_dwordx4 v[36:39], v56, s[32:35], s44 offen sc1
  buffer_store_dwordx4 v[24:27], v56, s[32:35], s44 offen offset:16 sc1
  s_waitcnt lgkmcnt(0)
PS_92:
  s_nop 1
  s_waitcnt vmcnt(0) lgkmcnt(0)
  s_barrier
  s_branch CL_35
CE_37:
  s_endpgm
.p2align 6
L_chain2:
  s_load_dwordx2 s[8:9], s[0:1], 24
  s_load_dwordx2 s[4:5], s[0:1], 0
  s_load_dwordx2 s[32:33], s[0:1], 88
  s_load_dwordx2 s[12:13], s[0:1], 48
  s_load_dwordx2 s[16:17], s[0:1], 56
  s_load_dwordx2 s[20:21], s[0:1], 64
  s_load_dwordx2 s[28:29], s[0:1], 72
  s_sub_u32 s40, s2, 16
  v_lshrrev_b32 v1, 6, v0
  s_nop 0
  v_readfirstlane_b32 s41, v1
  v_and_b32 v0, 63, v0
  v_lshlrev_b32 v78, 4, v0
  v_lshrrev_b32 v84, 4, v0
  v_and_b32 v85, 0xf0, v78
  v_lshl_or_b32 v3, v84, 13, v85
  s_mov_b32 s6, 0x700
  s_mov_b32 s7, 0x00020000
  s_mov_b32 s10, 0x380000
  s_mov_b32 s11, 0x00020000
  s_mov_b32 s34, 0x500000
  s_mov_b32 s35, 0x00020000
  s_mov_b32 s14, 0x188000
  s_mov_b32 s15, 0x00020000
  s_mov_b32 s18, 0x188000
  s_mov_b32 s19, 0x00020000
  s_mov_b32 s22, 0x188000
  s_mov_b32 s23, 0x00020000
  s_mov_b32 s30, 0x700
  s_mov_b32 s31, 0x00020000
  s_mov_b32 s42, -2
  s_mul_i32 s44, s41, 7
  s_add_u32 s45, s44, 0
  s_and_b32 s46, s45, 1
  s_lshr_b32 s45, s45, 1
  s_lshl_b32 s45, s45, 3
  s_add_u32 s45, s45, s46
  s_lshl_b32 s60, s45, 2
  s_add_u32 s45, s44, 1
  s_and_b32 s46, s45, 1
  s_lshr_b32 s45, s45, 1
  s_lshl_b32 s45, s45, 3
  s_add_u32 s45, s45, s46
  s_lshl_b32 s61, s45, 2
  s_add_u32 s45, s44, 2
  s_and_b32 s46, s45, 1
  s_lshr_b32 s45, s45, 1
  s_lshl_b32 s45, s45, 3
  s_add_u32 s45, s45, s46
  s_lshl_b32 s62, s45, 2
  s_add_u32 s45, s44, 3
  s_and_b32 s46, s45, 1
  s_lshr_b32 s45, s45, 1
  s_lshl_b32 s45, s45, 3
  s_add_u32 s45, s45, s46
  s_lshl_b32 s63, s45, 2
  s_add_u32 s45, s44, 4
  s_and_b32 s46, s45, 1
  s_lshr_b32 s45, s45, 1
  s_lshl_b32 s45, s45, 3
  s_add_u32 s45, s45, s46
  s_lshl_b32 s64, s45, 2
  s_add_u32 s45, s44, 5
  s_and_b32 s46, s45, 1
  s_lshr_b32 s45, s45, 1
  s_lshl_b32 s45, s45, 3
  s_add_u32 s45, s45, s46
  s_lshl_b32 s65, s45, 2
  s_add_u32 s45, s44, 6
  s_and_b32 s46, s45, 1
  s_lshr_b32 s45, s45, 1
  s_lshl_b32 s45, s45, 3
  s_add_u32 s45, s45, s46
  s_lshl_b32 s66, s45, 2
  s_mul_i32 s67, s41, 7168
  s_add_u32 s67, s67, 29696
  s_lshl_b32 s46, s40, 9
  s_mul_i32 s44, s41, 112
  v_lshlrev_b32 v86, 1, v0
  v_add_u32 v86, s44, v86
  v_and_b32 v87, 0xffffffe0, v86
  v_and_b32 v88, 3, v86
  v_lshl_add_u32 v87, v88, 3, v87
  v_bfe_u32 v88, v86, 2, 3
  v_add_u32 v87, v87, v88
  v_lshlrev_b32 v0, 1, v87
  s_mov_b32 s52, -1
  s_mov_b32 s53, 0xffffff
  v_mov_b32 v72, 0
  v_mov_b32 v74, 0
  v_mov_b32 v73, 0
  v_mov_b32 v75, 0
  s_waitcnt lgkmcnt(0)
  s_load_dword s43, s[32:33], 0
  s_mov_b64 exec, s[52:53]
  buffer_load_ushort v72, v0, s[4:7], 0 offen
  buffer_load_ushort v73, v0, s[4:7], 0 offen offset:16
  buffer_load_ushort v74, v0, s[4:7], 0 offen offset:896
  buffer_load_ushort v75, v0, s[4:7], 0 offen offset:912
  s_mov_b64 exec, -1
  s_lshl_b32 s45, s60, 13
  s_add_u32 s45, s45, s46
  buffer_load_dwordx4 a[4:7], v3, s[8:11], s45 offen offset:256 nt
  s_add_u32 s44, s45, 65536
  buffer_load_dwordx4 a[20:23], v3, s[8:11], s44 offen offset:256 nt
  s_add_u32 s44, s45, 131072
  buffer_load_dwordx4 a[36:39], v3, s[8:11], s44 offen offset:256 nt
  s_add_u32 s44, s45, 196608
  buffer_load_dwordx4 a[52:55], v3, s[8:11], s44 offen offset:256 nt
  s_lshl_b32 s45, s61, 13
  s_add_u32 s45, s45, s46
  buffer_load_dwordx4 a[12:15], v3, s[8:11], s45 offen offset:256 nt
  s_add_u32 s44, s45, 65536
  buffer_load_dwordx4 a[28:31], v3, s[8:11], s44 offen offset:256 nt
  s_add_u32 s44, s45, 131072
  buffer_load_dwordx4 a[44:47], v3, s[8:11], s44 offen offset:256 nt
  s_add_u32 s44, s45, 196608
  buffer_load_dwordx4 a[60:63], v3, s[8:11], s44 offen offset:256 nt
  s_lshl_b32 s45, s62, 13
  s_add_u32 s45, s45, s46
  buffer_load_dwordx4 a[68:71], v3, s[8:11], s45 offen offset:256 nt
  s_add_u32 s44, s45, 65536
  buffer_load_dwordx4 a[84:87], v3, s[8:11], s44 offen offset:256 nt
  s_add_u32 s44, s45, 131072
  buffer_load_dwordx4 a[100:103], v3, s[8:11], s44 offen offset:256 nt
  s_add_u32 s44, s45, 196608
  buffer_load_dwordx4 a[116:119], v3, s[8:11], s44 offen offset:256 nt
  s_lshl_b32 s45, s63, 13
  s_add_u32 s45, s45, s46
  buffer_load_dwordx4 a[76:79], v3, s[8:11], s45 offen offset:256 nt
  s_add_u32 s44, s45, 65536
  buffer_load_dwordx4 a[92:95], v3, s[8:11], s44 offen offset:256 nt
  s_add_u32 s44, s45, 131072
  buffer_load_dwordx4 a[108:111], v3, s[8:11], s44 offen offset:256 nt
  s_add_u32 s44, s45, 196608
  buffer_load_dwordx4 a[124:127], v3, s[8:11], s44 offen offset:256 nt
  s_lshl_b32 s45, s64, 13
  s_add_u32 s45, s45, s46
  buffer_load_dwordx4 a[132:135], v3, s[8:11], s45 offen offset:256 nt
  s_add_u32 s44, s45, 65536
  buffer_load_dwordx4 a[148:151], v3, s[8:11], s44 offen offset:256 nt
  s_add_u32 s44, s45, 131072
  buffer_load_dwordx4 a[164:167], v3, s[8:11], s44 offen offset:256 nt
  s_add_u32 s44, s45, 196608
  buffer_load_dwordx4 a[180:183], v3, s[8:11], s44 offen offset:256 nt
  s_lshl_b32 s45, s65, 13
  s_add_u32 s45, s45, s46
  buffer_load_dwordx4 a[140:143], v3, s[8:11], s45 offen offset:256 nt
  s_add_u32 s44, s45, 65536
  buffer_load_dwordx4 a[156:159], v3, s[8:11], s44 offen offset:256 nt
  s_add_u32 s44, s45, 131072
  buffer_load_dwordx4 a[172:175], v3, s[8:11], s44 offen offset:256 nt
  s_add_u32 s44, s45, 196608
  buffer_load_dwordx4 a[188:191], v3, s[8:11], s44 offen offset:256 nt
  s_lshl_b32 s45, s66, 13
  s_add_u32 s45, s45, s46
  buffer_load_dwordx4 a[196:199], v3, s[8:11], s45 offen offset:256 nt
  s_add_u32 s44, s45, 65536
  buffer_load_dwordx4 a[204:207], v3, s[8:11], s44 offen offset:256 nt
  s_add_u32 s44, s45, 131072
  buffer_load_dwordx4 a[212:215], v3, s[8:11], s44 offen offset:256 nt
  s_add_u32 s44, s45, 196608
  buffer_load_dwordx4 a[220:223], v3, s[8:11], s44 offen offset:256 nt
  s_waitcnt lgkmcnt(0)
  s_add_u32 s43, s43, 1
  s_max_u32 s43, s43, 1
  v_lshrrev_b32 v88, 4, v78
  v_and_b32 v89, 8, v88
  v_cmp_ne_u32 s[50:51], 0, v89
  v_and_b32 v89, 1, v88
  v_cmp_ne_u32 s[54:55], 0, v89
  v_mov_b32 v89, 0xffff
  v_mov_b32 v90, 0xffff0000
  v_cndmask_b32 v89, v89, v90, s[54:55]
  v_bfe_u32 v90, v88, 1, 2
  v_cmp_eq_u32 s[54:55], 0, v90
  s_nop 1
  v_cndmask_b32 v68, 0, v89, s[54:55]
  v_cmp_eq_u32 s[54:55], 1, v90
  s_nop 1
  v_cndmask_b32 v69, 0, v89, s[54:55]
  v_cmp_eq_u32 s[54:55], 2, v90
  s_nop 1
  v_cndmask_b32 v70, 0, v89, s[54:55]
  v_cmp_eq_u32 s[54:55], 3, v90
  s_nop 1
  v_cndmask_b32 v71, 0, v89, s[54:55]
  v_bfe_u32 v89, v88, 3, 1
  v_and_b32 v90, 7, v88
  v_add_u32 v79, s67, v78
  v_lshl_add_u32 v80, v89, 2, v84
  v_lshlrev_b32 v80, 4, v80
  s_lshl_b32 s44, s41, 9
  v_add_u32 v80, s44, v80
  s_lshl_b32 s44, s41, 12
  v_lshlrev_b32 v91, 11, v89
  v_add_u32 v91, s44, v91
  v_lshl_add_u32 v91, v90, 4, v91
  v_lshl_add_u32 v81, v84, 7, v91
  v_lshlrev_b32 v82, 1, v89
  v_xor_b32 v82, v82, v84
  v_lshl_add_u32 v82, v82, 7, v91
  v_add_u32 v82, 1536, v82
  v_mul_u32_u24 v4, 3584, v84
  v_add_u32 v1, v4, v85
  v_mul_u32_u24 v76, 896, v84
  v_mul_u32_u24 v77, 3584, v89
  v_add_u32 v77, v77, v76
  v_lshl_add_u32 v77, v90, 4, v77
  v_add_u32 v76, v76, v85
  s_lshl_b32 s69, s40, 2
  s_add_u32 s69, s69, s41
  s_lshl_b32 s68, s69, 8
  s_add_u32 s68, s68, 0x414000
  s_lshl_b32 s69, s69, 10
  s_waitcnt vmcnt(28)
  v_lshlrev_b32 v72, 16, v72
  v_lshlrev_b32 v74, 16, v74
  v_lshlrev_b32 v73, 16, v73
  v_lshlrev_b32 v75, 16, v75
CI_93:
  v_add_f32 v84, v72, v73
  v_mul_f32 v85, v72, v72
  v_fmac_f32 v85, v73, v73
  v_add_f32_dpp v84, v84, v84 row_ror:1 row_mask:0xf bank_mask:0xf
  s_nop 0
  v_add_f32_dpp v85, v85, v85 row_ror:1 row_mask:0xf bank_mask:0xf
  v_add_f32_dpp v84, v84, v84 row_ror:2 row_mask:0xf bank_mask:0xf
  s_nop 0
  v_add_f32_dpp v85, v85, v85 row_ror:2 row_mask:0xf bank_mask:0xf
  v_add_f32_dpp v84, v84, v84 row_ror:4 row_mask:0xf bank_mask:0xf
  s_nop 0
  v_add_f32_dpp v85, v85, v85 row_ror:4 row_mask:0xf bank_mask:0xf
  v_add_f32_dpp v84, v84, v84 row_ror:8 row_mask:0xf bank_mask:0xf
  s_nop 0
  v_add_f32_dpp v85, v85, v85 row_ror:8 row_mask:0xf bank_mask:0xf
  v_mov_b32 v86, v84
  v_mov_b32 v87, v85
  s_nop 0
  v_permlane16_swap_b32 v84, v86
  v_permlane16_swap_b32 v85, v87
  v_add_f32 v84, v84, v86
  v_add_f32 v85, v85, v87
  v_mov_b32 v86, v84
  v_mov_b32 v87, v85
  s_nop 0
  v_permlane32_swap_b32 v84, v86
  v_permlane32_swap_b32 v85, v87
  v_add_f32 v84, v84, v86
  v_add_f32 v85, v85, v87
  s_lshl_b32 s44, s41, 3
  v_mov_b32 v86, s44
  ds_write_b64 v86, v[84:85] offset:26624
  v_mov_b32 v86, 0
  v_lshrrev_b32 v90, 1, v78
  s_lshl_b32 s44, s41, 9
  v_add_u32 v90, s44, v90
  s_waitcnt lgkmcnt(0)
  s_barrier
  ds_read_b128 v[60:63], v86 offset:26624
  ds_read_b128 v[64:67], v86 offset:26640
  s_waitcnt lgkmcnt(0)
  v_add_f32 v84, v60, v62
  v_add_f32 v85, v61, v63
  v_add_f32 v86, v64, v66
  v_add_f32 v87, v65, v67
  v_add_f32 v84, v84, v86
  v_add_f32 v85, v85, v87
  v_mul_f32 v84, 0x3b124925, v84
  v_mul_f32 v85, 0x3b124925, v85
  v_fma_f32 v85, -v84, v84, v85
  v_max_f32 v85, 0, v85
  v_cvt_pk_bf16_f32 v87, v85, v85
  v_and_b32 v85, 0xffff0000, v87
  v_cvt_pk_bf16_f32 v86, v84, v84
  v_and_b32 v84, 0xffff0000, v86
  v_add_f32 v85, 0x3727c5ac, v85
  v_sub_f32 v88, v72, v84
  v_cvt_pk_bf16_f32 v87, v85, v85
  v_and_b32 v85, 0xffff0000, v87
  v_sub_f32 v89, v73, v84
  v_sqrt_f32 v85, v85
  v_cvt_pk_bf16_f32 v86, v88, v88
  v_and_b32 v88, 0xffff0000, v86
  v_cvt_pk_bf16_f32 v87, v85, v85
  v_and_b32 v85, 0xffff0000, v87
  v_rcp_f32 v85, v85
  v_cvt_pk_bf16_f32 v87, v89, v89
  v_and_b32 v89, 0xffff0000, v87
  v_mul_f32 v88, v88, v85
  v_mul_f32 v89, v89, v85
  v_cvt_pk_bf16_f32 v88, v88, v88
  v_cvt_pk_bf16_f32 v89, v89, v89
  v_cndmask_b32 v88, 0, v88, s[52:53]
  v_cndmask_b32 v89, 0, v89, s[52:53]
  ds_write_b64 v90, v[88:89] offset:24576
  v_and_b32 v84, 0x1ff, v81
  v_lshrrev_b32 v85, 11, v81
  v_lshl_or_b32 v84, v85, 10, v84
  v_lshrrev_b32 v86, 4, v78
  v_and_b32 v91, 3, v86
  v_bfe_u32 v85, v86, 2, 2
  s_lshl_b32 s44, s41, 5
  v_mov_b32 v87, s44
  v_lshl_add_u32 v88, v85, 3, v87
  v_add_u32 v88, v88, v91
  v_lshlrev_b32 v88, 2, v88
  v_add_u32 v88, 0x4000, v88
  v_lshl_add_u32 v89, v91, 3, v87
  v_lshl_add_u32 v89, v85, 1, v89
  v_lshlrev_b32 v89, 2, v89
  s_waitcnt vmcnt(0)
  ds_read_b128 v[60:63], v80 offset:24576
  ds_read_b128 v[64:67], v80 offset:24704
  ds_read_b128 v[44:47], v80 offset:24832
  ds_read_b128 v[48:51], v80 offset:24960
  s_waitcnt lgkmcnt(0)
  v_and_b32 v52, v60, v68
  v_and_b32 v53, v60, v69
  v_and_b32 v54, v60, v70
  v_and_b32 v55, v60, v71
  v_and_b32 v56, v61, v68
  v_and_b32 v57, v61, v69
  v_and_b32 v58, v61, v70
  v_and_b32 v59, v61, v71
  v_mfma_f32_16x16x32_bf16 v[8:11], a[4:7], v[52:55], 0
  v_mfma_f32_16x16x32_bf16 v[16:19], a[12:15], v[52:55], 0
  v_and_b32 v52, v62, v68
  v_and_b32 v53, v62, v69
  v_and_b32 v54, v62, v70
  v_and_b32 v55, v62, v71
  v_mfma_f32_16x16x32_bf16 v[8:11], a[20:23], v[56:59], v[8:11]
  v_mfma_f32_16x16x32_bf16 v[16:19], a[28:31], v[56:59], v[16:19]
  v_and_b32 v56, v63, v68
  v_and_b32 v57, v63, v69
  v_and_b32 v58, v63, v70
  v_and_b32 v59, v63, v71
  v_mfma_f32_16x16x32_bf16 v[8:11], a[36:39], v[52:55], v[8:11]
  v_mfma_f32_16x16x32_bf16 v[16:19], a[44:47], v[52:55], v[16:19]
  v_and_b32 v52, v64, v68
  v_and_b32 v53, v64, v69
  v_and_b32 v54, v64, v70
  v_and_b32 v55, v64, v71
  v_mfma_f32_16x16x32_bf16 v[8:11], a[52:55], v[56:59], v[8:11]
  v_mfma_f32_16x16x32_bf16 v[16:19], a[60:63], v[56:59], v[16:19]
  v_and_b32 v56, v65, v68
  v_and_b32 v57, v65, v69
  v_and_b32 v58, v65, v70
  v_and_b32 v59, v65, v71
  v_mfma_f32_16x16x32_bf16 v[8:11], a[68:71], v[52:55], v[8:11]
  v_mfma_f32_16x16x32_bf16 v[16:19], a[76:79], v[52:55], v[16:19]
  v_and_b32 v52, v66, v68
  v_and_b32 v53, v66, v69
  v_and_b32 v54, v66, v70
  v_and_b32 v55, v66, v71
  v_mfma_f32_16x16x32_bf16 v[8:11], a[84:87], v[56:59], v[8:11]
  v_mfma_f32_16x16x32_bf16 v[16:19], a[92:95], v[56:59], v[16:19]
  v_and_b32 v56, v67, v68
  v_and_b32 v57, v67, v69
  v_and_b32 v58, v67, v70
  v_and_b32 v59, v67, v71
  v_mfma_f32_16x16x32_bf16 v[8:11], a[100:103], v[52:55], v[8:11]
  v_mfma_f32_16x16x32_bf16 v[16:19], a[108:111], v[52:55], v[16:19]
  v_and_b32 v52, v44, v68
  v_and_b32 v53, v44, v69
  v_and_b32 v54, v44, v70
  v_and_b32 v55, v44, v71
  v_mfma_f32_16x16x32_bf16 v[8:11], a[116:119], v[56:59], v[8:11]
  v_mfma_f32_16x16x32_bf16 v[16:19], a[124:127], v[56:59], v[16:19]
  v_and_b32 v56, v45, v68
  v_and_b32 v57, v45, v69
  v_and_b32 v58, v45, v70
  v_and_b32 v59, v45, v71
  v_mfma_f32_16x16x32_bf16 v[8:11], a[132:135], v[52:55], v[8:11]
  v_mfma_f32_16x16x32_bf16 v[16:19], a[140:143], v[52:55], v[16:19]
  v_and_b32 v52, v46, v68
  v_and_b32 v53, v46, v69
  v_and_b32 v54, v46, v70
  v_and_b32 v55, v46, v71
  v_mfma_f32_16x16x32_bf16 v[8:11], a[148:151], v[56:59], v[8:11]
  v_mfma_f32_16x16x32_bf16 v[16:19], a[156:159], v[56:59], v[16:19]
  v_and_b32 v56, v47, v68
  v_and_b32 v57, v47, v69
  v_and_b32 v58, v47, v70
  v_and_b32 v59, v47, v71
  v_mfma_f32_16x16x32_bf16 v[8:11], a[164:167], v[52:55], v[8:11]
  v_mfma_f32_16x16x32_bf16 v[16:19], a[172:175], v[52:55], v[16:19]
  v_and_b32 v52, v48, v68
  v_and_b32 v53, v48, v69
  v_and_b32 v54, v48, v70
  v_and_b32 v55, v48, v71
  v_mfma_f32_16x16x32_bf16 v[8:11], a[180:183], v[56:59], v[8:11]
  v_mfma_f32_16x16x32_bf16 v[16:19], a[188:191], v[56:59], v[16:19]
  v_and_b32 v56, v49, v68
  v_and_b32 v57, v49, v69
  v_and_b32 v58, v49, v70
  v_and_b32 v59, v49, v71
  v_mfma_f32_16x16x32_bf16 v[8:11], a[196:199], v[52:55], v[8:11]
  v_and_b32 v52, v50, v68
  v_and_b32 v53, v50, v69
  v_and_b32 v54, v50, v70
  v_and_b32 v55, v50, v71
  v_mfma_f32_16x16x32_bf16 v[8:11], a[204:207], v[56:59], v[8:11]
  v_and_b32 v56, v51, v68
  v_and_b32 v57, v51, v69
  v_and_b32 v58, v51, v70
  v_and_b32 v59, v51, v71
  v_mfma_f32_16x16x32_bf16 v[8:11], a[212:215], v[52:55], v[8:11]
  s_nop 0
  v_mfma_f32_16x16x32_bf16 v[8:11], a[220:223], v[56:59], v[8:11]
  s_nop 7
  v_cndmask_b32 v8, v8, v16, s[50:51]
  v_cndmask_b32 v9, v9, v17, s[50:51]
  v_cndmask_b32 v10, v10, v18, s[50:51]
  v_cndmask_b32 v11, v11, v19, s[50:51]
  ds_write_b128 v84, v[8:11] offset:16384
  s_add_u32 s44, s42, 2
  s_lshl_b32 s44, s44, 4
  s_add_u32 s44, s44, s40
  s_lshl_b32 s44, s44, 10
  s_add_u32 s44, s44, 0x10200
  s_waitcnt lgkmcnt(0)
  s_barrier
  ds_read2_b32 v[4:5], v88 offset0:0 offset1:4
  v_add_u32 v90, 1024, v88
  ds_read2_b32 v[6:7], v90 offset0:0 offset1:4
  v_add_u32 v90, 2048, v88
  ds_read2_b32 v[8:9], v90 offset0:0 offset1:4
  v_add_u32 v90, 3072, v88
  ds_read2_b32 v[10:11], v90 offset0:0 offset1:4
  v_add_u32 v90, 4096, v88
  ds_read2_b32 v[12:13], v90 offset0:0 offset1:4
  v_add_u32 v90, 5120, v88
  ds_read2_b32 v[14:15], v90 offset0:0 offset1:4
  v_add_u32 v90, 6144, v88
  ds_read2_b32 v[16:17], v90 offset0:0 offset1:4
  v_add_u32 v90, 7168, v88
  ds_read2_b32 v[18:19], v90 offset0:0 offset1:4
  s_waitcnt lgkmcnt(0)
  v_add_f32 v4, v4, v12
  v_add_f32 v5, v5, v13
  v_add_f32 v6, v6, v14
  v_add_f32 v7, v7, v15
  v_add_f32 v8, v8, v16
  v_add_f32 v9, v9, v17
  v_add_f32 v10, v10, v18
  v_add_f32 v11, v11, v19
  v_add_f32 v4, v4, v8
  v_add_f32 v5, v5, v9
  v_add_f32 v6, v6, v10
  v_add_f32 v7, v7, v11
  v_add_f32 v4, v4, v6
  v_add_f32 v5, v5, v7
  v_cvt_pk_bf16_f32 v4, v4, v5
  v_mov_b32 v5, s43
  s_mov_b32 exec_hi, 0
  s_mov_b32 exec_lo, 0xffff
  buffer_store_dwordx2 v[4:5], v89, s[32:35], s44 offen sc1
  s_mov_b64 exec, -1
  v_swap_b32 v72, v74
  v_swap_b32 v73, v75
  s_add_u32 s42, s42, 1
  s_barrier
  s_cmp_lt_i32 s42, 0
  s_cbranch_scc1 CI_93
  s_load_dwordx2 s[76:77], s[0:1], 8
  s_load_dwordx2 s[80:81], s[0:1], 16
  s_mov_b32 s78, 0x10000000
  s_mov_b32 s79, 0x00020000
  s_mov_b32 s82, 0x10000000
  s_mov_b32 s83, 0x00020000
  s_lshl_b32 s84, s40, 23
  s_lshl_b32 s44, s41, 13
  s_add_u32 s84, s84, s44
  s_add_u32 s84, s84, 8290304
  s_add_u32 s85, s84, 0x8000000
  s_mul_i32 s88, s41, 32768
  s_add_u32 s88, s88, 29696
  s_mov_b32 s89, 0x3db8aa3b
  s_mov_b32 s90, 0xff7f0000
  s_lshl_b32 s93, s40, 10
  s_add_u32 s93, s93, 0x10000
  s_lshl_b32 s94, s40, 4
  s_add_u32 s94, s94, 15
  s_lshl_b32 s94, s94, 11
  s_add_u32 s94, s94, 0x100000
  s_getpc_b64 s[72:73]
PCH_94:
  s_sub_u32 s72, s72, (PCH_94 - interleave_layers__mha_block_cached__glu_gated_glu__decode_kernel)
  s_subb_u32 s73, s73, 0
  s_mov_b32 s74, (L_code_end - interleave_layers__mha_block_cached__glu_gated_glu__decode_kernel)
  s_mov_b32 s75, 0x00020000
  s_lshl_b32 s44, s41, 10
  buffer_load_dwordx4 v[4:7], v78, s[72:75], s44 offen
  s_add_u32 s44, s44, 4096
  buffer_load_dwordx4 v[8:11], v78, s[72:75], s44 offen
  s_add_u32 s44, s44, 4096
  buffer_load_dwordx4 v[12:15], v78, s[72:75], s44 offen
  s_add_u32 s44, s44, 4096
  buffer_load_dwordx4 v[16:19], v78, s[72:75], s44 offen
  s_add_u32 s44, s44, 4096
  buffer_load_dwordx4 v[20:23], v78, s[72:75], s44 offen
  s_add_u32 s44, s44, 4096
  buffer_load_dwordx4 v[24:27], v78, s[72:75], s44 offen
  s_add_u32 s44, s44, 4096
  buffer_load_dwordx4 v[28:31], v78, s[72:75], s44 offen
  s_add_u32 s44, s44, 4096
  buffer_load_dwordx4 v[32:35], v78, s[72:75], s44 offen
  s_add_u32 s44, s44, 4096
  buffer_load_dwordx4 v[36:39], v78, s[72:75], s44 offen
  s_add_u32 s44, s44, 4096
  buffer_load_dwordx4 v[40:43], v78, s[72:75], s44 offen
  s_add_u32 s44, s44, 4096
  buffer_load_dwordx4 v[44:47], v78, s[72:75], s44 offen
  s_add_u32 s44, s44, 4096
  buffer_load_dwordx4 v[48:51], v78, s[72:75], s44 offen
  s_add_u32 s44, s44, 4096
  buffer_load_dwordx4 v[4:7], v78, s[72:75], s44 offen
  s_add_u32 s44, s44, 4096
  buffer_load_dwordx4 v[8:11], v78, s[72:75], s44 offen
  s_add_u32 s44, s44, 4096
  buffer_load_dwordx4 v[12:15], v78, s[72:75], s44 offen
  s_add_u32 s44, s44, 4096
  buffer_load_dwordx4 v[16:19], v78, s[72:75], s44 offen
  s_add_u32 s44, s44, 4096
  buffer_load_dwordx4 v[20:23], v78, s[72:75], s44 offen
  s_add_u32 s44, s44, 4096
  buffer_load_dwordx4 v[24:27], v78, s[72:75], s44 offen
  s_add_u32 s44, s44, 4096
  s_waitcnt vmcnt(0)
  v_mov_b32 v8, 0
  v_mov_b32 v9, 0
  v_mov_b32 v10, 0
  v_mov_b32 v11, 0
  s_waitcnt lgkmcnt(0)
  s_lshl_b32 s44, s41, 19
  s_add_u32 s44, s44, s94
  buffer_store_dwordx4 v[8:11], v78, s[32:35], s44 offen sc1
  buffer_store_dwordx4 v[8:11], v78, s[32:35], s44 offen offset:1024 sc1
  v_mov_b32 v84, 28736
  ds_write_b128 v84, v[8:11]
  s_add_u32 s44, s69, 0x340000
  buffer_store_dwordx4 v[8:11], v78, s[32:35], s44 offen sc1
  s_add_u32 s44, s69, 0x350000
  buffer_store_dwordx4 v[8:11], v78, s[32:35], s44 offen sc1
  s_add_u32 s44, s69, 0x360000
  buffer_store_dwordx4 v[8:11], v78, s[32:35], s44 offen sc1
  s_add_u32 s44, s69, 0x370000
  buffer_store_dwordx4 v[8:11], v78, s[32:35], s44 offen sc1
  s_mul_i32 s44, s60, 3584
  s_mul_i32 s45, s40, 224
  s_add_u32 s44, s44, s45
  s_add_u32 s44, s44, 0
  buffer_load_dwordx4 a[0:3], v1, s[12:15], s44 offen nt
  buffer_load_dwordx4 a[4:7], v1, s[16:19], s44 offen nt
  s_mul_i32 s44, s61, 3584
  s_mul_i32 s45, s40, 224
  s_add_u32 s44, s44, s45
  s_add_u32 s44, s44, 0
  buffer_load_dwordx4 a[8:11], v1, s[12:15], s44 offen nt
  buffer_load_dwordx4 a[12:15], v1, s[16:19], s44 offen nt
  s_mul_i32 s44, s60, 3584
  s_mul_i32 s45, s40, 224
  s_add_u32 s44, s44, s45
  s_add_u32 s44, s44, 28672
  buffer_load_dwordx4 a[16:19], v1, s[12:15], s44 offen nt
  buffer_load_dwordx4 a[20:23], v1, s[16:19], s44 offen nt
  s_mul_i32 s44, s61, 3584
  s_mul_i32 s45, s40, 224
  s_add_u32 s44, s44, s45
  s_add_u32 s44, s44, 28672
  buffer_load_dwordx4 a[24:27], v1, s[12:15], s44 offen nt
  buffer_load_dwordx4 a[28:31], v1, s[16:19], s44 offen nt
  s_mul_i32 s44, s60, 3584
  s_mul_i32 s45, s40, 224
  s_add_u32 s44, s44, s45
  s_add_u32 s44, s44, 57344
  buffer_load_dwordx4 a[32:35], v1, s[12:15], s44 offen nt
  buffer_load_dwordx4 a[36:39], v1, s[16:19], s44 offen nt
  s_mul_i32 s44, s61, 3584
  s_mul_i32 s45, s40, 224
  s_add_u32 s44, s44, s45
  s_add_u32 s44, s44, 57344
  buffer_load_dwordx4 a[40:43], v1, s[12:15], s44 offen nt
  buffer_load_dwordx4 a[44:47], v1, s[16:19], s44 offen nt
  s_mul_i32 s44, s60, 3584
  s_mul_i32 s45, s40, 224
  s_add_u32 s44, s44, s45
  s_add_u32 s44, s44, 86016
  buffer_load_dwordx4 a[48:51], v1, s[12:15], s44 offen nt
  buffer_load_dwordx4 a[52:55], v1, s[16:19], s44 offen nt
  s_mul_i32 s44, s61, 3584
  s_mul_i32 s45, s40, 224
  s_add_u32 s44, s44, s45
  s_add_u32 s44, s44, 86016
  buffer_load_dwordx4 a[56:59], v1, s[12:15], s44 offen nt
  buffer_load_dwordx4 a[60:63], v1, s[16:19], s44 offen nt
  s_mul_i32 s44, s62, 3584
  s_mul_i32 s45, s40, 224
  s_add_u32 s44, s44, s45
  s_add_u32 s44, s44, 0
  buffer_load_dwordx4 a[64:67], v1, s[12:15], s44 offen nt
  buffer_load_dwordx4 a[68:71], v1, s[16:19], s44 offen nt
  s_mul_i32 s44, s63, 3584
  s_mul_i32 s45, s40, 224
  s_add_u32 s44, s44, s45
  s_add_u32 s44, s44, 0
  buffer_load_dwordx4 a[72:75], v1, s[12:15], s44 offen nt
  buffer_load_dwordx4 a[76:79], v1, s[16:19], s44 offen nt
  s_mul_i32 s44, s62, 3584
  s_mul_i32 s45, s40, 224
  s_add_u32 s44, s44, s45
  s_add_u32 s44, s44, 28672
  buffer_load_dwordx4 a[80:83], v1, s[12:15], s44 offen nt
  buffer_load_dwordx4 a[84:87], v1, s[16:19], s44 offen nt
  s_mul_i32 s44, s63, 3584
  s_mul_i32 s45, s40, 224
  s_add_u32 s44, s44, s45
  s_add_u32 s44, s44, 28672
  buffer_load_dwordx4 a[88:91], v1, s[12:15], s44 offen nt
  buffer_load_dwordx4 a[92:95], v1, s[16:19], s44 offen nt
  s_mul_i32 s44, s62, 3584
  s_mul_i32 s45, s40, 224
  s_add_u32 s44, s44, s45
  s_add_u32 s44, s44, 57344
  buffer_load_dwordx4 a[96:99], v1, s[12:15], s44 offen nt
  buffer_load_dwordx4 a[100:103], v1, s[16:19], s44 offen nt
  s_mul_i32 s44, s63, 3584
  s_mul_i32 s45, s40, 224
  s_add_u32 s44, s44, s45
  s_add_u32 s44, s44, 57344
  buffer_load_dwordx4 a[104:107], v1, s[12:15], s44 offen nt
  buffer_load_dwordx4 a[108:111], v1, s[16:19], s44 offen nt
  s_mul_i32 s44, s62, 3584
  s_mul_i32 s45, s40, 224
  s_add_u32 s44, s44, s45
  s_add_u32 s44, s44, 86016
  buffer_load_dwordx4 a[112:115], v1, s[12:15], s44 offen nt
  buffer_load_dwordx4 a[116:119], v1, s[16:19], s44 offen nt
  s_mul_i32 s44, s63, 3584
  s_mul_i32 s45, s40, 224
  s_add_u32 s44, s44, s45
  s_add_u32 s44, s44, 86016
  buffer_load_dwordx4 a[120:123], v1, s[12:15], s44 offen nt
  buffer_load_dwordx4 a[124:127], v1, s[16:19], s44 offen nt
  s_mul_i32 s44, s64, 3584
  s_mul_i32 s45, s40, 224
  s_add_u32 s44, s44, s45
  s_add_u32 s44, s44, 0
  buffer_load_dwordx4 a[128:131], v1, s[12:15], s44 offen nt
  buffer_load_dwordx4 a[132:135], v1, s[16:19], s44 offen nt
  s_mul_i32 s44, s65, 3584
  s_mul_i32 s45, s40, 224
  s_add_u32 s44, s44, s45
  s_add_u32 s44, s44, 0
  buffer_load_dwordx4 a[136:139], v1, s[12:15], s44 offen nt
  buffer_load_dwordx4 a[140:143], v1, s[16:19], s44 offen nt
  s_mul_i32 s44, s64, 3584
  s_mul_i32 s45, s40, 224
  s_add_u32 s44, s44, s45
  s_add_u32 s44, s44, 28672
  buffer_load_dwordx4 a[144:147], v1, s[12:15], s44 offen nt
  buffer_load_dwordx4 a[148:151], v1, s[16:19], s44 offen nt
  s_mul_i32 s44, s65, 3584
  s_mul_i32 s45, s40, 224
  s_add_u32 s44, s44, s45
  s_add_u32 s44, s44, 28672
  buffer_load_dwordx4 a[152:155], v1, s[12:15], s44 offen nt
  buffer_load_dwordx4 a[156:159], v1, s[16:19], s44 offen nt
  s_mul_i32 s44, s64, 3584
  s_mul_i32 s45, s40, 224
  s_add_u32 s44, s44, s45
  s_add_u32 s44, s44, 57344
  buffer_load_dwordx4 a[160:163], v1, s[12:15], s44 offen nt
  buffer_load_dwordx4 a[164:167], v1, s[16:19], s44 offen nt
  s_mul_i32 s44, s65, 3584
  s_mul_i32 s45, s40, 224
  s_add_u32 s44, s44, s45
  s_add_u32 s44, s44, 57344
  buffer_load_dwordx4 a[168:171], v1, s[12:15], s44 offen nt
  buffer_load_dwordx4 a[172:175], v1, s[16:19], s44 offen nt
  s_mul_i32 s44, s64, 3584
  s_mul_i32 s45, s40, 224
  s_add_u32 s44, s44, s45
  s_add_u32 s44, s44, 86016
  buffer_load_dwordx4 a[176:179], v1, s[12:15], s44 offen nt
  buffer_load_dwordx4 a[180:183], v1, s[16:19], s44 offen nt
  s_mul_i32 s44, s65, 3584
  s_mul_i32 s45, s40, 224
  s_add_u32 s44, s44, s45
  s_add_u32 s44, s44, 86016
  buffer_load_dwordx4 a[184:187], v1, s[12:15], s44 offen nt
  buffer_load_dwordx4 a[188:191], v1, s[16:19], s44 offen nt
  s_mul_i32 s44, s66, 3584
  s_mul_i32 s45, s40, 224
  s_add_u32 s44, s44, s45
  s_add_u32 s44, s44, 0
  buffer_load_dwordx4 a[192:195], v1, s[12:15], s44 offen nt
  s_waitcnt vmcnt(40)
  buffer_load_dwordx4 a[196:199], v1, s[16:19], s44 offen nt
  s_mul_i32 s44, s66, 3584
  s_mul_i32 s45, s40, 224
  s_add_u32 s44, s44, s45
  s_add_u32 s44, s44, 28672
  buffer_load_dwordx4 a[200:203], v1, s[12:15], s44 offen nt
  buffer_load_dwordx4 a[204:207], v1, s[16:19], s44 offen nt
  s_mul_i32 s44, s66, 3584
  s_mul_i32 s45, s40, 224
  s_add_u32 s44, s44, s45
  s_add_u32 s44, s44, 57344
  buffer_load_dwordx4 a[208:211], v1, s[12:15], s44 offen nt
  buffer_load_dwordx4 a[212:215], v1, s[16:19], s44 offen nt
  s_mul_i32 s44, s66, 3584
  s_mul_i32 s45, s40, 224
  s_add_u32 s44, s44, s45
  s_add_u32 s44, s44, 86016
  buffer_load_dwordx4 a[216:219], v1, s[12:15], s44 offen nt
  buffer_load_dwordx4 a[220:223], v1, s[16:19], s44 offen nt
  s_mul_i32 s45, s40, 112
  s_lshl_b32 s46, s41, 5
  s_add_u32 s45, s45, s46
  s_mul_i32 s45, s45, 896
  s_add_u32 s44, s45, 0
  buffer_load_dwordx4 a[224:227], v76, s[20:23], s44 offen nt
  buffer_load_dwordx4 a[228:231], v76, s[20:23], s44 offen offset:256 nt
  buffer_load_dwordx4 a[232:235], v76, s[20:23], s44 offen offset:512 nt
  buffer_load_dwordx4 a[248:251], v77, s[20:23], s44 offen offset:768 nt
  s_add_u32 s44, s45, 3584
  buffer_load_dwordx4 a[236:239], v76, s[20:23], s44 offen nt
  buffer_load_dwordx4 a[240:243], v76, s[20:23], s44 offen offset:256 nt
  buffer_load_dwordx4 a[244:247], v76, s[20:23], s44 offen offset:512 nt
  s_add_u32 s44, s45, 7168
  buffer_load_dwordx4 a[252:255], v76, s[20:23], s44 offen nt
  buffer_load_dwordx4 v[92:95], v76, s[20:23], s44 offen offset:256 nt
  s_waitcnt vmcnt(40)
  buffer_load_dwordx4 v[96:99], v76, s[20:23], s44 offen offset:512 nt
  buffer_load_dwordx4 v[112:115], v77, s[20:23], s44 offen offset:768 nt
  s_add_u32 s44, s45, 10752
  buffer_load_dwordx4 v[100:103], v76, s[20:23], s44 offen nt
  buffer_load_dwordx4 v[104:107], v76, s[20:23], s44 offen offset:256 nt
  buffer_load_dwordx4 v[108:111], v76, s[20:23], s44 offen offset:512 nt
  s_cmp_eq_u32 s41, 3
  s_cbranch_scc1 DNS_95
  s_add_u32 s44, s45, 14336
  buffer_load_dwordx4 v[116:119], v76, s[20:23], s44 offen nt
  buffer_load_dwordx4 v[120:123], v76, s[20:23], s44 offen offset:256 nt
  buffer_load_dwordx4 v[124:127], v76, s[20:23], s44 offen offset:512 nt
  buffer_load_dwordx4 v[140:143], v77, s[20:23], s44 offen offset:768 nt
  s_add_u32 s44, s45, 17920
  buffer_load_dwordx4 v[128:131], v76, s[20:23], s44 offen nt
  buffer_load_dwordx4 v[132:135], v76, s[20:23], s44 offen offset:256 nt
  buffer_load_dwordx4 v[136:139], v76, s[20:23], s44 offen offset:512 nt
  s_add_u32 s44, s45, 21504
  buffer_load_dwordx4 v[144:147], v76, s[20:23], s44 offen nt
  buffer_load_dwordx4 v[148:151], v76, s[20:23], s44 offen offset:256 nt
  buffer_load_dwordx4 v[152:155], v76, s[20:23], s44 offen offset:512 nt
  buffer_load_dwordx4 v[168:171], v77, s[20:23], s44 offen offset:768 nt
  s_add_u32 s44, s45, 25088
  s_waitcnt vmcnt(40)
  buffer_load_dwordx4 v[156:159], v76, s[20:23], s44 offen nt
  buffer_load_dwordx4 v[160:163], v76, s[20:23], s44 offen offset:256 nt
  buffer_load_dwordx4 v[164:167], v76, s[20:23], s44 offen offset:512 nt
DNS_95:
  s_waitcnt vmcnt(0) lgkmcnt(0)
  s_barrier
  s_waitcnt vmcnt(0)
  v_and_b32 v60, 0x70, v78
  v_lshlrev_b32 v60, 5, v60
  v_and_b32 v20, 0x80, v78
  v_lshrrev_b32 v20, 1, v20
  v_or_b32 v60, v60, v20
  v_and_b32 v20, 0x300, v78
  v_lshrrev_b32 v21, 4, v20
  v_or_b32 v60, v60, v21
  v_xor_b32 v61, 0x1040, v60
  v_lshlrev_b32 v62, 3, v20
  v_and_b32 v20, 0xf0, v78
  v_or_b32 v62, v62, v20
  v_add_u32 v66, s88, v78
  v_mov_b32 v65, 0xbdb8aa3b
  v_lshrrev_b32 v21, 2, v78
  v_xor_b32 v21, v21, v78
  v_and_b32 v21, 0x80, v21
  v_cmp_eq_u32 s[54:55], 0, v21
  v_mov_b32 v20, 0x03020100
  v_mov_b32 v63, 0x05040c0c
  v_mov_b32 v64, 0x07060c0c
  v_cndmask_b32 v63, v20, v63, s[54:55]
  v_cndmask_b32 v64, v20, v64, s[54:55]
  s_add_u32 s86, s84, 0
  s_add_u32 m0, s88, 0x0
  s_nop 0
  buffer_load_dwordx4 v60, s[76:79], s86 offen nt lds
  s_add_u32 m0, s88, 0x380
  s_nop 0
  buffer_load_dwordx4 v60, s[76:79], s86 offen offset:128 nt lds
  s_add_u32 m0, s88, 0x700
  s_nop 0
  buffer_load_dwordx4 v60, s[76:79], s86 offen offset:256 nt lds
  s_add_u32 m0, s88, 0xa80
  s_nop 0
  buffer_load_dwordx4 v60, s[76:79], s86 offen offset:384 nt lds
  s_add_u32 m0, s88, 0x1000
  s_nop 0
  buffer_load_dwordx4 v61, s[76:79], s86 offen nt lds
  s_add_u32 m0, s88, 0x1380
  s_nop 0
  buffer_load_dwordx4 v61, s[76:79], s86 offen offset:128 nt lds
  s_add_u32 m0, s88, 0x1700
  s_nop 0
  buffer_load_dwordx4 v61, s[76:79], s86 offen offset:256 nt lds
  s_add_u32 m0, s88, 0x1a80
  s_nop 0
  buffer_load_dwordx4 v61, s[76:79], s86 offen offset:384 nt lds
  s_add_u32 s87, s84, 0
  s_add_u32 m0, s88, 0x2000
  s_nop 0
  buffer_load_dwordx4 v62, s[80:83], s87 offen nt lds
  s_add_u32 m0, s88, 0x2300
  s_nop 0
  buffer_load_dwordx4 v62, s[80:83], s87 offen offset:256 nt lds
  s_add_u32 m0, s88, 0x2600
  s_nop 0
  buffer_load_dwordx4 v62, s[80:83], s87 offen offset:512 nt lds
  s_add_u32 m0, s88, 0x2900
  s_nop 0
  buffer_load_dwordx4 v62, s[80:83], s87 offen offset:768 nt lds
  s_add_u32 m0, s88, 0x2c00
  s_nop 0
  buffer_load_dwordx4 v62, s[80:83], s87 offen offset:1024 nt lds
  s_add_u32 m0, s88, 0x2f00
  s_nop 0
  buffer_load_dwordx4 v62, s[80:83], s87 offen offset:1280 nt lds
  s_add_u32 m0, s88, 0x3200
  s_nop 0
  buffer_load_dwordx4 v62, s[80:83], s87 offen offset:1536 nt lds
  s_add_u32 m0, s88, 0x3500
  s_nop 0
  buffer_load_dwordx4 v62, s[80:83], s87 offen offset:1792 nt lds
  s_add_u32 s86, s84, 32768
  s_add_u32 m0, s88, 0x4000
  s_nop 0
  buffer_load_dwordx4 v60, s[76:79], s86 offen nt lds
  s_add_u32 m0, s88, 0x4380
  s_nop 0
  buffer_load_dwordx4 v60, s[76:79], s86 offen offset:128 nt lds
  s_add_u32 m0, s88, 0x4700
  s_nop 0
  buffer_load_dwordx4 v60, s[76:79], s86 offen offset:256 nt lds
  s_add_u32 m0, s88, 0x4a80
  s_nop 0
  buffer_load_dwordx4 v60, s[76:79], s86 offen offset:384 nt lds
  s_add_u32 m0, s88, 0x5000
  s_nop 0
  buffer_load_dwordx4 v61, s[76:79], s86 offen nt lds
  s_add_u32 m0, s88, 0x5380
  s_nop 0
  buffer_load_dwordx4 v61, s[76:79], s86 offen offset:128 nt lds
  s_add_u32 m0, s88, 0x5700
  s_nop 0
  buffer_load_dwordx4 v61, s[76:79], s86 offen offset:256 nt lds
  s_add_u32 m0, s88, 0x5a80
  s_nop 0
  buffer_load_dwordx4 v61, s[76:79], s86 offen offset:384 nt lds
  s_waitcnt vmcnt(16)
  s_add_u32 s87, s84, 32768
  s_add_u32 m0, s88, 0x6000
  s_nop 0
  buffer_load_dwordx4 v62, s[80:83], s87 offen nt lds
  s_add_u32 m0, s88, 0x6300
  s_nop 0
  buffer_load_dwordx4 v62, s[80:83], s87 offen offset:256 nt lds
  s_add_u32 m0, s88, 0x6600
  s_nop 0
  buffer_load_dwordx4 v62, s[80:83], s87 offen offset:512 nt lds
  s_add_u32 m0, s88, 0x6900
  s_nop 0
  buffer_load_dwordx4 v62, s[80:83], s87 offen offset:768 nt lds
  s_add_u32 m0, s88, 0x6c00
  s_nop 0
  buffer_load_dwordx4 v62, s[80:83], s87 offen offset:1024 nt lds
  s_add_u32 m0, s88, 0x6f00
  s_nop 0
  buffer_load_dwordx4 v62, s[80:83], s87 offen offset:1280 nt lds
  s_add_u32 m0, s88, 0x7200
  s_nop 0
  buffer_load_dwordx4 v62, s[80:83], s87 offen offset:1536 nt lds
  s_add_u32 m0, s88, 0x7500
  s_nop 0
  buffer_load_dwordx4 v62, s[80:83], s87 offen offset:1792 nt lds
  s_waitcnt vmcnt(16)
  s_add_u32 s86, s84, 65536
  buffer_load_dwordx4 v[172:175], v60, s[76:79], s86 offen nt
  buffer_load_dwordx4 v[176:179], v60, s[76:79], s86 offen offset:128 nt
  buffer_load_dwordx4 v[180:183], v60, s[76:79], s86 offen offset:256 nt
  buffer_load_dwordx4 v[184:187], v60, s[76:79], s86 offen offset:384 nt
  buffer_load_dwordx4 v[188:191], v61, s[76:79], s86 offen nt
  buffer_load_dwordx4 v[192:195], v61, s[76:79], s86 offen offset:128 nt
  buffer_load_dwordx4 v[196:199], v61, s[76:79], s86 offen offset:256 nt
  buffer_load_dwordx4 v[200:203], v61, s[76:79], s86 offen offset:384 nt
  s_waitcnt vmcnt(16)
  s_add_u32 s87, s84, 65536
  buffer_load_dwordx4 v[204:207], v62, s[80:83], s87 offen nt
  buffer_load_dwordx4 v[208:211], v62, s[80:83], s87 offen offset:256 nt
  buffer_load_dwordx4 v[212:215], v62, s[80:83], s87 offen offset:512 nt
  buffer_load_dwordx4 v[216:219], v62, s[80:83], s87 offen offset:768 nt
  buffer_load_dwordx4 v[220:223], v62, s[80:83], s87 offen offset:1024 nt
  buffer_load_dwordx4 v[224:227], v62, s[80:83], s87 offen offset:1280 nt
  buffer_load_dwordx4 v[228:231], v62, s[80:83], s87 offen offset:1536 nt
  buffer_load_dwordx4 v[232:235], v62, s[80:83], s87 offen offset:1792 nt
  s_waitcnt vmcnt(23)
  s_add_u32 s44, s93, 0
  v_subrev_u32 v52, s88, v66
  buffer_load_dwordx4 v[236:239], v52, s[32:35], s44 offen sc1
  s_waitcnt vmcnt(0)
  v_mov_b32 v20, v236
  v_mov_b32 v21, v237
  v_mov_b32 v22, v238
  v_mov_b32 v23, v239
  s_mov_b32 s49, 0
  s_branch QC_97
QR_96:
  s_add_u32 s44, s93, 0
  v_subrev_u32 v20, s88, v66
  buffer_load_dwordx4 v[20:23], v20, s[32:35], s44 offen sc1
  s_waitcnt vmcnt(0)
QC_97:
  v_cmp_eq_u32 s[54:55], s43, v21
  v_cmp_eq_u32 s[56:57], s43, v23
  s_nop 1
  s_and_b64 s[54:55], s[54:55], s[56:57]
  s_cmp_eq_u64 s[54:55], -1
  s_cbranch_scc1 QO_98
  s_add_u32 s49, s49, 1
  s_cmp_gt_u32 s49, 40000
  s_cbranch_scc1 QO_98
  s_sleep 8
  s_branch QR_96
QO_98:
  v_subrev_u32 v52, s88, v66
  v_lshrrev_b32 v52, 1, v52
  v_add_u32 v52, 27648, v52
  ds_write2_b32 v52, v20, v22 offset0:0 offset1:1
  s_waitcnt lgkmcnt(0)
  v_and_b32 v52, 0x70, v60
  ds_read_b128 v[4:7], v52 offset:27648
  ds_read_b128 v[8:11], v52 offset:27776
  ds_read_b128 v[12:15], v52 offset:27904
  ds_read_b128 v[16:19], v52 offset:28032
  s_waitcnt lgkmcnt(0)
  ds_read_b128 v[36:39], v66 offset:0
  ds_read_b128 v[40:43], v66 offset:4096
  ds_read_b128 v[44:47], v66 offset:1024
  ds_read_b128 v[48:51], v66 offset:5120
  s_waitcnt lgkmcnt(3)
  v_mfma_f32_16x16x32_bf16 v[20:23], v[36:39], v[4:7], 0
  ds_read_b128 v[36:39], v66 offset:2048
  s_waitcnt lgkmcnt(3)
  v_mfma_f32_16x16x32_bf16 v[24:27], v[40:43], v[4:7], 0
  ds_read_b128 v[40:43], v66 offset:6144
  s_waitcnt lgkmcnt(3)
  v_mfma_f32_16x16x32_bf16 v[20:23], v[44:47], v[8:11], v[20:23]
  ds_read_b128 v[44:47], v66 offset:3072
  s_waitcnt lgkmcnt(3)
  v_mfma_f32_16x16x32_bf16 v[24:27], v[48:51], v[8:11], v[24:27]
  ds_read_b128 v[48:51], v66 offset:7168
  s_waitcnt lgkmcnt(3)
  v_mfma_f32_16x16x32_bf16 v[20:23], v[36:39], v[12:15], v[20:23]
  s_waitcnt lgkmcnt(2)
  v_mfma_f32_16x16x32_bf16 v[24:27], v[40:43], v[12:15], v[24:27]
  s_waitcnt lgkmcnt(1)
  v_mfma_f32_16x16x32_bf16 v[20:23], v[44:47], v[16:19], v[20:23]
  s_waitcnt lgkmcnt(0)
  v_mfma_f32_16x16x32_bf16 v[24:27], v[48:51], v[16:19], v[24:27]
  s_nop 7
  v_permlane32_swap_b32 v20, v24
  v_permlane32_swap_b32 v21, v25
  v_permlane32_swap_b32 v22, v26
  v_permlane32_swap_b32 v23, v27
  v_add_f32_dpp v20, v24, v20 row_ror:8 row_mask:0xf bank_mask:0xf
  v_add_f32_dpp v21, v25, v21 row_ror:8 row_mask:0xf bank_mask:0xf
  v_add_f32_dpp v22, v26, v22 row_ror:8 row_mask:0xf bank_mask:0xf
  v_add_f32_dpp v23, v27, v23 row_ror:8 row_mask:0xf bank_mask:0xf
  v_cvt_pk_bf16_f32 v24, v20, v21
  v_cvt_pk_bf16_f32 v25, v22, v23
  v_perm_b32 v20, v24, s90, v63
  v_perm_b32 v21, v24, s90, v64
  v_perm_b32 v22, v25, s90, v63
  v_perm_b32 v23, v25, s90, v64
  v_max3_f32 v26, v20, v21, v22
  v_max_f32 v26, v26, v23
  s_nop 1
  v_max_f32_dpp v26, v26, v26 row_ror:8 row_mask:0xf bank_mask:0xf
  s_nop 1
  v_max_f32_dpp v26, v26, v26 row_bcast:15 row_mask:0xa bank_mask:0xf
  s_nop 1
  v_max_f32_dpp v26, v26, v26 row_bcast:31 row_mask:0xc bank_mask:0xf
  s_nop 0
  v_readlane_b32 s91, v26, 63
  s_nop 1
  v_mul_f32 v86, s91, v65
  v_fma_f32 v20, v20, s89, v86
  v_fma_f32 v21, v21, s89, v86
  v_fma_f32 v22, v22, s89, v86
  v_fma_f32 v23, v23, s89, v86
  v_exp_f32 v20, v20
  v_exp_f32 v21, v21
  v_exp_f32 v22, v22
  v_exp_f32 v23, v23
  v_add_f32 v26, v20, v21
  v_add_f32 v24, v22, v23
  v_cvt_pk_bf16_f32 v20, v20, v20
  v_cvt_pk_bf16_f32 v21, v21, v21
  v_cvt_pk_bf16_f32 v22, v22, v22
  v_cvt_pk_bf16_f32 v23, v23, v23
  v_add_f32 v67, v26, v24
  v_and_b32 v52, v20, v68
  v_and_b32 v53, v20, v69
  v_and_b32 v54, v20, v70
  v_and_b32 v55, v20, v71
  v_and_b32 v56, v21, v68
  v_and_b32 v57, v21, v69
  v_and_b32 v58, v21, v70
  v_and_b32 v59, v21, v71
  ds_read_b128 v[36:39], v66 offset:8192
  ds_read_b128 v[40:43], v66 offset:9216
  ds_read_b128 v[44:47], v66 offset:10240
  ds_read_b128 v[48:51], v66 offset:11264
  s_waitcnt lgkmcnt(3)
  v_mfma_f32_16x16x32_bf16 v[28:31], v[36:39], v[52:55], 0
  ds_read_b128 v[36:39], v66 offset:12288
  s_waitcnt lgkmcnt(3)
  v_mfma_f32_16x16x32_bf16 v[32:35], v[40:43], v[52:55], 0
  ds_read_b128 v[40:43], v66 offset:13312
  v_and_b32 v52, v22, v68
  v_and_b32 v53, v22, v69
  v_and_b32 v54, v22, v70
  v_and_b32 v55, v22, v71
  s_waitcnt lgkmcnt(3)
  v_mfma_f32_16x16x32_bf16 v[28:31], v[44:47], v[56:59], v[28:31]
  ds_read_b128 v[44:47], v66 offset:14336
  s_waitcnt lgkmcnt(3)
  v_mfma_f32_16x16x32_bf16 v[32:35], v[48:51], v[56:59], v[32:35]
  ds_read_b128 v[48:51], v66 offset:15360
  v_and_b32 v56, v23, v68
  v_and_b32 v57, v23, v69
  v_and_b32 v58, v23, v70
  v_and_b32 v59, v23, v71
  s_waitcnt lgkmcnt(3)
  v_mfma_f32_16x16x32_bf16 v[28:31], v[36:39], v[52:55], v[28:31]
  s_waitcnt lgkmcnt(2)
  v_mfma_f32_16x16x32_bf16 v[32:35], v[40:43], v[52:55], v[32:35]
  s_waitcnt lgkmcnt(1)
  v_mfma_f32_16x16x32_bf16 v[28:31], v[44:47], v[56:59], v[28:31]
  s_waitcnt lgkmcnt(0)
  v_mfma_f32_16x16x32_bf16 v[32:35], v[48:51], v[56:59], v[32:35]
  ds_read_b128 v[36:39], v66 offset:16384
  ds_read_b128 v[40:43], v66 offset:20480
  ds_read_b128 v[44:47], v66 offset:17408
  ds_read_b128 v[48:51], v66 offset:21504
  s_waitcnt lgkmcnt(3)
  v_mfma_f32_16x16x32_bf16 v[20:23], v[36:39], v[4:7], 0
  ds_read_b128 v[36:39], v66 offset:18432
  s_waitcnt lgkmcnt(3)
  v_mfma_f32_16x16x32_bf16 v[24:27], v[40:43], v[4:7], 0
  ds_read_b128 v[40:43], v66 offset:22528
  s_waitcnt lgkmcnt(3)
  v_mfma_f32_16x16x32_bf16 v[20:23], v[44:47], v[8:11], v[20:23]
  ds_read_b128 v[44:47], v66 offset:19456
  s_waitcnt lgkmcnt(3)
  v_mfma_f32_16x16x32_bf16 v[24:27], v[48:51], v[8:11], v[24:27]
  ds_read_b128 v[48:51], v66 offset:23552
  s_waitcnt lgkmcnt(3)
  v_mfma_f32_16x16x32_bf16 v[20:23], v[36:39], v[12:15], v[20:23]
  s_waitcnt lgkmcnt(2)
  v_mfma_f32_16x16x32_bf16 v[24:27], v[40:43], v[12:15], v[24:27]
  s_waitcnt lgkmcnt(1)
  v_mfma_f32_16x16x32_bf16 v[20:23], v[44:47], v[16:19], v[20:23]
  s_waitcnt lgkmcnt(0)
  v_mfma_f32_16x16x32_bf16 v[24:27], v[48:51], v[16:19], v[24:27]
  s_nop 7
  v_permlane32_swap_b32 v20, v24
  v_permlane32_swap_b32 v21, v25
  v_permlane32_swap_b32 v22, v26
  v_permlane32_swap_b32 v23, v27
  v_add_f32_dpp v20, v24, v20 row_ror:8 row_mask:0xf bank_mask:0xf
  v_add_f32_dpp v21, v25, v21 row_ror:8 row_mask:0xf bank_mask:0xf
  v_add_f32_dpp v22, v26, v22 row_ror:8 row_mask:0xf bank_mask:0xf
  v_add_f32_dpp v23, v27, v23 row_ror:8 row_mask:0xf bank_mask:0xf
  v_cvt_pk_bf16_f32 v24, v20, v21
  v_cvt_pk_bf16_f32 v25, v22, v23
  v_perm_b32 v20, v24, s90, v63
  v_perm_b32 v21, v24, s90, v64
  v_perm_b32 v22, v25, s90, v63
  v_perm_b32 v23, v25, s90, v64
  v_max3_f32 v26, v20, v21, v22
  v_max3_f32 v26, v26, v23, s91
  s_nop 1
  v_max_f32_dpp v26, v26, v26 row_ror:8 row_mask:0xf bank_mask:0xf
  s_nop 1
  v_max_f32_dpp v26, v26, v26 row_bcast:15 row_mask:0xa bank_mask:0xf
  s_nop 1
  v_max_f32_dpp v26, v26, v26 row_bcast:31 row_mask:0xc bank_mask:0xf
  s_nop 0
  v_readlane_b32 s91, v26, 63
  s_nop 1
  v_mul_f32 v84, s91, v65
  v_fma_f32 v20, v20, s89, v84
  v_fma_f32 v21, v21, s89, v84
  v_fma_f32 v22, v22, s89, v84
  v_fma_f32 v23, v23, s89, v84
  v_sub_f32 v27, v84, v86
  v_exp_f32 v20, v20
  v_exp_f32 v21, v21
  v_exp_f32 v22, v22
  v_exp_f32 v23, v23
  v_exp_f32 v27, v27
  v_add_f32 v26, v20, v21
  v_add_f32 v24, v22, v23
  v_cvt_pk_bf16_f32 v20, v20, v20
  v_cvt_pk_bf16_f32 v21, v21, v21
  v_cvt_pk_bf16_f32 v22, v22, v22
  v_cvt_pk_bf16_f32 v23, v23, v23
  v_add_f32 v26, v26, v24
  v_fma_f32 v67, v67, v27, v26
  v_mul_f32 v28, v27, v28
  v_mul_f32 v29, v27, v29
  v_mul_f32 v30, v27, v30
  v_mul_f32 v31, v27, v31
  v_mul_f32 v32, v27, v32
  v_mul_f32 v33, v27, v33
  v_mul_f32 v34, v27, v34
  v_mul_f32 v35, v27, v35
  v_and_b32 v52, v20, v68
  v_and_b32 v53, v20, v69
  v_and_b32 v54, v20, v70
  v_and_b32 v55, v20, v71
  v_and_b32 v56, v21, v68
  v_and_b32 v57, v21, v69
  v_and_b32 v58, v21, v70
  v_and_b32 v59, v21, v71
  ds_read_b128 v[36:39], v66 offset:24576
  ds_read_b128 v[40:43], v66 offset:25600
  ds_read_b128 v[44:47], v66 offset:26624
  ds_read_b128 v[48:51], v66 offset:27648
  s_waitcnt lgkmcnt(3)
  v_mfma_f32_16x16x32_bf16 v[28:31], v[36:39], v[52:55], v[28:31]
  ds_read_b128 v[36:39], v66 offset:28672
  s_waitcnt lgkmcnt(3)
  v_mfma_f32_16x16x32_bf16 v[32:35], v[40:43], v[52:55], v[32:35]
  ds_read_b128 v[40:43], v66 offset:29696
  v_and_b32 v52, v22, v68
  v_and_b32 v53, v22, v69
  v_and_b32 v54, v22, v70
  v_and_b32 v55, v22, v71
  s_waitcnt lgkmcnt(3)
  v_mfma_f32_16x16x32_bf16 v[28:31], v[44:47], v[56:59], v[28:31]
  ds_read_b128 v[44:47], v66 offset:30720
  s_waitcnt lgkmcnt(3)
  v_mfma_f32_16x16x32_bf16 v[32:35], v[48:51], v[56:59], v[32:35]
  ds_read_b128 v[48:51], v66 offset:31744
  v_and_b32 v56, v23, v68
  v_and_b32 v57, v23, v69
  v_and_b32 v58, v23, v70
  v_and_b32 v59, v23, v71
  s_waitcnt lgkmcnt(3)
  v_mfma_f32_16x16x32_bf16 v[28:31], v[36:39], v[52:55], v[28:31]
  s_waitcnt lgkmcnt(2)
  v_mfma_f32_16x16x32_bf16 v[32:35], v[40:43], v[52:55], v[32:35]
  s_waitcnt lgkmcnt(1)
  v_mfma_f32_16x16x32_bf16 v[28:31], v[44:47], v[56:59], v[28:31]
  s_waitcnt lgkmcnt(0)
  v_mfma_f32_16x16x32_bf16 v[32:35], v[48:51], v[56:59], v[32:35]
  v_mfma_f32_16x16x32_bf16 v[20:23], v[172:175], v[4:7], 0
  v_mfma_f32_16x16x32_bf16 v[24:27], v[188:191], v[4:7], 0
  v_mfma_f32_16x16x32_bf16 v[20:23], v[176:179], v[8:11], v[20:23]
  v_mfma_f32_16x16x32_bf16 v[24:27], v[192:195], v[8:11], v[24:27]
  v_mfma_f32_16x16x32_bf16 v[20:23], v[180:183], v[12:15], v[20:23]
  v_mfma_f32_16x16x32_bf16 v[24:27], v[196:199], v[12:15], v[24:27]
  v_mfma_f32_16x16x32_bf16 v[20:23], v[184:187], v[16:19], v[20:23]
  v_mfma_f32_16x16x32_bf16 v[24:27], v[200:203], v[16:19], v[24:27]
  s_nop 7
  v_permlane32_swap_b32 v20, v24
  v_permlane32_swap_b32 v21, v25
  v_permlane32_swap_b32 v22, v26
  v_permlane32_swap_b32 v23, v27
  v_add_f32_dpp v20, v24, v20 row_ror:8 row_mask:0xf bank_mask:0xf
  v_add_f32_dpp v21, v25, v21 row_ror:8 row_mask:0xf bank_mask:0xf
  v_add_f32_dpp v22, v26, v22 row_ror:8 row_mask:0xf bank_mask:0xf
  v_add_f32_dpp v23, v27, v23 row_ror:8 row_mask:0xf bank_mask:0xf
  v_cvt_pk_bf16_f32 v24, v20, v21
  v_cvt_pk_bf16_f32 v25, v22, v23
  v_perm_b32 v20, v24, s90, v63
  v_perm_b32 v21, v24, s90, v64
  v_perm_b32 v22, v25, s90, v63
  v_perm_b32 v23, v25, s90, v64
  v_max3_f32 v26, v20, v21, v22
  v_max3_f32 v26, v26, v23, s91
  s_nop 1
  v_max_f32_dpp v26, v26, v26 row_ror:8 row_mask:0xf bank_mask:0xf
  s_nop 1
  v_max_f32_dpp v26, v26, v26 row_bcast:15 row_mask:0xa bank_mask:0xf
  s_nop 1
  v_max_f32_dpp v26, v26, v26 row_bcast:31 row_mask:0xc bank_mask:0xf
  s_nop 0
  v_readlane_b32 s91, v26, 63
  s_nop 1
  v_mul_f32 v86, s91, v65
  v_fma_f32 v20, v20, s89, v86
  v_fma_f32 v21, v21, s89, v86
  v_fma_f32 v22, v22, s89, v86
  v_fma_f32 v23, v23, s89, v86
  v_sub_f32 v27, v86, v84
  v_exp_f32 v20, v20
  v_exp_f32 v21, v21
  v_exp_f32 v22, v22
  v_exp_f32 v23, v23
  v_exp_f32 v27, v27
  v_add_f32 v26, v20, v21
  v_add_f32 v24, v22, v23
  v_cvt_pk_bf16_f32 v20, v20, v20
  v_cvt_pk_bf16_f32 v21, v21, v21
  v_cvt_pk_bf16_f32 v22, v22, v22
  v_cvt_pk_bf16_f32 v23, v23, v23
  v_add_f32 v26, v26, v24
  v_fma_f32 v67, v67, v27, v26
  v_mul_f32 v28, v27, v28
  v_mul_f32 v29, v27, v29
  v_mul_f32 v30, v27, v30
  v_mul_f32 v31, v27, v31
  v_mul_f32 v32, v27, v32
  v_mul_f32 v33, v27, v33
  v_mul_f32 v34, v27, v34
  v_mul_f32 v35, v27, v35
  v_and_b32 v52, v20, v68
  v_and_b32 v53, v20, v69
  v_and_b32 v54, v20, v70
  v_and_b32 v55, v20, v71
  v_and_b32 v56, v21, v68
  v_and_b32 v57, v21, v69
  v_and_b32 v58, v21, v70
  v_and_b32 v59, v21, v71
  v_mfma_f32_16x16x32_bf16 v[28:31], v[204:207], v[52:55], v[28:31]
  v_mfma_f32_16x16x32_bf16 v[32:35], v[208:211], v[52:55], v[32:35]
  v_and_b32 v52, v22, v68
  v_and_b32 v53, v22, v69
  v_and_b32 v54, v22, v70
  v_and_b32 v55, v22, v71
  v_mfma_f32_16x16x32_bf16 v[28:31], v[212:215], v[56:59], v[28:31]
  v_mfma_f32_16x16x32_bf16 v[32:35], v[216:219], v[56:59], v[32:35]
  v_and_b32 v56, v23, v68
  v_and_b32 v57, v23, v69
  v_and_b32 v58, v23, v70
  v_and_b32 v59, v23, v71
  v_mfma_f32_16x16x32_bf16 v[28:31], v[220:223], v[52:55], v[28:31]
  v_mfma_f32_16x16x32_bf16 v[32:35], v[224:227], v[52:55], v[32:35]
  v_mfma_f32_16x16x32_bf16 v[28:31], v[228:231], v[56:59], v[28:31]
  v_mfma_f32_16x16x32_bf16 v[32:35], v[232:235], v[56:59], v[32:35]
  v_subrev_u32 v27, s88, v66
  s_nop 6
  v_cndmask_b32 v52, v28, v32, s[50:51]
  v_cndmask_b32 v56, v32, v28, s[50:51]
  v_cndmask_b32 v53, v29, v33, s[50:51]
  v_cndmask_b32 v57, v33, v29, s[50:51]
  v_cndmask_b32 v54, v30, v34, s[50:51]
  v_cndmask_b32 v58, v34, v30, s[50:51]
  v_cndmask_b32 v55, v31, v35, s[50:51]
  v_cndmask_b32 v59, v35, v31, s[50:51]
  v_add_f32_dpp v67, v67, v67 row_ror:8 row_mask:0xf bank_mask:0xf
  v_add_f32_dpp v52, v56, v52 row_ror:8 row_mask:0xf bank_mask:0xf
  v_add_f32_dpp v53, v57, v53 row_ror:8 row_mask:0xf bank_mask:0xf
  v_add_f32_dpp v54, v58, v54 row_ror:8 row_mask:0xf bank_mask:0xf
  v_add_f32_dpp v55, v59, v55 row_ror:8 row_mask:0xf bank_mask:0xf
  v_mov_b32 v24, v67
  s_nop 1
  v_permlane16_swap_b32 v67, v24
  v_add_f32 v67, v67, v24
  v_mov_b32 v24, v67
  s_nop 1
  v_permlane32_swap_b32 v67, v24
  v_add_f32 v25, v67, v24
  v_sub_f32 v24, 0, v86
  s_lshl_b32 s44, s41, 10
  v_add_u32 v56, s44, v27
  ds_write_b128 v56, v[52:55] offset:0
  s_lshl_b32 s44, s41, 3
  v_mov_b32 v57, s44
  ds_write_b64 v57, v[24:25] offset:28672
  v_mov_b32 v58, 28736
  v_mov_b32 v59, 1
  s_waitcnt lgkmcnt(0)
  s_mov_b64 exec, 1
  ds_add_rtn_u32 v57, v58, v59
  s_waitcnt lgkmcnt(0)
  v_readfirstlane_b32 s44, v57
  s_mov_b64 exec, -1
  s_nop 0
  s_cmp_eq_u32 s44, 3
  s_cbranch_scc0 PS_99
  ds_read_b128 v[36:39], v27 offset:0
  ds_read_b128 v[40:43], v27 offset:1024
  ds_read_b128 v[44:47], v27 offset:2048
  ds_read_b128 v[48:51], v27 offset:3072
  v_mov_b32 v56, 0
  ds_read_b128 v[20:23], v56 offset:28672
  ds_read_b128 v[52:55], v56 offset:28688
  v_and_b32 v56, 0x70, v27
  v_lshlrev_b32 v56, 1, v56
  v_and_b32 v57, 0x80, v27
  v_lshl_or_b32 v56, v57, 3, v56
  v_and_b32 v57, 0x300, v27
  v_or_b32 v56, v56, v57
  s_add_u32 s44, s94, 0
  s_waitcnt lgkmcnt(0)
  s_mov_b64 exec, 1
  ds_add_u32 v58, v59
  s_mov_b64 exec, -1
  v_max3_f32 v25, v20, v22, v52
  v_max_f32 v25, v25, v54
  v_sub_f32 v20, v20, v25
  v_sub_f32 v22, v22, v25
  v_sub_f32 v52, v52, v25
  v_sub_f32 v54, v54, v25
  v_exp_f32 v20, v20
  v_exp_f32 v22, v22
  v_exp_f32 v52, v52
  v_exp_f32 v54, v54
  v_mov_b32 v27, s43
  v_mul_f32 v26, v20, v21
  v_fmac_f32 v26, v22, v23
  v_fmac_f32 v26, v52, v53
  v_fmac_f32 v26, v54, v55
  v_mul_f32 v36, v20, v36
  v_mul_f32 v37, v20, v37
  v_mul_f32 v38, v20, v38
  v_mul_f32 v39, v20, v39
  v_fmac_f32 v36, v22, v40
  v_fmac_f32 v37, v22, v41
  v_fmac_f32 v38, v22, v42
  v_fmac_f32 v39, v22, v43
  v_fmac_f32 v36, v52, v44
  v_fmac_f32 v37, v52, v45
  v_fmac_f32 v38, v52, v46
  v_fmac_f32 v39, v52, v47
  v_fmac_f32 v36, v54, v48
  v_fmac_f32 v37, v54, v49
  v_fmac_f32 v38, v54, v50
  v_fmac_f32 v39, v54, v51
  v_mov_b32 v24, v39
  v_mov_b32 v39, s43
  buffer_store_dwordx4 v[36:39], v56, s[32:35], s44 offen sc1
  buffer_store_dwordx4 v[24:27], v56, s[32:35], s44 offen offset:16 sc1
  s_waitcnt lgkmcnt(0)
PS_99:
  s_nop 1
  s_waitcnt vmcnt(0) lgkmcnt(0)
  s_barrier
CL_100:
  s_lshl_b32 s45, s42, 16
  s_lshl_b32 s46, s41, 10
  s_add_u32 s45, s45, s46
  s_add_u32 s45, s45, 0x300000
  v_lshlrev_b32 v84, 8, v78
  s_mov_b32 s49, 0
  s_mov_b64 exec, 0xffff
SP_105:
  buffer_load_dword v85, v84, s[32:35], s45 offen offset:8 sc1
  s_waitcnt vmcnt(0)
  v_cmp_eq_u32 s[54:55], s43, v85
  s_nop 1
  s_bcnt1_i32_b64 s44, s[54:55]
  s_cmp_ge_u32 s44, 6
  s_cbranch_scc1 SG_106
  s_add_u32 s49, s49, 1
  s_cmp_gt_u32 s49, 40000
  s_cbranch_scc1 SG_106
  s_sleep 8
  s_branch SP_105
SG_106:
  s_mov_b32 s49, 0
  s_mov_b64 exec, s[52:53]
  s_mov_b32 s46, 0xffff
GR_103:
  s_bitcmp0_b32 s46, 0
  s_cbranch_scc1 GS_107
  s_add_u32 s44, s45, 0
  buffer_load_dwordx3 v[4:6], v78, s[32:35], s44 offen sc1
GS_107:
  s_bitcmp0_b32 s46, 1
  s_cbranch_scc1 GS_108
  s_add_u32 s44, s45, 4096
  buffer_load_dwordx3 v[8:10], v78, s[32:35], s44 offen sc1
GS_108:
  s_bitcmp0_b32 s46, 2
  s_cbranch_scc1 GS_109
  s_add_u32 s44, s45, 8192
  buffer_load_dwordx3 v[12:14], v78, s[32:35], s44 offen sc1
GS_109:
  s_bitcmp0_b32 s46, 3
  s_cbranch_scc1 GS_110
  s_add_u32 s44, s45, 12288
  buffer_load_dwordx3 v[16:18], v78, s[32:35], s44 offen sc1
GS_110:
  s_bitcmp0_b32 s46, 4
  s_cbranch_scc1 GS_111
  s_add_u32 s44, s45, 16384
  buffer_load_dwordx3 v[20:22], v78, s[32:35], s44 offen sc1
GS_111:
  s_bitcmp0_b32 s46, 5
  s_cbranch_scc1 GS_112
  s_add_u32 s44, s45, 20480
  buffer_load_dwordx3 v[24:26], v78, s[32:35], s44 offen sc1
GS_112:
  s_bitcmp0_b32 s46, 6
  s_cbranch_scc1 GS_113
  s_add_u32 s44, s45, 24576
  buffer_load_dwordx3 v[28:30], v78, s[32:35], s44 offen sc1
GS_113:
  s_bitcmp0_b32 s46, 7
  s_cbranch_scc1 GS_114
  s_add_u32 s44, s45, 28672
  buffer_load_dwordx3 v[32:34], v78, s[32:35], s44 offen sc1
GS_114:
  s_bitcmp0_b32 s46, 8
  s_cbranch_scc1 GS_115
  s_add_u32 s44, s45, 32768
  buffer_load_dwordx3 v[36:38], v78, s[32:35], s44 offen sc1
GS_115:
  s_bitcmp0_b32 s46, 9
  s_cbranch_scc1 GS_116
  s_add_u32 s44, s45, 36864
  buffer_load_dwordx3 v[40:42], v78, s[32:35], s44 offen sc1
GS_116:
  s_bitcmp0_b32 s46, 10
  s_cbranch_scc1 GS_117
  s_add_u32 s44, s45, 40960
  buffer_load_dwordx3 v[44:46], v78, s[32:35], s44 offen sc1
GS_117:
  s_bitcmp0_b32 s46, 11
  s_cbranch_scc1 GS_118
  s_add_u32 s44, s45, 45056
  buffer_load_dwordx3 v[48:50], v78, s[32:35], s44 offen sc1
GS_118:
  s_bitcmp0_b32 s46, 12
  s_cbranch_scc1 GS_119
  s_add_u32 s44, s45, 49152
  buffer_load_dwordx3 v[52:54], v78, s[32:35], s44 offen sc1
GS_119:
  s_bitcmp0_b32 s46, 13
  s_cbranch_scc1 GS_120
  s_add_u32 s44, s45, 53248
  buffer_load_dwordx3 v[56:58], v78, s[32:35], s44 offen sc1
GS_120:
  s_bitcmp0_b32 s46, 14
  s_cbranch_scc1 GS_121
  s_add_u32 s44, s45, 57344
  buffer_load_dwordx3 v[60:62], v78, s[32:35], s44 offen sc1
GS_121:
  s_bitcmp0_b32 s46, 15
  s_cbranch_scc1 GS_122
  s_add_u32 s44, s45, 61440
  buffer_load_dwordx3 v[64:66], v78, s[32:35], s44 offen sc1
GS_122:
  s_waitcnt vmcnt(0)
  v_max3_u32 v84, v6, v10, v14
  v_max3_u32 v84, v84, v18, v22
  v_max3_u32 v84, v84, v26, v30
  v_max3_u32 v84, v84, v34, v38
  v_max3_u32 v84, v84, v42, v46
  v_max3_u32 v84, v84, v50, v54
  v_max3_u32 v84, v84, v58, v62
  v_max3_u32 v84, v84, v66, s43
  v_min3_u32 v85, v6, v10, v14
  v_min3_u32 v85, v85, v18, v22
  v_min3_u32 v85, v85, v26, v30
  v_min3_u32 v85, v85, v34, v38
  v_min3_u32 v85, v85, v42, v46
  v_min3_u32 v85, v85, v50, v54
  v_min3_u32 v85, v85, v58, v62
  v_min3_u32 v85, v85, v66, s43
  v_cmp_ne_u32 s[54:55], v84, v85
  s_nop 1
  s_cmp_eq_u64 s[54:55], 0
  s_cbranch_scc1 GO_104
  s_mov_b32 s46, 0
  v_cmp_ne_u32 s[56:57], s43, v6
  v_cmp_ne_u32 s[54:55], s43, v10
  s_nop 0
  s_cmp_lg_u64 s[56:57], 0
  s_cselect_b32 s44, 1, 0
  s_or_b32 s46, s46, s44
  v_cmp_ne_u32 s[56:57], s43, v14
  s_cmp_lg_u64 s[54:55], 0
  s_cselect_b32 s44, 2, 0
  s_or_b32 s46, s46, s44
  v_cmp_ne_u32 s[54:55], s43, v18
  s_cmp_lg_u64 s[56:57], 0
  s_cselect_b32 s44, 4, 0
  s_or_b32 s46, s46, s44
  v_cmp_ne_u32 s[56:57], s43, v22
  s_cmp_lg_u64 s[54:55], 0
  s_cselect_b32 s44, 8, 0
  s_or_b32 s46, s46, s44
  v_cmp_ne_u32 s[54:55], s43, v26
  s_cmp_lg_u64 s[56:57], 0
  s_cselect_b32 s44, 16, 0
  s_or_b32 s46, s46, s44
  v_cmp_ne_u32 s[56:57], s43, v30
  s_cmp_lg_u64 s[54:55], 0
  s_cselect_b32 s44, 32, 0
  s_or_b32 s46, s46, s44
  v_cmp_ne_u32 s[54:55], s43, v34
  s_cmp_lg_u64 s[56:57], 0
  s_cselect_b32 s44, 64, 0
  s_or_b32 s46, s46, s44
  v_cmp_ne_u32 s[56:57], s43, v38
  s_cmp_lg_u64 s[54:55], 0
  s_cselect_b32 s44, 128, 0
  s_or_b32 s46, s46, s44
  v_cmp_ne_u32 s[54:55], s43, v42
  s_cmp_lg_u64 s[56:57], 0
  s_cselect_b32 s44, 256, 0
  s_or_b32 s46, s46, s44
  v_cmp_ne_u32 s[56:57], s43, v46
  s_cmp_lg_u64 s[54:55], 0
  s_cselect_b32 s44, 512, 0
  s_or_b32 s46, s46, s44
  v_cmp_ne_u32 s[54:55], s43, v50
  s_cmp_lg_u64 s[56:57], 0
  s_cselect_b32 s44, 1024, 0
  s_or_b32 s46, s46, s44
  v_cmp_ne_u32 s[56:57], s43, v54
  s_cmp_lg_u64 s[54:55], 0
  s_cselect_b32 s44, 2048, 0
  s_or_b32 s46, s46, s44
  v_cmp_ne_u32 s[54:55], s43, v58
  s_cmp_lg_u64 s[56:57], 0
  s_cselect_b32 s44, 4096, 0
  s_or_b32 s46, s46, s44
  v_cmp_ne_u32 s[56:57], s43, v62
  s_cmp_lg_u64 s[54:55], 0
  s_cselect_b32 s44, 8192, 0
  s_or_b32 s46, s46, s44
  v_cmp_ne_u32 s[54:55], s43, v66
  s_cmp_lg_u64 s[56:57], 0
  s_cselect_b32 s44, 16384, 0
  s_or_b32 s46, s46, s44
  s_cmp_lg_u64 s[54:55], 0
  s_cselect_b32 s44, 32768, 0
  s_or_b32 s46, s46, s44
  s_add_u32 s49, s49, 1
  s_cmp_gt_u32 s49, 40000
  s_cbranch_scc1 GO_104
  s_sleep 1
  s_branch GR_103
GO_104:
  s_mov_b64 exec, -1
  v_add_f32 v4, v4, v36
  v_add_f32 v5, v5, v37
  v_add_f32 v8, v8, v40
  v_add_f32 v9, v9, v41
  v_add_f32 v12, v12, v44
  v_add_f32 v13, v13, v45
  v_add_f32 v16, v16, v48
  v_add_f32 v17, v17, v49
  v_add_f32 v20, v20, v52
  v_add_f32 v21, v21, v53
  v_add_f32 v24, v24, v56
  v_add_f32 v25, v25, v57
  v_add_f32 v28, v28, v60
  v_add_f32 v29, v29, v61
  v_add_f32 v32, v32, v64
  v_add_f32 v33, v33, v65
  v_add_f32 v4, v4, v20
  v_add_f32 v5, v5, v21
  v_add_f32 v8, v8, v24
  v_add_f32 v9, v9, v25
  v_add_f32 v12, v12, v28
  v_add_f32 v13, v13, v29
  v_add_f32 v16, v16, v32
  v_add_f32 v17, v17, v33
  v_add_f32 v4, v4, v12
  v_add_f32 v5, v5, v13
  v_add_f32 v8, v8, v16
  v_add_f32 v9, v9, v17
  v_add_f32 v4, v4, v8
  v_add_f32 v5, v5, v9
  v_cvt_pk_bf16_f32 v84, v4, v4
  v_and_b32 v4, 0xffff0000, v84
  v_cvt_pk_bf16_f32 v85, v5, v5
  v_and_b32 v5, 0xffff0000, v85
  v_add_f32 v4, v72, v4
  v_add_f32 v5, v73, v5
  v_cvt_pk_bf16_f32 v84, v4, v4
  v_and_b32 v76, 0xffff0000, v84
  v_cvt_pk_bf16_f32 v85, v5, v5
  v_and_b32 v77, 0xffff0000, v85
  v_cndmask_b32 v76, 0, v76, s[52:53]
  v_cndmask_b32 v77, 0, v77, s[52:53]
  v_add_f32 v84, v76, v77
  v_mul_f32 v85, v76, v76
  v_fmac_f32 v85, v77, v77
  v_add_f32_dpp v84, v84, v84 row_ror:1 row_mask:0xf bank_mask:0xf
  s_nop 0
  v_add_f32_dpp v85, v85, v85 row_ror:1 row_mask:0xf bank_mask:0xf
  v_add_f32_dpp v84, v84, v84 row_ror:2 row_mask:0xf bank_mask:0xf
  s_nop 0
  v_add_f32_dpp v85, v85, v85 row_ror:2 row_mask:0xf bank_mask:0xf
  v_add_f32_dpp v84, v84, v84 row_ror:4 row_mask:0xf bank_mask:0xf
  s_nop 0
  v_add_f32_dpp v85, v85, v85 row_ror:4 row_mask:0xf bank_mask:0xf
  v_add_f32_dpp v84, v84, v84 row_ror:8 row_mask:0xf bank_mask:0xf
  s_nop 0
  v_add_f32_dpp v85, v85, v85 row_ror:8 row_mask:0xf bank_mask:0xf
  v_mov_b32 v86, v84
  v_mov_b32 v87, v85
  s_nop 0
  v_permlane16_swap_b32 v84, v86
  v_permlane16_swap_b32 v85, v87
  v_add_f32 v84, v84, v86
  v_add_f32 v85, v85, v87
  v_mov_b32 v86, v84
  v_mov_b32 v87, v85
  s_nop 0
  v_permlane32_swap_b32 v84, v86
  v_permlane32_swap_b32 v85, v87
  v_add_f32 v84, v84, v86
  v_add_f32 v85, v85, v87
  s_lshl_b32 s44, s41, 3
  v_mov_b32 v86, s44
  ds_write_b64 v86, v[84:85] offset:26624
  v_mov_b32 v86, 0
  v_lshrrev_b32 v90, 1, v78
  s_lshl_b32 s44, s41, 9
  v_add_u32 v90, s44, v90
  s_waitcnt lgkmcnt(0)
  s_barrier
  ds_read_b128 v[60:63], v86 offset:26624
  ds_read_b128 v[64:67], v86 offset:26640
  s_waitcnt lgkmcnt(0)
  v_add_f32 v84, v60, v62
  v_add_f32 v85, v61, v63
  v_add_f32 v86, v64, v66
  v_add_f32 v87, v65, v67
  v_add_f32 v84, v84, v86
  v_add_f32 v85, v85, v87
  v_mul_f32 v84, 0x3b124925, v84
  v_mul_f32 v85, 0x3b124925, v85
  v_fma_f32 v85, -v84, v84, v85
  v_max_f32 v85, 0, v85
  v_cvt_pk_bf16_f32 v87, v85, v85
  v_and_b32 v85, 0xffff0000, v87
  v_cvt_pk_bf16_f32 v86, v84, v84
  v_and_b32 v84, 0xffff0000, v86
  v_add_f32 v85, 0x3727c5ac, v85
  v_sub_f32 v88, v76, v84
  v_cvt_pk_bf16_f32 v87, v85, v85
  v_and_b32 v85, 0xffff0000, v87
  v_sub_f32 v89, v77, v84
  v_sqrt_f32 v85, v85
  v_cvt_pk_bf16_f32 v86, v88, v88
  v_and_b32 v88, 0xffff0000, v86
  v_cvt_pk_bf16_f32 v87, v85, v85
  v_and_b32 v85, 0xffff0000, v87
  v_rcp_f32 v85, v85
  v_cvt_pk_bf16_f32 v87, v89, v89
  v_and_b32 v89, 0xffff0000, v87
  v_mul_f32 v88, v88, v85
  v_mul_f32 v89, v89, v85
  v_cvt_pk_bf16_f32 v88, v88, v88
  v_cvt_pk_bf16_f32 v89, v89, v89
  v_cndmask_b32 v88, 0, v88, s[52:53]
  v_cndmask_b32 v89, 0, v89, s[52:53]
  ds_write_b64 v90, v[88:89] offset:24576
  v_and_b32 v86, 0x1ff, v81
  v_lshrrev_b32 v87, 11, v81
  v_lshl_or_b32 v86, v87, 10, v86
  v_lshrrev_b32 v84, 2, v78
  v_and_b32 v85, 0x80, v84
  v_and_b32 v88, 0x7c, v84
  v_lshl_or_b32 v84, v85, 2, v88
  s_lshl_b32 s44, s41, 7
  v_add_u32 v84, s44, v84
  s_lshl_b32 s44, s41, 9
  v_add_u32 v88, s44, v88
  ds_read_b128 v[60:63], v80 offset:24576
  ds_read_b128 v[64:67], v80 offset:24704
  ds_read_b128 v[44:47], v80 offset:24832
  ds_read_b128 v[48:51], v80 offset:24960
  s_waitcnt lgkmcnt(0)
  v_and_b32 v52, v60, v68
  v_and_b32 v53, v60, v69
  v_and_b32 v54, v60, v70
  v_and_b32 v55, v60, v71
  v_and_b32 v56, v61, v68
  v_and_b32 v57, v61, v69
  v_and_b32 v58, v61, v70
  v_and_b32 v59, v61, v71
  v_mfma_f32_16x16x32_bf16 v[4:7], a[0:3], v[52:55], 0
  v_mfma_f32_16x16x32_bf16 v[8:11], a[4:7], v[52:55], 0
  v_mfma_f32_16x16x32_bf16 v[12:15], a[8:11], v[52:55], 0
  v_mfma_f32_16x16x32_bf16 v[16:19], a[12:15], v[52:55], 0
  v_and_b32 v52, v62, v68
  v_and_b32 v53, v62, v69
  v_and_b32 v54, v62, v70
  v_and_b32 v55, v62, v71
  v_mfma_f32_16x16x32_bf16 v[4:7], a[16:19], v[56:59], v[4:7]
  v_mfma_f32_16x16x32_bf16 v[8:11], a[20:23], v[56:59], v[8:11]
  v_mfma_f32_16x16x32_bf16 v[12:15], a[24:27], v[56:59], v[12:15]
  v_mfma_f32_16x16x32_bf16 v[16:19], a[28:31], v[56:59], v[16:19]
  v_and_b32 v56, v63, v68
  v_and_b32 v57, v63, v69
  v_and_b32 v58, v63, v70
  v_and_b32 v59, v63, v71
  v_mfma_f32_16x16x32_bf16 v[4:7], a[32:35], v[52:55], v[4:7]
  v_mfma_f32_16x16x32_bf16 v[8:11], a[36:39], v[52:55], v[8:11]
  v_mfma_f32_16x16x32_bf16 v[12:15], a[40:43], v[52:55], v[12:15]
  v_mfma_f32_16x16x32_bf16 v[16:19], a[44:47], v[52:55], v[16:19]
  v_and_b32 v52, v64, v68
  v_and_b32 v53, v64, v69
  v_and_b32 v54, v64, v70
  v_and_b32 v55, v64, v71
  v_mfma_f32_16x16x32_bf16 v[4:7], a[48:51], v[56:59], v[4:7]
  v_mfma_f32_16x16x32_bf16 v[8:11], a[52:55], v[56:59], v[8:11]
  v_mfma_f32_16x16x32_bf16 v[12:15], a[56:59], v[56:59], v[12:15]
  v_mfma_f32_16x16x32_bf16 v[16:19], a[60:63], v[56:59], v[16:19]
  v_and_b32 v56, v65, v68
  v_and_b32 v57, v65, v69
  v_and_b32 v58, v65, v70
  v_and_b32 v59, v65, v71
  v_mfma_f32_16x16x32_bf16 v[4:7], a[64:67], v[52:55], v[4:7]
  v_mfma_f32_16x16x32_bf16 v[8:11], a[68:71], v[52:55], v[8:11]
  v_mfma_f32_16x16x32_bf16 v[12:15], a[72:75], v[52:55], v[12:15]
  v_mfma_f32_16x16x32_bf16 v[16:19], a[76:79], v[52:55], v[16:19]
  v_and_b32 v52, v66, v68
  v_and_b32 v53, v66, v69
  v_and_b32 v54, v66, v70
  v_and_b32 v55, v66, v71
  v_mfma_f32_16x16x32_bf16 v[4:7], a[80:83], v[56:59], v[4:7]
  v_mfma_f32_16x16x32_bf16 v[8:11], a[84:87], v[56:59], v[8:11]
  v_mfma_f32_16x16x32_bf16 v[12:15], a[88:91], v[56:59], v[12:15]
  v_mfma_f32_16x16x32_bf16 v[16:19], a[92:95], v[56:59], v[16:19]
  v_and_b32 v56, v67, v68
  v_and_b32 v57, v67, v69
  v_and_b32 v58, v67, v70
  v_and_b32 v59, v67, v71
  v_mfma_f32_16x16x32_bf16 v[4:7], a[96:99], v[52:55], v[4:7]
  v_mfma_f32_16x16x32_bf16 v[8:11], a[100:103], v[52:55], v[8:11]
  v_mfma_f32_16x16x32_bf16 v[12:15], a[104:107], v[52:55], v[12:15]
  v_mfma_f32_16x16x32_bf16 v[16:19], a[108:111], v[52:55], v[16:19]
  v_and_b32 v52, v44, v68
  v_and_b32 v53, v44, v69
  v_and_b32 v54, v44, v70
  v_and_b32 v55, v44, v71
  v_mfma_f32_16x16x32_bf16 v[4:7], a[112:115], v[56:59], v[4:7]
  v_mfma_f32_16x16x32_bf16 v[8:11], a[116:119], v[56:59], v[8:11]
  v_mfma_f32_16x16x32_bf16 v[12:15], a[120:123], v[56:59], v[12:15]
  v_mfma_f32_16x16x32_bf16 v[16:19], a[124:127], v[56:59], v[16:19]
  v_and_b32 v56, v45, v68
  v_and_b32 v57, v45, v69
  v_and_b32 v58, v45, v70
  v_and_b32 v59, v45, v71
  v_mfma_f32_16x16x32_bf16 v[4:7], a[128:131], v[52:55], v[4:7]
  v_mfma_f32_16x16x32_bf16 v[8:11], a[132:135], v[52:55], v[8:11]
  v_mfma_f32_16x16x32_bf16 v[12:15], a[136:139], v[52:55], v[12:15]
  v_mfma_f32_16x16x32_bf16 v[16:19], a[140:143], v[52:55], v[16:19]
  v_and_b32 v52, v46, v68
  v_and_b32 v53, v46, v69
  v_and_b32 v54, v46, v70
  v_and_b32 v55, v46, v71
  v_mfma_f32_16x16x32_bf16 v[4:7], a[144:147], v[56:59], v[4:7]
  v_mfma_f32_16x16x32_bf16 v[8:11], a[148:151], v[56:59], v[8:11]
  v_mfma_f32_16x16x32_bf16 v[12:15], a[152:155], v[56:59], v[12:15]
  v_mfma_f32_16x16x32_bf16 v[16:19], a[156:159], v[56:59], v[16:19]
  v_and_b32 v56, v47, v68
  v_and_b32 v57, v47, v69
  v_and_b32 v58, v47, v70
  v_and_b32 v59, v47, v71
  v_mfma_f32_16x16x32_bf16 v[4:7], a[160:163], v[52:55], v[4:7]
  v_mfma_f32_16x16x32_bf16 v[8:11], a[164:167], v[52:55], v[8:11]
  v_mfma_f32_16x16x32_bf16 v[12:15], a[168:171], v[52:55], v[12:15]
  v_mfma_f32_16x16x32_bf16 v[16:19], a[172:175], v[52:55], v[16:19]
  v_and_b32 v52, v48, v68
  v_and_b32 v53, v48, v69
  v_and_b32 v54, v48, v70
  v_and_b32 v55, v48, v71
  v_mfma_f32_16x16x32_bf16 v[4:7], a[176:179], v[56:59], v[4:7]
  v_mfma_f32_16x16x32_bf16 v[8:11], a[180:183], v[56:59], v[8:11]
  v_mfma_f32_16x16x32_bf16 v[12:15], a[184:187], v[56:59], v[12:15]
  v_mfma_f32_16x16x32_bf16 v[16:19], a[188:191], v[56:59], v[16:19]
  v_and_b32 v56, v49, v68
  v_and_b32 v57, v49, v69
  v_and_b32 v58, v49, v70
  v_and_b32 v59, v49, v71
  v_mfma_f32_16x16x32_bf16 v[4:7], a[192:195], v[52:55], v[4:7]
  v_mfma_f32_16x16x32_bf16 v[8:11], a[196:199], v[52:55], v[8:11]
  v_and_b32 v52, v50, v68
  v_and_b32 v53, v50, v69
  v_and_b32 v54, v50, v70
  v_and_b32 v55, v50, v71
  v_mfma_f32_16x16x32_bf16 v[4:7], a[200:203], v[56:59], v[4:7]
  v_mfma_f32_16x16x32_bf16 v[8:11], a[204:207], v[56:59], v[8:11]
  v_and_b32 v56, v51, v68
  v_and_b32 v57, v51, v69
  v_and_b32 v58, v51, v70
  v_and_b32 v59, v51, v71
  v_mfma_f32_16x16x32_bf16 v[4:7], a[208:211], v[52:55], v[4:7]
  v_mfma_f32_16x16x32_bf16 v[8:11], a[212:215], v[52:55], v[8:11]
  v_mfma_f32_16x16x32_bf16 v[4:7], a[216:219], v[56:59], v[4:7]
  v_mfma_f32_16x16x32_bf16 v[8:11], a[220:223], v[56:59], v[8:11]
  s_nop 6
  v_cndmask_b32 v4, v4, v12, s[50:51]
  v_cndmask_b32 v5, v5, v13, s[50:51]
  v_cndmask_b32 v6, v6, v14, s[50:51]
  v_cndmask_b32 v7, v7, v15, s[50:51]
  ds_write_b128 v86, v[4:7] offset:16384
  v_cndmask_b32 v8, v8, v16, s[50:51]
  v_cndmask_b32 v9, v9, v17, s[50:51]
  v_cndmask_b32 v10, v10, v18, s[50:51]
  v_cndmask_b32 v11, v11, v19, s[50:51]
  ds_write_b128 v86, v[8:11] offset:16896
  s_waitcnt lgkmcnt(0)
  s_barrier
  ds_read_b32 v4, v84 offset:16384
  ds_read_b32 v5, v84 offset:17408
  ds_read_b32 v6, v84 offset:18432
  ds_read_b32 v7, v84 offset:19456
  ds_read_b32 v8, v84 offset:20480
  ds_read_b32 v9, v84 offset:21504
  ds_read_b32 v10, v84 offset:22528
  ds_read_b32 v11, v84 offset:23552
  s_waitcnt lgkmcnt(0)
  v_add_f32 v4, v4, v8
  v_add_f32 v5, v5, v9
  v_add_f32 v6, v6, v10
  v_add_f32 v7, v7, v11
  v_add_f32 v4, v4, v6
  v_add_f32 v5, v5, v7
  v_add_f32 v4, v4, v5
  v_cvt_pk_bf16_f32 v5, v4, v4
  v_and_b32 v4, 0xffff0000, v5
  v_mov_b32 v5, v4
  s_nop 1
  v_permlane32_swap_b32 v4, v5
  v_mul_f32 v4, 0xbfb8aa3b, v4
  v_exp_f32 v4, v4
  s_nop 0
  v_add_f32 v4, 1.0, v4
  v_rcp_f32 v4, v4
  s_nop 0
  v_cvt_pk_bf16_f32 v6, v4, v4
  v_and_b32 v4, 0xffff0000, v6
  v_mul_f32 v4, v4, v5
  v_cvt_pk_bf16_f32 v4, v4, v4
  ds_write_b32 v88, v4 offset:24576
  ds_read_b128 v[60:63], v80 offset:24576
  s_waitcnt lgkmcnt(0)
  v_and_b32 v52, v60, v68
  v_and_b32 v53, v60, v69
  v_and_b32 v54, v60, v70
  v_and_b32 v55, v60, v71
  v_and_b32 v56, v61, v68
  v_and_b32 v57, v61, v69
  v_and_b32 v58, v61, v70
  v_and_b32 v59, v61, v71
  v_mfma_f32_16x16x32_bf16 v[4:7], a[224:227], v[52:55], 0
  v_mfma_f32_16x16x32_bf16 v[8:11], a[228:231], v[52:55], 0
  v_mfma_f32_16x16x32_bf16 v[12:15], a[232:235], v[52:55], 0
  v_mfma_f32_16x16x32_bf16 v[16:19], a[236:239], v[52:55], 0
  v_mfma_f32_16x16x32_bf16 v[20:23], a[240:243], v[52:55], 0
  v_mfma_f32_16x16x32_bf16 v[24:27], a[244:247], v[52:55], 0
  v_mfma_f32_16x16x32_bf16 v[28:31], a[248:251], v[52:55], 0
  v_mfma_f32_16x16x32_bf16 v[4:7], a[252:255], v[56:59], v[4:7]
  v_mfma_f32_16x16x32_bf16 v[8:11], v[92:95], v[56:59], v[8:11]
  v_mfma_f32_16x16x32_bf16 v[12:15], v[96:99], v[56:59], v[12:15]
  v_mfma_f32_16x16x32_bf16 v[16:19], v[100:103], v[56:59], v[16:19]
  v_mfma_f32_16x16x32_bf16 v[20:23], v[104:107], v[56:59], v[20:23]
  v_mfma_f32_16x16x32_bf16 v[24:27], v[108:111], v[56:59], v[24:27]
  v_mfma_f32_16x16x32_bf16 v[28:31], v[112:115], v[56:59], v[28:31]
  s_cmp_eq_u32 s41, 3
  s_cbranch_scc1 DS_123
  v_and_b32 v52, v62, v68
  v_and_b32 v53, v62, v69
  v_and_b32 v54, v62, v70
  v_and_b32 v55, v62, v71
  v_and_b32 v56, v63, v68
  v_and_b32 v57, v63, v69
  v_and_b32 v58, v63, v70
  v_and_b32 v59, v63, v71
  v_mfma_f32_16x16x32_bf16 v[4:7], v[116:119], v[52:55], v[4:7]
  v_mfma_f32_16x16x32_bf16 v[8:11], v[120:123], v[52:55], v[8:11]
  v_mfma_f32_16x16x32_bf16 v[12:15], v[124:127], v[52:55], v[12:15]
  v_mfma_f32_16x16x32_bf16 v[16:19], v[128:131], v[52:55], v[16:19]
  v_mfma_f32_16x16x32_bf16 v[20:23], v[132:135], v[52:55], v[20:23]
  v_mfma_f32_16x16x32_bf16 v[24:27], v[136:139], v[52:55], v[24:27]
  v_mfma_f32_16x16x32_bf16 v[28:31], v[140:143], v[52:55], v[28:31]
  v_mfma_f32_16x16x32_bf16 v[4:7], v[144:147], v[56:59], v[4:7]
  v_mfma_f32_16x16x32_bf16 v[8:11], v[148:151], v[56:59], v[8:11]
  v_mfma_f32_16x16x32_bf16 v[12:15], v[152:155], v[56:59], v[12:15]
  v_mfma_f32_16x16x32_bf16 v[16:19], v[156:159], v[56:59], v[16:19]
  v_mfma_f32_16x16x32_bf16 v[20:23], v[160:163], v[56:59], v[20:23]
  v_mfma_f32_16x16x32_bf16 v[24:27], v[164:167], v[56:59], v[24:27]
  v_mfma_f32_16x16x32_bf16 v[28:31], v[168:171], v[56:59], v[28:31]
DS_123:
  v_lshrrev_b32 v84, 1, v78
  s_mul_i32 s44, s41, 448
  v_add_u32 v84, s44, v84
  s_lshl_b32 s44, s42, 16
  s_add_u32 s44, s44, s69
  s_add_u32 s44, s44, 0x340000
  v_cndmask_b32 v4, v4, v16, s[50:51]
  v_cndmask_b32 v5, v5, v17, s[50:51]
  v_cndmask_b32 v6, v6, v18, s[50:51]
  v_cndmask_b32 v7, v7, v19, s[50:51]
  ds_write_b128 v81, v[4:7] offset:0
  v_cndmask_b32 v8, v8, v20, s[50:51]
  v_cndmask_b32 v9, v9, v21, s[50:51]
  v_cndmask_b32 v10, v10, v22, s[50:51]
  v_cndmask_b32 v11, v11, v23, s[50:51]
  ds_write_b128 v81, v[8:11] offset:512
  v_cndmask_b32 v12, v12, v24, s[50:51]
  v_cndmask_b32 v13, v13, v25, s[50:51]
  v_cndmask_b32 v14, v14, v26, s[50:51]
  v_cndmask_b32 v15, v15, v27, s[50:51]
  ds_write_b128 v81, v[12:15] offset:1024
  ds_write_b128 v82, v[28:31] offset:0
  s_waitcnt lgkmcnt(0)
  s_barrier
  ds_read_b64 v[4:5], v84 offset:0
  ds_read_b64 v[6:7], v84 offset:2048
  ds_read_b64 v[8:9], v84 offset:4096
  ds_read_b64 v[10:11], v84 offset:6144
  ds_read_b64 v[12:13], v84 offset:8192
  ds_read_b64 v[14:15], v84 offset:10240
  ds_read_b64 v[16:17], v84 offset:12288
  ds_read_b64 v[18:19], v84 offset:14336
  s_waitcnt lgkmcnt(4)
  v_add_f32 v4, v4, v8
  v_add_f32 v5, v5, v9
  v_add_f32 v6, v6, v10
  v_add_f32 v7, v7, v11
  s_waitcnt lgkmcnt(0)
  v_add_f32 v12, v12, v16
  v_add_f32 v13, v13, v17
  v_add_f32 v14, v14, v18
  v_add_f32 v15, v15, v19
  v_add_f32 v4, v4, v12
  v_add_f32 v5, v5, v13
  v_add_f32 v6, v6, v14
  v_add_f32 v7, v7, v15
  v_add_f32 v4, v4, v6
  v_add_f32 v5, v5, v7
  v_mov_b32 v6, s43
  s_mov_b64 exec, s[52:53]
  buffer_store_dwordx3 v[4:6], v78, s[32:35], s44 offen sc1
  s_mov_b64 exec, -1
  s_cmp_lt_i32 s42, 2
  s_cbranch_scc1 CZ_124
  s_cmp_lg_u32 s40, 0
  s_cbranch_scc1 CX_101
CZ_124:
  s_lshl_b32 s45, s42, 16
  s_lshl_b32 s46, s41, 10
  s_add_u32 s45, s45, s46
  s_add_u32 s45, s45, 0x340000
  s_mov_b32 s49, 0
  s_mov_b64 exec, s[52:53]
  s_mov_b32 s46, 0xffff
GR_125:
  s_bitcmp0_b32 s46, 0
  s_cbranch_scc1 GS_127
  s_add_u32 s44, s45, 0
  buffer_load_dwordx3 v[4:6], v78, s[32:35], s44 offen sc1
GS_127:
  s_bitcmp0_b32 s46, 1
  s_cbranch_scc1 GS_128
  s_add_u32 s44, s45, 4096
  buffer_load_dwordx3 v[8:10], v78, s[32:35], s44 offen sc1
GS_128:
  s_bitcmp0_b32 s46, 2
  s_cbranch_scc1 GS_129
  s_add_u32 s44, s45, 8192
  buffer_load_dwordx3 v[12:14], v78, s[32:35], s44 offen sc1
GS_129:
  s_bitcmp0_b32 s46, 3
  s_cbranch_scc1 GS_130
  s_add_u32 s44, s45, 12288
  buffer_load_dwordx3 v[16:18], v78, s[32:35], s44 offen sc1
GS_130:
  s_bitcmp0_b32 s46, 4
  s_cbranch_scc1 GS_131
  s_add_u32 s44, s45, 16384
  buffer_load_dwordx3 v[20:22], v78, s[32:35], s44 offen sc1
GS_131:
  s_bitcmp0_b32 s46, 5
  s_cbranch_scc1 GS_132
  s_add_u32 s44, s45, 20480
  buffer_load_dwordx3 v[24:26], v78, s[32:35], s44 offen sc1
GS_132:
  s_bitcmp0_b32 s46, 6
  s_cbranch_scc1 GS_133
  s_add_u32 s44, s45, 24576
  buffer_load_dwordx3 v[28:30], v78, s[32:35], s44 offen sc1
GS_133:
  s_bitcmp0_b32 s46, 7
  s_cbranch_scc1 GS_134
  s_add_u32 s44, s45, 28672
  buffer_load_dwordx3 v[32:34], v78, s[32:35], s44 offen sc1
GS_134:
  s_bitcmp0_b32 s46, 8
  s_cbranch_scc1 GS_135
  s_add_u32 s44, s45, 32768
  buffer_load_dwordx3 v[36:38], v78, s[32:35], s44 offen sc1
GS_135:
  s_bitcmp0_b32 s46, 9
  s_cbranch_scc1 GS_136
  s_add_u32 s44, s45, 36864
  buffer_load_dwordx3 v[40:42], v78, s[32:35], s44 offen sc1
GS_136:
  s_bitcmp0_b32 s46, 10
  s_cbranch_scc1 GS_137
  s_add_u32 s44, s45, 40960
  buffer_load_dwordx3 v[44:46], v78, s[32:35], s44 offen sc1
GS_137:
  s_bitcmp0_b32 s46, 11
  s_cbranch_scc1 GS_138
  s_add_u32 s44, s45, 45056
  buffer_load_dwordx3 v[48:50], v78, s[32:35], s44 offen sc1
GS_138:
  s_bitcmp0_b32 s46, 12
  s_cbranch_scc1 GS_139
  s_add_u32 s44, s45, 49152
  buffer_load_dwordx3 v[52:54], v78, s[32:35], s44 offen sc1
GS_139:
  s_bitcmp0_b32 s46, 13
  s_cbranch_scc1 GS_140
  s_add_u32 s44, s45, 53248
  buffer_load_dwordx3 v[56:58], v78, s[32:35], s44 offen sc1
GS_140:
  s_bitcmp0_b32 s46, 14
  s_cbranch_scc1 GS_141
  s_add_u32 s44, s45, 57344
  buffer_load_dwordx3 v[60:62], v78, s[32:35], s44 offen sc1
GS_141:
  s_bitcmp0_b32 s46, 15
  s_cbranch_scc1 GS_142
  s_add_u32 s44, s45, 61440
  buffer_load_dwordx3 v[64:66], v78, s[32:35], s44 offen sc1
GS_142:
  s_waitcnt vmcnt(0)
  v_max3_u32 v84, v6, v10, v14
  v_max3_u32 v84, v84, v18, v22
  v_max3_u32 v84, v84, v26, v30
  v_max3_u32 v84, v84, v34, v38
  v_max3_u32 v84, v84, v42, v46
  v_max3_u32 v84, v84, v50, v54
  v_max3_u32 v84, v84, v58, v62
  v_max3_u32 v84, v84, v66, s43
  v_min3_u32 v85, v6, v10, v14
  v_min3_u32 v85, v85, v18, v22
  v_min3_u32 v85, v85, v26, v30
  v_min3_u32 v85, v85, v34, v38
  v_min3_u32 v85, v85, v42, v46
  v_min3_u32 v85, v85, v50, v54
  v_min3_u32 v85, v85, v58, v62
  v_min3_u32 v85, v85, v66, s43
  v_cmp_ne_u32 s[54:55], v84, v85
  s_nop 1
  s_cmp_eq_u64 s[54:55], 0
  s_cbranch_scc1 GO_126
  s_mov_b32 s46, 0
  v_cmp_ne_u32 s[56:57], s43, v6
  v_cmp_ne_u32 s[54:55], s43, v10
  s_nop 0
  s_cmp_lg_u64 s[56:57], 0
  s_cselect_b32 s44, 1, 0
  s_or_b32 s46, s46, s44
  v_cmp_ne_u32 s[56:57], s43, v14
  s_cmp_lg_u64 s[54:55], 0
  s_cselect_b32 s44, 2, 0
  s_or_b32 s46, s46, s44
  v_cmp_ne_u32 s[54:55], s43, v18
  s_cmp_lg_u64 s[56:57], 0
  s_cselect_b32 s44, 4, 0
  s_or_b32 s46, s46, s44
  v_cmp_ne_u32 s[56:57], s43, v22
  s_cmp_lg_u64 s[54:55], 0
  s_cselect_b32 s44, 8, 0
  s_or_b32 s46, s46, s44
  v_cmp_ne_u32 s[54:55], s43, v26
  s_cmp_lg_u64 s[56:57], 0
  s_cselect_b32 s44, 16, 0
  s_or_b32 s46, s46, s44
  v_cmp_ne_u32 s[56:57], s43, v30
  s_cmp_lg_u64 s[54:55], 0
  s_cselect_b32 s44, 32, 0
  s_or_b32 s46, s46, s44
  v_cmp_ne_u32 s[54:55], s43, v34
  s_cmp_lg_u64 s[56:57], 0
  s_cselect_b32 s44, 64, 0
  s_or_b32 s46, s46, s44
  v_cmp_ne_u32 s[56:57], s43, v38
  s_cmp_lg_u64 s[54:55], 0
  s_cselect_b32 s44, 128, 0
  s_or_b32 s46, s46, s44
  v_cmp_ne_u32 s[54:55], s43, v42
  s_cmp_lg_u64 s[56:57], 0
  s_cselect_b32 s44, 256, 0
  s_or_b32 s46, s46, s44
  v_cmp_ne_u32 s[56:57], s43, v46
  s_cmp_lg_u64 s[54:55], 0
  s_cselect_b32 s44, 512, 0
  s_or_b32 s46, s46, s44
  v_cmp_ne_u32 s[54:55], s43, v50
  s_cmp_lg_u64 s[56:57], 0
  s_cselect_b32 s44, 1024, 0
  s_or_b32 s46, s46, s44
  v_cmp_ne_u32 s[56:57], s43, v54
  s_cmp_lg_u64 s[54:55], 0
  s_cselect_b32 s44, 2048, 0
  s_or_b32 s46, s46, s44
  v_cmp_ne_u32 s[54:55], s43, v58
  s_cmp_lg_u64 s[56:57], 0
  s_cselect_b32 s44, 4096, 0
  s_or_b32 s46, s46, s44
  v_cmp_ne_u32 s[56:57], s43, v62
  s_cmp_lg_u64 s[54:55], 0
  s_cselect_b32 s44, 8192, 0
  s_or_b32 s46, s46, s44
  v_cmp_ne_u32 s[54:55], s43, v66
  s_cmp_lg_u64 s[56:57], 0
  s_cselect_b32 s44, 16384, 0
  s_or_b32 s46, s46, s44
  s_cmp_lg_u64 s[54:55], 0
  s_cselect_b32 s44, 32768, 0
  s_or_b32 s46, s46, s44
  s_add_u32 s49, s49, 1
  s_cmp_gt_u32 s49, 40000
  s_cbranch_scc1 GO_126
  s_sleep 1
  s_branch GR_125
GO_126:
  s_mov_b64 exec, -1
  v_add_f32 v4, v4, v36
  v_add_f32 v5, v5, v37
  v_add_f32 v8, v8, v40
  v_add_f32 v9, v9, v41
  v_add_f32 v12, v12, v44
  v_add_f32 v13, v13, v45
  v_add_f32 v16, v16, v48
  v_add_f32 v17, v17, v49
  v_add_f32 v20, v20, v52
  v_add_f32 v21, v21, v53
  v_add_f32 v24, v24, v56
  v_add_f32 v25, v25, v57
  v_add_f32 v28, v28, v60
  v_add_f32 v29, v29, v61
  v_add_f32 v32, v32, v64
  v_add_f32 v33, v33, v65
  v_add_f32 v4, v4, v20
  v_add_f32 v5, v5, v21
  v_add_f32 v8, v8, v24
  v_add_f32 v9, v9, v25
  v_add_f32 v12, v12, v28
  v_add_f32 v13, v13, v29
  v_add_f32 v16, v16, v32
  v_add_f32 v17, v17, v33
  v_add_f32 v4, v4, v12
  v_add_f32 v5, v5, v13
  v_add_f32 v8, v8, v16
  v_add_f32 v9, v9, v17
  v_add_f32 v4, v4, v8
  v_add_f32 v5, v5, v9
  v_cvt_pk_bf16_f32 v84, v4, v4
  v_and_b32 v4, 0xffff0000, v84
  v_cvt_pk_bf16_f32 v85, v5, v5
  v_and_b32 v5, 0xffff0000, v85
  v_add_f32 v4, v76, v4
  v_add_f32 v5, v77, v5
  v_cvt_pk_bf16_f32 v84, v4, v4
  v_and_b32 v72, 0xffff0000, v84
  v_cvt_pk_bf16_f32 v85, v5, v5
  v_and_b32 v73, 0xffff0000, v85
  v_cndmask_b32 v72, 0, v72, s[52:53]
  v_cndmask_b32 v73, 0, v73, s[52:53]
  s_cmp_lt_i32 s42, 2
  s_cbranch_scc1 CX_101
  s_sub_u32 s44, s42, 2
  s_mul_i32 s44, s44, 896
  s_mov_b64 exec, s[52:53]
  buffer_store_short v84, v0, s[28:31], s44 offen
  buffer_store_short v85, v0, s[28:31], s44 offen offset:16
  s_mov_b64 exec, -1
CX_101:
  v_swap_b32 v72, v74
  v_swap_b32 v73, v75
  s_add_u32 s42, s42, 1
  s_cmp_ge_i32 s42, 4
  s_cbranch_scc1 CE_102
  s_waitcnt lgkmcnt(0)
  s_barrier
  s_cmp_gt_i32 s42, 2
  s_cbranch_scc1 CL_100
  s_cmp_eq_u32 s42, 2
  s_cbranch_scc1 MS_143
  s_waitcnt vmcnt(0)
  v_and_b32 v60, 0x70, v78
  v_lshlrev_b32 v60, 5, v60
  v_and_b32 v20, 0x80, v78
  v_lshrrev_b32 v20, 1, v20
  v_or_b32 v60, v60, v20
  v_and_b32 v20, 0x300, v78
  v_lshrrev_b32 v21, 4, v20
  v_or_b32 v60, v60, v21
  v_xor_b32 v61, 0x1040, v60
  v_lshlrev_b32 v62, 3, v20
  v_and_b32 v20, 0xf0, v78
  v_or_b32 v62, v62, v20
  v_add_u32 v66, s88, v78
  v_mov_b32 v65, 0xbdb8aa3b
  v_lshrrev_b32 v21, 2, v78
  v_xor_b32 v21, v21, v78
  v_and_b32 v21, 0x80, v21
  v_cmp_eq_u32 s[54:55], 0, v21
  v_mov_b32 v20, 0x03020100
  v_mov_b32 v63, 0x05040c0c
  v_mov_b32 v64, 0x07060c0c
  v_cndmask_b32 v63, v20, v63, s[54:55]
  v_cndmask_b32 v64, v20, v64, s[54:55]
  s_add_u32 s44, s93, 32768
  v_subrev_u32 v52, s88, v66
  buffer_load_dwordx4 v[240:243], v52, s[32:35], s44 offen sc1
  s_waitcnt vmcnt(0)
  v_mov_b32 v20, v240
  v_mov_b32 v21, v241
  v_mov_b32 v22, v242
  v_mov_b32 v23, v243
  s_mov_b32 s49, 0
  s_branch QC_145
QR_144:
  s_add_u32 s44, s93, 32768
  v_subrev_u32 v20, s88, v66
  buffer_load_dwordx4 v[20:23], v20, s[32:35], s44 offen sc1
  s_waitcnt vmcnt(0)
QC_145:
  v_cmp_eq_u32 s[54:55], s43, v21
  v_cmp_eq_u32 s[56:57], s43, v23
  s_nop 1
  s_and_b64 s[54:55], s[54:55], s[56:57]
  s_cmp_eq_u64 s[54:55], -1
  s_cbranch_scc1 QO_146
  s_add_u32 s49, s49, 1
  s_cmp_gt_u32 s49, 40000
  s_cbranch_scc1 QO_146
  s_sleep 8
  s_branch QR_144
QO_146:
  v_subrev_u32 v52, s88, v66
  v_lshrrev_b32 v52, 1, v52
  v_add_u32 v52, 27648, v52
  ds_write2_b32 v52, v20, v22 offset0:0 offset1:1
  s_waitcnt lgkmcnt(0)
  v_and_b32 v52, 0x70, v60
  ds_read_b128 v[4:7], v52 offset:27648
  ds_read_b128 v[8:11], v52 offset:27776
  ds_read_b128 v[12:15], v52 offset:27904
  ds_read_b128 v[16:19], v52 offset:28032
  s_waitcnt lgkmcnt(0)
  ds_read_b128 v[36:39], v66 offset:0
  ds_read_b128 v[40:43], v66 offset:4096
  ds_read_b128 v[44:47], v66 offset:1024
  ds_read_b128 v[48:51], v66 offset:5120
  s_waitcnt lgkmcnt(3)
  v_mfma_f32_16x16x32_bf16 v[20:23], v[36:39], v[4:7], 0
  ds_read_b128 v[36:39], v66 offset:2048
  s_waitcnt lgkmcnt(3)
  v_mfma_f32_16x16x32_bf16 v[24:27], v[40:43], v[4:7], 0
  ds_read_b128 v[40:43], v66 offset:6144
  s_waitcnt lgkmcnt(3)
  v_mfma_f32_16x16x32_bf16 v[20:23], v[44:47], v[8:11], v[20:23]
  ds_read_b128 v[44:47], v66 offset:3072
  s_waitcnt lgkmcnt(3)
  v_mfma_f32_16x16x32_bf16 v[24:27], v[48:51], v[8:11], v[24:27]
  ds_read_b128 v[48:51], v66 offset:7168
  s_waitcnt lgkmcnt(3)
  v_mfma_f32_16x16x32_bf16 v[20:23], v[36:39], v[12:15], v[20:23]
  s_waitcnt lgkmcnt(2)
  v_mfma_f32_16x16x32_bf16 v[24:27], v[40:43], v[12:15], v[24:27]
  s_waitcnt lgkmcnt(1)
  v_mfma_f32_16x16x32_bf16 v[20:23], v[44:47], v[16:19], v[20:23]
  s_waitcnt lgkmcnt(0)
  v_mfma_f32_16x16x32_bf16 v[24:27], v[48:51], v[16:19], v[24:27]
  s_add_u32 s86, s85, 0
  s_add_u32 m0, s88, 0x0
  s_nop 0
  buffer_load_dwordx4 v60, s[76:79], s86 offen nt lds
  s_add_u32 m0, s88, 0x380
  s_nop 0
  buffer_load_dwordx4 v60, s[76:79], s86 offen offset:128 nt lds
  s_add_u32 m0, s88, 0x700
  s_nop 0
  buffer_load_dwordx4 v60, s[76:79], s86 offen offset:256 nt lds
  s_add_u32 m0, s88, 0xa80
  s_nop 0
  buffer_load_dwordx4 v60, s[76:79], s86 offen offset:384 nt lds
  s_add_u32 m0, s88, 0x1000
  s_nop 0
  buffer_load_dwordx4 v61, s[76:79], s86 offen nt lds
  s_add_u32 m0, s88, 0x1380
  s_nop 0
  buffer_load_dwordx4 v61, s[76:79], s86 offen offset:128 nt lds
  s_add_u32 m0, s88, 0x1700
  s_nop 0
  buffer_load_dwordx4 v61, s[76:79], s86 offen offset:256 nt lds
  s_add_u32 m0, s88, 0x1a80
  s_nop 0
  buffer_load_dwordx4 v61, s[76:79], s86 offen offset:384 nt lds
  s_add_u32 s87, s85, 0
  buffer_load_dwordx4 v[244:247], v62, s[80:83], s87 offen nt
  buffer_load_dwordx4 v[248:251], v62, s[80:83], s87 offen offset:256 nt
  buffer_load_dwordx4 v[252:255], v62, s[80:83], s87 offen offset:512 nt
  buffer_load_dwordx4 v[236:239], v62, s[80:83], s87 offen offset:768 nt
  buffer_load_dwordx4 v[240:243], v62, s[80:83], s87 offen offset:1024 nt
  v_permlane32_swap_b32 v20, v24
  v_permlane32_swap_b32 v21, v25
  v_permlane32_swap_b32 v22, v26
  v_permlane32_swap_b32 v23, v27
  v_add_f32_dpp v20, v24, v20 row_ror:8 row_mask:0xf bank_mask:0xf
  v_add_f32_dpp v21, v25, v21 row_ror:8 row_mask:0xf bank_mask:0xf
  v_add_f32_dpp v22, v26, v22 row_ror:8 row_mask:0xf bank_mask:0xf
  v_add_f32_dpp v23, v27, v23 row_ror:8 row_mask:0xf bank_mask:0xf
  v_cvt_pk_bf16_f32 v24, v20, v21
  v_cvt_pk_bf16_f32 v25, v22, v23
  v_perm_b32 v20, v24, s90, v63
  v_perm_b32 v21, v24, s90, v64
  v_perm_b32 v22, v25, s90, v63
  v_perm_b32 v23, v25, s90, v64
  v_max3_f32 v26, v20, v21, v22
  v_max_f32 v26, v26, v23
  s_nop 1
  v_max_f32_dpp v26, v26, v26 row_ror:8 row_mask:0xf bank_mask:0xf
  s_nop 1
  v_max_f32_dpp v26, v26, v26 row_bcast:15 row_mask:0xa bank_mask:0xf
  s_nop 1
  v_max_f32_dpp v26, v26, v26 row_bcast:31 row_mask:0xc bank_mask:0xf
  s_nop 0
  v_readlane_b32 s91, v26, 63
  s_nop 1
  v_mul_f32 v84, s91, v65
  v_fma_f32 v20, v20, s89, v84
  v_fma_f32 v21, v21, s89, v84
  v_fma_f32 v22, v22, s89, v84
  v_fma_f32 v23, v23, s89, v84
  v_exp_f32 v20, v20
  v_exp_f32 v21, v21
  v_exp_f32 v22, v22
  v_exp_f32 v23, v23
  v_add_f32 v26, v20, v21
  v_add_f32 v24, v22, v23
  v_cvt_pk_bf16_f32 v20, v20, v20
  v_cvt_pk_bf16_f32 v21, v21, v21
  v_cvt_pk_bf16_f32 v22, v22, v22
  v_cvt_pk_bf16_f32 v23, v23, v23
  v_add_f32 v67, v26, v24
  v_and_b32 v52, v20, v68
  v_and_b32 v53, v20, v69
  v_and_b32 v54, v20, v70
  v_and_b32 v55, v20, v71
  v_and_b32 v56, v21, v68
  v_and_b32 v57, v21, v69
  v_and_b32 v58, v21, v70
  v_and_b32 v59, v21, v71
  ds_read_b128 v[36:39], v66 offset:8192
  ds_read_b128 v[40:43], v66 offset:9216
  ds_read_b128 v[44:47], v66 offset:10240
  ds_read_b128 v[48:51], v66 offset:11264
  s_waitcnt lgkmcnt(3)
  v_mfma_f32_16x16x32_bf16 v[28:31], v[36:39], v[52:55], 0
  ds_read_b128 v[36:39], v66 offset:12288
  s_waitcnt lgkmcnt(3)
  v_mfma_f32_16x16x32_bf16 v[32:35], v[40:43], v[52:55], 0
  ds_read_b128 v[40:43], v66 offset:13312
  v_and_b32 v52, v22, v68
  v_and_b32 v53, v22, v69
  v_and_b32 v54, v22, v70
  v_and_b32 v55, v22, v71
  s_waitcnt lgkmcnt(3)
  v_mfma_f32_16x16x32_bf16 v[28:31], v[44:47], v[56:59], v[28:31]
  ds_read_b128 v[44:47], v66 offset:14336
  s_waitcnt lgkmcnt(3)
  v_mfma_f32_16x16x32_bf16 v[32:35], v[48:51], v[56:59], v[32:35]
  ds_read_b128 v[48:51], v66 offset:15360
  v_and_b32 v56, v23, v68
  v_and_b32 v57, v23, v69
  v_and_b32 v58, v23, v70
  v_and_b32 v59, v23, v71
  s_waitcnt lgkmcnt(3)
  v_mfma_f32_16x16x32_bf16 v[28:31], v[36:39], v[52:55], v[28:31]
  s_waitcnt lgkmcnt(2)
  v_mfma_f32_16x16x32_bf16 v[32:35], v[40:43], v[52:55], v[32:35]
  s_waitcnt lgkmcnt(1)
  v_mfma_f32_16x16x32_bf16 v[28:31], v[44:47], v[56:59], v[28:31]
  s_waitcnt lgkmcnt(0)
  v_mfma_f32_16x16x32_bf16 v[32:35], v[48:51], v[56:59], v[32:35]
  s_add_u32 m0, s88, 0x1b00
  s_nop 0
  buffer_load_dwordx4 v62, s[80:83], s87 offen offset:1280 nt lds
  s_add_u32 m0, s88, 0x1e00
  s_nop 0
  buffer_load_dwordx4 v62, s[80:83], s87 offen offset:1536 nt lds
  s_add_u32 m0, s88, 0x2100
  s_nop 0
  buffer_load_dwordx4 v62, s[80:83], s87 offen offset:1792 nt lds
  s_add_u32 s86, s85, 32768
  s_add_u32 m0, s88, 0x2c00
  s_nop 0
  buffer_load_dwordx4 v60, s[76:79], s86 offen nt lds
  s_add_u32 m0, s88, 0x2f80
  s_nop 0
  buffer_load_dwordx4 v60, s[76:79], s86 offen offset:128 nt lds
  s_add_u32 m0, s88, 0x3300
  s_nop 0
  buffer_load_dwordx4 v60, s[76:79], s86 offen offset:256 nt lds
  s_add_u32 m0, s88, 0x3680
  s_nop 0
  buffer_load_dwordx4 v60, s[76:79], s86 offen offset:384 nt lds
  s_add_u32 m0, s88, 0x3c00
  s_nop 0
  buffer_load_dwordx4 v61, s[76:79], s86 offen nt lds
  ds_read_b128 v[36:39], v66 offset:16384
  ds_read_b128 v[40:43], v66 offset:20480
  ds_read_b128 v[44:47], v66 offset:17408
  ds_read_b128 v[48:51], v66 offset:21504
  s_waitcnt lgkmcnt(3)
  v_mfma_f32_16x16x32_bf16 v[20:23], v[36:39], v[4:7], 0
  ds_read_b128 v[36:39], v66 offset:18432
  s_waitcnt lgkmcnt(3)
  v_mfma_f32_16x16x32_bf16 v[24:27], v[40:43], v[4:7], 0
  ds_read_b128 v[40:43], v66 offset:22528
  s_waitcnt lgkmcnt(3)
  v_mfma_f32_16x16x32_bf16 v[20:23], v[44:47], v[8:11], v[20:23]
  ds_read_b128 v[44:47], v66 offset:19456
  s_waitcnt lgkmcnt(3)
  v_mfma_f32_16x16x32_bf16 v[24:27], v[48:51], v[8:11], v[24:27]
  ds_read_b128 v[48:51], v66 offset:23552
  s_waitcnt lgkmcnt(3)
  v_mfma_f32_16x16x32_bf16 v[20:23], v[36:39], v[12:15], v[20:23]
  s_waitcnt lgkmcnt(2)
  v_mfma_f32_16x16x32_bf16 v[24:27], v[40:43], v[12:15], v[24:27]
  s_waitcnt lgkmcnt(1)
  v_mfma_f32_16x16x32_bf16 v[20:23], v[44:47], v[16:19], v[20:23]
  s_waitcnt lgkmcnt(0)
  v_mfma_f32_16x16x32_bf16 v[24:27], v[48:51], v[16:19], v[24:27]
  s_add_u32 m0, s88, 0x3f80
  s_nop 0
  buffer_load_dwordx4 v61, s[76:79], s86 offen offset:128 nt lds
  s_add_u32 m0, s88, 0x4300
  s_nop 0
  buffer_load_dwordx4 v61, s[76:79], s86 offen offset:256 nt lds
  s_add_u32 m0, s88, 0x4680
  s_nop 0
  buffer_load_dwordx4 v61, s[76:79], s86 offen offset:384 nt lds
  s_waitcnt vmcnt(19)
  s_add_u32 s87, s85, 32768
  s_add_u32 m0, s88, 0x4c00
  s_nop 0
  buffer_load_dwordx4 v62, s[80:83], s87 offen nt lds
  s_add_u32 m0, s88, 0x4f00
  s_nop 0
  buffer_load_dwordx4 v62, s[80:83], s87 offen offset:256 nt lds
  s_add_u32 m0, s88, 0x5200
  s_nop 0
  buffer_load_dwordx4 v62, s[80:83], s87 offen offset:512 nt lds
  s_add_u32 m0, s88, 0x5500
  s_nop 0
  buffer_load_dwordx4 v62, s[80:83], s87 offen offset:768 nt lds
  s_add_u32 m0, s88, 0x5800
  s_nop 0
  buffer_load_dwordx4 v62, s[80:83], s87 offen offset:1024 nt lds
  v_permlane32_swap_b32 v20, v24
  v_permlane32_swap_b32 v21, v25
  v_permlane32_swap_b32 v22, v26
  v_permlane32_swap_b32 v23, v27
  v_add_f32_dpp v20, v24, v20 row_ror:8 row_mask:0xf bank_mask:0xf
  v_add_f32_dpp v21, v25, v21 row_ror:8 row_mask:0xf bank_mask:0xf
  v_add_f32_dpp v22, v26, v22 row_ror:8 row_mask:0xf bank_mask:0xf
  v_add_f32_dpp v23, v27, v23 row_ror:8 row_mask:0xf bank_mask:0xf
  v_cvt_pk_bf16_f32 v24, v20, v21
  v_cvt_pk_bf16_f32 v25, v22, v23
  v_perm_b32 v20, v24, s90, v63
  v_perm_b32 v21, v24, s90, v64
  v_perm_b32 v22, v25, s90, v63
  v_perm_b32 v23, v25, s90, v64
  v_max3_f32 v26, v20, v21, v22
  v_max3_f32 v26, v26, v23, s91
  s_nop 1
  v_max_f32_dpp v26, v26, v26 row_ror:8 row_mask:0xf bank_mask:0xf
  s_nop 1
  v_max_f32_dpp v26, v26, v26 row_bcast:15 row_mask:0xa bank_mask:0xf
  s_nop 1
  v_max_f32_dpp v26, v26, v26 row_bcast:31 row_mask:0xc bank_mask:0xf
  s_nop 0
  v_readlane_b32 s91, v26, 63
  s_nop 1
  v_mul_f32 v86, s91, v65
  v_fma_f32 v20, v20, s89, v86
  v_fma_f32 v21, v21, s89, v86
  v_fma_f32 v22, v22, s89, v86
  v_fma_f32 v23, v23, s89, v86
  v_sub_f32 v27, v86, v84
  v_exp_f32 v20, v20
  v_exp_f32 v21, v21
  v_exp_f32 v22, v22
  v_exp_f32 v23, v23
  v_exp_f32 v27, v27
  v_add_f32 v26, v20, v21
  v_add_f32 v24, v22, v23
  v_cvt_pk_bf16_f32 v20, v20, v20
  v_cvt_pk_bf16_f32 v21, v21, v21
  v_cvt_pk_bf16_f32 v22, v22, v22
  v_cvt_pk_bf16_f32 v23, v23, v23
  v_add_f32 v26, v26, v24
  v_fma_f32 v67, v67, v27, v26
  v_mul_f32 v28, v27, v28
  v_mul_f32 v29, v27, v29
  v_mul_f32 v30, v27, v30
  v_mul_f32 v31, v27, v31
  v_mul_f32 v32, v27, v32
  v_mul_f32 v33, v27, v33
  v_mul_f32 v34, v27, v34
  v_mul_f32 v35, v27, v35
  v_and_b32 v52, v20, v68
  v_and_b32 v53, v20, v69
  v_and_b32 v54, v20, v70
  v_and_b32 v55, v20, v71
  v_and_b32 v56, v21, v68
  v_and_b32 v57, v21, v69
  v_and_b32 v58, v21, v70
  v_and_b32 v59, v21, v71
  ds_read_b128 v[36:39], v66 offset:24576
  ds_read_b128 v[40:43], v66 offset:25600
  ds_read_b128 v[44:47], v66 offset:26624
  ds_read_b128 v[48:51], v66 offset:27648
  s_waitcnt lgkmcnt(3)
  v_mfma_f32_16x16x32_bf16 v[28:31], v[36:39], v[52:55], v[28:31]
  ds_read_b128 v[36:39], v66 offset:28672
  s_waitcnt lgkmcnt(3)
  v_mfma_f32_16x16x32_bf16 v[32:35], v[40:43], v[52:55], v[32:35]
  ds_read_b128 v[40:43], v66 offset:29696
  v_and_b32 v52, v22, v68
  v_and_b32 v53, v22, v69
  v_and_b32 v54, v22, v70
  v_and_b32 v55, v22, v71
  s_waitcnt lgkmcnt(3)
  v_mfma_f32_16x16x32_bf16 v[28:31], v[44:47], v[56:59], v[28:31]
  ds_read_b128 v[44:47], v66 offset:30720
  s_waitcnt lgkmcnt(3)
  v_mfma_f32_16x16x32_bf16 v[32:35], v[48:51], v[56:59], v[32:35]
  ds_read_b128 v[48:51], v66 offset:31744
  v_and_b32 v56, v23, v68
  v_and_b32 v57, v23, v69
  v_and_b32 v58, v23, v70
  v_and_b32 v59, v23, v71
  s_waitcnt lgkmcnt(3)
  v_mfma_f32_16x16x32_bf16 v[28:31], v[36:39], v[52:55], v[28:31]
  s_waitcnt lgkmcnt(2)
  v_mfma_f32_16x16x32_bf16 v[32:35], v[40:43], v[52:55], v[32:35]
  s_waitcnt lgkmcnt(1)
  v_mfma_f32_16x16x32_bf16 v[28:31], v[44:47], v[56:59], v[28:31]
  s_waitcnt lgkmcnt(0)
  v_mfma_f32_16x16x32_bf16 v[32:35], v[48:51], v[56:59], v[32:35]
  s_waitcnt vmcnt(16)
  s_add_u32 m0, s88, 0x5b00
  s_nop 0
  buffer_load_dwordx4 v62, s[80:83], s87 offen offset:1280 nt lds
  s_add_u32 m0, s88, 0x5e00
  s_nop 0
  buffer_load_dwordx4 v62, s[80:83], s87 offen offset:1536 nt lds
  s_add_u32 m0, s88, 0x6100
  s_nop 0
  buffer_load_dwordx4 v62, s[80:83], s87 offen offset:1792 nt lds
  s_add_u32 s86, s85, 65536
  s_add_u32 m0, s88, 0x6c00
  s_nop 0
  buffer_load_dwordx4 v60, s[76:79], s86 offen nt lds
  s_add_u32 m0, s88, 0x6f80
  s_nop 0
  buffer_load_dwordx4 v60, s[76:79], s86 offen offset:128 nt lds
  s_add_u32 m0, s88, 0x7300
  s_nop 0
  buffer_load_dwordx4 v60, s[76:79], s86 offen offset:256 nt lds
  s_add_u32 m0, s88, 0x7680
  s_nop 0
  buffer_load_dwordx4 v60, s[76:79], s86 offen offset:384 nt lds
  s_add_u32 m0, s88, 0x7c00
  s_nop 0
  buffer_load_dwordx4 v61, s[76:79], s86 offen nt lds
  v_mfma_f32_16x16x32_bf16 v[20:23], v[172:175], v[4:7], 0
  v_mfma_f32_16x16x32_bf16 v[24:27], v[188:191], v[4:7], 0
  v_mfma_f32_16x16x32_bf16 v[20:23], v[176:179], v[8:11], v[20:23]
  v_mfma_f32_16x16x32_bf16 v[24:27], v[192:195], v[8:11], v[24:27]
  v_mfma_f32_16x16x32_bf16 v[20:23], v[180:183], v[12:15], v[20:23]
  v_mfma_f32_16x16x32_bf16 v[24:27], v[196:199], v[12:15], v[24:27]
  v_mfma_f32_16x16x32_bf16 v[20:23], v[184:187], v[16:19], v[20:23]
  v_mfma_f32_16x16x32_bf16 v[24:27], v[200:203], v[16:19], v[24:27]
  s_waitcnt vmcnt(16)
  buffer_load_dwordx4 v[172:175], v61, s[76:79], s86 offen offset:128 nt
  buffer_load_dwordx4 v[176:179], v61, s[76:79], s86 offen offset:256 nt
  buffer_load_dwordx4 v[180:183], v61, s[76:79], s86 offen offset:384 nt
  s_add_u32 s87, s85, 65536
  buffer_load_dwordx4 v[184:187], v62, s[80:83], s87 offen nt
  buffer_load_dwordx4 v[188:191], v62, s[80:83], s87 offen offset:256 nt
  buffer_load_dwordx4 v[192:195], v62, s[80:83], s87 offen offset:512 nt
  buffer_load_dwordx4 v[196:199], v62, s[80:83], s87 offen offset:768 nt
  buffer_load_dwordx4 v[200:203], v62, s[80:83], s87 offen offset:1024 nt
  v_permlane32_swap_b32 v20, v24
  v_permlane32_swap_b32 v21, v25
  v_permlane32_swap_b32 v22, v26
  v_permlane32_swap_b32 v23, v27
  v_add_f32_dpp v20, v24, v20 row_ror:8 row_mask:0xf bank_mask:0xf
  v_add_f32_dpp v21, v25, v21 row_ror:8 row_mask:0xf bank_mask:0xf
  v_add_f32_dpp v22, v26, v22 row_ror:8 row_mask:0xf bank_mask:0xf
  v_add_f32_dpp v23, v27, v23 row_ror:8 row_mask:0xf bank_mask:0xf
  v_cvt_pk_bf16_f32 v24, v20, v21
  v_cvt_pk_bf16_f32 v25, v22, v23
  v_perm_b32 v20, v24, s90, v63
  v_perm_b32 v21, v24, s90, v64
  v_perm_b32 v22, v25, s90, v63
  v_perm_b32 v23, v25, s90, v64
  v_max3_f32 v26, v20, v21, v22
  v_max3_f32 v26, v26, v23, s91
  s_nop 1
  v_max_f32_dpp v26, v26, v26 row_ror:8 row_mask:0xf bank_mask:0xf
  s_nop 1
  v_max_f32_dpp v26, v26, v26 row_bcast:15 row_mask:0xa bank_mask:0xf
  s_nop 1
  v_max_f32_dpp v26, v26, v26 row_bcast:31 row_mask:0xc bank_mask:0xf
  s_nop 0
  v_readlane_b32 s91, v26, 63
  s_nop 1
  v_mul_f32 v84, s91, v65
  v_fma_f32 v20, v20, s89, v84
  v_fma_f32 v21, v21, s89, v84
  v_fma_f32 v22, v22, s89, v84
  v_fma_f32 v23, v23, s89, v84
  v_sub_f32 v27, v84, v86
  v_exp_f32 v20, v20
  v_exp_f32 v21, v21
  v_exp_f32 v22, v22
  v_exp_f32 v23, v23
  v_exp_f32 v27, v27
  v_add_f32 v26, v20, v21
  v_add_f32 v24, v22, v23
  v_cvt_pk_bf16_f32 v20, v20, v20
  v_cvt_pk_bf16_f32 v21, v21, v21
  v_cvt_pk_bf16_f32 v22, v22, v22
  v_cvt_pk_bf16_f32 v23, v23, v23
  v_add_f32 v26, v26, v24
  v_fma_f32 v67, v67, v27, v26
  v_mul_f32 v28, v27, v28
  v_mul_f32 v29, v27, v29
  v_mul_f32 v30, v27, v30
  v_mul_f32 v31, v27, v31
  v_mul_f32 v32, v27, v32
  v_mul_f32 v33, v27, v33
  v_mul_f32 v34, v27, v34
  v_mul_f32 v35, v27, v35
  v_and_b32 v52, v20, v68
  v_and_b32 v53, v20, v69
  v_and_b32 v54, v20, v70
  v_and_b32 v55, v20, v71
  v_and_b32 v56, v21, v68
  v_and_b32 v57, v21, v69
  v_and_b32 v58, v21, v70
  v_and_b32 v59, v21, v71
  v_mfma_f32_16x16x32_bf16 v[28:31], v[204:207], v[52:55], v[28:31]
  v_mfma_f32_16x16x32_bf16 v[32:35], v[208:211], v[52:55], v[32:35]
  v_and_b32 v52, v22, v68
  v_and_b32 v53, v22, v69
  v_and_b32 v54, v22, v70
  v_and_b32 v55, v22, v71
  v_mfma_f32_16x16x32_bf16 v[28:31], v[212:215], v[56:59], v[28:31]
  v_mfma_f32_16x16x32_bf16 v[32:35], v[216:219], v[56:59], v[32:35]
  v_and_b32 v56, v23, v68
  v_and_b32 v57, v23, v69
  v_and_b32 v58, v23, v70
  v_and_b32 v59, v23, v71
  v_mfma_f32_16x16x32_bf16 v[28:31], v[220:223], v[52:55], v[28:31]
  v_mfma_f32_16x16x32_bf16 v[32:35], v[224:227], v[52:55], v[32:35]
  v_mfma_f32_16x16x32_bf16 v[28:31], v[228:231], v[56:59], v[28:31]
  v_mfma_f32_16x16x32_bf16 v[32:35], v[232:235], v[56:59], v[32:35]
  s_waitcnt vmcnt(20)
  buffer_load_dwordx4 v[204:207], v62, s[80:83], s87 offen offset:1280 nt
  buffer_load_dwordx4 v[208:211], v62, s[80:83], s87 offen offset:1536 nt
  buffer_load_dwordx4 v[212:215], v62, s[80:83], s87 offen offset:1792 nt
  s_add_u32 s44, s93, 16384
  v_subrev_u32 v52, s88, v66
  buffer_load_dwordx4 v[216:219], v52, s[32:35], s44 offen sc1
  v_subrev_u32 v27, s88, v66
  v_cndmask_b32 v52, v28, v32, s[50:51]
  v_cndmask_b32 v56, v32, v28, s[50:51]
  v_cndmask_b32 v53, v29, v33, s[50:51]
  v_cndmask_b32 v57, v33, v29, s[50:51]
  v_cndmask_b32 v54, v30, v34, s[50:51]
  v_cndmask_b32 v58, v34, v30, s[50:51]
  v_cndmask_b32 v55, v31, v35, s[50:51]
  v_cndmask_b32 v59, v35, v31, s[50:51]
  v_add_f32_dpp v67, v67, v67 row_ror:8 row_mask:0xf bank_mask:0xf
  v_add_f32_dpp v52, v56, v52 row_ror:8 row_mask:0xf bank_mask:0xf
  v_add_f32_dpp v53, v57, v53 row_ror:8 row_mask:0xf bank_mask:0xf
  v_add_f32_dpp v54, v58, v54 row_ror:8 row_mask:0xf bank_mask:0xf
  v_add_f32_dpp v55, v59, v55 row_ror:8 row_mask:0xf bank_mask:0xf
  v_mov_b32 v24, v67
  s_nop 1
  v_permlane16_swap_b32 v67, v24
  v_add_f32 v67, v67, v24
  v_mov_b32 v24, v67
  s_nop 1
  v_permlane32_swap_b32 v67, v24
  v_add_f32 v25, v67, v24
  v_sub_f32 v24, 0, v84
  s_lshl_b32 s44, s41, 10
  v_add_u32 v56, s44, v27
  ds_write_b128 v56, v[52:55] offset:0
  s_lshl_b32 s44, s41, 3
  v_mov_b32 v57, s44
  ds_write_b64 v57, v[24:25] offset:28672
  v_mov_b32 v58, 28744
  v_mov_b32 v59, 1
  s_waitcnt lgkmcnt(0)
  s_mov_b64 exec, 1
  ds_add_rtn_u32 v57, v58, v59
  s_waitcnt lgkmcnt(0)
  v_readfirstlane_b32 s44, v57
  s_mov_b64 exec, -1
  s_nop 0
  s_cmp_eq_u32 s44, 3
  s_cbranch_scc0 PS_147
  ds_read_b128 v[36:39], v27 offset:0
  ds_read_b128 v[40:43], v27 offset:1024
  ds_read_b128 v[44:47], v27 offset:2048
  ds_read_b128 v[48:51], v27 offset:3072
  v_mov_b32 v56, 0
  ds_read_b128 v[20:23], v56 offset:28672
  ds_read_b128 v[52:55], v56 offset:28688
  v_and_b32 v56, 0x70, v27
  v_lshlrev_b32 v56, 1, v56
  v_and_b32 v57, 0x80, v27
  v_lshl_or_b32 v56, v57, 3, v56
  v_and_b32 v57, 0x300, v27
  v_or_b32 v56, v56, v57
  s_add_u32 s44, s94, 1048576
  s_waitcnt lgkmcnt(0)
  s_mov_b64 exec, 1
  ds_add_u32 v58, v59
  s_mov_b64 exec, -1
  v_max3_f32 v25, v20, v22, v52
  v_max_f32 v25, v25, v54
  v_sub_f32 v20, v20, v25
  v_sub_f32 v22, v22, v25
  v_sub_f32 v52, v52, v25
  v_sub_f32 v54, v54, v25
  v_exp_f32 v20, v20
  v_exp_f32 v22, v22
  v_exp_f32 v52, v52
  v_exp_f32 v54, v54
  v_mov_b32 v27, s43
  v_mul_f32 v26, v20, v21
  v_fmac_f32 v26, v22, v23
  v_fmac_f32 v26, v52, v53
  v_fmac_f32 v26, v54, v55
  v_mul_f32 v36, v20, v36
  v_mul_f32 v37, v20, v37
  v_mul_f32 v38, v20, v38
  v_mul_f32 v39, v20, v39
  v_fmac_f32 v36, v22, v40
  v_fmac_f32 v37, v22, v41
  v_fmac_f32 v38, v22, v42
  v_fmac_f32 v39, v22, v43
  v_fmac_f32 v36, v52, v44
  v_fmac_f32 v37, v52, v45
  v_fmac_f32 v38, v52, v46
  v_fmac_f32 v39, v52, v47
  v_fmac_f32 v36, v54, v48
  v_fmac_f32 v37, v54, v49
  v_fmac_f32 v38, v54, v50
  v_fmac_f32 v39, v54, v51
  v_mov_b32 v24, v39
  v_mov_b32 v39, s43
  buffer_store_dwordx4 v[36:39], v56, s[32:35], s44 offen sc1
  buffer_store_dwordx4 v[24:27], v56, s[32:35], s44 offen offset:16 sc1
  s_waitcnt lgkmcnt(0)
PS_147:
  s_nop 1
  s_waitcnt vmcnt(0) lgkmcnt(0)
  s_barrier
  v_mov_b32 v20, v216
  v_mov_b32 v21, v217
  v_mov_b32 v22, v218
  v_mov_b32 v23, v219
  s_mov_b32 s49, 0
  s_branch QC_149
QR_148:
  s_add_u32 s44, s93, 16384
  v_subrev_u32 v20, s88, v66
  buffer_load_dwordx4 v[20:23], v20, s[32:35], s44 offen sc1
  s_waitcnt vmcnt(0)
QC_149:
  v_cmp_eq_u32 s[54:55], s43, v21
  v_cmp_eq_u32 s[56:57], s43, v23
  s_nop 1
  s_and_b64 s[54:55], s[54:55], s[56:57]
  s_cmp_eq_u64 s[54:55], -1
  s_cbranch_scc1 QO_150
  s_add_u32 s49, s49, 1
  s_cmp_gt_u32 s49, 40000
  s_cbranch_scc1 QO_150
  s_sleep 8
  s_branch QR_148
QO_150:
  v_subrev_u32 v52, s88, v66
  v_lshrrev_b32 v52, 1, v52
  v_add_u32 v52, 27648, v52
  ds_write2_b32 v52, v20, v22 offset0:128 offset1:129
  s_waitcnt lgkmcnt(0)
  v_and_b32 v52, 0x70, v60
  ds_read_b128 v[4:7], v52 offset:28160
  ds_read_b128 v[8:11], v52 offset:28288
  ds_read_b128 v[12:15], v52 offset:28416
  ds_read_b128 v[16:19], v52 offset:28544
  s_waitcnt lgkmcnt(0)
  ds_read_b128 v[36:39], v66 offset:0
  ds_read_b128 v[40:43], v66 offset:4096
  ds_read_b128 v[44:47], v66 offset:1024
  ds_read_b128 v[48:51], v66 offset:5120
  s_waitcnt lgkmcnt(3)
  v_mfma_f32_16x16x32_bf16 v[20:23], v[36:39], v[4:7], 0
  ds_read_b128 v[36:39], v66 offset:2048
  s_waitcnt lgkmcnt(3)
  v_mfma_f32_16x16x32_bf16 v[24:27], v[40:43], v[4:7], 0
  ds_read_b128 v[40:43], v66 offset:6144
  s_waitcnt lgkmcnt(3)
  v_mfma_f32_16x16x32_bf16 v[20:23], v[44:47], v[8:11], v[20:23]
  ds_read_b128 v[44:47], v66 offset:3072
  s_waitcnt lgkmcnt(3)
  v_mfma_f32_16x16x32_bf16 v[24:27], v[48:51], v[8:11], v[24:27]
  ds_read_b128 v[48:51], v66 offset:7168
  s_waitcnt lgkmcnt(3)
  v_mfma_f32_16x16x32_bf16 v[20:23], v[36:39], v[12:15], v[20:23]
  s_waitcnt lgkmcnt(2)
  v_mfma_f32_16x16x32_bf16 v[24:27], v[40:43], v[12:15], v[24:27]
  s_waitcnt lgkmcnt(1)
  v_mfma_f32_16x16x32_bf16 v[20:23], v[44:47], v[16:19], v[20:23]
  s_waitcnt lgkmcnt(0)
  v_mfma_f32_16x16x32_bf16 v[24:27], v[48:51], v[16:19], v[24:27]
  s_nop 7
  v_permlane32_swap_b32 v20, v24
  v_permlane32_swap_b32 v21, v25
  v_permlane32_swap_b32 v22, v26
  v_permlane32_swap_b32 v23, v27
  v_add_f32_dpp v20, v24, v20 row_ror:8 row_mask:0xf bank_mask:0xf
  v_add_f32_dpp v21, v25, v21 row_ror:8 row_mask:0xf bank_mask:0xf
  v_add_f32_dpp v22, v26, v22 row_ror:8 row_mask:0xf bank_mask:0xf
  v_add_f32_dpp v23, v27, v23 row_ror:8 row_mask:0xf bank_mask:0xf
  v_cvt_pk_bf16_f32 v24, v20, v21
  v_cvt_pk_bf16_f32 v25, v22, v23
  v_perm_b32 v20, v24, s90, v63
  v_perm_b32 v21, v24, s90, v64
  v_perm_b32 v22, v25, s90, v63
  v_perm_b32 v23, v25, s90, v64
  v_max3_f32 v26, v20, v21, v22
  v_max_f32 v26, v26, v23
  s_nop 1
  v_max_f32_dpp v26, v26, v26 row_ror:8 row_mask:0xf bank_mask:0xf
  s_nop 1
  v_max_f32_dpp v26, v26, v26 row_bcast:15 row_mask:0xa bank_mask:0xf
  s_nop 1
  v_max_f32_dpp v26, v26, v26 row_bcast:31 row_mask:0xc bank_mask:0xf
  s_nop 0
  v_readlane_b32 s92, v26, 63
  s_nop 1
  v_mul_f32 v86, s92, v65
  v_fma_f32 v20, v20, s89, v86
  v_fma_f32 v21, v21, s89, v86
  v_fma_f32 v22, v22, s89, v86
  v_fma_f32 v23, v23, s89, v86
  v_exp_f32 v20, v20
  v_exp_f32 v21, v21
  v_exp_f32 v22, v22
  v_exp_f32 v23, v23
  v_add_f32 v26, v20, v21
  v_add_f32 v24, v22, v23
  v_cvt_pk_bf16_f32 v20, v20, v20
  v_cvt_pk_bf16_f32 v21, v21, v21
  v_cvt_pk_bf16_f32 v22, v22, v22
  v_cvt_pk_bf16_f32 v23, v23, v23
  v_add_f32 v67, v26, v24
  v_and_b32 v52, v20, v68
  v_and_b32 v53, v20, v69
  v_and_b32 v54, v20, v70
  v_and_b32 v55, v20, v71
  v_and_b32 v56, v21, v68
  v_and_b32 v57, v21, v69
  v_and_b32 v58, v21, v70
  v_and_b32 v59, v21, v71
  ds_read_b128 v[36:39], v66 offset:8192
  ds_read_b128 v[40:43], v66 offset:9216
  ds_read_b128 v[44:47], v66 offset:10240
  v_mfma_f32_16x16x32_bf16 v[28:31], v[244:247], v[52:55], 0
  v_mfma_f32_16x16x32_bf16 v[32:35], v[248:251], v[52:55], 0
  v_and_b32 v52, v22, v68
  v_and_b32 v53, v22, v69
  v_and_b32 v54, v22, v70
  v_and_b32 v55, v22, v71
  v_mfma_f32_16x16x32_bf16 v[28:31], v[252:255], v[56:59], v[28:31]
  v_mfma_f32_16x16x32_bf16 v[32:35], v[236:239], v[56:59], v[32:35]
  v_and_b32 v56, v23, v68
  v_and_b32 v57, v23, v69
  v_and_b32 v58, v23, v70
  v_and_b32 v59, v23, v71
  v_mfma_f32_16x16x32_bf16 v[28:31], v[240:243], v[52:55], v[28:31]
  s_waitcnt lgkmcnt(2)
  v_mfma_f32_16x16x32_bf16 v[32:35], v[36:39], v[52:55], v[32:35]
  s_waitcnt lgkmcnt(1)
  v_mfma_f32_16x16x32_bf16 v[28:31], v[40:43], v[56:59], v[28:31]
  s_waitcnt lgkmcnt(0)
  v_mfma_f32_16x16x32_bf16 v[32:35], v[44:47], v[56:59], v[32:35]
  ds_read_b128 v[36:39], v66 offset:11264
  ds_read_b128 v[40:43], v66 offset:15360
  ds_read_b128 v[44:47], v66 offset:12288
  ds_read_b128 v[48:51], v66 offset:16384
  s_waitcnt lgkmcnt(3)
  v_mfma_f32_16x16x32_bf16 v[20:23], v[36:39], v[4:7], 0
  ds_read_b128 v[36:39], v66 offset:13312
  s_waitcnt lgkmcnt(3)
  v_mfma_f32_16x16x32_bf16 v[24:27], v[40:43], v[4:7], 0
  ds_read_b128 v[40:43], v66 offset:17408
  s_waitcnt lgkmcnt(3)
  v_mfma_f32_16x16x32_bf16 v[20:23], v[44:47], v[8:11], v[20:23]
  ds_read_b128 v[44:47], v66 offset:14336
  s_waitcnt lgkmcnt(3)
  v_mfma_f32_16x16x32_bf16 v[24:27], v[48:51], v[8:11], v[24:27]
  ds_read_b128 v[48:51], v66 offset:18432
  s_waitcnt lgkmcnt(3)
  v_mfma_f32_16x16x32_bf16 v[20:23], v[36:39], v[12:15], v[20:23]
  s_waitcnt lgkmcnt(2)
  v_mfma_f32_16x16x32_bf16 v[24:27], v[40:43], v[12:15], v[24:27]
  s_waitcnt lgkmcnt(1)
  v_mfma_f32_16x16x32_bf16 v[20:23], v[44:47], v[16:19], v[20:23]
  s_waitcnt lgkmcnt(0)
  v_mfma_f32_16x16x32_bf16 v[24:27], v[48:51], v[16:19], v[24:27]
  s_nop 7
  v_permlane32_swap_b32 v20, v24
  v_permlane32_swap_b32 v21, v25
  v_permlane32_swap_b32 v22, v26
  v_permlane32_swap_b32 v23, v27
  v_add_f32_dpp v20, v24, v20 row_ror:8 row_mask:0xf bank_mask:0xf
  v_add_f32_dpp v21, v25, v21 row_ror:8 row_mask:0xf bank_mask:0xf
  v_add_f32_dpp v22, v26, v22 row_ror:8 row_mask:0xf bank_mask:0xf
  v_add_f32_dpp v23, v27, v23 row_ror:8 row_mask:0xf bank_mask:0xf
  v_cvt_pk_bf16_f32 v24, v20, v21
  v_cvt_pk_bf16_f32 v25, v22, v23
  v_perm_b32 v20, v24, s90, v63
  v_perm_b32 v21, v24, s90, v64
  v_perm_b32 v22, v25, s90, v63
  v_perm_b32 v23, v25, s90, v64
  v_max3_f32 v26, v20, v21, v22
  v_max3_f32 v26, v26, v23, s92
  s_nop 1
  v_max_f32_dpp v26, v26, v26 row_ror:8 row_mask:0xf bank_mask:0xf
  s_nop 1
  v_max_f32_dpp v26, v26, v26 row_bcast:15 row_mask:0xa bank_mask:0xf
  s_nop 1
  v_max_f32_dpp v26, v26, v26 row_bcast:31 row_mask:0xc bank_mask:0xf
  s_nop 0
  v_readlane_b32 s92, v26, 63
  s_nop 1
  v_mul_f32 v85, s92, v65
  v_fma_f32 v20, v20, s89, v85
  v_fma_f32 v21, v21, s89, v85
  v_fma_f32 v22, v22, s89, v85
  v_fma_f32 v23, v23, s89, v85
  v_sub_f32 v27, v85, v86
  v_exp_f32 v20, v20
  v_exp_f32 v21, v21
  v_exp_f32 v22, v22
  v_exp_f32 v23, v23
  v_exp_f32 v27, v27
  v_add_f32 v26, v20, v21
  v_add_f32 v24, v22, v23
  v_cvt_pk_bf16_f32 v20, v20, v20
  v_cvt_pk_bf16_f32 v21, v21, v21
  v_cvt_pk_bf16_f32 v22, v22, v22
  v_cvt_pk_bf16_f32 v23, v23, v23
  v_add_f32 v26, v26, v24
  v_fma_f32 v67, v67, v27, v26
  v_mul_f32 v28, v27, v28
  v_mul_f32 v29, v27, v29
  v_mul_f32 v30, v27, v30
  v_mul_f32 v31, v27, v31
  v_mul_f32 v32, v27, v32
  v_mul_f32 v33, v27, v33
  v_mul_f32 v34, v27, v34
  v_mul_f32 v35, v27, v35
  v_and_b32 v52, v20, v68
  v_and_b32 v53, v20, v69
  v_and_b32 v54, v20, v70
  v_and_b32 v55, v20, v71
  v_and_b32 v56, v21, v68
  v_and_b32 v57, v21, v69
  v_and_b32 v58, v21, v70
  v_and_b32 v59, v21, v71
  ds_read_b128 v[36:39], v66 offset:19456
  ds_read_b128 v[40:43], v66 offset:20480
  ds_read_b128 v[44:47], v66 offset:21504
  ds_read_b128 v[48:51], v66 offset:22528
  s_waitcnt lgkmcnt(3)
  v_mfma_f32_16x16x32_bf16 v[28:31], v[36:39], v[52:55], v[28:31]
  ds_read_b128 v[36:39], v66 offset:23552
  s_waitcnt lgkmcnt(3)
  v_mfma_f32_16x16x32_bf16 v[32:35], v[40:43], v[52:55], v[32:35]
  ds_read_b128 v[40:43], v66 offset:24576
  v_and_b32 v52, v22, v68
  v_and_b32 v53, v22, v69
  v_and_b32 v54, v22, v70
  v_and_b32 v55, v22, v71
  s_waitcnt lgkmcnt(3)
  v_mfma_f32_16x16x32_bf16 v[28:31], v[44:47], v[56:59], v[28:31]
  ds_read_b128 v[44:47], v66 offset:25600
  s_waitcnt lgkmcnt(3)
  v_mfma_f32_16x16x32_bf16 v[32:35], v[48:51], v[56:59], v[32:35]
  ds_read_b128 v[48:51], v66 offset:26624
  v_and_b32 v56, v23, v68
  v_and_b32 v57, v23, v69
  v_and_b32 v58, v23, v70
  v_and_b32 v59, v23, v71
  s_waitcnt lgkmcnt(3)
  v_mfma_f32_16x16x32_bf16 v[28:31], v[36:39], v[52:55], v[28:31]
  s_waitcnt lgkmcnt(2)
  v_mfma_f32_16x16x32_bf16 v[32:35], v[40:43], v[52:55], v[32:35]
  s_waitcnt lgkmcnt(1)
  v_mfma_f32_16x16x32_bf16 v[28:31], v[44:47], v[56:59], v[28:31]
  s_waitcnt lgkmcnt(0)
  v_mfma_f32_16x16x32_bf16 v[32:35], v[48:51], v[56:59], v[32:35]
  ds_read_b128 v[36:39], v66 offset:27648
  ds_read_b128 v[40:43], v66 offset:31744
  ds_read_b128 v[44:47], v66 offset:28672
  ds_read_b128 v[48:51], v66 offset:29696
  s_waitcnt lgkmcnt(3)
  v_mfma_f32_16x16x32_bf16 v[20:23], v[36:39], v[4:7], 0
  ds_read_b128 v[36:39], v66 offset:30720
  s_waitcnt lgkmcnt(3)
  v_mfma_f32_16x16x32_bf16 v[24:27], v[40:43], v[4:7], 0
  s_waitcnt lgkmcnt(2)
  v_mfma_f32_16x16x32_bf16 v[20:23], v[44:47], v[8:11], v[20:23]
  v_mfma_f32_16x16x32_bf16 v[24:27], v[172:175], v[8:11], v[24:27]
  s_waitcnt lgkmcnt(1)
  v_mfma_f32_16x16x32_bf16 v[20:23], v[48:51], v[12:15], v[20:23]
  v_mfma_f32_16x16x32_bf16 v[24:27], v[176:179], v[12:15], v[24:27]
  s_waitcnt lgkmcnt(0)
  v_mfma_f32_16x16x32_bf16 v[20:23], v[36:39], v[16:19], v[20:23]
  v_mfma_f32_16x16x32_bf16 v[24:27], v[180:183], v[16:19], v[24:27]
  s_nop 7
  v_permlane32_swap_b32 v20, v24
  v_permlane32_swap_b32 v21, v25
  v_permlane32_swap_b32 v22, v26
  v_permlane32_swap_b32 v23, v27
  v_add_f32_dpp v20, v24, v20 row_ror:8 row_mask:0xf bank_mask:0xf
  v_add_f32_dpp v21, v25, v21 row_ror:8 row_mask:0xf bank_mask:0xf
  v_add_f32_dpp v22, v26, v22 row_ror:8 row_mask:0xf bank_mask:0xf
  v_add_f32_dpp v23, v27, v23 row_ror:8 row_mask:0xf bank_mask:0xf
  v_cvt_pk_bf16_f32 v24, v20, v21
  v_cvt_pk_bf16_f32 v25, v22, v23
  v_perm_b32 v20, v24, s90, v63
  v_perm_b32 v21, v24, s90, v64
  v_perm_b32 v22, v25, s90, v63
  v_perm_b32 v23, v25, s90, v64
  v_max3_f32 v26, v20, v21, v22
  v_max3_f32 v26, v26, v23, s92
  s_nop 1
  v_max_f32_dpp v26, v26, v26 row_ror:8 row_mask:0xf bank_mask:0xf
  s_nop 1
  v_max_f32_dpp v26, v26, v26 row_bcast:15 row_mask:0xa bank_mask:0xf
  s_nop 1
  v_max_f32_dpp v26, v26, v26 row_bcast:31 row_mask:0xc bank_mask:0xf
  s_nop 0
  v_readlane_b32 s92, v26, 63
  s_nop 1
  v_mul_f32 v86, s92, v65
  v_fma_f32 v20, v20, s89, v86
  v_fma_f32 v21, v21, s89, v86
  v_fma_f32 v22, v22, s89, v86
  v_fma_f32 v23, v23, s89, v86
  v_sub_f32 v27, v86, v85
  v_exp_f32 v20, v20
  v_exp_f32 v21, v21
  v_exp_f32 v22, v22
  v_exp_f32 v23, v23
  v_exp_f32 v27, v27
  v_add_f32 v26, v20, v21
  v_add_f32 v24, v22, v23
  v_cvt_pk_bf16_f32 v20, v20, v20
  v_cvt_pk_bf16_f32 v21, v21, v21
  v_cvt_pk_bf16_f32 v22, v22, v22
  v_cvt_pk_bf16_f32 v23, v23, v23
  v_add_f32 v26, v26, v24
  v_fma_f32 v67, v67, v27, v26
  v_mul_f32 v28, v27, v28
  v_mul_f32 v29, v27, v29
  v_mul_f32 v30, v27, v30
  v_mul_f32 v31, v27, v31
  v_mul_f32 v32, v27, v32
  v_mul_f32 v33, v27, v33
  v_mul_f32 v34, v27, v34
  v_mul_f32 v35, v27, v35
  v_and_b32 v52, v20, v68
  v_and_b32 v53, v20, v69
  v_and_b32 v54, v20, v70
  v_and_b32 v55, v20, v71
  v_and_b32 v56, v21, v68
  v_and_b32 v57, v21, v69
  v_and_b32 v58, v21, v70
  v_and_b32 v59, v21, v71
  v_mfma_f32_16x16x32_bf16 v[28:31], v[184:187], v[52:55], v[28:31]
  v_mfma_f32_16x16x32_bf16 v[32:35], v[188:191], v[52:55], v[32:35]
  v_and_b32 v52, v22, v68
  v_and_b32 v53, v22, v69
  v_and_b32 v54, v22, v70
  v_and_b32 v55, v22, v71
  v_mfma_f32_16x16x32_bf16 v[28:31], v[192:195], v[56:59], v[28:31]
  v_mfma_f32_16x16x32_bf16 v[32:35], v[196:199], v[56:59], v[32:35]
  v_and_b32 v56, v23, v68
  v_and_b32 v57, v23, v69
  v_and_b32 v58, v23, v70
  v_and_b32 v59, v23, v71
  v_mfma_f32_16x16x32_bf16 v[28:31], v[200:203], v[52:55], v[28:31]
  v_mfma_f32_16x16x32_bf16 v[32:35], v[204:207], v[52:55], v[32:35]
  v_mfma_f32_16x16x32_bf16 v[28:31], v[208:211], v[56:59], v[28:31]
  v_mfma_f32_16x16x32_bf16 v[32:35], v[212:215], v[56:59], v[32:35]
  v_subrev_u32 v27, s88, v66
  s_nop 6
  v_cndmask_b32 v52, v28, v32, s[50:51]
  v_cndmask_b32 v56, v32, v28, s[50:51]
  v_cndmask_b32 v53, v29, v33, s[50:51]
  v_cndmask_b32 v57, v33, v29, s[50:51]
  v_cndmask_b32 v54, v30, v34, s[50:51]
  v_cndmask_b32 v58, v34, v30, s[50:51]
  v_cndmask_b32 v55, v31, v35, s[50:51]
  v_cndmask_b32 v59, v35, v31, s[50:51]
  v_add_f32_dpp v67, v67, v67 row_ror:8 row_mask:0xf bank_mask:0xf
  v_add_f32_dpp v52, v56, v52 row_ror:8 row_mask:0xf bank_mask:0xf
  v_add_f32_dpp v53, v57, v53 row_ror:8 row_mask:0xf bank_mask:0xf
  v_add_f32_dpp v54, v58, v54 row_ror:8 row_mask:0xf bank_mask:0xf
  v_add_f32_dpp v55, v59, v55 row_ror:8 row_mask:0xf bank_mask:0xf
  v_mov_b32 v24, v67
  s_nop 1
  v_permlane16_swap_b32 v67, v24
  v_add_f32 v67, v67, v24
  v_mov_b32 v24, v67
  s_nop 1
  v_permlane32_swap_b32 v67, v24
  v_add_f32 v25, v67, v24
  v_sub_f32 v24, 0, v86
  s_lshl_b32 s44, s41, 10
  v_add_u32 v56, s44, v27
  ds_write_b128 v56, v[52:55] offset:0
  s_lshl_b32 s44, s41, 3
  v_mov_b32 v57, s44
  ds_write_b64 v57, v[24:25] offset:28672
  v_mov_b32 v58, 28740
  v_mov_b32 v59, 1
  s_waitcnt lgkmcnt(0)
  s_mov_b64 exec, 1
  ds_add_rtn_u32 v57, v58, v59
  s_waitcnt lgkmcnt(0)
  v_readfirstlane_b32 s44, v57
  s_mov_b64 exec, -1
  s_nop 0
  s_cmp_eq_u32 s44, 3
  s_cbranch_scc0 PS_151
  ds_read_b128 v[36:39], v27 offset:0
  ds_read_b128 v[40:43], v27 offset:1024
  ds_read_b128 v[44:47], v27 offset:2048
  ds_read_b128 v[48:51], v27 offset:3072
  v_mov_b32 v56, 0
  ds_read_b128 v[20:23], v56 offset:28672
  ds_read_b128 v[52:55], v56 offset:28688
  v_and_b32 v56, 0x70, v27
  v_lshlrev_b32 v56, 1, v56
  v_and_b32 v57, 0x80, v27
  v_lshl_or_b32 v56, v57, 3, v56
  v_and_b32 v57, 0x300, v27
  v_or_b32 v56, v56, v57
  s_add_u32 s44, s94, 524288
  s_waitcnt lgkmcnt(0)
  s_mov_b64 exec, 1
  ds_add_u32 v58, v59
  s_mov_b64 exec, -1
  v_max3_f32 v25, v20, v22, v52
  v_max_f32 v25, v25, v54
  v_sub_f32 v20, v20, v25
  v_sub_f32 v22, v22, v25
  v_sub_f32 v52, v52, v25
  v_sub_f32 v54, v54, v25
  v_exp_f32 v20, v20
  v_exp_f32 v22, v22
  v_exp_f32 v52, v52
  v_exp_f32 v54, v54
  v_mov_b32 v27, s43
  v_mul_f32 v26, v20, v21
  v_fmac_f32 v26, v22, v23
  v_fmac_f32 v26, v52, v53
  v_fmac_f32 v26, v54, v55
  v_mul_f32 v36, v20, v36
  v_mul_f32 v37, v20, v37
  v_mul_f32 v38, v20, v38
  v_mul_f32 v39, v20, v39
  v_fmac_f32 v36, v22, v40
  v_fmac_f32 v37, v22, v41
  v_fmac_f32 v38, v22, v42
  v_fmac_f32 v39, v22, v43
  v_fmac_f32 v36, v52, v44
  v_fmac_f32 v37, v52, v45
  v_fmac_f32 v38, v52, v46
  v_fmac_f32 v39, v52, v47
  v_fmac_f32 v36, v54, v48
  v_fmac_f32 v37, v54, v49
  v_fmac_f32 v38, v54, v50
  v_fmac_f32 v39, v54, v51
  v_mov_b32 v24, v39
  v_mov_b32 v39, s43
  buffer_store_dwordx4 v[36:39], v56, s[32:35], s44 offen sc1
  buffer_store_dwordx4 v[24:27], v56, s[32:35], s44 offen offset:16 sc1
  s_waitcnt lgkmcnt(0)
PS_151:
  s_nop 1
  s_waitcnt vmcnt(0) lgkmcnt(0)
  s_barrier
  s_branch CL_100
MS_143:
  s_waitcnt vmcnt(0)
  v_and_b32 v60, 0x70, v78
  v_lshlrev_b32 v60, 5, v60
  v_and_b32 v20, 0x80, v78
  v_lshrrev_b32 v20, 1, v20
  v_or_b32 v60, v60, v20
  v_and_b32 v20, 0x300, v78
  v_lshrrev_b32 v21, 4, v20
  v_or_b32 v60, v60, v21
  v_xor_b32 v61, 0x1040, v60
  v_lshlrev_b32 v62, 3, v20
  v_and_b32 v20, 0xf0, v78
  v_or_b32 v62, v62, v20
  v_add_u32 v66, s88, v78
  v_mov_b32 v65, 0xbdb8aa3b
  v_lshrrev_b32 v21, 2, v78
  v_xor_b32 v21, v21, v78
  v_and_b32 v21, 0x80, v21
  v_cmp_eq_u32 s[54:55], 0, v21
  v_mov_b32 v20, 0x03020100
  v_mov_b32 v63, 0x05040c0c
  v_mov_b32 v64, 0x07060c0c
  v_cndmask_b32 v63, v20, v63, s[54:55]
  v_cndmask_b32 v64, v20, v64, s[54:55]
  s_add_u32 s44, s93, 49152
  v_subrev_u32 v52, s88, v66
  buffer_load_dwordx4 v[220:223], v52, s[32:35], s44 offen sc1
  s_waitcnt vmcnt(0)
  v_mov_b32 v20, v220
  v_mov_b32 v21, v221
  v_mov_b32 v22, v222
  v_mov_b32 v23, v223
  s_mov_b32 s49, 0
  s_branch QC_153
QR_152:
  s_add_u32 s44, s93, 49152
  v_subrev_u32 v20, s88, v66
  buffer_load_dwordx4 v[20:23], v20, s[32:35], s44 offen sc1
  s_waitcnt vmcnt(0)
QC_153:
  v_cmp_eq_u32 s[54:55], s43, v21
  v_cmp_eq_u32 s[56:57], s43, v23
  s_nop 1
  s_and_b64 s[54:55], s[54:55], s[56:57]
  s_cmp_eq_u64 s[54:55], -1
  s_cbranch_scc1 QO_154
  s_add_u32 s49, s49, 1
  s_cmp_gt_u32 s49, 40000
  s_cbranch_scc1 QO_154
  s_sleep 8
  s_branch QR_152
QO_154:
  v_subrev_u32 v52, s88, v66
  v_lshrrev_b32 v52, 1, v52
  v_add_u32 v52, 27648, v52
  ds_write2_b32 v52, v20, v22 offset0:128 offset1:129
  s_waitcnt lgkmcnt(0)
  v_and_b32 v52, 0x70, v60
  ds_read_b128 v[4:7], v52 offset:28160
  ds_read_b128 v[8:11], v52 offset:28288
  ds_read_b128 v[12:15], v52 offset:28416
  ds_read_b128 v[16:19], v52 offset:28544
  s_waitcnt lgkmcnt(0)
  ds_read_b128 v[36:39], v66 offset:0
  ds_read_b128 v[40:43], v66 offset:4096
  ds_read_b128 v[44:47], v66 offset:1024
  ds_read_b128 v[48:51], v66 offset:5120
  s_waitcnt lgkmcnt(3)
  v_mfma_f32_16x16x32_bf16 v[20:23], v[36:39], v[4:7], 0
  ds_read_b128 v[36:39], v66 offset:2048
  s_waitcnt lgkmcnt(3)
  v_mfma_f32_16x16x32_bf16 v[24:27], v[40:43], v[4:7], 0
  ds_read_b128 v[40:43], v66 offset:6144
  s_waitcnt lgkmcnt(3)
  v_mfma_f32_16x16x32_bf16 v[20:23], v[44:47], v[8:11], v[20:23]
  ds_read_b128 v[44:47], v66 offset:3072
  s_waitcnt lgkmcnt(3)
  v_mfma_f32_16x16x32_bf16 v[24:27], v[48:51], v[8:11], v[24:27]
  ds_read_b128 v[48:51], v66 offset:7168
  s_waitcnt lgkmcnt(3)
  v_mfma_f32_16x16x32_bf16 v[20:23], v[36:39], v[12:15], v[20:23]
  s_waitcnt lgkmcnt(2)
  v_mfma_f32_16x16x32_bf16 v[24:27], v[40:43], v[12:15], v[24:27]
  s_waitcnt lgkmcnt(1)
  v_mfma_f32_16x16x32_bf16 v[20:23], v[44:47], v[16:19], v[20:23]
  s_waitcnt lgkmcnt(0)
  v_mfma_f32_16x16x32_bf16 v[24:27], v[48:51], v[16:19], v[24:27]
  s_nop 7
  v_permlane32_swap_b32 v20, v24
  v_permlane32_swap_b32 v21, v25
  v_permlane32_swap_b32 v22, v26
  v_permlane32_swap_b32 v23, v27
  v_add_f32_dpp v20, v24, v20 row_ror:8 row_mask:0xf bank_mask:0xf
  v_add_f32_dpp v21, v25, v21 row_ror:8 row_mask:0xf bank_mask:0xf
  v_add_f32_dpp v22, v26, v22 row_ror:8 row_mask:0xf bank_mask:0xf
  v_add_f32_dpp v23, v27, v23 row_ror:8 row_mask:0xf bank_mask:0xf
  v_cvt_pk_bf16_f32 v24, v20, v21
  v_cvt_pk_bf16_f32 v25, v22, v23
  v_perm_b32 v20, v24, s90, v63
  v_perm_b32 v21, v24, s90, v64
  v_perm_b32 v22, v25, s90, v63
  v_perm_b32 v23, v25, s90, v64
  v_max3_f32 v26, v20, v21, v22
  v_max_f32 v26, v26, v23
  s_nop 1
  v_max_f32_dpp v26, v26, v26 row_ror:8 row_mask:0xf bank_mask:0xf
  s_nop 1
  v_max_f32_dpp v26, v26, v26 row_bcast:15 row_mask:0xa bank_mask:0xf
  s_nop 1
  v_max_f32_dpp v26, v26, v26 row_bcast:31 row_mask:0xc bank_mask:0xf
  s_nop 0
  v_readlane_b32 s92, v26, 63
  s_nop 1
  v_mul_f32 v85, s92, v65
  v_fma_f32 v20, v20, s89, v85
  v_fma_f32 v21, v21, s89, v85
  v_fma_f32 v22, v22, s89, v85
  v_fma_f32 v23, v23, s89, v85
  v_exp_f32 v20, v20
  v_exp_f32 v21, v21
  v_exp_f32 v22, v22
  v_exp_f32 v23, v23
  v_add_f32 v26, v20, v21
  v_add_f32 v24, v22, v23
  v_cvt_pk_bf16_f32 v20, v20, v20
  v_cvt_pk_bf16_f32 v21, v21, v21
  v_cvt_pk_bf16_f32 v22, v22, v22
  v_cvt_pk_bf16_f32 v23, v23, v23
  v_add_f32 v67, v26, v24
  v_and_b32 v52, v20, v68
  v_and_b32 v53, v20, v69
  v_and_b32 v54, v20, v70
  v_and_b32 v55, v20, v71
  v_and_b32 v56, v21, v68
  v_and_b32 v57, v21, v69
  v_and_b32 v58, v21, v70
  v_and_b32 v59, v21, v71
  ds_read_b128 v[36:39], v66 offset:8192
  ds_read_b128 v[40:43], v66 offset:9216
  ds_read_b128 v[44:47], v66 offset:10240
  v_mfma_f32_16x16x32_bf16 v[28:31], v[244:247], v[52:55], 0
  v_mfma_f32_16x16x32_bf16 v[32:35], v[248:251], v[52:55], 0
  v_and_b32 v52, v22, v68
  v_and_b32 v53, v22, v69
  v_and_b32 v54, v22, v70
  v_and_b32 v55, v22, v71
  v_mfma_f32_16x16x32_bf16 v[28:31], v[252:255], v[56:59], v[28:31]
  v_mfma_f32_16x16x32_bf16 v[32:35], v[236:239], v[56:59], v[32:35]
  v_and_b32 v56, v23, v68
  v_and_b32 v57, v23, v69
  v_and_b32 v58, v23, v70
  v_and_b32 v59, v23, v71
  v_mfma_f32_16x16x32_bf16 v[28:31], v[240:243], v[52:55], v[28:31]
  s_waitcnt lgkmcnt(2)
  v_mfma_f32_16x16x32_bf16 v[32:35], v[36:39], v[52:55], v[32:35]
  s_waitcnt lgkmcnt(1)
  v_mfma_f32_16x16x32_bf16 v[28:31], v[40:43], v[56:59], v[28:31]
  s_waitcnt lgkmcnt(0)
  v_mfma_f32_16x16x32_bf16 v[32:35], v[44:47], v[56:59], v[32:35]
  ds_read_b128 v[36:39], v66 offset:11264
  ds_read_b128 v[40:43], v66 offset:15360
  ds_read_b128 v[44:47], v66 offset:12288
  ds_read_b128 v[48:51], v66 offset:16384
  s_waitcnt lgkmcnt(3)
  v_mfma_f32_16x16x32_bf16 v[20:23], v[36:39], v[4:7], 0
  ds_read_b128 v[36:39], v66 offset:13312
  s_waitcnt lgkmcnt(3)
  v_mfma_f32_16x16x32_bf16 v[24:27], v[40:43], v[4:7], 0
  ds_read_b128 v[40:43], v66 offset:17408
  s_waitcnt lgkmcnt(3)
  v_mfma_f32_16x16x32_bf16 v[20:23], v[44:47], v[8:11], v[20:23]
  ds_read_b128 v[44:47], v66 offset:14336
  s_waitcnt lgkmcnt(3)
  v_mfma_f32_16x16x32_bf16 v[24:27], v[48:51], v[8:11], v[24:27]
  ds_read_b128 v[48:51], v66 offset:18432
  s_waitcnt lgkmcnt(3)
  v_mfma_f32_16x16x32_bf16 v[20:23], v[36:39], v[12:15], v[20:23]
  s_waitcnt lgkmcnt(2)
  v_mfma_f32_16x16x32_bf16 v[24:27], v[40:43], v[12:15], v[24:27]
  s_waitcnt lgkmcnt(1)
  v_mfma_f32_16x16x32_bf16 v[20:23], v[44:47], v[16:19], v[20:23]
  s_waitcnt lgkmcnt(0)
  v_mfma_f32_16x16x32_bf16 v[24:27], v[48:51], v[16:19], v[24:27]
  s_nop 7
  v_permlane32_swap_b32 v20, v24
  v_permlane32_swap_b32 v21, v25
  v_permlane32_swap_b32 v22, v26
  v_permlane32_swap_b32 v23, v27
  v_add_f32_dpp v20, v24, v20 row_ror:8 row_mask:0xf bank_mask:0xf
  v_add_f32_dpp v21, v25, v21 row_ror:8 row_mask:0xf bank_mask:0xf
  v_add_f32_dpp v22, v26, v22 row_ror:8 row_mask:0xf bank_mask:0xf
  v_add_f32_dpp v23, v27, v23 row_ror:8 row_mask:0xf bank_mask:0xf
  v_cvt_pk_bf16_f32 v24, v20, v21
  v_cvt_pk_bf16_f32 v25, v22, v23
  v_perm_b32 v20, v24, s90, v63
  v_perm_b32 v21, v24, s90, v64
  v_perm_b32 v22, v25, s90, v63
  v_perm_b32 v23, v25, s90, v64
  v_max3_f32 v26, v20, v21, v22
  v_max3_f32 v26, v26, v23, s92
  s_nop 1
  v_max_f32_dpp v26, v26, v26 row_ror:8 row_mask:0xf bank_mask:0xf
  s_nop 1
  v_max_f32_dpp v26, v26, v26 row_bcast:15 row_mask:0xa bank_mask:0xf
  s_nop 1
  v_max_f32_dpp v26, v26, v26 row_bcast:31 row_mask:0xc bank_mask:0xf
  s_nop 0
  v_readlane_b32 s92, v26, 63
  s_nop 1
  v_mul_f32 v86, s92, v65
  v_fma_f32 v20, v20, s89, v86
  v_fma_f32 v21, v21, s89, v86
  v_fma_f32 v22, v22, s89, v86
  v_fma_f32 v23, v23, s89, v86
  v_sub_f32 v27, v86, v85
  v_exp_f32 v20, v20
  v_exp_f32 v21, v21
  v_exp_f32 v22, v22
  v_exp_f32 v23, v23
  v_exp_f32 v27, v27
  v_add_f32 v26, v20, v21
  v_add_f32 v24, v22, v23
  v_cvt_pk_bf16_f32 v20, v20, v20
  v_cvt_pk_bf16_f32 v21, v21, v21
  v_cvt_pk_bf16_f32 v22, v22, v22
  v_cvt_pk_bf16_f32 v23, v23, v23
  v_add_f32 v26, v26, v24
  v_fma_f32 v67, v67, v27, v26
  v_mul_f32 v28, v27, v28
  v_mul_f32 v29, v27, v29
  v_mul_f32 v30, v27, v30
  v_mul_f32 v31, v27, v31
  v_mul_f32 v32, v27, v32
  v_mul_f32 v33, v27, v33
  v_mul_f32 v34, v27, v34
  v_mul_f32 v35, v27, v35
  v_and_b32 v52, v20, v68
  v_and_b32 v53, v20, v69
  v_and_b32 v54, v20, v70
  v_and_b32 v55, v20, v71
  v_and_b32 v56, v21, v68
  v_and_b32 v57, v21, v69
  v_and_b32 v58, v21, v70
  v_and_b32 v59, v21, v71
  ds_read_b128 v[36:39], v66 offset:19456
  ds_read_b128 v[40:43], v66 offset:20480
  ds_read_b128 v[44:47], v66 offset:21504
  ds_read_b128 v[48:51], v66 offset:22528
  s_waitcnt lgkmcnt(3)
  v_mfma_f32_16x16x32_bf16 v[28:31], v[36:39], v[52:55], v[28:31]
  ds_read_b128 v[36:39], v66 offset:23552
  s_waitcnt lgkmcnt(3)
  v_mfma_f32_16x16x32_bf16 v[32:35], v[40:43], v[52:55], v[32:35]
  ds_read_b128 v[40:43], v66 offset:24576
  v_and_b32 v52, v22, v68
  v_and_b32 v53, v22, v69
  v_and_b32 v54, v22, v70
  v_and_b32 v55, v22, v71
  s_waitcnt lgkmcnt(3)
  v_mfma_f32_16x16x32_bf16 v[28:31], v[44:47], v[56:59], v[28:31]
  ds_read_b128 v[44:47], v66 offset:25600
  s_waitcnt lgkmcnt(3)
  v_mfma_f32_16x16x32_bf16 v[32:35], v[48:51], v[56:59], v[32:35]
  ds_read_b128 v[48:51], v66 offset:26624
  v_and_b32 v56, v23, v68
  v_and_b32 v57, v23, v69
  v_and_b32 v58, v23, v70
  v_and_b32 v59, v23, v71
  s_waitcnt lgkmcnt(3)
  v_mfma_f32_16x16x32_bf16 v[28:31], v[36:39], v[52:55], v[28:31]
  s_waitcnt lgkmcnt(2)
  v_mfma_f32_16x16x32_bf16 v[32:35], v[40:43], v[52:55], v[32:35]
  s_waitcnt lgkmcnt(1)
  v_mfma_f32_16x16x32_bf16 v[28:31], v[44:47], v[56:59], v[28:31]
  s_waitcnt lgkmcnt(0)
  v_mfma_f32_16x16x32_bf16 v[32:35], v[48:51], v[56:59], v[32:35]
  ds_read_b128 v[36:39], v66 offset:27648
  ds_read_b128 v[40:43], v66 offset:31744
  ds_read_b128 v[44:47], v66 offset:28672
  ds_read_b128 v[48:51], v66 offset:29696
  s_waitcnt lgkmcnt(3)
  v_mfma_f32_16x16x32_bf16 v[20:23], v[36:39], v[4:7], 0
  ds_read_b128 v[36:39], v66 offset:30720
  s_waitcnt lgkmcnt(3)
  v_mfma_f32_16x16x32_bf16 v[24:27], v[40:43], v[4:7], 0
  s_waitcnt lgkmcnt(2)
  v_mfma_f32_16x16x32_bf16 v[20:23], v[44:47], v[8:11], v[20:23]
  v_mfma_f32_16x16x32_bf16 v[24:27], v[172:175], v[8:11], v[24:27]
  s_waitcnt lgkmcnt(1)
  v_mfma_f32_16x16x32_bf16 v[20:23], v[48:51], v[12:15], v[20:23]
  v_mfma_f32_16x16x32_bf16 v[24:27], v[176:179], v[12:15], v[24:27]
  s_waitcnt lgkmcnt(0)
  v_mfma_f32_16x16x32_bf16 v[20:23], v[36:39], v[16:19], v[20:23]
  v_mfma_f32_16x16x32_bf16 v[24:27], v[180:183], v[16:19], v[24:27]
  s_nop 7
  v_permlane32_swap_b32 v20, v24
  v_permlane32_swap_b32 v21, v25
  v_permlane32_swap_b32 v22, v26
  v_permlane32_swap_b32 v23, v27
  v_add_f32_dpp v20, v24, v20 row_ror:8 row_mask:0xf bank_mask:0xf
  v_add_f32_dpp v21, v25, v21 row_ror:8 row_mask:0xf bank_mask:0xf
  v_add_f32_dpp v22, v26, v22 row_ror:8 row_mask:0xf bank_mask:0xf
  v_add_f32_dpp v23, v27, v23 row_ror:8 row_mask:0xf bank_mask:0xf
  v_cvt_pk_bf16_f32 v24, v20, v21
  v_cvt_pk_bf16_f32 v25, v22, v23
  v_perm_b32 v20, v24, s90, v63
  v_perm_b32 v21, v24, s90, v64
  v_perm_b32 v22, v25, s90, v63
  v_perm_b32 v23, v25, s90, v64
  v_max3_f32 v26, v20, v21, v22
  v_max3_f32 v26, v26, v23, s92
  s_nop 1
  v_max_f32_dpp v26, v26, v26 row_ror:8 row_mask:0xf bank_mask:0xf
  s_nop 1
  v_max_f32_dpp v26, v26, v26 row_bcast:15 row_mask:0xa bank_mask:0xf
  s_nop 1
  v_max_f32_dpp v26, v26, v26 row_bcast:31 row_mask:0xc bank_mask:0xf
  s_nop 0
  v_readlane_b32 s92, v26, 63
  s_nop 1
  v_mul_f32 v85, s92, v65
  v_fma_f32 v20, v20, s89, v85
  v_fma_f32 v21, v21, s89, v85
  v_fma_f32 v22, v22, s89, v85
  v_fma_f32 v23, v23, s89, v85
  v_sub_f32 v27, v85, v86
  v_exp_f32 v20, v20
  v_exp_f32 v21, v21
  v_exp_f32 v22, v22
  v_exp_f32 v23, v23
  v_exp_f32 v27, v27
  v_add_f32 v26, v20, v21
  v_add_f32 v24, v22, v23
  v_cvt_pk_bf16_f32 v20, v20, v20
  v_cvt_pk_bf16_f32 v21, v21, v21
  v_cvt_pk_bf16_f32 v22, v22, v22
  v_cvt_pk_bf16_f32 v23, v23, v23
  v_add_f32 v26, v26, v24
  v_fma_f32 v67, v67, v27, v26
  v_mul_f32 v28, v27, v28
  v_mul_f32 v29, v27, v29
  v_mul_f32 v30, v27, v30
  v_mul_f32 v31, v27, v31
  v_mul_f32 v32, v27, v32
  v_mul_f32 v33, v27, v33
  v_mul_f32 v34, v27, v34
  v_mul_f32 v35, v27, v35
  v_and_b32 v52, v20, v68
  v_and_b32 v53, v20, v69
  v_and_b32 v54, v20, v70
  v_and_b32 v55, v20, v71
  v_and_b32 v56, v21, v68
  v_and_b32 v57, v21, v69
  v_and_b32 v58, v21, v70
  v_and_b32 v59, v21, v71
  v_mfma_f32_16x16x32_bf16 v[28:31], v[184:187], v[52:55], v[28:31]
  v_mfma_f32_16x16x32_bf16 v[32:35], v[188:191], v[52:55], v[32:35]
  v_and_b32 v52, v22, v68
  v_and_b32 v53, v22, v69
  v_and_b32 v54, v22, v70
  v_and_b32 v55, v22, v71
  v_mfma_f32_16x16x32_bf16 v[28:31], v[192:195], v[56:59], v[28:31]
  v_mfma_f32_16x16x32_bf16 v[32:35], v[196:199], v[56:59], v[32:35]
  v_and_b32 v56, v23, v68
  v_and_b32 v57, v23, v69
  v_and_b32 v58, v23, v70
  v_and_b32 v59, v23, v71
  v_mfma_f32_16x16x32_bf16 v[28:31], v[200:203], v[52:55], v[28:31]
  v_mfma_f32_16x16x32_bf16 v[32:35], v[204:207], v[52:55], v[32:35]
  v_mfma_f32_16x16x32_bf16 v[28:31], v[208:211], v[56:59], v[28:31]
  v_mfma_f32_16x16x32_bf16 v[32:35], v[212:215], v[56:59], v[32:35]
  v_subrev_u32 v27, s88, v66
  s_nop 6
  v_cndmask_b32 v52, v28, v32, s[50:51]
  v_cndmask_b32 v56, v32, v28, s[50:51]
  v_cndmask_b32 v53, v29, v33, s[50:51]
  v_cndmask_b32 v57, v33, v29, s[50:51]
  v_cndmask_b32 v54, v30, v34, s[50:51]
  v_cndmask_b32 v58, v34, v30, s[50:51]
  v_cndmask_b32 v55, v31, v35, s[50:51]
  v_cndmask_b32 v59, v35, v31, s[50:51]
  v_add_f32_dpp v67, v67, v67 row_ror:8 row_mask:0xf bank_mask:0xf
  v_add_f32_dpp v52, v56, v52 row_ror:8 row_mask:0xf bank_mask:0xf
  v_add_f32_dpp v53, v57, v53 row_ror:8 row_mask:0xf bank_mask:0xf
  v_add_f32_dpp v54, v58, v54 row_ror:8 row_mask:0xf bank_mask:0xf
  v_add_f32_dpp v55, v59, v55 row_ror:8 row_mask:0xf bank_mask:0xf
  v_mov_b32 v24, v67
  s_nop 1
  v_permlane16_swap_b32 v67, v24
  v_add_f32 v67, v67, v24
  v_mov_b32 v24, v67
  s_nop 1
  v_permlane32_swap_b32 v67, v24
  v_add_f32 v25, v67, v24
  v_sub_f32 v24, 0, v85
  s_lshl_b32 s44, s41, 10
  v_add_u32 v56, s44, v27
  ds_write_b128 v56, v[52:55] offset:0
  s_lshl_b32 s44, s41, 3
  v_mov_b32 v57, s44
  ds_write_b64 v57, v[24:25] offset:28672
  v_mov_b32 v58, 28748
  v_mov_b32 v59, 1
  s_waitcnt lgkmcnt(0)
  s_mov_b64 exec, 1
  ds_add_rtn_u32 v57, v58, v59
  s_waitcnt lgkmcnt(0)
  v_readfirstlane_b32 s44, v57
  s_mov_b64 exec, -1
  s_nop 0
  s_cmp_eq_u32 s44, 3
  s_cbranch_scc0 PS_155
  ds_read_b128 v[36:39], v27 offset:0
  ds_read_b128 v[40:43], v27 offset:1024
  ds_read_b128 v[44:47], v27 offset:2048
  ds_read_b128 v[48:51], v27 offset:3072
  v_mov_b32 v56, 0
  ds_read_b128 v[20:23], v56 offset:28672
  ds_read_b128 v[52:55], v56 offset:28688
  v_and_b32 v56, 0x70, v27
  v_lshlrev_b32 v56, 1, v56
  v_and_b32 v57, 0x80, v27
  v_lshl_or_b32 v56, v57, 3, v56
  v_and_b32 v57, 0x300, v27
  v_or_b32 v56, v56, v57
  s_add_u32 s44, s94, 1572864
  s_waitcnt lgkmcnt(0)
  s_mov_b64 exec, 1
  ds_add_u32 v58, v59
  s_mov_b64 exec, -1
  v_max3_f32 v25, v20, v22, v52
  v_max_f32 v25, v25, v54
  v_sub_f32 v20, v20, v25
  v_sub_f32 v22, v22, v25
  v_sub_f32 v52, v52, v25
  v_sub_f32 v54, v54, v25
  v_exp_f32 v20, v20
  v_exp_f32 v22, v22
  v_exp_f32 v52, v52
  v_exp_f32 v54, v54
  v_mov_b32 v27, s43
  v_mul_f32 v26, v20, v21
  v_fmac_f32 v26, v22, v23
  v_fmac_f32 v26, v52, v53
  v_fmac_f32 v26, v54, v55
  v_mul_f32 v36, v20, v36
  v_mul_f32 v37, v20, v37
  v_mul_f32 v38, v20, v38
  v_mul_f32 v39, v20, v39
  v_fmac_f32 v36, v22, v40
  v_fmac_f32 v37, v22, v41
  v_fmac_f32 v38, v22, v42
  v_fmac_f32 v39, v22, v43
  v_fmac_f32 v36, v52, v44
  v_fmac_f32 v37, v52, v45
  v_fmac_f32 v38, v52, v46
  v_fmac_f32 v39, v52, v47
  v_fmac_f32 v36, v54, v48
  v_fmac_f32 v37, v54, v49
  v_fmac_f32 v38, v54, v50
  v_fmac_f32 v39, v54, v51
  v_mov_b32 v24, v39
  v_mov_b32 v39, s43
  buffer_store_dwordx4 v[36:39], v56, s[32:35], s44 offen sc1
  buffer_store_dwordx4 v[24:27], v56, s[32:35], s44 offen offset:16 sc1
  s_waitcnt lgkmcnt(0)
PS_155:
  s_nop 1
  s_waitcnt vmcnt(0) lgkmcnt(0)
  s_barrier
  s_branch CL_100
CE_102:
  s_or_b32 s44, s40, s41
  s_cmp_lg_u32 s44, 0
  s_cbranch_scc1 CF_156
  v_mov_b32 v84, s43
  s_mov_b64 exec, 1
  buffer_store_dword v84, off, s[32:35], 0 sc1
CF_156:
  s_endpgm
L_code_end:
.section .rodata,"a"
.p2align 6
.amdhsa_kernel interleave_layers__mha_block_cached__glu_gated_glu__decode_kernel
  .amdhsa_next_free_vgpr 512
  .amdhsa_next_free_sgpr 96
  .amdhsa_accum_offset 256
  .amdhsa_group_segment_fixed_size 0
  .amdhsa_kernarg_size 96
  .amdhsa_user_sgpr_count 2
  .amdhsa_user_sgpr_kernarg_segment_ptr 1
  .amdhsa_system_sgpr_workgroup_id_x 1
.end_amdhsa_kernel
```
